```python
import torch

def _softmax(x, axis=-1):
    return torch.softmax(x, dim=axis)

def _gelu(x):
    return torch.nn.functional.gelu(x, approximate='tanh')

def _silu(x):
    return torch.nn.functional.silu(x)

def _sigmoid(x):
    return torch.sigmoid(x)

def _layernorm(x, axis=-1, eps=1e-05):
    m = x.mean(dim=axis, keepdim=True)
    v = x.var(dim=axis, keepdim=True, unbiased=False)
    return (x - m) / torch.sqrt(v + eps)

def _scatter_add(tgt, idx, src, axis=0):
    return tgt.clone().index_add_(axis, idx, src)

def _segment_sum(src, seg, n):
    out = torch.zeros((n,) + src.shape[1:], dtype=src.dtype)
    return out.index_add_(0, seg, src)

def _pad(x, pw):
    flat = tuple((v for pair in reversed(pw) for v in pair))
    return torch.nn.functional.pad(x, flat)
kernel_name = 'standalone__conformer_family_branchformer__speech'

def setup_inputs():

    _w = lambda a: (lambda t: t.to(torch.bfloat16) if t.is_floating_point() else t)(torch.as_tensor(a))
    B, T, D, K = (2, 4000, 512, 31)
    s = float(D) ** (-0.5)
    return {'x': _w((lambda *s: torch.randn(*s, dtype=torch.bfloat16) * 0.05)(B, T, D)), 'w_q': _w((lambda *s: torch.randn(*s, dtype=torch.bfloat16) * 1.6)(D, D) * s), 'w_k': _w((lambda *s: torch.randn(*s, dtype=torch.bfloat16) * 1.6)(D, D) * s), 'w_v': _w((lambda *s: torch.randn(*s, dtype=torch.bfloat16) * 0.8)(D, D) * s), 'w_ao': _w((lambda *s: torch.randn(*s, dtype=torch.bfloat16) * 0.8)(D, D) * s), 'w_up': _w((lambda *s: torch.randn(*s, dtype=torch.bfloat16) * 1.6)(D, 2 * D) * s), 'dw': _w((lambda *s: torch.randn(*s, dtype=torch.bfloat16) * 1.6)(K, D) * (1.0 / K)), 'w_dn': _w((lambda *s: torch.randn(*s, dtype=torch.bfloat16) * 0.8)(D, D) * s), 'w_merge': _w((lambda *s: torch.randn(*s, dtype=torch.bfloat16) * 0.8)(2 * D, D) * s)}

def reference(x, w_q, w_k, w_v, w_ao, w_up, dw, w_dn, w_merge):
    B, T, D = x.shape
    K = dw.shape[0]
    xa = _layernorm(x, axis=-1)
    q = torch.einsum('btd,de->bte', xa, w_q)
    k = torch.einsum('btd,de->bte', xa, w_k)
    v = torch.einsum('btd,de->bte', xa, w_v)
    logits = torch.einsum('btd,bsd->bts', q, k) * float(D) ** (-0.5)
    attn = _softmax(logits, axis=-1)
    ya = torch.einsum('bts,bsd->btd', attn, v)
    ya = torch.einsum('btd,de->bte', ya, w_ao)
    xc = _layernorm(x, axis=-1)
    h = _gelu(torch.einsum('btd,de->bte', xc, w_up))
    u = h[..., :D].clone()
    g = _layernorm(h[..., D:], axis=-1)
    pad = K // 2
    gp = _pad(g, ((0, 0), (pad, pad), (0, 0)))
    conv = torch.zeros_like(g)
    for i in range(K):
        conv = conv + gp[:, i:i + T, :] * dw[i][None, None, :]
    yc = torch.einsum('btd,de->bte', u * conv, w_dn)
    merged = torch.concatenate([ya, yc], axis=-1)
    out = torch.einsum('btf,fd->btd', merged, w_merge)
    return x + out
```

```asm
; @launch grid=(256,1,1) block=(256,1,1) lds=149504
.amdgcn_target "amdgcn-amd-amdhsa--gfx950"
.text
.globl standalone__conformer_family_branchformer__speech_kernel
.p2align 8
.type standalone__conformer_family_branchformer__speech_kernel,@function
standalone__conformer_family_branchformer__speech_kernel:
s_cmp_ge_u32 s2, 256
s_cbranch_scc1 L_end
s_load_dwordx2 s[4:5], s[0:1], 88
s_load_dwordx2 s[16:17], s[0:1], 0
s_load_dwordx2 s[20:21], s[0:1], 72
s_load_dwordx16 s[36:51], s[0:1], 8
s_and_b32 s30, s2, 7
s_lshr_b32 s31, s2, 3
s_and_b32 s32, s31, 3
s_lshr_b32 s31, s31, 2
s_lshl_b32 s30, s30, 3
s_add_u32 s30, s30, s31
s_lshr_b32 s33, s30, 5
s_and_b32 s34, s30, 31
v_lshrrev_b32 v9, 6, v0
v_and_b32_e64 v0, 63, v0
s_nop 0
v_readfirstlane_b32 s24, v9
v_lshlrev_b32 v1, 4, v0
s_lshl_b32 s27, s32, 2
s_add_u32 s27, s27, s24
s_getpc_b64 s[60:61]
pc_1:
s_add_u32 s60, s60, standalone__conformer_family_branchformer__speech_kernel-pc_1
s_addc_u32 s61, s61, (standalone__conformer_family_branchformer__speech_kernel-pc_1)>>32
s_mul_i32 s62, s27, 8192
v_lshlrev_b32 v10, 7, v0
v_add_u32 v10, s62, v10
v_min_u32 v11, L_R0-standalone__conformer_family_branchformer__speech_kernel-4, v10
global_load_dword v120, v11, s[60:61]
v_and_b32 v2, 15, v0
v_lshrrev_b32 v3, 4, v0
s_lshl_b32 s64, s34, 2
s_add_u32 s64, s64, s32
s_cmp_lt_u32 s64, 125
s_cselect_b32 s65, 0, 0x70000000
s_mul_i32 s66, s33, 125
s_add_u32 s64, s64, s66
s_lshl_b32 s64, s64, 2
s_add_u32 s64, s64, s24
s_lshl_b32 s64, s64, 13
s_add_u32 s64, s64, s65
s_add_u32 s65, s64, 4096
s_mov_b32 s18, 8192000
s_mov_b32 s19, 0x20000
s_waitcnt lgkmcnt(0)
buffer_load_dwordx4 v[16:19], v1, s[16:19], s64 offen offset:0
buffer_load_dwordx4 v[20:23], v1, s[16:19], s64 offen offset:1024
buffer_load_dwordx4 v[24:27], v1, s[16:19], s64 offen offset:2048
buffer_load_dwordx4 v[28:31], v1, s[16:19], s64 offen offset:3072
buffer_load_dwordx4 v[32:35], v1, s[16:19], s65 offen offset:0
buffer_load_dwordx4 v[36:39], v1, s[16:19], s65 offen offset:1024
buffer_load_dwordx4 v[40:43], v1, s[16:19], s65 offen offset:2048
buffer_load_dwordx4 v[44:47], v1, s[16:19], s65 offen offset:3072
s_add_u32 s6, s4, 80777216
s_addc_u32 s7, s5, 0
s_load_dword s71, s[6:7], 0
v_lshrrev_b32 v4, 3, v0
v_and_b32 v5, 7, v0
v_and_b32 v6, 2, v4
v_lshlrev_b32 v6, 1, v6
v_xor_b32 v5, v5, v6
v_lshlrev_b32 v5, 4, v5
s_and_b32 s66, s24, 1
s_lshr_b32 s67, s24, 1
s_and_b32 s25, s2, 3
s_bfe_u32 s26, s2, 0x10003
s_lshl_b32 s26, s26, 2
s_add_u32 s25, s25, s26
s_bfe_u32 s26, s2, 0x10002
s_bfe_u32 s27, s2, 0x20004
s_lshl_b32 s27, s27, 1
s_add_u32 s26, s26, s27
s_and_b32 s68, s2, 0xc0
s_lshl_b32 s27, s26, 3
s_add_u32 s68, s68, s27
s_add_u32 s68, s68, s25
s_mov_b32 s31, s68
s_mul_i32 s29, s24, 8320
s_cmp_ge_u32 s31, 64
s_cbranch_scc1 L_notM
s_mov_b32 s52, s36
s_mov_b32 s53, s37
s_mov_b32 s54, 524288
s_mov_b32 s55, 0x00020000
s_mov_b32 s56, s38
s_mov_b32 s57, s39
s_mov_b32 s58, 524288
s_mov_b32 s59, 0x00020000
s_lshl_b32 s27, s66, 8
s_lshl_b32 s28, s67, 2
s_add_u32 s27, s27, s28
s_lshl_b32 s27, s27, 10
s_lshl_b32 s69, s25, 14
s_add_u32 s69, s69, s27
s_lshl_b32 s70, s26, 14
s_add_u32 s70, s70, s27
s_add_u32 m0, s29, 0
s_add_u32 s28, s69, 131072
buffer_load_dwordx4 v1, s[52:55], s69 offen offset:0 lds
s_add_u32 m0, s29, 16
s_nop 0
buffer_load_dwordx4 v1, s[52:55], s69 offen offset:1024 lds
s_add_u32 m0, s29, 32
s_nop 0
buffer_load_dwordx4 v1, s[52:55], s69 offen offset:2048 lds
s_add_u32 m0, s29, 48
s_nop 0
buffer_load_dwordx4 v1, s[52:55], s69 offen offset:3072 lds
s_add_u32 m0, s29, 4160
s_add_u32 s69, s69, 8192
buffer_load_dwordx4 v1, s[52:55], s28 offen offset:0 lds
s_add_u32 m0, s29, 4176
s_nop 0
buffer_load_dwordx4 v1, s[52:55], s28 offen offset:1024 lds
s_add_u32 m0, s29, 4192
s_nop 0
buffer_load_dwordx4 v1, s[52:55], s28 offen offset:2048 lds
s_add_u32 m0, s29, 4208
s_nop 0
buffer_load_dwordx4 v1, s[52:55], s28 offen offset:3072 lds
s_add_u32 m0, s29, 33280
s_add_u32 s28, s69, 131072
buffer_load_dwordx4 v1, s[52:55], s69 offen offset:0 lds
s_add_u32 m0, s29, 33296
s_nop 0
buffer_load_dwordx4 v1, s[52:55], s69 offen offset:1024 lds
s_add_u32 m0, s29, 33312
s_nop 0
buffer_load_dwordx4 v1, s[52:55], s69 offen offset:2048 lds
s_add_u32 m0, s29, 33328
s_nop 0
buffer_load_dwordx4 v1, s[52:55], s69 offen offset:3072 lds
s_add_u32 m0, s29, 37440
s_nop 0
buffer_load_dwordx4 v1, s[52:55], s28 offen offset:0 lds
s_add_u32 m0, s29, 37456
s_nop 0
buffer_load_dwordx4 v1, s[52:55], s28 offen offset:1024 lds
s_add_u32 m0, s29, 37472
s_nop 0
buffer_load_dwordx4 v1, s[52:55], s28 offen offset:2048 lds
s_add_u32 m0, s29, 37488
s_nop 0
buffer_load_dwordx4 v1, s[52:55], s28 offen offset:3072 lds
s_add_u32 m0, s29, 66560
s_add_u32 s28, s70, 131072
buffer_load_dwordx4 v1, s[56:59], s70 offen offset:0 lds
s_add_u32 m0, s29, 66576
s_nop 0
buffer_load_dwordx4 v1, s[56:59], s70 offen offset:1024 lds
s_add_u32 m0, s29, 66592
s_nop 0
buffer_load_dwordx4 v1, s[56:59], s70 offen offset:2048 lds
s_add_u32 m0, s29, 66608
s_nop 0
buffer_load_dwordx4 v1, s[56:59], s70 offen offset:3072 lds
s_add_u32 m0, s29, 70720
s_add_u32 s70, s70, 8192
buffer_load_dwordx4 v1, s[56:59], s28 offen offset:0 lds
s_add_u32 m0, s29, 70736
s_nop 0
buffer_load_dwordx4 v1, s[56:59], s28 offen offset:1024 lds
s_add_u32 m0, s29, 70752
s_nop 0
buffer_load_dwordx4 v1, s[56:59], s28 offen offset:2048 lds
s_add_u32 m0, s29, 70768
s_nop 0
buffer_load_dwordx4 v1, s[56:59], s28 offen offset:3072 lds
s_mov_b32 s8, s4
s_mov_b32 s9, s5
s_mov_b32 s10, 8192000
s_mov_b32 s11, 0x00020000
s_mov_b32 s12, s4
s_mov_b32 s13, s5
s_mov_b32 s14, 268435456
s_mov_b32 s15, 0x00020000
s_add_u32 s72, s4, 80740352
s_addc_u32 s73, s5, 0
s_mov_b32 s74, 36928
s_mov_b32 s75, 0x00020000
s_lshl_b32 s48, s32, 2
s_add_u32 s48, s48, s24
s_lshr_b32 s47, s48, 1
s_lshl_b32 s48, s48, 15
s_add_u32 s48, s48, 76546048
s_lshl_b32 s50, s47, 7
s_add_u32 s50, s50, 28672
s_lshl_b32 s47, s47, 7
s_add_u32 s47, s47, 32768
s_lshl_b32 s39, s30, 6
s_add_u32 s39, s39, 24576
v_mov_b32 v15, s47
v_add_u32 v14, 1024, v15
v_cmp_gt_u32 vcc, 32, v0
v_lshlrev_b32 v4, 2, v2
v_add_u32 v5, s39, v4
v_cndmask_b32 v15, v15, v14, vcc
v_add_u32_e64 v15, v4, v15
s_lshl_b32 s51, s32, 4
s_add_u32 s51, s51, s39
s_lshl_b32 s39, s24, 2
s_add_u32 s51, s51, s39
s_lshl_b32 s68, s68, 4
s_add_u32 s68, s68, s39
s_add_u32 s68, s68, 28672
s_mov_b32 s36, 0xffff0000
s_mov_b32 s37, 989855744
s_mov_b32 s38, 0x3f803f80
v_mov_b32 v10, 925353388
s_waitcnt lgkmcnt(0)
s_mul_i32 s71, s71, 0x9E3779B1
s_add_u32 s71, s71, 0x7F4A7C15
v_mov_b32_e64 v7, s71
s_waitcnt vmcnt(24)
v_dot2_f32_bf16 v112, v16, s38, 0
v_dot2_f32_bf16 v113, v20, s38, 0
v_dot2_f32_bf16 v114, v24, s38, 0
v_dot2_f32_bf16 v115, v28, s38, 0
v_dot2_f32_bf16 v116, v32, s38, 0
v_dot2_f32_bf16 v117, v36, s38, 0
v_dot2_f32_bf16 v118, v40, s38, 0
v_dot2_f32_bf16 v119, v44, s38, 0
v_dot2_f32_bf16 v112, v17, s38, v112
v_dot2_f32_bf16 v113, v21, s38, v113
v_dot2_f32_bf16 v114, v25, s38, v114
v_dot2_f32_bf16 v115, v29, s38, v115
v_dot2_f32_bf16 v116, v33, s38, v116
v_dot2_f32_bf16 v117, v37, s38, v117
v_dot2_f32_bf16 v118, v41, s38, v118
v_dot2_f32_bf16 v119, v45, s38, v119
v_dot2_f32_bf16 v112, v18, s38, v112
v_dot2_f32_bf16 v113, v22, s38, v113
v_dot2_f32_bf16 v114, v26, s38, v114
v_dot2_f32_bf16 v115, v30, s38, v115
v_dot2_f32_bf16 v116, v34, s38, v116
v_dot2_f32_bf16 v117, v38, s38, v117
v_dot2_f32_bf16 v118, v42, s38, v118
v_dot2_f32_bf16 v119, v46, s38, v119
v_dot2_f32_bf16 v112, v19, s38, v112
v_dot2_f32_bf16 v113, v23, s38, v113
v_dot2_f32_bf16 v114, v27, s38, v114
v_dot2_f32_bf16 v115, v31, s38, v115
v_dot2_f32_bf16 v116, v35, s38, v116
v_dot2_f32_bf16 v117, v39, s38, v117
s_add_u32 m0, s29, 99840
s_add_u32 s28, s70, 131072
buffer_load_dwordx4 v1, s[56:59], s70 offen offset:0 lds
v_dot2_f32_bf16 v118, v43, s38, v118
v_dot2_f32_bf16 v119, v47, s38, v119
v_lshlrev_b32 v48, 16, v16
v_and_b32 v49, s36, v16
v_lshlrev_b32 v50, 16, v17
v_and_b32 v51, s36, v17
v_lshlrev_b32 v52, 16, v18
v_and_b32 v53, s36, v18
v_lshlrev_b32 v54, 16, v19
v_and_b32 v55, s36, v19
v_lshlrev_b32 v56, 16, v20
v_and_b32 v57, s36, v20
v_lshlrev_b32 v58, 16, v21
v_and_b32 v59, s36, v21
v_lshlrev_b32 v60, 16, v22
v_and_b32 v61, s36, v22
v_lshlrev_b32 v62, 16, v23
v_and_b32 v63, s36, v23
v_lshlrev_b32 v64, 16, v24
v_and_b32 v65, s36, v24
v_lshlrev_b32 v66, 16, v25
v_and_b32 v67, s36, v25
v_lshlrev_b32 v68, 16, v26
v_and_b32 v69, s36, v26
v_lshlrev_b32 v70, 16, v27
v_and_b32 v71, s36, v27
v_lshlrev_b32 v72, 16, v28
v_and_b32 v73, s36, v28
v_lshlrev_b32 v74, 16, v29
v_and_b32 v75, s36, v29
s_add_u32 m0, s29, 99856
s_nop 0
buffer_load_dwordx4 v1, s[56:59], s70 offen offset:1024 lds
v_lshlrev_b32 v76, 16, v30
v_and_b32 v77, s36, v30
v_lshlrev_b32 v78, 16, v31
v_and_b32 v79, s36, v31
s_nop 1
v_permlane32_swap_b32 v112, v113
v_permlane32_swap_b32 v114, v115
v_permlane32_swap_b32 v116, v117
v_permlane32_swap_b32 v118, v119
v_add_f32 v112, v112, v113
v_add_f32 v114, v114, v115
v_add_f32 v116, v116, v117
v_add_f32 v118, v118, v119
s_nop 0
v_permlane16_swap_b32 v112, v114
v_permlane16_swap_b32 v116, v118
v_add_f32 v112, v112, v114
v_add_f32 v116, v116, v118
s_nop 0
v_add_f32_dpp v112, v112, v112 row_ror:8 row_mask:0xf bank_mask:0xf
v_add_f32_dpp v116, v116, v116 row_ror:8 row_mask:0xf bank_mask:0xf
s_nop 0
v_add_f32_dpp v112, v112, v112 row_ror:4 row_mask:0xf bank_mask:0xf
v_add_f32_dpp v116, v116, v116 row_ror:4 row_mask:0xf bank_mask:0xf
s_nop 0
v_add_f32_dpp v112, v112, v112 row_ror:2 row_mask:0xf bank_mask:0xf
v_add_f32_dpp v116, v116, v116 row_ror:2 row_mask:0xf bank_mask:0xf
s_nop 0
v_add_f32_dpp v112, v112, v112 row_ror:1 row_mask:0xf bank_mask:0xf
v_add_f32_dpp v116, v116, v116 row_ror:1 row_mask:0xf bank_mask:0xf
s_add_u32 m0, s29, 99872
s_nop 0
buffer_load_dwordx4 v1, s[56:59], s70 offen offset:2048 lds
v_mul_f32_e64 v112, s37, v112
v_mul_f32 v116, s37, v116
s_nop 0
v_readlane_b32 s40, v112, 0
v_readlane_b32 s41, v112, 32
v_readlane_b32 s42, v112, 16
v_readlane_b32 s43, v112, 48
v_readlane_b32 s44, v116, 0
v_readlane_b32 s45, v116, 32
v_readlane_b32 s46, v116, 16
v_readlane_b32 s47, v116, 48
v_lshlrev_b32 v80, 16, v32
v_and_b32 v81, s36, v32
v_lshlrev_b32 v82, 16, v33
v_and_b32 v83, s36, v33
v_lshlrev_b32 v84, 16, v34
v_and_b32 v85, s36, v34
v_lshlrev_b32 v86, 16, v35
v_and_b32 v87, s36, v35
v_lshlrev_b32 v88, 16, v36
v_and_b32 v89, s36, v36
v_lshlrev_b32 v90, 16, v37
v_and_b32 v91, s36, v37
v_lshlrev_b32 v92, 16, v38
v_and_b32 v93, s36, v38
v_lshlrev_b32 v94, 16, v39
v_and_b32 v95, s36, v39
v_lshlrev_b32 v96, 16, v40
v_and_b32 v97, s36, v40
v_lshlrev_b32_e64 v98, 16, v41
s_add_u32 m0, s29, 99888
s_nop 0
buffer_load_dwordx4 v1, s[56:59], s70 offen offset:3072 lds
v_and_b32 v99, s36, v41
v_lshlrev_b32 v100, 16, v42
v_and_b32 v101, s36, v42
v_lshlrev_b32 v102, 16, v43
v_and_b32 v103, s36, v43
v_lshlrev_b32 v104, 16, v44
v_and_b32 v105, s36, v44
v_lshlrev_b32 v106, 16, v45
v_and_b32 v107, s36, v45
v_lshlrev_b32 v108, 16, v46
v_and_b32 v109, s36, v46
v_lshlrev_b32 v110, 16, v47
v_and_b32 v111, s36, v47
v_pk_add_f32 v[48:49], v[48:49], s[40:41] op_sel:[0,0] op_sel_hi:[1,0] neg_lo:[0,1] neg_hi:[0,1]
v_pk_add_f32 v[50:51], v[50:51], s[40:41] op_sel:[0,0] op_sel_hi:[1,0] neg_lo:[0,1] neg_hi:[0,1]
v_pk_add_f32 v[52:53], v[52:53], s[40:41] op_sel:[0,0] op_sel_hi:[1,0] neg_lo:[0,1] neg_hi:[0,1]
v_pk_add_f32 v[54:55], v[54:55], s[40:41] op_sel:[0,0] op_sel_hi:[1,0] neg_lo:[0,1] neg_hi:[0,1]
v_pk_add_f32 v[56:57], v[56:57], s[40:41] op_sel:[0,1] op_sel_hi:[1,1] neg_lo:[0,1] neg_hi:[0,1]
v_pk_add_f32 v[58:59], v[58:59], s[40:41] op_sel:[0,1] op_sel_hi:[1,1] neg_lo:[0,1] neg_hi:[0,1]
v_pk_add_f32 v[60:61], v[60:61], s[40:41] op_sel:[0,1] op_sel_hi:[1,1] neg_lo:[0,1] neg_hi:[0,1]
v_pk_add_f32 v[62:63], v[62:63], s[40:41] op_sel:[0,1] op_sel_hi:[1,1] neg_lo:[0,1] neg_hi:[0,1]
v_pk_add_f32 v[64:65], v[64:65], s[42:43] op_sel:[0,0] op_sel_hi:[1,0] neg_lo:[0,1] neg_hi:[0,1]
v_pk_add_f32 v[66:67], v[66:67], s[42:43] op_sel:[0,0] op_sel_hi:[1,0] neg_lo:[0,1] neg_hi:[0,1]
v_pk_add_f32 v[68:69], v[68:69], s[42:43] op_sel:[0,0] op_sel_hi:[1,0] neg_lo:[0,1] neg_hi:[0,1]
v_pk_add_f32 v[70:71], v[70:71], s[42:43] op_sel:[0,0] op_sel_hi:[1,0] neg_lo:[0,1] neg_hi:[0,1]
v_pk_add_f32 v[72:73], v[72:73], s[42:43] op_sel:[0,1] op_sel_hi:[1,1] neg_lo:[0,1] neg_hi:[0,1]
v_pk_add_f32 v[74:75], v[74:75], s[42:43] op_sel:[0,1] op_sel_hi:[1,1] neg_lo:[0,1] neg_hi:[0,1]
v_pk_add_f32 v[76:77], v[76:77], s[42:43] op_sel:[0,1] op_sel_hi:[1,1] neg_lo:[0,1] neg_hi:[0,1]
v_pk_add_f32 v[78:79], v[78:79], s[42:43] op_sel:[0,1] op_sel_hi:[1,1] neg_lo:[0,1] neg_hi:[0,1]
v_pk_add_f32 v[80:81], v[80:81], s[44:45] op_sel:[0,0] op_sel_hi:[1,0] neg_lo:[0,1] neg_hi:[0,1]
s_add_u32 m0, s29, 104000
s_nop 0
s_nop 0
buffer_load_dwordx4 v1, s[56:59], s28 offen offset:0 lds
v_pk_add_f32 v[82:83], v[82:83], s[44:45] op_sel:[0,0] op_sel_hi:[1,0] neg_lo:[0,1] neg_hi:[0,1]
v_pk_add_f32 v[84:85], v[84:85], s[44:45] op_sel:[0,0] op_sel_hi:[1,0] neg_lo:[0,1] neg_hi:[0,1]
v_pk_add_f32 v[86:87], v[86:87], s[44:45] op_sel:[0,0] op_sel_hi:[1,0] neg_lo:[0,1] neg_hi:[0,1]
v_pk_add_f32 v[88:89], v[88:89], s[44:45] op_sel:[0,1] op_sel_hi:[1,1] neg_lo:[0,1] neg_hi:[0,1]
v_pk_add_f32 v[90:91], v[90:91], s[44:45] op_sel:[0,1] op_sel_hi:[1,1] neg_lo:[0,1] neg_hi:[0,1]
v_pk_add_f32 v[92:93], v[92:93], s[44:45] op_sel:[0,1] op_sel_hi:[1,1] neg_lo:[0,1] neg_hi:[0,1]
v_pk_add_f32 v[94:95], v[94:95], s[44:45] op_sel:[0,1] op_sel_hi:[1,1] neg_lo:[0,1] neg_hi:[0,1]
v_pk_add_f32 v[96:97], v[96:97], s[46:47] op_sel:[0,0] op_sel_hi:[1,0] neg_lo:[0,1] neg_hi:[0,1]
v_pk_add_f32 v[98:99], v[98:99], s[46:47] op_sel:[0,0] op_sel_hi:[1,0] neg_lo:[0,1] neg_hi:[0,1]
v_pk_add_f32 v[100:101], v[100:101], s[46:47] op_sel:[0,0] op_sel_hi:[1,0] neg_lo:[0,1] neg_hi:[0,1]
v_pk_add_f32 v[102:103], v[102:103], s[46:47] op_sel:[0,0] op_sel_hi:[1,0] neg_lo:[0,1] neg_hi:[0,1]
v_pk_add_f32 v[104:105], v[104:105], s[46:47] op_sel:[0,1] op_sel_hi:[1,1] neg_lo:[0,1] neg_hi:[0,1]
v_pk_add_f32 v[106:107], v[106:107], s[46:47] op_sel:[0,1] op_sel_hi:[1,1] neg_lo:[0,1] neg_hi:[0,1]
v_pk_add_f32 v[108:109], v[108:109], s[46:47] op_sel:[0,1] op_sel_hi:[1,1] neg_lo:[0,1] neg_hi:[0,1]
v_pk_add_f32 v[110:111], v[110:111], s[46:47] op_sel:[0,1] op_sel_hi:[1,1] neg_lo:[0,1] neg_hi:[0,1]
v_pk_mul_f32 v[16:17], v[48:49], v[48:49]
v_pk_mul_f32 v[18:19], v[56:57], v[56:57]
v_pk_mul_f32 v[20:21], v[64:65], v[64:65]
v_pk_mul_f32 v[22:23], v[72:73], v[72:73]
v_pk_mul_f32 v[24:25], v[80:81], v[80:81]
v_pk_mul_f32 v[26:27], v[88:89], v[88:89]
v_pk_mul_f32 v[28:29], v[96:97], v[96:97]
v_pk_mul_f32 v[30:31], v[104:105], v[104:105]
v_pk_fma_f32 v[16:17], v[50:51], v[50:51], v[16:17]
v_pk_fma_f32 v[18:19], v[58:59], v[58:59], v[18:19]
v_pk_fma_f32 v[20:21], v[66:67], v[66:67], v[20:21]
v_pk_fma_f32 v[22:23], v[74:75], v[74:75], v[22:23]
v_pk_fma_f32 v[24:25], v[82:83], v[82:83], v[24:25]
v_pk_fma_f32 v[26:27], v[90:91], v[90:91], v[26:27]
v_pk_fma_f32 v[28:29], v[98:99], v[98:99], v[28:29]
s_add_u32 m0, s29, 104016
s_nop 0
s_nop 0
buffer_load_dwordx4 v1, s[56:59], s28 offen offset:1024 lds
v_pk_fma_f32 v[30:31], v[106:107], v[106:107], v[30:31]
v_pk_fma_f32 v[16:17], v[52:53], v[52:53], v[16:17]
v_pk_fma_f32 v[18:19], v[60:61], v[60:61], v[18:19]
v_pk_fma_f32 v[20:21], v[68:69], v[68:69], v[20:21]
v_pk_fma_f32 v[22:23], v[76:77], v[76:77], v[22:23]
v_pk_fma_f32 v[24:25], v[84:85], v[84:85], v[24:25]
v_pk_fma_f32 v[26:27], v[92:93], v[92:93], v[26:27]
v_pk_fma_f32 v[28:29], v[100:101], v[100:101], v[28:29]
v_pk_fma_f32 v[30:31], v[108:109], v[108:109], v[30:31]
v_pk_fma_f32 v[16:17], v[54:55], v[54:55], v[16:17]
v_pk_fma_f32 v[18:19], v[62:63], v[62:63], v[18:19]
v_pk_fma_f32 v[20:21], v[70:71], v[70:71], v[20:21]
v_pk_fma_f32 v[22:23], v[78:79], v[78:79], v[22:23]
v_pk_fma_f32 v[24:25], v[86:87], v[86:87], v[24:25]
v_pk_fma_f32 v[26:27], v[94:95], v[94:95], v[26:27]
v_pk_fma_f32 v[28:29], v[102:103], v[102:103], v[28:29]
v_pk_fma_f32 v[30:31], v[110:111], v[110:111], v[30:31]
v_add_f32 v112, v16, v17
v_add_f32 v113, v18, v19
v_add_f32 v114, v20, v21
v_add_f32 v115, v22, v23
v_add_f32 v116, v24, v25
v_add_f32 v117, v26, v27
v_add_f32_e64 v118, v28, v29
v_add_f32 v119, v30, v31
s_nop 1
v_permlane32_swap_b32 v112, v113
v_permlane32_swap_b32 v114, v115
v_permlane32_swap_b32 v116, v117
v_permlane32_swap_b32 v118, v119
s_add_u32 m0, s29, 104032
s_nop 0
buffer_load_dwordx4 v1, s[56:59], s28 offen offset:2048 lds
v_add_f32 v112, v112, v113
v_add_f32 v114, v114, v115
v_add_f32 v116, v116, v117
v_add_f32 v118, v118, v119
s_nop 0
v_permlane16_swap_b32 v112, v114
v_permlane16_swap_b32 v116, v118
v_add_f32_e64 v112, v112, v114
v_add_f32 v116, v116, v118
s_nop 0
v_add_f32_dpp v112, v112, v112 row_ror:8 row_mask:0xf bank_mask:0xf
v_add_f32_dpp v116, v116, v116 row_ror:8 row_mask:0xf bank_mask:0xf
s_nop 0
v_add_f32_dpp v112, v112, v112 row_ror:4 row_mask:0xf bank_mask:0xf
v_add_f32_dpp v116, v116, v116 row_ror:4 row_mask:0xf bank_mask:0xf
s_nop 0
v_add_f32_dpp v112, v112, v112 row_ror:2 row_mask:0xf bank_mask:0xf
v_add_f32_dpp v116, v116, v116 row_ror:2 row_mask:0xf bank_mask:0xf
s_nop 0
v_add_f32_dpp v112, v112, v112 row_ror:1 row_mask:0xf bank_mask:0xf
v_add_f32_dpp v116, v116, v116 row_ror:1 row_mask:0xf bank_mask:0xf
v_fma_f32 v112, v112, s37, v10
v_fma_f32 v116, v116, s37, v10
v_rsq_f32 v112, v112
v_rsq_f32 v116, v116
s_nop 0
v_readlane_b32 s40, v112, 0
v_readlane_b32 s41, v112, 32
v_readlane_b32 s42, v112, 16
v_readlane_b32 s43, v112, 48
s_add_u32 m0, s29, 104048
s_nop 0
buffer_load_dwordx4 v1, s[56:59], s28 offen offset:3072 lds
v_readlane_b32 s44, v116, 0
v_readlane_b32 s45, v116, 32
v_readlane_b32 s46, v116, 16
v_readlane_b32 s47, v116, 48
s_nop 0
v_pk_mul_f32 v[48:49], v[48:49], s[40:41] op_sel:[0,0] op_sel_hi:[1,0]
v_pk_mul_f32 v[50:51], v[50:51], s[40:41] op_sel:[0,0] op_sel_hi:[1,0]
v_pk_mul_f32 v[52:53], v[52:53], s[40:41] op_sel:[0,0] op_sel_hi:[1,0]
v_pk_mul_f32 v[54:55], v[54:55], s[40:41] op_sel:[0,0] op_sel_hi:[1,0]
v_cvt_pk_bf16_f32 v16, v48, v49
v_cvt_pk_bf16_f32 v17, v50, v51
v_cvt_pk_bf16_f32 v18, v52, v53
v_cvt_pk_bf16_f32 v19, v54, v55
buffer_store_dwordx4 v[16:19], v1, s[8:11], s64 offen offset:0 sc1
v_pk_mul_f32 v[56:57], v[56:57], s[40:41] op_sel:[0,1] op_sel_hi:[1,1]
v_pk_mul_f32 v[58:59], v[58:59], s[40:41] op_sel:[0,1] op_sel_hi:[1,1]
v_pk_mul_f32 v[60:61], v[60:61], s[40:41] op_sel:[0,1] op_sel_hi:[1,1]
v_pk_mul_f32 v[62:63], v[62:63], s[40:41] op_sel:[0,1] op_sel_hi:[1,1]
v_cvt_pk_bf16_f32 v20, v56, v57
v_cvt_pk_bf16_f32 v21, v58, v59
v_cvt_pk_bf16_f32 v22, v60, v61
v_cvt_pk_bf16_f32 v23, v62, v63
buffer_store_dwordx4 v[20:23], v1, s[8:11], s64 offen offset:1024 sc1
v_pk_mul_f32 v[64:65], v[64:65], s[42:43] op_sel:[0,0] op_sel_hi:[1,0]
v_pk_mul_f32 v[66:67], v[66:67], s[42:43] op_sel:[0,0] op_sel_hi:[1,0]
v_pk_mul_f32 v[68:69], v[68:69], s[42:43] op_sel:[0,0] op_sel_hi:[1,0]
v_pk_mul_f32 v[70:71], v[70:71], s[42:43] op_sel:[0,0] op_sel_hi:[1,0]
v_cvt_pk_bf16_f32 v24, v64, v65
v_cvt_pk_bf16_f32 v25, v66, v67
v_cvt_pk_bf16_f32 v26, v68, v69
v_cvt_pk_bf16_f32 v27, v70, v71
buffer_store_dwordx4 v[24:27], v1, s[8:11], s64 offen offset:2048 sc1
v_pk_mul_f32 v[72:73], v[72:73], s[42:43] op_sel:[0,1] op_sel_hi:[1,1]
v_pk_mul_f32 v[74:75], v[74:75], s[42:43] op_sel:[0,1] op_sel_hi:[1,1]
v_pk_mul_f32 v[76:77], v[76:77], s[42:43] op_sel:[0,1] op_sel_hi:[1,1]
v_pk_mul_f32 v[78:79], v[78:79], s[42:43] op_sel:[0,1] op_sel_hi:[1,1]
v_cvt_pk_bf16_f32 v28, v72, v73
v_cvt_pk_bf16_f32 v29, v74, v75
v_cvt_pk_bf16_f32 v30, v76, v77
v_cvt_pk_bf16_f32 v31, v78, v79
buffer_store_dwordx4 v[28:31], v1, s[8:11], s64 offen offset:3072 sc1
v_pk_mul_f32 v[80:81], v[80:81], s[44:45] op_sel:[0,0] op_sel_hi:[1,0]
v_pk_mul_f32 v[82:83], v[82:83], s[44:45] op_sel:[0,0] op_sel_hi:[1,0]
v_pk_mul_f32 v[84:85], v[84:85], s[44:45] op_sel:[0,0] op_sel_hi:[1,0]
v_pk_mul_f32 v[86:87], v[86:87], s[44:45] op_sel:[0,0] op_sel_hi:[1,0]
v_cvt_pk_bf16_f32 v32, v80, v81
v_cvt_pk_bf16_f32 v33, v82, v83
v_cvt_pk_bf16_f32 v34, v84, v85
v_cvt_pk_bf16_f32 v35, v86, v87
buffer_store_dwordx4 v[32:35], v1, s[8:11], s65 offen offset:0 sc1
v_pk_mul_f32 v[88:89], v[88:89], s[44:45] op_sel:[0,1] op_sel_hi:[1,1]
v_pk_mul_f32 v[90:91], v[90:91], s[44:45] op_sel:[0,1] op_sel_hi:[1,1]
v_pk_mul_f32 v[92:93], v[92:93], s[44:45] op_sel:[0,1] op_sel_hi:[1,1]
v_pk_mul_f32 v[94:95], v[94:95], s[44:45] op_sel:[0,1] op_sel_hi:[1,1]
v_cvt_pk_bf16_f32 v36, v88, v89
v_cvt_pk_bf16_f32 v37, v90, v91
v_cvt_pk_bf16_f32 v38, v92, v93
v_cvt_pk_bf16_f32 v39, v94, v95
buffer_store_dwordx4 v[36:39], v1, s[8:11], s65 offen offset:1024 sc1
v_pk_mul_f32 v[96:97], v[96:97], s[46:47] op_sel:[0,0] op_sel_hi:[1,0]
v_pk_mul_f32 v[98:99], v[98:99], s[46:47] op_sel:[0,0] op_sel_hi:[1,0]
v_pk_mul_f32 v[100:101], v[100:101], s[46:47] op_sel:[0,0] op_sel_hi:[1,0]
v_pk_mul_f32 v[102:103], v[102:103], s[46:47] op_sel:[0,0] op_sel_hi:[1,0]
v_cvt_pk_bf16_f32 v40, v96, v97
v_cvt_pk_bf16_f32 v41, v98, v99
v_cvt_pk_bf16_f32 v42, v100, v101
v_cvt_pk_bf16_f32 v43, v102, v103
buffer_store_dwordx4 v[40:43], v1, s[8:11], s65 offen offset:2048 sc1
v_pk_mul_f32 v[104:105], v[104:105], s[46:47] op_sel:[0,1] op_sel_hi:[1,1]
v_pk_mul_f32 v[106:107], v[106:107], s[46:47] op_sel:[0,1] op_sel_hi:[1,1]
v_pk_mul_f32 v[108:109], v[108:109], s[46:47] op_sel:[0,1] op_sel_hi:[1,1]
v_pk_mul_f32 v[110:111], v[110:111], s[46:47] op_sel:[0,1] op_sel_hi:[1,1]
v_cvt_pk_bf16_f32 v44, v104, v105
v_cvt_pk_bf16_f32 v45, v106, v107
v_cvt_pk_bf16_f32 v46, v108, v109
v_cvt_pk_bf16_f32 v47, v110, v111
buffer_store_dwordx4 v[44:47], v1, s[8:11], s65 offen offset:3072 sc1
v_mul_u32_u24 v6, 1040, v2
v_lshl_add_u32 v6, v3, 8, v6
s_mul_i32 s27, s66, 33280
v_add_u32_e64 v9, s27, v6
s_mul_i32 s27, s67, 33280
s_add_u32 s27, s27, 66560
v_add_u32_e64 v8, s27, v6
s_waitcnt vmcnt(8)
s_barrier
buffer_load_dword v14, v15, s[72:75], 0 offen sc1
ds_read_b128 v[64:67], v9 offset:0
ds_read_b128 v[68:71], v9 offset:16640
ds_read_b128 v[72:75], v8 offset:0
ds_read_b128 v[76:79], v8 offset:16640
ds_read_b128 v[80:83], v9 offset:16
ds_read_b128 v[84:87], v9 offset:16656
ds_read_b128 v[88:91], v8 offset:16
ds_read_b128 v[92:95], v8 offset:16656
s_waitcnt lgkmcnt(4)
s_nop 0
v_mfma_f32_16x16x32_bf16 v[48:51], v[64:67], v[72:75], 0
ds_read_b128 v[96:99], v9 offset:32
ds_read_b128 v[100:103], v9 offset:16672
ds_read_b128 v[104:107], v8 offset:32
ds_read_b128 v[108:111], v8 offset:16672
v_mfma_f32_16x16x32_bf16 v[52:55], v[68:71], v[72:75], 0
v_mfma_f32_16x16x32_bf16 v[56:59], v[64:67], v[76:79], 0
v_mfma_f32_16x16x32_bf16 v[60:63], v[68:71], v[76:79], 0
s_waitcnt lgkmcnt(4)
s_nop 0
v_mfma_f32_16x16x32_bf16 v[48:51], v[80:83], v[88:91], v[48:51]
ds_read_b128 v[64:67], v9 offset:48
ds_read_b128 v[68:71], v9 offset:16688
ds_read_b128 v[72:75], v8 offset:48
ds_read_b128 v[76:79], v8 offset:16688
v_mfma_f32_16x16x32_bf16 v[52:55], v[84:87], v[88:91], v[52:55]
v_mfma_f32_16x16x32_bf16 v[56:59], v[80:83], v[92:95], v[56:59]
v_mfma_f32_16x16x32_bf16 v[60:63], v[84:87], v[92:95], v[60:63]
s_waitcnt lgkmcnt(4)
s_nop 0
v_mfma_f32_16x16x32_bf16 v[48:51], v[96:99], v[104:107], v[48:51]
ds_read_b128 v[80:83], v9 offset:64
ds_read_b128 v[84:87], v9 offset:16704
ds_read_b128 v[88:91], v8 offset:64
ds_read_b128 v[92:95], v8 offset:16704
v_mfma_f32_16x16x32_bf16 v[52:55], v[100:103], v[104:107], v[52:55]
v_mfma_f32_16x16x32_bf16 v[56:59], v[96:99], v[108:111], v[56:59]
v_mfma_f32_16x16x32_bf16 v[60:63], v[100:103], v[108:111], v[60:63]
s_waitcnt lgkmcnt(4)
s_nop 0
v_mfma_f32_16x16x32_bf16 v[48:51], v[64:67], v[72:75], v[48:51]
ds_read_b128 v[96:99], v9 offset:80
ds_read_b128 v[100:103], v9 offset:16720
ds_read_b128 v[104:107], v8 offset:80
ds_read_b128 v[108:111], v8 offset:16720
v_mfma_f32_16x16x32_bf16 v[52:55], v[68:71], v[72:75], v[52:55]
v_mfma_f32_16x16x32_bf16 v[56:59], v[64:67], v[76:79], v[56:59]
v_mfma_f32_16x16x32_bf16 v[60:63], v[68:71], v[76:79], v[60:63]
s_waitcnt lgkmcnt(4)
s_nop 0
v_mfma_f32_16x16x32_bf16 v[48:51], v[80:83], v[88:91], v[48:51]
ds_read_b128 v[64:67], v9 offset:96
ds_read_b128 v[68:71], v9 offset:16736
ds_read_b128 v[72:75], v8 offset:96
ds_read_b128 v[76:79], v8 offset:16736
v_mfma_f32_16x16x32_bf16 v[52:55], v[84:87], v[88:91], v[52:55]
v_mfma_f32_16x16x32_bf16 v[56:59], v[80:83], v[92:95], v[56:59]
v_mfma_f32_16x16x32_bf16 v[60:63], v[84:87], v[92:95], v[60:63]
s_waitcnt lgkmcnt(4)
s_nop 0
v_mfma_f32_16x16x32_bf16 v[48:51], v[96:99], v[104:107], v[48:51]
ds_read_b128 v[80:83], v9 offset:112
ds_read_b128 v[84:87], v9 offset:16752
ds_read_b128 v[88:91], v8 offset:112
ds_read_b128 v[92:95], v8 offset:16752
v_mfma_f32_16x16x32_bf16 v[52:55], v[100:103], v[104:107], v[52:55]
v_mfma_f32_16x16x32_bf16 v[56:59], v[96:99], v[108:111], v[56:59]
v_mfma_f32_16x16x32_bf16 v[60:63], v[100:103], v[108:111], v[60:63]
s_waitcnt lgkmcnt(4)
s_nop 0
v_mfma_f32_16x16x32_bf16 v[48:51], v[64:67], v[72:75], v[48:51]
ds_read_b128 v[96:99], v9 offset:128
ds_read_b128 v[100:103], v9 offset:16768
ds_read_b128 v[104:107], v8 offset:128
ds_read_b128 v[108:111], v8 offset:16768
v_mfma_f32_16x16x32_bf16 v[52:55], v[68:71], v[72:75], v[52:55]
v_mfma_f32_16x16x32_bf16 v[56:59], v[64:67], v[76:79], v[56:59]
v_mfma_f32_16x16x32_bf16 v[60:63], v[68:71], v[76:79], v[60:63]
s_waitcnt lgkmcnt(4)
s_nop 0
v_mfma_f32_16x16x32_bf16 v[48:51], v[80:83], v[88:91], v[48:51]
ds_read_b128 v[64:67], v9 offset:144
ds_read_b128 v[68:71], v9 offset:16784
ds_read_b128 v[72:75], v8 offset:144
ds_read_b128 v[76:79], v8 offset:16784
v_mfma_f32_16x16x32_bf16 v[52:55], v[84:87], v[88:91], v[52:55]
v_mfma_f32_16x16x32_bf16 v[56:59], v[80:83], v[92:95], v[56:59]
v_mfma_f32_16x16x32_bf16 v[60:63], v[84:87], v[92:95], v[60:63]
s_waitcnt vmcnt(0)
s_mov_b64 exec, 1
buffer_store_dword v7, off, s[72:75], s51 sc1
s_mov_b64 exec, -1
v_cmp_ne_u32 vcc, v7, v14
s_cbranch_vccnz L_sp_2
L_bk_3:
s_waitcnt lgkmcnt(4)
v_mfma_f32_16x16x32_bf16 v[48:51], v[96:99], v[104:107], v[48:51]
ds_read_b128 v[80:83], v9 offset:160
ds_read_b128 v[84:87], v9 offset:16800
ds_read_b128 v[88:91], v8 offset:160
ds_read_b128 v[92:95], v8 offset:16800
v_mfma_f32_16x16x32_bf16 v[52:55], v[100:103], v[104:107], v[52:55]
v_mfma_f32_16x16x32_bf16 v[56:59], v[96:99], v[108:111], v[56:59]
s_add_u32 s49, s48, 0
buffer_load_dwordx4 a[0:3], v1, s[12:15], s49 offen offset:0 sc1
v_mfma_f32_16x16x32_bf16 v[60:63], v[100:103], v[108:111], v[60:63]
buffer_load_dwordx4 a[4:7], v1, s[12:15], s49 offen offset:1024 sc1
s_waitcnt lgkmcnt(4)
v_mfma_f32_16x16x32_bf16 v[48:51], v[64:67], v[72:75], v[48:51]
ds_read_b128 v[96:99], v9 offset:176
ds_read_b128 v[100:103], v9 offset:16816
ds_read_b128 v[104:107], v8 offset:176
ds_read_b128 v[108:111], v8 offset:16816
v_mfma_f32_16x16x32_bf16 v[52:55], v[68:71], v[72:75], v[52:55]
v_mfma_f32_16x16x32_bf16 v[56:59], v[64:67], v[76:79], v[56:59]
buffer_load_dwordx4 a[8:11], v1, s[12:15], s49 offen offset:2048 sc1
v_mfma_f32_16x16x32_bf16 v[60:63], v[68:71], v[76:79], v[60:63]
buffer_load_dwordx4 a[12:15], v1, s[12:15], s49 offen offset:3072 sc1
s_waitcnt lgkmcnt(4)
s_nop 0
v_mfma_f32_16x16x32_bf16 v[48:51], v[80:83], v[88:91], v[48:51]
ds_read_b128 v[64:67], v9 offset:192
ds_read_b128 v[68:71], v9 offset:16832
ds_read_b128 v[72:75], v8 offset:192
ds_read_b128 v[76:79], v8 offset:16832
v_mfma_f32_16x16x32_bf16 v[52:55], v[84:87], v[88:91], v[52:55]
v_mfma_f32_16x16x32_bf16 v[56:59], v[80:83], v[92:95], v[56:59]
s_add_u32 s49, s48, 4096
buffer_load_dwordx4 a[16:19], v1, s[12:15], s49 offen offset:0 sc1
v_mfma_f32_16x16x32_bf16 v[60:63], v[84:87], v[92:95], v[60:63]
buffer_load_dwordx4 a[20:23], v1, s[12:15], s49 offen offset:1024 sc1
s_waitcnt lgkmcnt(4)
s_nop 0
v_mfma_f32_16x16x32_bf16 v[48:51], v[96:99], v[104:107], v[48:51]
ds_read_b128 v[80:83], v9 offset:208
ds_read_b128 v[84:87], v9 offset:16848
ds_read_b128 v[88:91], v8 offset:208
ds_read_b128 v[92:95], v8 offset:16848
v_mfma_f32_16x16x32_bf16 v[52:55], v[100:103], v[104:107], v[52:55]
v_mfma_f32_16x16x32_bf16 v[56:59], v[96:99], v[108:111], v[56:59]
buffer_load_dwordx4 a[24:27], v1, s[12:15], s49 offen offset:2048 sc1
v_mfma_f32_16x16x32_bf16 v[60:63], v[100:103], v[108:111], v[60:63]
buffer_load_dwordx4 a[28:31], v1, s[12:15], s49 offen offset:3072 sc1
s_waitcnt lgkmcnt(4)
s_nop 0
v_mfma_f32_16x16x32_bf16 v[48:51], v[64:67], v[72:75], v[48:51]
ds_read_b128 v[96:99], v9 offset:224
ds_read_b128 v[100:103], v9 offset:16864
ds_read_b128 v[104:107], v8 offset:224
ds_read_b128 v[108:111], v8 offset:16864
v_mfma_f32_16x16x32_bf16 v[52:55], v[68:71], v[72:75], v[52:55]
v_mfma_f32_16x16x32_bf16 v[56:59], v[64:67], v[76:79], v[56:59]
s_add_u32 s49, s48, 8192
buffer_load_dwordx4 a[32:35], v1, s[12:15], s49 offen offset:0 sc1
v_mfma_f32_16x16x32_bf16 v[60:63], v[68:71], v[76:79], v[60:63]
buffer_load_dwordx4 a[36:39], v1, s[12:15], s49 offen offset:1024 sc1
s_waitcnt lgkmcnt(4)
s_nop 0
v_mfma_f32_16x16x32_bf16 v[48:51], v[80:83], v[88:91], v[48:51]
ds_read_b128 v[64:67], v9 offset:240
ds_read_b128 v[68:71], v9 offset:16880
ds_read_b128 v[72:75], v8 offset:240
ds_read_b128 v[76:79], v8 offset:16880
v_mfma_f32_16x16x32_bf16 v[52:55], v[84:87], v[88:91], v[52:55]
v_mfma_f32_16x16x32_bf16 v[56:59], v[80:83], v[92:95], v[56:59]
buffer_load_dwordx4 a[40:43], v1, s[12:15], s49 offen offset:2048 sc1
v_mfma_f32_16x16x32_bf16 v[60:63], v[84:87], v[92:95], v[60:63]
buffer_load_dwordx4 a[44:47], v1, s[12:15], s49 offen offset:3072 sc1
s_waitcnt lgkmcnt(4)
s_nop 0
v_mfma_f32_16x16x32_bf16 v[48:51], v[96:99], v[104:107], v[48:51]
v_mfma_f32_16x16x32_bf16 v[52:55], v[100:103], v[104:107], v[52:55]
v_mfma_f32_16x16x32_bf16 v[56:59], v[96:99], v[108:111], v[56:59]
s_add_u32 s49, s48, 12288
buffer_load_dwordx4 a[48:51], v1, s[12:15], s49 offen offset:0 sc1
v_mfma_f32_16x16x32_bf16 v[60:63], v[100:103], v[108:111], v[60:63]
buffer_load_dwordx4 a[52:55], v1, s[12:15], s49 offen offset:1024 sc1
s_waitcnt lgkmcnt(0)
s_nop 0
v_mfma_f32_16x16x32_bf16 v[48:51], v[64:67], v[72:75], v[48:51]
v_mfma_f32_16x16x32_bf16 v[52:55], v[68:71], v[72:75], v[52:55]
v_mfma_f32_16x16x32_bf16 v[56:59], v[64:67], v[76:79], v[56:59]
buffer_load_dwordx4 a[56:59], v1, s[12:15], s49 offen offset:2048 sc1
v_mfma_f32_16x16x32_bf16 v[60:63], v[68:71], v[76:79], v[60:63]
buffer_load_dwordx4 a[60:63], v1, s[12:15], s49 offen offset:3072 sc1
buffer_load_dword v4, v5, s[72:75], 0 offen sc1
s_barrier
s_lshl_b32 s28, s26, 1
s_add_u32 s28, s28, s67
s_lshl_b32 s28, s28, 15
s_lshl_b32 s27, s25, 1
s_add_u32 s27, s27, s66
s_lshl_b32 s27, s27, 11
s_add_u32 s28, s28, s27
s_add_u32 s28, s28, 75497472
s_add_u32 s29, s28, 1024
s_mov_b32 s27, 1031967726
v_mul_f32 v48, s27, v48
v_mul_f32 v49, s27, v49
v_mul_f32 v50, s27, v50
v_mul_f32 v51, s27, v51
v_mul_f32 v52, s27, v52
v_mul_f32 v53, s27, v53
v_mul_f32 v54, s27, v54
v_mul_f32 v55, s27, v55
v_mul_f32 v56, s27, v56
v_mul_f32 v57, s27, v57
v_mul_f32 v58, s27, v58
v_mul_f32 v59, s27, v59
v_mul_f32 v60, s27, v60
v_mul_f32 v61, s27, v61
v_mul_f32_e64 v62, s27, v62
v_mul_f32 v63, s27, v63
s_branch L_pst
L_notM:
s_cmp_ge_u32 s31, 192
s_cbranch_scc1 L_notW
s_lshr_b32 s35, s31, 7
s_mov_b32 s56, s50
s_mov_b32 s57, s51
s_mov_b32 s58, 1048576
s_mov_b32 s59, 0x00020000
s_cmp_eq_u32 s35, 0
s_cselect_b32 s52, s42, s48
s_cselect_b32 s53, s43, s49
s_mov_b32 s54, 524288
s_mov_b32 s55, 0x20000
s_lshl_b32 s69, s67, 2
s_lshl_b32 s70, s66, 4
s_add_u32 s69, s69, s70
s_lshl_b32 s70, s24, 3
s_cmp_eq_u32 s35, 0
s_cselect_b32 s69, s69, s70
s_cselect_b32 s70, 8, 4
s_lshl_b32 s27, s26, 6
s_add_u32 s69, s69, s27
s_lshl_b32 s69, s69, 10
s_lshl_b32 s70, s70, 10
v_lshl_add_u32 v8, v4, 10, v5
s_lshl_b32 s60, s35, 19
s_lshl_b32 s27, s25, 7
s_add_u32 s60, s60, s27
s_lshl_b32 s27, s24, 17
s_add_u32 s60, s60, s27
s_lshl_b32 s27, s24, 14
s_add_u32 m0, s29, 0
s_add_u32 s28, s69, s70
buffer_load_dwordx4 v1, s[52:55], s69 offen offset:0 lds
s_add_u32 m0, s29, 16
s_nop 0
buffer_load_dwordx4 v1, s[52:55], s69 offen offset:1024 lds
s_add_u32 m0, s29, 32
s_nop 0
buffer_load_dwordx4 v1, s[52:55], s69 offen offset:2048 lds
s_add_u32 m0, s29, 48
s_nop 0
buffer_load_dwordx4 v1, s[52:55], s69 offen offset:3072 lds
s_add_u32 m0, s29, 4160
s_add_u32 s69, s69, 32768
buffer_load_dwordx4 v1, s[52:55], s28 offen offset:0 lds
s_add_u32 m0, s29, 4176
s_nop 0
buffer_load_dwordx4 v1, s[52:55], s28 offen offset:1024 lds
s_add_u32 m0, s29, 4192
s_nop 0
buffer_load_dwordx4 v1, s[52:55], s28 offen offset:2048 lds
s_add_u32 m0, s29, 4208
s_nop 0
buffer_load_dwordx4 v1, s[52:55], s28 offen offset:3072 lds
s_add_u32 m0, s29, 33280
s_add_u32 s28, s69, s70
buffer_load_dwordx4 v1, s[52:55], s69 offen offset:0 lds
s_add_u32 m0, s29, 33296
s_nop 0
buffer_load_dwordx4 v1, s[52:55], s69 offen offset:1024 lds
s_add_u32 m0, s29, 33312
s_nop 0
buffer_load_dwordx4 v1, s[52:55], s69 offen offset:2048 lds
s_add_u32 m0, s29, 33328
s_nop 0
buffer_load_dwordx4 v1, s[52:55], s69 offen offset:3072 lds
s_add_u32 m0, s29, 37440
s_nop 0
buffer_load_dwordx4 v1, s[52:55], s28 offen offset:0 lds
s_add_u32 m0, s29, 37456
s_nop 0
buffer_load_dwordx4 v1, s[52:55], s28 offen offset:1024 lds
s_add_u32 m0, s29, 37472
s_nop 0
buffer_load_dwordx4 v1, s[52:55], s28 offen offset:2048 lds
s_add_u32 m0, s29, 37488
s_nop 0
buffer_load_dwordx4 v1, s[52:55], s28 offen offset:3072 lds
s_add_u32 m0, s27, 66560
s_nop 0
buffer_load_dwordx4 v8, s[56:59], s60 offen lds
s_add_u32 m0, s27, 67584
s_add_u32 s60, s60, 8192
buffer_load_dwordx4 v8, s[56:59], s60 offen lds
s_add_u32 m0, s27, 68608
s_add_u32 s60, s60, 8192
buffer_load_dwordx4 v8, s[56:59], s60 offen lds
s_add_u32 m0, s27, 69632
s_add_u32 s60, s60, 8192
buffer_load_dwordx4 v8, s[56:59], s60 offen lds
s_add_u32 m0, s27, 70656
s_add_u32 s60, s60, 8192
buffer_load_dwordx4 v8, s[56:59], s60 offen lds
s_add_u32 m0, s27, 71680
s_add_u32 s60, s60, 8192
buffer_load_dwordx4 v8, s[56:59], s60 offen lds
s_add_u32 m0, s27, 72704
s_add_u32 s60, s60, 8192
buffer_load_dwordx4 v8, s[56:59], s60 offen lds
s_add_u32 m0, s27, 73728
s_add_u32 s60, s60, 8192
buffer_load_dwordx4 v8, s[56:59], s60 offen lds
s_mov_b32 s8, s4
s_mov_b32 s9, s5
s_mov_b32 s10, 8192000
s_mov_b32 s11, 0x00020000
s_mov_b32 s12, s4
s_mov_b32 s13, s5
s_mov_b32 s14, 268435456
s_mov_b32 s15, 0x00020000
s_add_u32 s72, s4, 80740352
s_addc_u32 s73, s5, 0
s_mov_b32 s74, 36928
s_mov_b32 s75, 0x00020000
s_lshl_b32 s48, s32, 2
s_add_u32 s48, s48, s24
s_lshr_b32 s47, s48, 1
s_lshl_b32 s48, s48, 15
s_add_u32 s48, s48, 76546048
s_lshl_b32 s50, s47, 7
s_add_u32 s50, s50, 28672
s_lshl_b32 s47, s47, 7
s_add_u32 s47, s47, 32768
s_lshl_b32 s39, s30, 6
s_add_u32 s39, s39, 24576
v_mov_b32_e64 v15, s47
v_add_u32 v14, 1024, v15
v_cmp_gt_u32 vcc, 32, v0
v_lshlrev_b32 v4, 2, v2
v_add_u32 v5, s39, v4
v_cndmask_b32 v15, v15, v14, vcc
v_add_u32_e64 v15, v4, v15
s_lshl_b32 s51, s32, 4
s_add_u32 s51, s51, s39
s_lshl_b32 s39, s24, 2
s_add_u32 s51, s51, s39
s_lshl_b32 s68, s68, 4
s_add_u32 s68, s68, s39
s_add_u32 s68, s68, 28672
s_mov_b32 s36, 0xffff0000
s_mov_b32 s37, 989855744
s_mov_b32 s38, 0x3f803f80
v_mov_b32 v10, 925353388
s_waitcnt lgkmcnt(0)
s_mul_i32 s71, s71, 0x9E3779B1
s_add_u32 s71, s71, 0x7F4A7C15
v_mov_b32_e64 v7, s71
s_waitcnt vmcnt(24)
v_dot2_f32_bf16 v112, v16, s38, 0
v_dot2_f32_bf16 v113, v20, s38, 0
v_dot2_f32_bf16 v114, v24, s38, 0
v_dot2_f32_bf16 v115, v28, s38, 0
v_dot2_f32_bf16 v116, v32, s38, 0
v_dot2_f32_bf16 v117, v36, s38, 0
v_dot2_f32_bf16 v118, v40, s38, 0
v_dot2_f32_bf16 v119, v44, s38, 0
v_dot2_f32_bf16 v112, v17, s38, v112
v_dot2_f32_bf16 v113, v21, s38, v113
v_dot2_f32_bf16 v114, v25, s38, v114
v_dot2_f32_bf16 v115, v29, s38, v115
v_dot2_f32_bf16 v116, v33, s38, v116
v_dot2_f32_bf16 v117, v37, s38, v117
v_dot2_f32_bf16 v118, v41, s38, v118
v_dot2_f32_bf16 v119, v45, s38, v119
v_dot2_f32_bf16 v112, v18, s38, v112
v_dot2_f32_bf16 v113, v22, s38, v113
v_dot2_f32_bf16 v114, v26, s38, v114
v_dot2_f32_bf16 v115, v30, s38, v115
v_dot2_f32_bf16 v116, v34, s38, v116
v_dot2_f32_bf16 v117, v38, s38, v117
v_dot2_f32_bf16 v118, v42, s38, v118
v_dot2_f32_bf16 v119, v46, s38, v119
v_dot2_f32_bf16 v112, v19, s38, v112
v_dot2_f32_bf16 v113, v23, s38, v113
v_dot2_f32_bf16 v114, v27, s38, v114
v_dot2_f32_bf16 v115, v31, s38, v115
v_dot2_f32_bf16 v116, v35, s38, v116
v_dot2_f32_bf16 v117, v39, s38, v117
s_add_u32 m0, s27, 74752
s_add_u32 s60, s60, 8192
buffer_load_dwordx4 v8, s[56:59], s60 offen lds
v_dot2_f32_bf16 v118, v43, s38, v118
v_dot2_f32_bf16 v119, v47, s38, v119
v_lshlrev_b32 v48, 16, v16
v_and_b32 v49, s36, v16
v_lshlrev_b32 v50, 16, v17
v_and_b32 v51, s36, v17
v_lshlrev_b32 v52, 16, v18
v_and_b32 v53, s36, v18
v_lshlrev_b32 v54, 16, v19
v_and_b32 v55, s36, v19
v_lshlrev_b32 v56, 16, v20
v_and_b32 v57, s36, v20
v_lshlrev_b32 v58, 16, v21
v_and_b32 v59, s36, v21
v_lshlrev_b32 v60, 16, v22
v_and_b32 v61, s36, v22
v_lshlrev_b32 v62, 16, v23
v_and_b32 v63, s36, v23
v_lshlrev_b32 v64, 16, v24
v_and_b32 v65, s36, v24
v_lshlrev_b32 v66, 16, v25
v_and_b32 v67, s36, v25
v_lshlrev_b32 v68, 16, v26
v_and_b32 v69, s36, v26
v_lshlrev_b32 v70, 16, v27
v_and_b32 v71, s36, v27
v_lshlrev_b32 v72, 16, v28
v_and_b32 v73, s36, v28
v_lshlrev_b32 v74, 16, v29
v_and_b32 v75, s36, v29
s_add_u32 m0, s27, 75776
s_add_u32 s60, s60, 8192
buffer_load_dwordx4 v8, s[56:59], s60 offen lds
v_lshlrev_b32 v76, 16, v30
v_and_b32 v77, s36, v30
v_lshlrev_b32 v78, 16, v31
v_and_b32 v79, s36, v31
s_nop 1
v_permlane32_swap_b32 v112, v113
v_permlane32_swap_b32 v114, v115
v_permlane32_swap_b32 v116, v117
v_permlane32_swap_b32 v118, v119
v_add_f32 v112, v112, v113
v_add_f32 v114, v114, v115
v_add_f32 v116, v116, v117
v_add_f32 v118, v118, v119
s_nop 0
v_permlane16_swap_b32 v112, v114
v_permlane16_swap_b32 v116, v118
v_add_f32_e64 v112, v112, v114
v_add_f32 v116, v116, v118
s_nop 0
v_add_f32_dpp v112, v112, v112 row_ror:8 row_mask:0xf bank_mask:0xf
v_add_f32_dpp v116, v116, v116 row_ror:8 row_mask:0xf bank_mask:0xf
s_nop 0
v_add_f32_dpp v112, v112, v112 row_ror:4 row_mask:0xf bank_mask:0xf
v_add_f32_dpp v116, v116, v116 row_ror:4 row_mask:0xf bank_mask:0xf
s_nop 0
v_add_f32_dpp v112, v112, v112 row_ror:2 row_mask:0xf bank_mask:0xf
v_add_f32_dpp v116, v116, v116 row_ror:2 row_mask:0xf bank_mask:0xf
s_nop 0
v_add_f32_dpp v112, v112, v112 row_ror:1 row_mask:0xf bank_mask:0xf
v_add_f32_dpp v116, v116, v116 row_ror:1 row_mask:0xf bank_mask:0xf
s_add_u32 m0, s27, 76800
s_add_u32 s60, s60, 8192
buffer_load_dwordx4 v8, s[56:59], s60 offen lds
v_mul_f32 v112, s37, v112
v_mul_f32 v116, s37, v116
s_nop 0
v_readlane_b32 s40, v112, 0
v_readlane_b32 s41, v112, 32
v_readlane_b32 s42, v112, 16
v_readlane_b32 s43, v112, 48
v_readlane_b32 s44, v116, 0
v_readlane_b32 s45, v116, 32
v_readlane_b32 s46, v116, 16
v_readlane_b32 s47, v116, 48
v_lshlrev_b32 v80, 16, v32
v_and_b32 v81, s36, v32
v_lshlrev_b32 v82, 16, v33
v_and_b32 v83, s36, v33
v_lshlrev_b32 v84, 16, v34
v_and_b32 v85, s36, v34
v_lshlrev_b32 v86, 16, v35
v_and_b32 v87, s36, v35
v_lshlrev_b32 v88, 16, v36
v_and_b32 v89, s36, v36
v_lshlrev_b32 v90, 16, v37
v_and_b32 v91, s36, v37
v_lshlrev_b32 v92, 16, v38
v_and_b32 v93, s36, v38
v_lshlrev_b32 v94, 16, v39
v_and_b32 v95, s36, v39
v_lshlrev_b32 v96, 16, v40
v_and_b32 v97, s36, v40
v_lshlrev_b32_e64 v98, 16, v41
s_add_u32 m0, s27, 77824
s_add_u32 s60, s60, 8192
buffer_load_dwordx4 v8, s[56:59], s60 offen lds
v_and_b32 v99, s36, v41
v_lshlrev_b32 v100, 16, v42
v_and_b32 v101, s36, v42
v_lshlrev_b32 v102, 16, v43
v_and_b32 v103, s36, v43
v_lshlrev_b32 v104, 16, v44
v_and_b32 v105, s36, v44
v_lshlrev_b32 v106, 16, v45
v_and_b32 v107, s36, v45
v_lshlrev_b32 v108, 16, v46
v_and_b32 v109, s36, v46
v_lshlrev_b32 v110, 16, v47
v_and_b32_e64 v111, s36, v47
v_pk_add_f32 v[48:49], v[48:49], s[40:41] op_sel:[0,0] op_sel_hi:[1,0] neg_lo:[0,1] neg_hi:[0,1]
v_pk_add_f32 v[50:51], v[50:51], s[40:41] op_sel:[0,0] op_sel_hi:[1,0] neg_lo:[0,1] neg_hi:[0,1]
v_pk_add_f32 v[52:53], v[52:53], s[40:41] op_sel:[0,0] op_sel_hi:[1,0] neg_lo:[0,1] neg_hi:[0,1]
v_pk_add_f32 v[54:55], v[54:55], s[40:41] op_sel:[0,0] op_sel_hi:[1,0] neg_lo:[0,1] neg_hi:[0,1]
v_pk_add_f32 v[56:57], v[56:57], s[40:41] op_sel:[0,1] op_sel_hi:[1,1] neg_lo:[0,1] neg_hi:[0,1]
v_pk_add_f32 v[58:59], v[58:59], s[40:41] op_sel:[0,1] op_sel_hi:[1,1] neg_lo:[0,1] neg_hi:[0,1]
v_pk_add_f32 v[60:61], v[60:61], s[40:41] op_sel:[0,1] op_sel_hi:[1,1] neg_lo:[0,1] neg_hi:[0,1]
v_pk_add_f32 v[62:63], v[62:63], s[40:41] op_sel:[0,1] op_sel_hi:[1,1] neg_lo:[0,1] neg_hi:[0,1]
v_pk_add_f32 v[64:65], v[64:65], s[42:43] op_sel:[0,0] op_sel_hi:[1,0] neg_lo:[0,1] neg_hi:[0,1]
v_pk_add_f32 v[66:67], v[66:67], s[42:43] op_sel:[0,0] op_sel_hi:[1,0] neg_lo:[0,1] neg_hi:[0,1]
v_pk_add_f32 v[68:69], v[68:69], s[42:43] op_sel:[0,0] op_sel_hi:[1,0] neg_lo:[0,1] neg_hi:[0,1]
v_pk_add_f32 v[70:71], v[70:71], s[42:43] op_sel:[0,0] op_sel_hi:[1,0] neg_lo:[0,1] neg_hi:[0,1]
v_pk_add_f32 v[72:73], v[72:73], s[42:43] op_sel:[0,1] op_sel_hi:[1,1] neg_lo:[0,1] neg_hi:[0,1]
v_pk_add_f32 v[74:75], v[74:75], s[42:43] op_sel:[0,1] op_sel_hi:[1,1] neg_lo:[0,1] neg_hi:[0,1]
v_pk_add_f32 v[76:77], v[76:77], s[42:43] op_sel:[0,1] op_sel_hi:[1,1] neg_lo:[0,1] neg_hi:[0,1]
v_pk_add_f32 v[78:79], v[78:79], s[42:43] op_sel:[0,1] op_sel_hi:[1,1] neg_lo:[0,1] neg_hi:[0,1]
v_pk_add_f32 v[80:81], v[80:81], s[44:45] op_sel:[0,0] op_sel_hi:[1,0] neg_lo:[0,1] neg_hi:[0,1]
s_add_u32 m0, s27, 78848
s_add_u32 s60, s60, 8192
buffer_load_dwordx4 v8, s[56:59], s60 offen lds
v_pk_add_f32 v[82:83], v[82:83], s[44:45] op_sel:[0,0] op_sel_hi:[1,0] neg_lo:[0,1] neg_hi:[0,1]
v_pk_add_f32 v[84:85], v[84:85], s[44:45] op_sel:[0,0] op_sel_hi:[1,0] neg_lo:[0,1] neg_hi:[0,1]
v_pk_add_f32 v[86:87], v[86:87], s[44:45] op_sel:[0,0] op_sel_hi:[1,0] neg_lo:[0,1] neg_hi:[0,1]
v_pk_add_f32 v[88:89], v[88:89], s[44:45] op_sel:[0,1] op_sel_hi:[1,1] neg_lo:[0,1] neg_hi:[0,1]
v_pk_add_f32 v[90:91], v[90:91], s[44:45] op_sel:[0,1] op_sel_hi:[1,1] neg_lo:[0,1] neg_hi:[0,1]
v_pk_add_f32 v[92:93], v[92:93], s[44:45] op_sel:[0,1] op_sel_hi:[1,1] neg_lo:[0,1] neg_hi:[0,1]
v_pk_add_f32 v[94:95], v[94:95], s[44:45] op_sel:[0,1] op_sel_hi:[1,1] neg_lo:[0,1] neg_hi:[0,1]
v_pk_add_f32 v[96:97], v[96:97], s[46:47] op_sel:[0,0] op_sel_hi:[1,0] neg_lo:[0,1] neg_hi:[0,1]
v_pk_add_f32 v[98:99], v[98:99], s[46:47] op_sel:[0,0] op_sel_hi:[1,0] neg_lo:[0,1] neg_hi:[0,1]
v_pk_add_f32 v[100:101], v[100:101], s[46:47] op_sel:[0,0] op_sel_hi:[1,0] neg_lo:[0,1] neg_hi:[0,1]
v_pk_add_f32 v[102:103], v[102:103], s[46:47] op_sel:[0,0] op_sel_hi:[1,0] neg_lo:[0,1] neg_hi:[0,1]
v_pk_add_f32 v[104:105], v[104:105], s[46:47] op_sel:[0,1] op_sel_hi:[1,1] neg_lo:[0,1] neg_hi:[0,1]
v_pk_add_f32 v[106:107], v[106:107], s[46:47] op_sel:[0,1] op_sel_hi:[1,1] neg_lo:[0,1] neg_hi:[0,1]
v_pk_add_f32 v[108:109], v[108:109], s[46:47] op_sel:[0,1] op_sel_hi:[1,1] neg_lo:[0,1] neg_hi:[0,1]
v_pk_add_f32 v[110:111], v[110:111], s[46:47] op_sel:[0,1] op_sel_hi:[1,1] neg_lo:[0,1] neg_hi:[0,1]
v_pk_mul_f32 v[16:17], v[48:49], v[48:49]
v_pk_mul_f32 v[18:19], v[56:57], v[56:57]
v_pk_mul_f32 v[20:21], v[64:65], v[64:65]
v_pk_mul_f32 v[22:23], v[72:73], v[72:73]
v_pk_mul_f32 v[24:25], v[80:81], v[80:81]
v_pk_mul_f32 v[26:27], v[88:89], v[88:89]
v_pk_mul_f32 v[28:29], v[96:97], v[96:97]
v_pk_mul_f32 v[30:31], v[104:105], v[104:105]
v_pk_fma_f32 v[16:17], v[50:51], v[50:51], v[16:17]
v_pk_fma_f32 v[18:19], v[58:59], v[58:59], v[18:19]
v_pk_fma_f32 v[20:21], v[66:67], v[66:67], v[20:21]
v_pk_fma_f32 v[22:23], v[74:75], v[74:75], v[22:23]
v_pk_fma_f32 v[24:25], v[82:83], v[82:83], v[24:25]
v_pk_fma_f32 v[26:27], v[90:91], v[90:91], v[26:27]
v_pk_fma_f32 v[28:29], v[98:99], v[98:99], v[28:29]
s_add_u32 m0, s27, 79872
s_add_u32 s60, s60, 8192
buffer_load_dwordx4 v8, s[56:59], s60 offen lds
v_pk_fma_f32 v[30:31], v[106:107], v[106:107], v[30:31]
v_pk_fma_f32 v[16:17], v[52:53], v[52:53], v[16:17]
v_pk_fma_f32 v[18:19], v[60:61], v[60:61], v[18:19]
v_pk_fma_f32 v[20:21], v[68:69], v[68:69], v[20:21]
v_pk_fma_f32 v[22:23], v[76:77], v[76:77], v[22:23]
v_pk_fma_f32 v[24:25], v[84:85], v[84:85], v[24:25]
v_pk_fma_f32 v[26:27], v[92:93], v[92:93], v[26:27]
v_pk_fma_f32 v[28:29], v[100:101], v[100:101], v[28:29]
v_pk_fma_f32 v[30:31], v[108:109], v[108:109], v[30:31]
v_pk_fma_f32 v[16:17], v[54:55], v[54:55], v[16:17]
v_pk_fma_f32 v[18:19], v[62:63], v[62:63], v[18:19]
v_pk_fma_f32 v[20:21], v[70:71], v[70:71], v[20:21]
v_pk_fma_f32 v[22:23], v[78:79], v[78:79], v[22:23]
v_pk_fma_f32 v[24:25], v[86:87], v[86:87], v[24:25]
v_pk_fma_f32 v[26:27], v[94:95], v[94:95], v[26:27]
v_pk_fma_f32 v[28:29], v[102:103], v[102:103], v[28:29]
v_pk_fma_f32 v[30:31], v[110:111], v[110:111], v[30:31]
v_add_f32 v112, v16, v17
v_add_f32 v113, v18, v19
v_add_f32 v114, v20, v21
v_add_f32 v115, v22, v23
v_add_f32 v116, v24, v25
v_add_f32 v117, v26, v27
v_add_f32_e64 v118, v28, v29
v_add_f32 v119, v30, v31
s_nop 1
v_permlane32_swap_b32 v112, v113
v_permlane32_swap_b32 v114, v115
v_permlane32_swap_b32 v116, v117
v_permlane32_swap_b32 v118, v119
s_add_u32 m0, s27, 80896
s_add_u32 s60, s60, 8192
buffer_load_dwordx4 v8, s[56:59], s60 offen lds
v_add_f32 v112, v112, v113
v_add_f32 v114, v114, v115
v_add_f32 v116, v116, v117
v_add_f32 v118, v118, v119
s_nop 0
v_permlane16_swap_b32 v112, v114
v_permlane16_swap_b32 v116, v118
v_add_f32 v112, v112, v114
v_add_f32 v116, v116, v118
s_nop 0
v_add_f32_dpp v112, v112, v112 row_ror:8 row_mask:0xf bank_mask:0xf
v_add_f32_dpp v116, v116, v116 row_ror:8 row_mask:0xf bank_mask:0xf
s_nop 0
v_add_f32_dpp v112, v112, v112 row_ror:4 row_mask:0xf bank_mask:0xf
v_add_f32_dpp v116, v116, v116 row_ror:4 row_mask:0xf bank_mask:0xf
s_nop 0
v_add_f32_dpp v112, v112, v112 row_ror:2 row_mask:0xf bank_mask:0xf
v_add_f32_dpp v116, v116, v116 row_ror:2 row_mask:0xf bank_mask:0xf
s_nop 0
v_add_f32_dpp v112, v112, v112 row_ror:1 row_mask:0xf bank_mask:0xf
v_add_f32_dpp v116, v116, v116 row_ror:1 row_mask:0xf bank_mask:0xf
v_fma_f32 v112, v112, s37, v10
v_fma_f32 v116, v116, s37, v10
v_rsq_f32 v112, v112
v_rsq_f32 v116, v116
s_nop 0
v_readlane_b32 s40, v112, 0
v_readlane_b32 s41, v112, 32
v_readlane_b32 s42, v112, 16
v_readlane_b32 s43, v112, 48
s_add_u32 m0, s27, 81920
s_add_u32 s60, s60, 8192
buffer_load_dwordx4 v8, s[56:59], s60 offen lds
v_readlane_b32 s44, v116, 0
v_readlane_b32 s45, v116, 32
v_readlane_b32 s46, v116, 16
v_readlane_b32 s47, v116, 48
s_nop 0
s_nop 0
v_pk_mul_f32 v[48:49], v[48:49], s[40:41] op_sel:[0,0] op_sel_hi:[1,0]
v_pk_mul_f32 v[50:51], v[50:51], s[40:41] op_sel:[0,0] op_sel_hi:[1,0]
v_pk_mul_f32 v[52:53], v[52:53], s[40:41] op_sel:[0,0] op_sel_hi:[1,0]
v_pk_mul_f32 v[54:55], v[54:55], s[40:41] op_sel:[0,0] op_sel_hi:[1,0]
v_cvt_pk_bf16_f32 v16, v48, v49
v_cvt_pk_bf16_f32 v17, v50, v51
v_cvt_pk_bf16_f32 v18, v52, v53
v_cvt_pk_bf16_f32 v19, v54, v55
buffer_store_dwordx4 v[16:19], v1, s[8:11], s64 offen offset:0 sc1
v_pk_mul_f32 v[56:57], v[56:57], s[40:41] op_sel:[0,1] op_sel_hi:[1,1]
v_pk_mul_f32 v[58:59], v[58:59], s[40:41] op_sel:[0,1] op_sel_hi:[1,1]
v_pk_mul_f32 v[60:61], v[60:61], s[40:41] op_sel:[0,1] op_sel_hi:[1,1]
v_pk_mul_f32 v[62:63], v[62:63], s[40:41] op_sel:[0,1] op_sel_hi:[1,1]
v_cvt_pk_bf16_f32 v20, v56, v57
v_cvt_pk_bf16_f32 v21, v58, v59
v_cvt_pk_bf16_f32 v22, v60, v61
v_cvt_pk_bf16_f32 v23, v62, v63
buffer_store_dwordx4 v[20:23], v1, s[8:11], s64 offen offset:1024 sc1
v_pk_mul_f32 v[64:65], v[64:65], s[42:43] op_sel:[0,0] op_sel_hi:[1,0]
v_pk_mul_f32 v[66:67], v[66:67], s[42:43] op_sel:[0,0] op_sel_hi:[1,0]
v_pk_mul_f32 v[68:69], v[68:69], s[42:43] op_sel:[0,0] op_sel_hi:[1,0]
v_pk_mul_f32 v[70:71], v[70:71], s[42:43] op_sel:[0,0] op_sel_hi:[1,0]
v_cvt_pk_bf16_f32 v24, v64, v65
v_cvt_pk_bf16_f32 v25, v66, v67
v_cvt_pk_bf16_f32 v26, v68, v69
v_cvt_pk_bf16_f32 v27, v70, v71
buffer_store_dwordx4 v[24:27], v1, s[8:11], s64 offen offset:2048 sc1
v_pk_mul_f32 v[72:73], v[72:73], s[42:43] op_sel:[0,1] op_sel_hi:[1,1]
v_pk_mul_f32 v[74:75], v[74:75], s[42:43] op_sel:[0,1] op_sel_hi:[1,1]
v_pk_mul_f32 v[76:77], v[76:77], s[42:43] op_sel:[0,1] op_sel_hi:[1,1]
v_pk_mul_f32 v[78:79], v[78:79], s[42:43] op_sel:[0,1] op_sel_hi:[1,1]
v_cvt_pk_bf16_f32 v28, v72, v73
v_cvt_pk_bf16_f32 v29, v74, v75
v_cvt_pk_bf16_f32 v30, v76, v77
v_cvt_pk_bf16_f32 v31, v78, v79
buffer_store_dwordx4 v[28:31], v1, s[8:11], s64 offen offset:3072 sc1
v_pk_mul_f32 v[80:81], v[80:81], s[44:45] op_sel:[0,0] op_sel_hi:[1,0]
v_pk_mul_f32 v[82:83], v[82:83], s[44:45] op_sel:[0,0] op_sel_hi:[1,0]
v_pk_mul_f32 v[84:85], v[84:85], s[44:45] op_sel:[0,0] op_sel_hi:[1,0]
v_pk_mul_f32 v[86:87], v[86:87], s[44:45] op_sel:[0,0] op_sel_hi:[1,0]
v_cvt_pk_bf16_f32 v32, v80, v81
v_cvt_pk_bf16_f32 v33, v82, v83
v_cvt_pk_bf16_f32 v34, v84, v85
v_cvt_pk_bf16_f32 v35, v86, v87
buffer_store_dwordx4 v[32:35], v1, s[8:11], s65 offen offset:0 sc1
v_pk_mul_f32 v[88:89], v[88:89], s[44:45] op_sel:[0,1] op_sel_hi:[1,1]
v_pk_mul_f32 v[90:91], v[90:91], s[44:45] op_sel:[0,1] op_sel_hi:[1,1]
v_pk_mul_f32 v[92:93], v[92:93], s[44:45] op_sel:[0,1] op_sel_hi:[1,1]
v_pk_mul_f32 v[94:95], v[94:95], s[44:45] op_sel:[0,1] op_sel_hi:[1,1]
v_cvt_pk_bf16_f32 v36, v88, v89
v_cvt_pk_bf16_f32 v37, v90, v91
v_cvt_pk_bf16_f32 v38, v92, v93
v_cvt_pk_bf16_f32 v39, v94, v95
buffer_store_dwordx4 v[36:39], v1, s[8:11], s65 offen offset:1024 sc1
v_pk_mul_f32 v[96:97], v[96:97], s[46:47] op_sel:[0,0] op_sel_hi:[1,0]
v_pk_mul_f32 v[98:99], v[98:99], s[46:47] op_sel:[0,0] op_sel_hi:[1,0]
v_pk_mul_f32 v[100:101], v[100:101], s[46:47] op_sel:[0,0] op_sel_hi:[1,0]
v_pk_mul_f32 v[102:103], v[102:103], s[46:47] op_sel:[0,0] op_sel_hi:[1,0]
v_cvt_pk_bf16_f32 v40, v96, v97
v_cvt_pk_bf16_f32 v41, v98, v99
v_cvt_pk_bf16_f32 v42, v100, v101
v_cvt_pk_bf16_f32 v43, v102, v103
buffer_store_dwordx4 v[40:43], v1, s[8:11], s65 offen offset:2048 sc1
v_pk_mul_f32 v[104:105], v[104:105], s[46:47] op_sel:[0,1] op_sel_hi:[1,1]
v_pk_mul_f32 v[106:107], v[106:107], s[46:47] op_sel:[0,1] op_sel_hi:[1,1]
v_pk_mul_f32 v[108:109], v[108:109], s[46:47] op_sel:[0,1] op_sel_hi:[1,1]
v_pk_mul_f32 v[110:111], v[110:111], s[46:47] op_sel:[0,1] op_sel_hi:[1,1]
v_cvt_pk_bf16_f32 v44, v104, v105
v_cvt_pk_bf16_f32 v45, v106, v107
v_cvt_pk_bf16_f32 v46, v108, v109
v_cvt_pk_bf16_f32 v47, v110, v111
buffer_store_dwordx4 v[44:47], v1, s[8:11], s65 offen offset:3072 sc1
v_mul_u32_u24 v6, 1040, v2
v_lshl_add_u32 v6, v3, 8, v6
s_mul_i32 s27, s66, 33280
v_add_u32_e64 v9, s27, v6
v_bfe_u32 v11, v0, 2, 2
v_lshl_add_u32 v8, v3, 7, v11
v_lshlrev_b32 v8, 7, v8
v_and_b32 v12, 3, v0
v_and_b32 v11, 2, v11
v_lshlrev_b32 v11, 1, v11
v_or_b32 v12, v12, v11
s_lshl_b32 s27, s67, 2
v_xor_b32_e64 v12, s27, v12
v_lshl_add_u32 v8, v12, 4, v8
v_add_u32 v8, 66560, v8
s_waitcnt vmcnt(8)
s_barrier
buffer_load_dword v14, v15, s[72:75], 0 offen sc1
ds_read_b128 v[64:67], v9 offset:0
ds_read_b128 v[68:71], v9 offset:16640
ds_read_b64_tr_b16 v[72:73], v8 offset:0
ds_read_b64_tr_b16 v[74:75], v8 offset:512
ds_read_b64_tr_b16 v[76:77], v8 offset:8
ds_read_b64_tr_b16 v[78:79], v8 offset:520
ds_read_b128 v[80:83], v9 offset:16
ds_read_b128 v[84:87], v9 offset:16656
ds_read_b64_tr_b16 v[88:89], v8 offset:1024
ds_read_b64_tr_b16 v[90:91], v8 offset:1536
ds_read_b64_tr_b16 v[92:93], v8 offset:1032
ds_read_b64_tr_b16 v[94:95], v8 offset:1544
s_waitcnt lgkmcnt(6)
s_nop 0
v_mfma_f32_16x16x32_bf16 v[48:51], v[64:67], v[72:75], 0
ds_read_b128 v[96:99], v9 offset:32
ds_read_b128 v[100:103], v9 offset:16672
ds_read_b64_tr_b16 v[104:105], v8 offset:2048
ds_read_b64_tr_b16 v[106:107], v8 offset:2560
ds_read_b64_tr_b16 v[108:109], v8 offset:2056
ds_read_b64_tr_b16 v[110:111], v8 offset:2568
v_mfma_f32_16x16x32_bf16 v[52:55], v[68:71], v[72:75], 0
v_mfma_f32_16x16x32_bf16 v[56:59], v[64:67], v[76:79], 0
v_mfma_f32_16x16x32_bf16 v[60:63], v[68:71], v[76:79], 0
s_waitcnt lgkmcnt(6)
s_nop 0
v_mfma_f32_16x16x32_bf16 v[48:51], v[80:83], v[88:91], v[48:51]
ds_read_b128 v[64:67], v9 offset:48
ds_read_b128 v[68:71], v9 offset:16688
ds_read_b64_tr_b16 v[72:73], v8 offset:3072
ds_read_b64_tr_b16 v[74:75], v8 offset:3584
ds_read_b64_tr_b16 v[76:77], v8 offset:3080
ds_read_b64_tr_b16 v[78:79], v8 offset:3592
v_mfma_f32_16x16x32_bf16 v[52:55], v[84:87], v[88:91], v[52:55]
v_mfma_f32_16x16x32_bf16 v[56:59], v[80:83], v[92:95], v[56:59]
v_mfma_f32_16x16x32_bf16 v[60:63], v[84:87], v[92:95], v[60:63]
s_waitcnt lgkmcnt(6)
s_nop 0
v_mfma_f32_16x16x32_bf16 v[48:51], v[96:99], v[104:107], v[48:51]
ds_read_b128 v[80:83], v9 offset:64
ds_read_b128 v[84:87], v9 offset:16704
ds_read_b64_tr_b16 v[88:89], v8 offset:4096
ds_read_b64_tr_b16 v[90:91], v8 offset:4608
ds_read_b64_tr_b16 v[92:93], v8 offset:4104
ds_read_b64_tr_b16 v[94:95], v8 offset:4616
v_mfma_f32_16x16x32_bf16 v[52:55], v[100:103], v[104:107], v[52:55]
v_mfma_f32_16x16x32_bf16 v[56:59], v[96:99], v[108:111], v[56:59]
v_mfma_f32_16x16x32_bf16 v[60:63], v[100:103], v[108:111], v[60:63]
s_waitcnt lgkmcnt(6)
s_nop 0
v_mfma_f32_16x16x32_bf16 v[48:51], v[64:67], v[72:75], v[48:51]
ds_read_b128 v[96:99], v9 offset:80
ds_read_b128 v[100:103], v9 offset:16720
ds_read_b64_tr_b16 v[104:105], v8 offset:5120
ds_read_b64_tr_b16 v[106:107], v8 offset:5632
ds_read_b64_tr_b16 v[108:109], v8 offset:5128
ds_read_b64_tr_b16 v[110:111], v8 offset:5640
v_mfma_f32_16x16x32_bf16 v[52:55], v[68:71], v[72:75], v[52:55]
v_mfma_f32_16x16x32_bf16 v[56:59], v[64:67], v[76:79], v[56:59]
v_mfma_f32_16x16x32_bf16 v[60:63], v[68:71], v[76:79], v[60:63]
s_waitcnt lgkmcnt(6)
s_nop 0
v_mfma_f32_16x16x32_bf16 v[48:51], v[80:83], v[88:91], v[48:51]
ds_read_b128 v[64:67], v9 offset:96
ds_read_b128 v[68:71], v9 offset:16736
ds_read_b64_tr_b16 v[72:73], v8 offset:6144
ds_read_b64_tr_b16 v[74:75], v8 offset:6656
ds_read_b64_tr_b16 v[76:77], v8 offset:6152
ds_read_b64_tr_b16 v[78:79], v8 offset:6664
v_mfma_f32_16x16x32_bf16 v[52:55], v[84:87], v[88:91], v[52:55]
v_mfma_f32_16x16x32_bf16 v[56:59], v[80:83], v[92:95], v[56:59]
v_mfma_f32_16x16x32_bf16 v[60:63], v[84:87], v[92:95], v[60:63]
s_waitcnt lgkmcnt(6)
s_nop 0
v_mfma_f32_16x16x32_bf16 v[48:51], v[96:99], v[104:107], v[48:51]
ds_read_b128 v[80:83], v9 offset:112
ds_read_b128 v[84:87], v9 offset:16752
ds_read_b64_tr_b16 v[88:89], v8 offset:7168
ds_read_b64_tr_b16 v[90:91], v8 offset:7680
ds_read_b64_tr_b16 v[92:93], v8 offset:7176
ds_read_b64_tr_b16 v[94:95], v8 offset:7688
v_mfma_f32_16x16x32_bf16 v[52:55], v[100:103], v[104:107], v[52:55]
v_mfma_f32_16x16x32_bf16 v[56:59], v[96:99], v[108:111], v[56:59]
v_mfma_f32_16x16x32_bf16 v[60:63], v[100:103], v[108:111], v[60:63]
s_waitcnt lgkmcnt(6)
s_nop 0
v_mfma_f32_16x16x32_bf16 v[48:51], v[64:67], v[72:75], v[48:51]
ds_read_b128 v[96:99], v9 offset:128
ds_read_b128 v[100:103], v9 offset:16768
ds_read_b64_tr_b16 v[104:105], v8 offset:8192
ds_read_b64_tr_b16 v[106:107], v8 offset:8704
ds_read_b64_tr_b16 v[108:109], v8 offset:8200
ds_read_b64_tr_b16 v[110:111], v8 offset:8712
v_mfma_f32_16x16x32_bf16 v[52:55], v[68:71], v[72:75], v[52:55]
v_mfma_f32_16x16x32_bf16 v[56:59], v[64:67], v[76:79], v[56:59]
v_mfma_f32_16x16x32_bf16 v[60:63], v[68:71], v[76:79], v[60:63]
s_waitcnt lgkmcnt(6)
s_nop 0
v_mfma_f32_16x16x32_bf16 v[48:51], v[80:83], v[88:91], v[48:51]
ds_read_b128 v[64:67], v9 offset:144
ds_read_b128 v[68:71], v9 offset:16784
ds_read_b64_tr_b16 v[72:73], v8 offset:9216
ds_read_b64_tr_b16 v[74:75], v8 offset:9728
ds_read_b64_tr_b16 v[76:77], v8 offset:9224
ds_read_b64_tr_b16 v[78:79], v8 offset:9736
v_mfma_f32_16x16x32_bf16 v[52:55], v[84:87], v[88:91], v[52:55]
v_mfma_f32_16x16x32_bf16 v[56:59], v[80:83], v[92:95], v[56:59]
v_mfma_f32_16x16x32_bf16 v[60:63], v[84:87], v[92:95], v[60:63]
s_waitcnt vmcnt(0)
s_mov_b64 exec, 1
buffer_store_dword v7, off, s[72:75], s51 sc1
s_mov_b64 exec, -1
v_cmp_ne_u32 vcc, v7, v14
s_cbranch_vccnz L_sp_4
L_bk_5:
s_waitcnt lgkmcnt(6)
v_mfma_f32_16x16x32_bf16 v[48:51], v[96:99], v[104:107], v[48:51]
ds_read_b128 v[80:83], v9 offset:160
ds_read_b128 v[84:87], v9 offset:16800
ds_read_b64_tr_b16 v[88:89], v8 offset:10240
ds_read_b64_tr_b16 v[90:91], v8 offset:10752
ds_read_b64_tr_b16 v[92:93], v8 offset:10248
ds_read_b64_tr_b16 v[94:95], v8 offset:10760
v_mfma_f32_16x16x32_bf16 v[52:55], v[100:103], v[104:107], v[52:55]
v_mfma_f32_16x16x32_bf16 v[56:59], v[96:99], v[108:111], v[56:59]
s_add_u32 s49, s48, 0
buffer_load_dwordx4 a[0:3], v1, s[12:15], s49 offen offset:0 sc1
v_mfma_f32_16x16x32_bf16 v[60:63], v[100:103], v[108:111], v[60:63]
buffer_load_dwordx4 a[4:7], v1, s[12:15], s49 offen offset:1024 sc1
s_waitcnt lgkmcnt(6)
v_mfma_f32_16x16x32_bf16 v[48:51], v[64:67], v[72:75], v[48:51]
ds_read_b128 v[96:99], v9 offset:176
ds_read_b128 v[100:103], v9 offset:16816
ds_read_b64_tr_b16 v[104:105], v8 offset:11264
ds_read_b64_tr_b16 v[106:107], v8 offset:11776
ds_read_b64_tr_b16 v[108:109], v8 offset:11272
ds_read_b64_tr_b16 v[110:111], v8 offset:11784
v_mfma_f32_16x16x32_bf16 v[52:55], v[68:71], v[72:75], v[52:55]
v_mfma_f32_16x16x32_bf16 v[56:59], v[64:67], v[76:79], v[56:59]
buffer_load_dwordx4 a[8:11], v1, s[12:15], s49 offen offset:2048 sc1
v_mfma_f32_16x16x32_bf16 v[60:63], v[68:71], v[76:79], v[60:63]
buffer_load_dwordx4 a[12:15], v1, s[12:15], s49 offen offset:3072 sc1
s_waitcnt lgkmcnt(6)
s_nop 0
v_mfma_f32_16x16x32_bf16 v[48:51], v[80:83], v[88:91], v[48:51]
ds_read_b128 v[64:67], v9 offset:192
ds_read_b128 v[68:71], v9 offset:16832
ds_read_b64_tr_b16 v[72:73], v8 offset:12288
ds_read_b64_tr_b16 v[74:75], v8 offset:12800
ds_read_b64_tr_b16 v[76:77], v8 offset:12296
ds_read_b64_tr_b16 v[78:79], v8 offset:12808
v_mfma_f32_16x16x32_bf16 v[52:55], v[84:87], v[88:91], v[52:55]
v_mfma_f32_16x16x32_bf16 v[56:59], v[80:83], v[92:95], v[56:59]
s_add_u32 s49, s48, 4096
buffer_load_dwordx4 a[16:19], v1, s[12:15], s49 offen offset:0 sc1
v_mfma_f32_16x16x32_bf16 v[60:63], v[84:87], v[92:95], v[60:63]
buffer_load_dwordx4 a[20:23], v1, s[12:15], s49 offen offset:1024 sc1
s_waitcnt lgkmcnt(6)
s_nop 0
v_mfma_f32_16x16x32_bf16 v[48:51], v[96:99], v[104:107], v[48:51]
ds_read_b128 v[80:83], v9 offset:208
ds_read_b128 v[84:87], v9 offset:16848
ds_read_b64_tr_b16 v[88:89], v8 offset:13312
ds_read_b64_tr_b16 v[90:91], v8 offset:13824
ds_read_b64_tr_b16 v[92:93], v8 offset:13320
ds_read_b64_tr_b16 v[94:95], v8 offset:13832
v_mfma_f32_16x16x32_bf16 v[52:55], v[100:103], v[104:107], v[52:55]
v_mfma_f32_16x16x32_bf16 v[56:59], v[96:99], v[108:111], v[56:59]
buffer_load_dwordx4 a[24:27], v1, s[12:15], s49 offen offset:2048 sc1
v_mfma_f32_16x16x32_bf16 v[60:63], v[100:103], v[108:111], v[60:63]
buffer_load_dwordx4 a[28:31], v1, s[12:15], s49 offen offset:3072 sc1
s_waitcnt lgkmcnt(6)
s_nop 0
v_mfma_f32_16x16x32_bf16 v[48:51], v[64:67], v[72:75], v[48:51]
ds_read_b128 v[96:99], v9 offset:224
ds_read_b128 v[100:103], v9 offset:16864
ds_read_b64_tr_b16 v[104:105], v8 offset:14336
ds_read_b64_tr_b16 v[106:107], v8 offset:14848
ds_read_b64_tr_b16 v[108:109], v8 offset:14344
ds_read_b64_tr_b16 v[110:111], v8 offset:14856
v_mfma_f32_16x16x32_bf16 v[52:55], v[68:71], v[72:75], v[52:55]
v_mfma_f32_16x16x32_bf16 v[56:59], v[64:67], v[76:79], v[56:59]
s_add_u32 s49, s48, 8192
buffer_load_dwordx4 a[32:35], v1, s[12:15], s49 offen offset:0 sc1
v_mfma_f32_16x16x32_bf16 v[60:63], v[68:71], v[76:79], v[60:63]
buffer_load_dwordx4 a[36:39], v1, s[12:15], s49 offen offset:1024 sc1
s_waitcnt lgkmcnt(6)
s_nop 0
v_mfma_f32_16x16x32_bf16 v[48:51], v[80:83], v[88:91], v[48:51]
ds_read_b128 v[64:67], v9 offset:240
ds_read_b128 v[68:71], v9 offset:16880
ds_read_b64_tr_b16 v[72:73], v8 offset:15360
ds_read_b64_tr_b16 v[74:75], v8 offset:15872
ds_read_b64_tr_b16 v[76:77], v8 offset:15368
ds_read_b64_tr_b16 v[78:79], v8 offset:15880
v_mfma_f32_16x16x32_bf16 v[52:55], v[84:87], v[88:91], v[52:55]
v_mfma_f32_16x16x32_bf16 v[56:59], v[80:83], v[92:95], v[56:59]
buffer_load_dwordx4 a[40:43], v1, s[12:15], s49 offen offset:2048 sc1
v_mfma_f32_16x16x32_bf16 v[60:63], v[84:87], v[92:95], v[60:63]
buffer_load_dwordx4 a[44:47], v1, s[12:15], s49 offen offset:3072 sc1
s_waitcnt lgkmcnt(6)
s_nop 0
v_mfma_f32_16x16x32_bf16 v[48:51], v[96:99], v[104:107], v[48:51]
v_mfma_f32_16x16x32_bf16 v[52:55], v[100:103], v[104:107], v[52:55]
v_mfma_f32_16x16x32_bf16 v[56:59], v[96:99], v[108:111], v[56:59]
s_add_u32 s49, s48, 12288
buffer_load_dwordx4 a[48:51], v1, s[12:15], s49 offen offset:0 sc1
v_mfma_f32_16x16x32_bf16 v[60:63], v[100:103], v[108:111], v[60:63]
buffer_load_dwordx4 a[52:55], v1, s[12:15], s49 offen offset:1024 sc1
s_waitcnt lgkmcnt(0)
s_nop 0
v_mfma_f32_16x16x32_bf16 v[48:51], v[64:67], v[72:75], v[48:51]
v_mfma_f32_16x16x32_bf16 v[52:55], v[68:71], v[72:75], v[52:55]
v_mfma_f32_16x16x32_bf16 v[56:59], v[64:67], v[76:79], v[56:59]
buffer_load_dwordx4 a[56:59], v1, s[12:15], s49 offen offset:2048 sc1
v_mfma_f32_16x16x32_bf16 v[60:63], v[68:71], v[76:79], v[60:63]
buffer_load_dwordx4 a[60:63], v1, s[12:15], s49 offen offset:3072 sc1
buffer_load_dword v4, v5, s[72:75], 0 offen sc1
s_barrier
s_lshl_b32 s69, s25, 2
s_lshl_b32 s27, s67, 1
s_add_u32 s69, s69, s27
s_lshl_b32 s70, s26, 1
s_add_u32 s70, s70, s66
s_lshl_b32 s28, s69, 14
s_lshl_b32 s29, s70, 10
s_add_u32 s28, s28, s29
s_add_u32 s28, s28, 77594624
s_lshr_b32 s29, s69, 3
s_lshl_b32 s29, s29, 4
s_add_u32 s29, s29, s70
s_lshl_b32 s29, s29, 13
s_and_b32 s27, s69, 7
s_lshl_b32 s27, s27, 10
s_add_u32 s29, s29, s27
s_add_u32 s29, s29, 81788928
s_cmp_eq_u32 s35, 0
s_cselect_b32 s28, s28, s29
s_cselect_b32 s29, 16, 1
s_lshl_b32 s29, s29, 10
s_add_u32 s29, s29, s28
L_pst:
s_nop 0
v_cvt_pk_bf16_f32 v176, v48, v49
v_cvt_pk_bf16_f32 v177, v50, v51
v_cvt_pk_bf16_f32 v178, v52, v53
v_cvt_pk_bf16_f32 v179, v54, v55
v_cvt_pk_bf16_f32 v180, v56, v57
v_cvt_pk_bf16_f32 v181, v58, v59
v_cvt_pk_bf16_f32 v182, v60, v61
v_cvt_pk_bf16_f32 v183, v62, v63
buffer_store_dwordx4 v[176:179], v1, s[12:15], s28 offen sc1
buffer_store_dwordx4 v[180:183], v1, s[12:15], s29 offen sc1
s_branch L_pd
L_notW:
s_sub_u32 s25, s31, 192
s_and_b32 s26, s25, 3
s_lshl_b32 s69, s25, 3
s_lshr_b32 s25, s25, 2
s_mov_b32 s52, s44
s_mov_b32 s53, s45
s_mov_b32 s54, 1048576
s_mov_b32 s55, 0x00020000
s_mov_b32 s56, s46
s_mov_b32 s57, s47
s_mov_b32 s58, 31744
s_mov_b32 s59, 0x00020000
s_mov_b32 s60, s40
s_mov_b32 s61, s41
s_mov_b32 s62, 524288
s_mov_b32 s63, 0x00020000
v_lshl_add_u32 v8, v4, 11, v5
s_lshl_b32 s28, s24, 18
s_lshl_b32 s27, s26, 16
s_add_u32 s28, s28, s27
s_lshl_b32 s27, s25, 7
s_add_u32 s28, s28, s27
s_lshl_b32 s27, s24, 12
s_lshl_b32 s35, s24, 1
s_add_u32 s69, s69, s35
s_lshr_b32 s35, s69, 4
s_lshl_b32 s35, s35, 14
s_and_b32 s29, s69, 15
s_lshl_b32 s29, s29, 6
s_add_u32 s35, s35, s29
v_lshlrev_b32 v9, 10, v2
v_lshl_add_u32 v9, v3, 4, v9
s_sub_u32 s70, s31, 248
s_lshl_b32 s70, s70, 2
s_add_u32 s70, s70, s24
s_cmp_ge_u32 s31, 248
s_cselect_b32 s70, s70, 0x8000
s_lshl_b32 s29, s70, 5
v_and_b32 v11, 1, v3
v_lshlrev_b32_e64 v11, 14, v11
v_lshl_add_u32 v11, v2, 1, v11
s_add_u32 m0, s27, 0
s_nop 0
buffer_load_dwordx4 v8, s[52:55], s28 offen lds
s_add_u32 m0, s27, 1024
s_add_u32 s28, s28, 16384
buffer_load_dwordx4 v8, s[52:55], s28 offen lds
s_add_u32 m0, s27, 2048
s_add_u32 s28, s28, 16384
buffer_load_dwordx4 v8, s[52:55], s28 offen lds
s_add_u32 m0, s27, 3072
s_add_u32 s28, s28, 16384
buffer_load_dwordx4 v8, s[52:55], s28 offen lds
buffer_load_dwordx4 v[128:131], v9, s[60:63], s35 offen offset:0
buffer_load_dwordx4 v[132:135], v9, s[60:63], s35 offen offset:64
buffer_load_ushort v136, v11, s[56:59], s29 offen offset:0
buffer_load_ushort v137, v11, s[56:59], s29 offen offset:1024
buffer_load_ushort v138, v11, s[56:59], s29 offen offset:2048
buffer_load_ushort v139, v11, s[56:59], s29 offen offset:3072
s_add_u32 s29, s29, 4096
buffer_load_ushort v140, v11, s[56:59], s29 offen offset:0
buffer_load_ushort v141, v11, s[56:59], s29 offen offset:1024
buffer_load_ushort v142, v11, s[56:59], s29 offen offset:2048
buffer_load_ushort v143, v11, s[56:59], s29 offen offset:3072
s_add_u32 s29, s29, 4096
buffer_load_ushort v144, v11, s[56:59], s29 offen offset:0
buffer_load_ushort v145, v11, s[56:59], s29 offen offset:1024
buffer_load_ushort v146, v11, s[56:59], s29 offen offset:2048
buffer_load_ushort v147, v11, s[56:59], s29 offen offset:3072
s_add_u32 s29, s29, 4096
buffer_load_ushort v148, v11, s[56:59], s29 offen offset:0
buffer_load_ushort v149, v11, s[56:59], s29 offen offset:1024
buffer_load_ushort v150, v11, s[56:59], s29 offen offset:2048
buffer_load_ushort v151, v11, s[56:59], s29 offen offset:3072
s_mov_b32 s8, s4
s_mov_b32 s9, s5
s_mov_b32 s10, 8192000
s_mov_b32 s11, 0x00020000
s_mov_b32 s12, s4
s_mov_b32 s13, s5
s_mov_b32 s14, 268435456
s_mov_b32 s15, 0x00020000
s_add_u32 s72, s4, 80740352
s_addc_u32 s73, s5, 0
s_mov_b32 s74, 36928
s_mov_b32 s75, 0x00020000
s_lshl_b32 s48, s32, 2
s_add_u32 s48, s48, s24
s_lshr_b32 s47, s48, 1
s_lshl_b32 s48, s48, 15
s_add_u32 s48, s48, 76546048
s_lshl_b32 s50, s47, 7
s_add_u32 s50, s50, 28672
s_lshl_b32 s47, s47, 7
s_add_u32 s47, s47, 32768
s_lshl_b32 s39, s30, 6
s_add_u32 s39, s39, 24576
v_mov_b32_e64 v15, s47
v_add_u32 v14, 1024, v15
v_cmp_gt_u32 vcc, 32, v0
v_lshlrev_b32 v4, 2, v2
v_add_u32 v5, s39, v4
v_cndmask_b32 v15, v15, v14, vcc
v_add_u32_e64 v15, v4, v15
s_lshl_b32 s51, s32, 4
s_add_u32 s51, s51, s39
s_lshl_b32 s39, s24, 2
s_add_u32 s51, s51, s39
s_lshl_b32 s68, s68, 4
s_add_u32 s68, s68, s39
s_add_u32 s68, s68, 28672
s_mov_b32 s36, 0xffff0000
s_mov_b32 s37, 989855744
s_mov_b32 s38, 0x3f803f80
v_mov_b32 v10, 925353388
s_waitcnt lgkmcnt(0)
s_mul_i32 s71, s71, 0x9E3779B1
s_add_u32 s71, s71, 0x7F4A7C15
v_mov_b32 v7, s71
v_bfe_u32 v6, v0, 2, 2
v_lshl_add_u32 v8, v3, 5, v6
v_lshlrev_b32 v8, 7, v8
v_and_b32 v9, 3, v0
v_and_b32 v6, 2, v6
v_lshlrev_b32 v6, 5, v6
s_cmp_lt_u32 s25, 8
s_cselect_b32 s27, 3, 4
s_cselect_b32 s28, 32, 8
v_lshlrev_b32 v9, s27, v9
v_add_u32 v8, v8, v9
s_lshl_b32 s27, s24, 10
v_add_u32 v8, s27, v8
v_add_u32 v9, v8, v6
v_add_u32 v11, s28, v9
v_xor_b32 v6, 64, v6
v_add_u32_e64 v12, v8, v6
v_add_u32 v13, s28, v12
s_lshl_b32 s28, s25, 16
s_add_u32 s28, s28, 76021760
s_lshl_b32 s29, s26, 2
s_add_u32 s29, s29, s24
s_lshl_b32 s35, s29, 2
s_lshl_b32 s29, s29, 11
s_add_u32 s28, s28, s29
s_add_u32 s29, s28, 32768
s_lshl_b32 s27, s25, 7
s_add_u32 s35, s35, s27
s_add_u32 s35, s35, 32768
s_waitcnt vmcnt(18)
s_barrier
s_nop 0
ds_read_b64_tr_b16 v[160:161], v9 offset:0
ds_read_b64_tr_b16 v[162:163], v9 offset:512
ds_read_b64_tr_b16 v[164:165], v11 offset:0
ds_read_b64_tr_b16 v[166:167], v11 offset:512
ds_read_b64_tr_b16 v[168:169], v12 offset:0
ds_read_b64_tr_b16 v[170:171], v12 offset:512
ds_read_b64_tr_b16 v[172:173], v13 offset:0
ds_read_b64_tr_b16 v[174:175], v13 offset:512
s_waitcnt lgkmcnt(0)
s_nop 0
buffer_store_dwordx4 v[160:163], v1, s[12:15], s28 offen offset:0 sc1
buffer_store_dwordx4 v[164:167], v1, s[12:15], s28 offen offset:1024 sc1
buffer_store_dwordx4 v[168:171], v1, s[12:15], s29 offen offset:0 sc1
buffer_store_dwordx4 v[172:175], v1, s[12:15], s29 offen offset:1024 sc1
v_dot2_f32_bf16 v112, v16, s38, 0
v_dot2_f32_bf16 v113, v20, s38, 0
v_dot2_f32_bf16 v114, v24, s38, 0
v_dot2_f32_bf16 v115, v28, s38, 0
v_dot2_f32_bf16 v116, v32, s38, 0
v_dot2_f32_bf16 v117, v36, s38, 0
v_dot2_f32_bf16 v118, v40, s38, 0
v_dot2_f32_bf16 v119, v44, s38, 0
v_dot2_f32_bf16 v112, v17, s38, v112
v_dot2_f32_bf16 v113, v21, s38, v113
v_dot2_f32_bf16 v114, v25, s38, v114
v_dot2_f32_bf16 v115, v29, s38, v115
v_dot2_f32_bf16 v116, v33, s38, v116
v_dot2_f32_bf16 v117, v37, s38, v117
v_dot2_f32_bf16 v118, v41, s38, v118
v_dot2_f32_bf16 v119, v45, s38, v119
v_dot2_f32_bf16 v112, v18, s38, v112
v_dot2_f32_bf16 v113, v22, s38, v113
v_dot2_f32_bf16 v114, v26, s38, v114
v_dot2_f32_bf16 v115, v30, s38, v115
v_dot2_f32_bf16 v116, v34, s38, v116
v_dot2_f32_bf16 v117, v38, s38, v117
v_dot2_f32_bf16 v118, v42, s38, v118
v_dot2_f32_bf16 v119, v46, s38, v119
v_dot2_f32_bf16 v112, v19, s38, v112
v_dot2_f32_bf16 v113, v23, s38, v113
v_dot2_f32_bf16 v114, v27, s38, v114
v_dot2_f32_bf16 v115, v31, s38, v115
v_dot2_f32_bf16 v116, v35, s38, v116
v_dot2_f32_bf16 v117, v39, s38, v117
v_dot2_f32_bf16 v118, v43, s38, v118
v_dot2_f32_bf16 v119, v47, s38, v119
v_lshlrev_b32 v48, 16, v16
v_and_b32 v49, s36, v16
v_lshlrev_b32 v50, 16, v17
v_and_b32 v51, s36, v17
v_lshlrev_b32 v52, 16, v18
v_and_b32 v53, s36, v18
v_lshlrev_b32 v54, 16, v19
v_and_b32 v55, s36, v19
v_lshlrev_b32 v56, 16, v20
v_and_b32 v57, s36, v20
v_lshlrev_b32 v58, 16, v21
v_and_b32 v59, s36, v21
v_lshlrev_b32 v60, 16, v22
v_and_b32 v61, s36, v22
v_lshlrev_b32 v62, 16, v23
v_and_b32 v63, s36, v23
v_lshlrev_b32 v64, 16, v24
v_and_b32 v65, s36, v24
v_lshlrev_b32 v66, 16, v25
v_and_b32 v67, s36, v25
v_lshlrev_b32 v68, 16, v26
v_and_b32 v69, s36, v26
v_lshlrev_b32 v70, 16, v27
v_and_b32 v71, s36, v27
v_lshlrev_b32 v72, 16, v28
v_and_b32 v73, s36, v28
v_lshlrev_b32 v74, 16, v29
v_and_b32 v75, s36, v29
v_lshlrev_b32 v76, 16, v30
v_and_b32 v77, s36, v30
v_lshlrev_b32 v78, 16, v31
v_and_b32 v79, s36, v31
s_nop 1
v_permlane32_swap_b32 v112, v113
v_permlane32_swap_b32 v114, v115
v_permlane32_swap_b32 v116, v117
v_permlane32_swap_b32 v118, v119
v_add_f32 v112, v112, v113
v_add_f32 v114, v114, v115
v_add_f32 v116, v116, v117
v_add_f32 v118, v118, v119
s_nop 0
v_permlane16_swap_b32 v112, v114
v_permlane16_swap_b32 v116, v118
v_add_f32_e64 v112, v112, v114
v_add_f32 v116, v116, v118
s_nop 0
v_add_f32_dpp v112, v112, v112 row_ror:8 row_mask:0xf bank_mask:0xf
v_add_f32_dpp v116, v116, v116 row_ror:8 row_mask:0xf bank_mask:0xf
s_nop 0
v_add_f32_dpp v112, v112, v112 row_ror:4 row_mask:0xf bank_mask:0xf
v_add_f32_dpp v116, v116, v116 row_ror:4 row_mask:0xf bank_mask:0xf
s_nop 0
v_add_f32_dpp v112, v112, v112 row_ror:2 row_mask:0xf bank_mask:0xf
v_add_f32_dpp v116, v116, v116 row_ror:2 row_mask:0xf bank_mask:0xf
s_nop 0
v_add_f32_dpp v112, v112, v112 row_ror:1 row_mask:0xf bank_mask:0xf
v_add_f32_dpp v116, v116, v116 row_ror:1 row_mask:0xf bank_mask:0xf
v_mul_f32 v112, s37, v112
v_mul_f32 v116, s37, v116
s_nop 0
v_readlane_b32 s40, v112, 0
v_readlane_b32 s41, v112, 32
v_readlane_b32 s42, v112, 16
v_readlane_b32 s43, v112, 48
v_readlane_b32 s44, v116, 0
v_readlane_b32 s45, v116, 32
v_readlane_b32 s46, v116, 16
v_readlane_b32 s47, v116, 48
v_lshlrev_b32 v80, 16, v32
v_and_b32 v81, s36, v32
v_lshlrev_b32 v82, 16, v33
v_and_b32 v83, s36, v33
v_lshlrev_b32 v84, 16, v34
v_and_b32 v85, s36, v34
v_lshlrev_b32 v86, 16, v35
v_and_b32 v87, s36, v35
v_lshlrev_b32 v88, 16, v36
v_and_b32 v89, s36, v36
v_lshlrev_b32 v90, 16, v37
v_and_b32 v91, s36, v37
v_lshlrev_b32 v92, 16, v38
v_and_b32 v93, s36, v38
v_lshlrev_b32 v94, 16, v39
v_and_b32 v95, s36, v39
v_lshlrev_b32 v96, 16, v40
v_and_b32 v97, s36, v40
v_lshlrev_b32 v98, 16, v41
v_and_b32 v99, s36, v41
v_lshlrev_b32 v100, 16, v42
v_and_b32 v101, s36, v42
v_lshlrev_b32 v102, 16, v43
v_and_b32 v103, s36, v43
v_lshlrev_b32 v104, 16, v44
v_and_b32 v105, s36, v44
v_lshlrev_b32 v106, 16, v45
v_and_b32 v107, s36, v45
v_lshlrev_b32 v108, 16, v46
v_and_b32 v109, s36, v46
v_lshlrev_b32 v110, 16, v47
v_and_b32 v111, s36, v47
v_pk_add_f32 v[48:49], v[48:49], s[40:41] op_sel:[0,0] op_sel_hi:[1,0] neg_lo:[0,1] neg_hi:[0,1]
v_pk_add_f32 v[50:51], v[50:51], s[40:41] op_sel:[0,0] op_sel_hi:[1,0] neg_lo:[0,1] neg_hi:[0,1]
v_pk_add_f32 v[52:53], v[52:53], s[40:41] op_sel:[0,0] op_sel_hi:[1,0] neg_lo:[0,1] neg_hi:[0,1]
v_pk_add_f32 v[54:55], v[54:55], s[40:41] op_sel:[0,0] op_sel_hi:[1,0] neg_lo:[0,1] neg_hi:[0,1]
v_pk_add_f32 v[56:57], v[56:57], s[40:41] op_sel:[0,1] op_sel_hi:[1,1] neg_lo:[0,1] neg_hi:[0,1]
v_pk_add_f32 v[58:59], v[58:59], s[40:41] op_sel:[0,1] op_sel_hi:[1,1] neg_lo:[0,1] neg_hi:[0,1]
v_pk_add_f32 v[60:61], v[60:61], s[40:41] op_sel:[0,1] op_sel_hi:[1,1] neg_lo:[0,1] neg_hi:[0,1]
v_pk_add_f32 v[62:63], v[62:63], s[40:41] op_sel:[0,1] op_sel_hi:[1,1] neg_lo:[0,1] neg_hi:[0,1]
v_pk_add_f32 v[64:65], v[64:65], s[42:43] op_sel:[0,0] op_sel_hi:[1,0] neg_lo:[0,1] neg_hi:[0,1]
v_pk_add_f32 v[66:67], v[66:67], s[42:43] op_sel:[0,0] op_sel_hi:[1,0] neg_lo:[0,1] neg_hi:[0,1]
v_pk_add_f32 v[68:69], v[68:69], s[42:43] op_sel:[0,0] op_sel_hi:[1,0] neg_lo:[0,1] neg_hi:[0,1]
v_pk_add_f32 v[70:71], v[70:71], s[42:43] op_sel:[0,0] op_sel_hi:[1,0] neg_lo:[0,1] neg_hi:[0,1]
v_pk_add_f32 v[72:73], v[72:73], s[42:43] op_sel:[0,1] op_sel_hi:[1,1] neg_lo:[0,1] neg_hi:[0,1]
v_pk_add_f32 v[74:75], v[74:75], s[42:43] op_sel:[0,1] op_sel_hi:[1,1] neg_lo:[0,1] neg_hi:[0,1]
v_pk_add_f32 v[76:77], v[76:77], s[42:43] op_sel:[0,1] op_sel_hi:[1,1] neg_lo:[0,1] neg_hi:[0,1]
v_pk_add_f32 v[78:79], v[78:79], s[42:43] op_sel:[0,1] op_sel_hi:[1,1] neg_lo:[0,1] neg_hi:[0,1]
v_pk_add_f32 v[80:81], v[80:81], s[44:45] op_sel:[0,0] op_sel_hi:[1,0] neg_lo:[0,1] neg_hi:[0,1]
v_pk_add_f32 v[82:83], v[82:83], s[44:45] op_sel:[0,0] op_sel_hi:[1,0] neg_lo:[0,1] neg_hi:[0,1]
v_pk_add_f32 v[84:85], v[84:85], s[44:45] op_sel:[0,0] op_sel_hi:[1,0] neg_lo:[0,1] neg_hi:[0,1]
v_pk_add_f32 v[86:87], v[86:87], s[44:45] op_sel:[0,0] op_sel_hi:[1,0] neg_lo:[0,1] neg_hi:[0,1]
v_pk_add_f32 v[88:89], v[88:89], s[44:45] op_sel:[0,1] op_sel_hi:[1,1] neg_lo:[0,1] neg_hi:[0,1]
v_pk_add_f32 v[90:91], v[90:91], s[44:45] op_sel:[0,1] op_sel_hi:[1,1] neg_lo:[0,1] neg_hi:[0,1]
v_pk_add_f32 v[92:93], v[92:93], s[44:45] op_sel:[0,1] op_sel_hi:[1,1] neg_lo:[0,1] neg_hi:[0,1]
v_pk_add_f32 v[94:95], v[94:95], s[44:45] op_sel:[0,1] op_sel_hi:[1,1] neg_lo:[0,1] neg_hi:[0,1]
v_pk_add_f32 v[96:97], v[96:97], s[46:47] op_sel:[0,0] op_sel_hi:[1,0] neg_lo:[0,1] neg_hi:[0,1]
v_pk_add_f32 v[98:99], v[98:99], s[46:47] op_sel:[0,0] op_sel_hi:[1,0] neg_lo:[0,1] neg_hi:[0,1]
v_pk_add_f32 v[100:101], v[100:101], s[46:47] op_sel:[0,0] op_sel_hi:[1,0] neg_lo:[0,1] neg_hi:[0,1]
v_pk_add_f32 v[102:103], v[102:103], s[46:47] op_sel:[0,0] op_sel_hi:[1,0] neg_lo:[0,1] neg_hi:[0,1]
v_pk_add_f32 v[104:105], v[104:105], s[46:47] op_sel:[0,1] op_sel_hi:[1,1] neg_lo:[0,1] neg_hi:[0,1]
v_pk_add_f32 v[106:107], v[106:107], s[46:47] op_sel:[0,1] op_sel_hi:[1,1] neg_lo:[0,1] neg_hi:[0,1]
v_pk_add_f32 v[108:109], v[108:109], s[46:47] op_sel:[0,1] op_sel_hi:[1,1] neg_lo:[0,1] neg_hi:[0,1]
v_pk_add_f32 v[110:111], v[110:111], s[46:47] op_sel:[0,1] op_sel_hi:[1,1] neg_lo:[0,1] neg_hi:[0,1]
v_pk_mul_f32 v[16:17], v[48:49], v[48:49]
v_pk_mul_f32 v[18:19], v[56:57], v[56:57]
v_pk_mul_f32 v[20:21], v[64:65], v[64:65]
v_pk_mul_f32 v[22:23], v[72:73], v[72:73]
v_pk_mul_f32 v[24:25], v[80:81], v[80:81]
v_pk_mul_f32 v[26:27], v[88:89], v[88:89]
v_pk_mul_f32 v[28:29], v[96:97], v[96:97]
v_pk_mul_f32 v[30:31], v[104:105], v[104:105]
v_pk_fma_f32 v[16:17], v[50:51], v[50:51], v[16:17]
v_pk_fma_f32 v[18:19], v[58:59], v[58:59], v[18:19]
v_pk_fma_f32 v[20:21], v[66:67], v[66:67], v[20:21]
v_pk_fma_f32 v[22:23], v[74:75], v[74:75], v[22:23]
v_pk_fma_f32 v[24:25], v[82:83], v[82:83], v[24:25]
v_pk_fma_f32 v[26:27], v[90:91], v[90:91], v[26:27]
v_pk_fma_f32 v[28:29], v[98:99], v[98:99], v[28:29]
v_pk_fma_f32 v[30:31], v[106:107], v[106:107], v[30:31]
v_pk_fma_f32 v[16:17], v[52:53], v[52:53], v[16:17]
v_pk_fma_f32 v[18:19], v[60:61], v[60:61], v[18:19]
v_pk_fma_f32 v[20:21], v[68:69], v[68:69], v[20:21]
v_pk_fma_f32 v[22:23], v[76:77], v[76:77], v[22:23]
v_pk_fma_f32 v[24:25], v[84:85], v[84:85], v[24:25]
v_pk_fma_f32 v[26:27], v[92:93], v[92:93], v[26:27]
v_pk_fma_f32 v[28:29], v[100:101], v[100:101], v[28:29]
v_pk_fma_f32 v[30:31], v[108:109], v[108:109], v[30:31]
v_pk_fma_f32 v[16:17], v[54:55], v[54:55], v[16:17]
v_pk_fma_f32 v[18:19], v[62:63], v[62:63], v[18:19]
v_pk_fma_f32 v[20:21], v[70:71], v[70:71], v[20:21]
v_pk_fma_f32 v[22:23], v[78:79], v[78:79], v[22:23]
v_pk_fma_f32 v[24:25], v[86:87], v[86:87], v[24:25]
v_pk_fma_f32 v[26:27], v[94:95], v[94:95], v[26:27]
v_pk_fma_f32 v[28:29], v[102:103], v[102:103], v[28:29]
v_pk_fma_f32 v[30:31], v[110:111], v[110:111], v[30:31]
v_add_f32 v112, v16, v17
v_add_f32 v113, v18, v19
v_add_f32 v114, v20, v21
v_add_f32 v115, v22, v23
v_add_f32 v116, v24, v25
v_add_f32 v117, v26, v27
v_add_f32 v118, v28, v29
v_add_f32 v119, v30, v31
s_nop 1
v_permlane32_swap_b32 v112, v113
v_permlane32_swap_b32 v114, v115
v_permlane32_swap_b32 v116, v117
v_permlane32_swap_b32 v118, v119
v_add_f32 v112, v112, v113
v_add_f32 v114, v114, v115
v_add_f32 v116, v116, v117
v_add_f32 v118, v118, v119
s_nop 0
v_permlane16_swap_b32 v112, v114
v_permlane16_swap_b32 v116, v118
v_add_f32_e64 v112, v112, v114
v_add_f32 v116, v116, v118
s_nop 0
v_add_f32_dpp v112, v112, v112 row_ror:8 row_mask:0xf bank_mask:0xf
v_add_f32_dpp v116, v116, v116 row_ror:8 row_mask:0xf bank_mask:0xf
s_nop 0
v_add_f32_dpp v112, v112, v112 row_ror:4 row_mask:0xf bank_mask:0xf
v_add_f32_dpp v116, v116, v116 row_ror:4 row_mask:0xf bank_mask:0xf
s_nop 0
v_add_f32_dpp v112, v112, v112 row_ror:2 row_mask:0xf bank_mask:0xf
v_add_f32_dpp v116, v116, v116 row_ror:2 row_mask:0xf bank_mask:0xf
s_nop 0
v_add_f32_dpp v112, v112, v112 row_ror:1 row_mask:0xf bank_mask:0xf
v_add_f32_dpp v116, v116, v116 row_ror:1 row_mask:0xf bank_mask:0xf
v_fma_f32 v112, v112, s37, v10
v_fma_f32 v116, v116, s37, v10
v_rsq_f32 v112, v112
v_rsq_f32 v116, v116
s_nop 0
v_readlane_b32 s40, v112, 0
v_readlane_b32 s41, v112, 32
v_readlane_b32 s42, v112, 16
v_readlane_b32 s43, v112, 48
v_readlane_b32 s44, v116, 0
v_readlane_b32 s45, v116, 32
v_readlane_b32 s46, v116, 16
v_readlane_b32 s47, v116, 48
s_nop 0
s_nop 0
v_pk_mul_f32 v[48:49], v[48:49], s[40:41] op_sel:[0,0] op_sel_hi:[1,0]
v_pk_mul_f32 v[50:51], v[50:51], s[40:41] op_sel:[0,0] op_sel_hi:[1,0]
v_pk_mul_f32 v[52:53], v[52:53], s[40:41] op_sel:[0,0] op_sel_hi:[1,0]
v_pk_mul_f32 v[54:55], v[54:55], s[40:41] op_sel:[0,0] op_sel_hi:[1,0]
v_cvt_pk_bf16_f32 v16, v48, v49
v_cvt_pk_bf16_f32 v17, v50, v51
v_cvt_pk_bf16_f32 v18, v52, v53
v_cvt_pk_bf16_f32 v19, v54, v55
s_waitcnt vmcnt(0)
s_mov_b64 exec, 1
buffer_store_dword v7, off, s[72:75], s35 sc1
s_mov_b64 exec, -1
s_nop 0
buffer_store_dwordx4 v[16:19], v1, s[8:11], s64 offen offset:0 sc1
v_pk_mul_f32 v[56:57], v[56:57], s[40:41] op_sel:[0,1] op_sel_hi:[1,1]
v_pk_mul_f32 v[58:59], v[58:59], s[40:41] op_sel:[0,1] op_sel_hi:[1,1]
v_pk_mul_f32 v[60:61], v[60:61], s[40:41] op_sel:[0,1] op_sel_hi:[1,1]
v_pk_mul_f32 v[62:63], v[62:63], s[40:41] op_sel:[0,1] op_sel_hi:[1,1]
v_cvt_pk_bf16_f32 v20, v56, v57
v_cvt_pk_bf16_f32 v21, v58, v59
v_cvt_pk_bf16_f32 v22, v60, v61
v_cvt_pk_bf16_f32 v23, v62, v63
buffer_store_dwordx4 v[20:23], v1, s[8:11], s64 offen offset:1024 sc1
v_pk_mul_f32 v[64:65], v[64:65], s[42:43] op_sel:[0,0] op_sel_hi:[1,0]
v_pk_mul_f32 v[66:67], v[66:67], s[42:43] op_sel:[0,0] op_sel_hi:[1,0]
v_pk_mul_f32 v[68:69], v[68:69], s[42:43] op_sel:[0,0] op_sel_hi:[1,0]
v_pk_mul_f32 v[70:71], v[70:71], s[42:43] op_sel:[0,0] op_sel_hi:[1,0]
v_cvt_pk_bf16_f32 v24, v64, v65
v_cvt_pk_bf16_f32 v25, v66, v67
v_cvt_pk_bf16_f32 v26, v68, v69
v_cvt_pk_bf16_f32 v27, v70, v71
buffer_store_dwordx4 v[24:27], v1, s[8:11], s64 offen offset:2048 sc1
v_pk_mul_f32 v[72:73], v[72:73], s[42:43] op_sel:[0,1] op_sel_hi:[1,1]
v_pk_mul_f32 v[74:75], v[74:75], s[42:43] op_sel:[0,1] op_sel_hi:[1,1]
v_pk_mul_f32 v[76:77], v[76:77], s[42:43] op_sel:[0,1] op_sel_hi:[1,1]
v_pk_mul_f32 v[78:79], v[78:79], s[42:43] op_sel:[0,1] op_sel_hi:[1,1]
v_cvt_pk_bf16_f32 v28, v72, v73
v_cvt_pk_bf16_f32 v29, v74, v75
v_cvt_pk_bf16_f32 v30, v76, v77
v_cvt_pk_bf16_f32 v31, v78, v79
buffer_store_dwordx4 v[28:31], v1, s[8:11], s64 offen offset:3072 sc1
v_pk_mul_f32 v[80:81], v[80:81], s[44:45] op_sel:[0,0] op_sel_hi:[1,0]
v_pk_mul_f32 v[82:83], v[82:83], s[44:45] op_sel:[0,0] op_sel_hi:[1,0]
v_pk_mul_f32 v[84:85], v[84:85], s[44:45] op_sel:[0,0] op_sel_hi:[1,0]
v_pk_mul_f32 v[86:87], v[86:87], s[44:45] op_sel:[0,0] op_sel_hi:[1,0]
v_cvt_pk_bf16_f32 v32, v80, v81
v_cvt_pk_bf16_f32 v33, v82, v83
v_cvt_pk_bf16_f32 v34, v84, v85
v_cvt_pk_bf16_f32 v35, v86, v87
buffer_store_dwordx4 v[32:35], v1, s[8:11], s65 offen offset:0 sc1
v_pk_mul_f32 v[88:89], v[88:89], s[44:45] op_sel:[0,1] op_sel_hi:[1,1]
v_pk_mul_f32 v[90:91], v[90:91], s[44:45] op_sel:[0,1] op_sel_hi:[1,1]
v_pk_mul_f32 v[92:93], v[92:93], s[44:45] op_sel:[0,1] op_sel_hi:[1,1]
v_pk_mul_f32 v[94:95], v[94:95], s[44:45] op_sel:[0,1] op_sel_hi:[1,1]
v_cvt_pk_bf16_f32 v36, v88, v89
v_cvt_pk_bf16_f32 v37, v90, v91
v_cvt_pk_bf16_f32 v38, v92, v93
v_cvt_pk_bf16_f32 v39, v94, v95
buffer_store_dwordx4 v[36:39], v1, s[8:11], s65 offen offset:1024 sc1
v_pk_mul_f32 v[96:97], v[96:97], s[46:47] op_sel:[0,0] op_sel_hi:[1,0]
v_pk_mul_f32 v[98:99], v[98:99], s[46:47] op_sel:[0,0] op_sel_hi:[1,0]
v_pk_mul_f32 v[100:101], v[100:101], s[46:47] op_sel:[0,0] op_sel_hi:[1,0]
v_pk_mul_f32 v[102:103], v[102:103], s[46:47] op_sel:[0,0] op_sel_hi:[1,0]
v_cvt_pk_bf16_f32 v40, v96, v97
v_cvt_pk_bf16_f32 v41, v98, v99
v_cvt_pk_bf16_f32 v42, v100, v101
v_cvt_pk_bf16_f32 v43, v102, v103
buffer_store_dwordx4 v[40:43], v1, s[8:11], s65 offen offset:2048 sc1
v_pk_mul_f32 v[104:105], v[104:105], s[46:47] op_sel:[0,1] op_sel_hi:[1,1]
v_pk_mul_f32 v[106:107], v[106:107], s[46:47] op_sel:[0,1] op_sel_hi:[1,1]
v_pk_mul_f32 v[108:109], v[108:109], s[46:47] op_sel:[0,1] op_sel_hi:[1,1]
v_pk_mul_f32 v[110:111], v[110:111], s[46:47] op_sel:[0,1] op_sel_hi:[1,1]
v_cvt_pk_bf16_f32 v44, v104, v105
v_cvt_pk_bf16_f32 v45, v106, v107
v_cvt_pk_bf16_f32 v46, v108, v109
v_cvt_pk_bf16_f32 v47, v110, v111
buffer_store_dwordx4 v[44:47], v1, s[8:11], s65 offen offset:3072 sc1
v_lshl_or_b32 v64, v137, 16, v136
v_lshl_or_b32 v65, v139, 16, v138
v_lshl_or_b32 v66, v141, 16, v140
v_lshl_or_b32 v67, v143, 16, v142
v_lshl_or_b32 v68, v145, 16, v144
v_lshl_or_b32 v69, v147, 16, v146
v_lshl_or_b32 v70, v149, 16, v148
v_lshl_or_b32 v71, v151, 16, v150
s_lshl_b32 s69, s69, 10
s_add_u32 s69, s69, 78118912
buffer_store_dwordx4 v[128:131], v1, s[12:15], s69 offen offset:0 sc1
buffer_store_dwordx4 v[132:135], v1, s[12:15], s69 offen offset:1024 sc1
s_add_u32 s56, s4, 79691776
s_addc_u32 s57, s5, 0
s_mov_b32 s58, 65536
s_mov_b32 s59, 0x00020000
s_lshl_b32 s70, s70, 11
buffer_store_dwordx4 v[64:67], v1, s[56:59], s70 offen offset:0 sc1
buffer_store_dwordx4 v[68:71], v1, s[56:59], s70 offen offset:1024 sc1
s_barrier
s_waitcnt vmcnt(0)
s_mov_b64 exec, 1
buffer_store_dword v7, off, s[72:75], s51 sc1
s_mov_b64 exec, -1
s_mov_b64 exec, 1
buffer_store_dword v7, off, s[72:75], s68 sc1
s_mov_b64 exec, -1
buffer_load_dword v14, v15, s[72:75], 0 offen sc1
s_waitcnt vmcnt(0)
v_cmp_ne_u32_e64 vcc, v7, v14
s_cbranch_vccnz L_sp_6
L_bk_7:
s_add_u32 s49, s48, 0
buffer_load_dwordx4 a[0:3], v1, s[12:15], s49 offen offset:0 sc1
buffer_load_dwordx4 a[4:7], v1, s[12:15], s49 offen offset:1024 sc1
buffer_load_dwordx4 a[8:11], v1, s[12:15], s49 offen offset:2048 sc1
buffer_load_dwordx4 a[12:15], v1, s[12:15], s49 offen offset:3072 sc1
s_add_u32 s49, s48, 4096
buffer_load_dwordx4 a[16:19], v1, s[12:15], s49 offen offset:0 sc1
buffer_load_dwordx4 a[20:23], v1, s[12:15], s49 offen offset:1024 sc1
buffer_load_dwordx4 a[24:27], v1, s[12:15], s49 offen offset:2048 sc1
buffer_load_dwordx4 a[28:31], v1, s[12:15], s49 offen offset:3072 sc1
s_add_u32 s49, s48, 8192
buffer_load_dwordx4 a[32:35], v1, s[12:15], s49 offen offset:0 sc1
buffer_load_dwordx4 a[36:39], v1, s[12:15], s49 offen offset:1024 sc1
buffer_load_dwordx4 a[40:43], v1, s[12:15], s49 offen offset:2048 sc1
buffer_load_dwordx4 a[44:47], v1, s[12:15], s49 offen offset:3072 sc1
s_add_u32 s49, s48, 12288
buffer_load_dwordx4 a[48:51], v1, s[12:15], s49 offen offset:0 sc1
buffer_load_dwordx4 a[52:55], v1, s[12:15], s49 offen offset:1024 sc1
buffer_load_dwordx4 a[56:59], v1, s[12:15], s49 offen offset:2048 sc1
buffer_load_dwordx4 a[60:63], v1, s[12:15], s49 offen offset:3072 sc1
buffer_load_dword v4, v5, s[72:75], 0 offen sc1
s_mov_b32 s68, 0x100000
s_mov_b64 exec, 1
buffer_store_dword v7, off, s[72:75], s68 sc1
s_mov_b64 exec, -1
s_mov_b64 exec, 1
buffer_store_dword v7, off, s[72:75], s68 sc1
s_mov_b64 exec, -1
L_pd:
s_mov_b32 s6, s68
s_mov_b32 s7, s50
s_mul_i32 s25, s33, 4000
s_lshl_b32 s39, s34, 7
s_add_u32 s25, s25, s39
s_lshl_b32 s39, s24, 3
s_add_u32 s25, s25, s39
s_lshl_b32 s25, s25, 10
s_mul_i32 s35, s24, 8320
s_sub_u32 s35, s35, 65536
s_cmp_gt_u32 s32, 0
s_cselect_b32 s38, 1, 0
s_cselect_b32 s39, 33280, 0
s_add_u32 s27, s35, s39
s_cmp_gt_u32 s32, 0
s_cselect_b32 s28, 0, 99840
s_add_u32 s28, s28, s35
s_lshl_b32 s45, s32, 2
s_add_u32 s45, s45, s24
s_lshl_b32 s46, s45, 15
s_add_u32 s46, s46, 75497472
s_waitcnt vmcnt(2)
v_cmp_ne_u32 vcc, v7, v4
s_cbranch_vccnz L_sp_8
L_bk_9:
s_add_u32 m0, s27, 65536
s_add_u32 s29, s25, 4096
buffer_load_dwordx4 v1, s[8:11], s25 offen offset:0 sc1 lds
s_add_u32 m0, s27, 65552
s_nop 0
buffer_load_dwordx4 v1, s[8:11], s25 offen offset:1024 sc1 lds
s_add_u32 m0, s27, 65568
s_nop 0
buffer_load_dwordx4 v1, s[8:11], s25 offen offset:2048 sc1 lds
s_add_u32 m0, s27, 65584
s_nop 0
buffer_load_dwordx4 v1, s[8:11], s25 offen offset:3072 sc1 lds
s_add_u32 m0, s27, 69696
s_add_u32 s25, s25, 32768
buffer_load_dwordx4 v1, s[8:11], s29 offen offset:0 sc1 lds
s_add_u32 m0, s27, 69712
s_nop 0
buffer_load_dwordx4 v1, s[8:11], s29 offen offset:1024 sc1 lds
s_add_u32 m0, s27, 69728
s_nop 0
buffer_load_dwordx4 v1, s[8:11], s29 offen offset:2048 sc1 lds
s_add_u32 m0, s27, 69744
s_nop 0
buffer_load_dwordx4 v1, s[8:11], s29 offen offset:3072 sc1 lds
s_add_u32 m0, s27, 98816
s_add_u32 s29, s25, 4096
buffer_load_dwordx4 v1, s[8:11], s25 offen offset:0 sc1 lds
s_add_u32 m0, s27, 98832
s_nop 0
buffer_load_dwordx4 v1, s[8:11], s25 offen offset:1024 sc1 lds
s_add_u32 m0, s27, 98848
s_nop 0
buffer_load_dwordx4 v1, s[8:11], s25 offen offset:2048 sc1 lds
s_add_u32 m0, s27, 98864
s_nop 0
buffer_load_dwordx4 v1, s[8:11], s25 offen offset:3072 sc1 lds
s_add_u32 m0, s27, 102976
s_add_u32 s25, s25, 32768
buffer_load_dwordx4 v1, s[8:11], s29 offen offset:0 sc1 lds
s_add_u32 m0, s27, 102992
s_nop 0
buffer_load_dwordx4 v1, s[8:11], s29 offen offset:1024 sc1 lds
s_add_u32 m0, s27, 103008
s_nop 0
buffer_load_dwordx4 v1, s[8:11], s29 offen offset:2048 sc1 lds
s_add_u32 m0, s27, 103024
s_nop 0
buffer_load_dwordx4 v1, s[8:11], s29 offen offset:3072 sc1 lds
v_and_b32 v13, 3, v0
v_and_b32 v14, 4, v0
v_add_u32_e64 v13, v13, v14
v_bfe_u32 v14, v0, 4, 1
v_lshl_add_u32 v13, v14, 3, v13
v_lshlrev_b32_e64 v13, 4, v13
v_bfe_u32 v15, v0, 3, 1
v_lshl_add_u32 v13, v15, 10, v13
v_lshrrev_b32_e64 v15, 5, v0
v_lshl_add_u32 v6, v15, 8, v13
s_add_u32 s72, s4, 80740352
s_addc_u32 s73, s5, 0
s_mov_b32 s74, 36928
s_mov_b32 s75, 0x00020000
s_mul_i32 s37, s33, 4096000
s_add_u32 s37, s37, 67108864
s_add_u32 s64, s4, s37
s_addc_u32 s65, s5, 0
s_nop 0
s_mov_b32 s66, 4096000
s_mov_b32 s67, 0x20000
s_mov_b32 s18, 8192000
s_mov_b32 s19, 0x20000
s_mov_b32 s22, 8192000
s_mov_b32 s23, 0x20000
s_add_u32 s68, s4, 16777216
s_addc_u32 s69, s5, 0
s_mov_b32 s70, 33947648
s_mov_b32 s71, 0x00020000
s_lshl_b32 s40, s30, 1
s_add_u32 s40, s40, s32
s_sub_u32 s40, s40, 1
s_lshl_b32 s40, s40, 2
s_add_u32 s40, s40, s24
s_and_b32 s41, s40, 31
s_lshr_b32 s42, s40, 5
v_and_b32 v13, 15, v0
v_lshlrev_b32 v8, 2, v13
v_lshlrev_b32_e64 v13, 4, v13
v_lshl_add_u32 v13, v15, 8, v13
v_lshl_add_u32 v11, v14, 10, v13
v_lshl_add_u32 v12, v14, 14, v13
v_and_b32_e64 v13, 15, v0
v_mul_u32_u24 v13, 1040, v13
v_lshrrev_b32_e64 v15, 4, v0
v_lshl_add_u32 v13, v15, 8, v13
s_mul_i32 s39, s38, 33280
v_add_u32_e64 v2, s39, v13
v_add_u32 v3, 66560, v2
s_sub_u32 s39, s28, s35
v_add_u32_e64 v10, s39, v13
s_cmp_eq_u32 s32, 3
s_cselect_b32 s37, 0x50000000, 0
s_lshl_b32 s43, s42, 15
s_add_u32 s43, s43, 78118912
s_add_u32 s43, s43, s37
s_lshl_b32 s44, s41, 14
s_add_u32 s44, s44, 77594624
s_add_u32 s44, s44, s37
v_mov_b32 v12, 3222493025
v_mov_b32 v13, 3184710632
s_lshr_b32 s36, s41, 3
s_lshl_b32 s36, s36, 4
s_add_u32 s36, s36, s42
s_lshl_b32 s36, s36, 13
s_add_u32 s36, s36, s37
s_and_b32 s37, s41, 7
s_lshl_b32 s37, s37, 10
s_add_u32 s36, s36, s37
s_add_u32 s36, s36, 82313216
s_mul_i32 s48, s33, 250
s_lshl_b32 s49, s34, 3
s_add_u32 s48, s48, s49
s_lshl_b32 s48, s48, 14
s_lshl_b32 s49, s45, 10
s_add_u32 s50, s48, s49
s_lshl_b32 s49, s45, 11
s_add_u32 s51, s48, s49
s_lshl_b32 s49, s24, 15
s_add_u32 s48, s48, s49
s_add_u32 s49, s33, 1
s_mul_i32 s49, s49, 4096000
s_add_u32 s52, s4, 8388608
s_addc_u32 s53, s5, 0
s_mov_b32 s54, s49
s_mov_b32 s55, 0x20000
s_add_u32 s56, s4, 58720256
s_addc_u32 s57, s5, 0
s_mov_b32 s58, s49
s_mov_b32 s59, 0x20000
s_add_u32 s60, s4, 67108864
s_addc_u32 s61, s5, 0
s_mov_b32 s62, s49
s_mov_b32 s63, 0x20000
s_lshl_b32 s40, s30, 6
s_lshl_b32 s41, s45, 2
s_add_u32 s41, s41, s40
s_mul_i32 s26, s32, 992
s_mul_i32 s39, s33, 4000
s_add_u32 s26, s26, s39
s_lshl_b32 s39, s38, 5
s_add_u32 s26, s26, s39
s_lshl_b32 s39, s24, 3
s_add_u32 s26, s26, s39
s_lshl_b32 s26, s26, 10
v_and_b32 v15, 31, v0
v_lshlrev_b32_e64 v15, 2, v15
s_waitcnt vmcnt(0)
s_barrier
ds_read_b128 v[32:35], v2 offset:0
ds_read_b128 v[36:39], v2 offset:33280
ds_read_b128 v[40:43], v2 offset:16640
ds_read_b128 v[44:47], v2 offset:49920
ds_read_b128 v[48:51], v2 offset:16
ds_read_b128 v[52:55], v2 offset:33296
ds_read_b128 v[56:59], v2 offset:16656
ds_read_b128 v[60:63], v2 offset:49936
ds_read_b128 v[64:67], v2 offset:32
ds_read_b128 v[68:71], v2 offset:33312
ds_read_b128 v[72:75], v2 offset:16672
ds_read_b128 v[76:79], v2 offset:49952
s_waitcnt lgkmcnt(9)
v_mfma_f32_16x16x32_bf16 v[128:131], a[0:3], v[32:35], 0
v_mfma_f32_16x16x32_bf16 v[132:135], a[4:7], v[32:35], 0
ds_read_b128 v[80:83], v2 offset:48
v_mfma_f32_16x16x32_bf16 v[144:147], a[0:3], v[36:39], 0
s_mov_b64 exec, 1
buffer_store_dword v7, off, s[72:75], s6 sc1
s_mov_b64 exec, -1
v_mfma_f32_16x16x32_bf16 v[148:151], a[4:7], v[36:39], 0
s_waitcnt lgkmcnt(9)
ds_read_b128 v[84:87], v2 offset:33328
v_mfma_f32_16x16x32_bf16 v[136:139], a[0:3], v[40:43], 0
v_mfma_f32_16x16x32_bf16 v[140:143], a[4:7], v[40:43], 0
s_add_u32 s47, s46, 1064960
ds_read_b128 v[88:91], v2 offset:16688
v_mfma_f32_16x16x32_bf16 v[152:155], a[0:3], v[44:47], 0
buffer_load_dwordx4 a[64:67], v1, s[12:15], s47 offen offset:0 sc1
v_mfma_f32_16x16x32_bf16 v[156:159], a[4:7], v[44:47], 0
s_waitcnt lgkmcnt(9)
s_nop 0
ds_read_b128 v[92:95], v2 offset:49968
v_mfma_f32_16x16x32_bf16 v[128:131], a[8:11], v[48:51], v[128:131]
v_mfma_f32_16x16x32_bf16 v[132:135], a[12:15], v[48:51], v[132:135]
s_add_u32 m0, s27, 132096
s_add_u32 s29, s25, 4096
ds_read_b128 v[32:35], v2 offset:64
v_mfma_f32_16x16x32_bf16 v[144:147], a[8:11], v[52:55], v[144:147]
buffer_load_dwordx4 v1, s[8:11], s25 offen offset:0 sc1 lds
v_mfma_f32_16x16x32_bf16 v[148:151], a[12:15], v[52:55], v[148:151]
s_waitcnt lgkmcnt(9)
s_nop 0
ds_read_b128 v[36:39], v2 offset:33344
v_mfma_f32_16x16x32_bf16 v[136:139], a[8:11], v[56:59], v[136:139]
v_mfma_f32_16x16x32_bf16 v[140:143], a[12:15], v[56:59], v[140:143]
ds_read_b128 v[40:43], v2 offset:16704
v_mfma_f32_16x16x32_bf16 v[152:155], a[8:11], v[60:63], v[152:155]
buffer_load_dwordx4 a[68:71], v1, s[12:15], s47 offen offset:1024 sc1
v_mfma_f32_16x16x32_bf16 v[156:159], a[12:15], v[60:63], v[156:159]
s_waitcnt lgkmcnt(9)
s_nop 0
ds_read_b128 v[44:47], v2 offset:49984
v_mfma_f32_16x16x32_bf16 v[128:131], a[16:19], v[64:67], v[128:131]
v_mfma_f32_16x16x32_bf16 v[132:135], a[20:23], v[64:67], v[132:135]
s_add_u32 m0, s27, 132112
ds_read_b128 v[48:51], v2 offset:80
v_mfma_f32_16x16x32_bf16 v[144:147], a[16:19], v[68:71], v[144:147]
buffer_load_dwordx4 v1, s[8:11], s25 offen offset:1024 sc1 lds
v_mfma_f32_16x16x32_bf16 v[148:151], a[20:23], v[68:71], v[148:151]
s_waitcnt lgkmcnt(9)
s_nop 0
ds_read_b128 v[52:55], v2 offset:33360
v_mfma_f32_16x16x32_bf16 v[136:139], a[16:19], v[72:75], v[136:139]
v_mfma_f32_16x16x32_bf16 v[140:143], a[20:23], v[72:75], v[140:143]
ds_read_b128 v[56:59], v2 offset:16720
v_mfma_f32_16x16x32_bf16 v[152:155], a[16:19], v[76:79], v[152:155]
buffer_load_dwordx4 a[72:75], v1, s[12:15], s47 offen offset:2048 sc1
v_mfma_f32_16x16x32_bf16 v[156:159], a[20:23], v[76:79], v[156:159]
s_waitcnt lgkmcnt(9)
s_nop 0
ds_read_b128 v[60:63], v2 offset:50000
v_mfma_f32_16x16x32_bf16 v[128:131], a[24:27], v[80:83], v[128:131]
v_mfma_f32_16x16x32_bf16 v[132:135], a[28:31], v[80:83], v[132:135]
s_add_u32 m0, s27, 132128
ds_read_b128 v[64:67], v2 offset:96
v_mfma_f32_16x16x32_bf16 v[144:147], a[24:27], v[84:87], v[144:147]
buffer_load_dwordx4 v1, s[8:11], s25 offen offset:2048 sc1 lds
v_mfma_f32_16x16x32_bf16 v[148:151], a[28:31], v[84:87], v[148:151]
s_waitcnt lgkmcnt(9)
s_nop 0
ds_read_b128 v[68:71], v2 offset:33376
v_mfma_f32_16x16x32_bf16 v[136:139], a[24:27], v[88:91], v[136:139]
v_mfma_f32_16x16x32_bf16 v[140:143], a[28:31], v[88:91], v[140:143]
ds_read_b128 v[72:75], v2 offset:16736
v_mfma_f32_16x16x32_bf16 v[152:155], a[24:27], v[92:95], v[152:155]
buffer_load_dwordx4 a[76:79], v1, s[12:15], s47 offen offset:3072 sc1
v_mfma_f32_16x16x32_bf16 v[156:159], a[28:31], v[92:95], v[156:159]
s_waitcnt lgkmcnt(9)
s_nop 0
ds_read_b128 v[76:79], v2 offset:50016
v_mfma_f32_16x16x32_bf16 v[128:131], a[32:35], v[32:35], v[128:131]
v_mfma_f32_16x16x32_bf16 v[132:135], a[36:39], v[32:35], v[132:135]
s_add_u32 m0, s27, 132144
ds_read_b128 v[80:83], v2 offset:112
v_mfma_f32_16x16x32_bf16 v[144:147], a[32:35], v[36:39], v[144:147]
buffer_load_dwordx4 v1, s[8:11], s25 offen offset:3072 sc1 lds
v_mfma_f32_16x16x32_bf16 v[148:151], a[36:39], v[36:39], v[148:151]
s_waitcnt lgkmcnt(9)
s_nop 0
s_add_u32 s47, s46, 1069056
ds_read_b128 v[84:87], v2 offset:33392
v_mfma_f32_16x16x32_bf16 v[136:139], a[32:35], v[40:43], v[136:139]
buffer_load_dwordx4 a[80:83], v1, s[12:15], s47 offen offset:0 sc1
v_mfma_f32_16x16x32_bf16 v[140:143], a[36:39], v[40:43], v[140:143]
ds_read_b128 v[88:91], v2 offset:16752
v_mfma_f32_16x16x32_bf16 v[152:155], a[32:35], v[44:47], v[152:155]
v_mfma_f32_16x16x32_bf16 v[156:159], a[36:39], v[44:47], v[156:159]
s_waitcnt lgkmcnt(9)
s_nop 0
s_add_u32 m0, s27, 136256
s_add_u32 s25, s25, 32768
ds_read_b128 v[92:95], v2 offset:50032
v_mfma_f32_16x16x32_bf16 v[128:131], a[40:43], v[48:51], v[128:131]
buffer_load_dwordx4 v1, s[8:11], s29 offen offset:0 sc1 lds
v_mfma_f32_16x16x32_bf16 v[132:135], a[44:47], v[48:51], v[132:135]
ds_read_b128 v[32:35], v2 offset:128
v_mfma_f32_16x16x32_bf16 v[144:147], a[40:43], v[52:55], v[144:147]
v_mfma_f32_16x16x32_bf16 v[148:151], a[44:47], v[52:55], v[148:151]
s_waitcnt lgkmcnt(9)
s_nop 0
ds_read_b128 v[36:39], v2 offset:33408
v_mfma_f32_16x16x32_bf16 v[136:139], a[40:43], v[56:59], v[136:139]
buffer_load_dwordx4 a[84:87], v1, s[12:15], s47 offen offset:1024 sc1
v_mfma_f32_16x16x32_bf16 v[140:143], a[44:47], v[56:59], v[140:143]
ds_read_b128 v[40:43], v2 offset:16768
v_mfma_f32_16x16x32_bf16 v[152:155], a[40:43], v[60:63], v[152:155]
v_mfma_f32_16x16x32_bf16 v[156:159], a[44:47], v[60:63], v[156:159]
s_waitcnt lgkmcnt(9)
s_nop 0
s_add_u32 m0, s27, 136272
ds_read_b128 v[44:47], v2 offset:50048
v_mfma_f32_16x16x32_bf16 v[128:131], a[48:51], v[64:67], v[128:131]
buffer_load_dwordx4 v1, s[8:11], s29 offen offset:1024 sc1 lds
v_mfma_f32_16x16x32_bf16 v[132:135], a[52:55], v[64:67], v[132:135]
ds_read_b128 v[48:51], v2 offset:144
v_mfma_f32_16x16x32_bf16 v[144:147], a[48:51], v[68:71], v[144:147]
v_mfma_f32_16x16x32_bf16 v[148:151], a[52:55], v[68:71], v[148:151]
s_waitcnt lgkmcnt(9)
s_nop 0
ds_read_b128 v[52:55], v2 offset:33424
v_mfma_f32_16x16x32_bf16 v[136:139], a[48:51], v[72:75], v[136:139]
buffer_load_dwordx4 a[88:91], v1, s[12:15], s47 offen offset:2048 sc1
v_mfma_f32_16x16x32_bf16 v[140:143], a[52:55], v[72:75], v[140:143]
ds_read_b128 v[56:59], v2 offset:16784
v_mfma_f32_16x16x32_bf16 v[152:155], a[48:51], v[76:79], v[152:155]
v_mfma_f32_16x16x32_bf16 v[156:159], a[52:55], v[76:79], v[156:159]
s_waitcnt lgkmcnt(9)
s_nop 0
s_add_u32 m0, s27, 136288
ds_read_b128 v[60:63], v2 offset:50064
v_mfma_f32_16x16x32_bf16 v[128:131], a[56:59], v[80:83], v[128:131]
buffer_load_dwordx4 v1, s[8:11], s29 offen offset:2048 sc1 lds
v_mfma_f32_16x16x32_bf16 v[132:135], a[60:63], v[80:83], v[132:135]
ds_read_b128 v[64:67], v2 offset:160
v_mfma_f32_16x16x32_bf16 v[144:147], a[56:59], v[84:87], v[144:147]
v_mfma_f32_16x16x32_bf16 v[148:151], a[60:63], v[84:87], v[148:151]
s_waitcnt lgkmcnt(9)
s_nop 0
ds_read_b128 v[68:71], v2 offset:33440
v_mfma_f32_16x16x32_bf16 v[136:139], a[56:59], v[88:91], v[136:139]
buffer_load_dwordx4 a[92:95], v1, s[12:15], s47 offen offset:3072 sc1
v_mfma_f32_16x16x32_bf16 v[140:143], a[60:63], v[88:91], v[140:143]
ds_read_b128 v[72:75], v2 offset:16800
v_mfma_f32_16x16x32_bf16 v[152:155], a[56:59], v[92:95], v[152:155]
v_mfma_f32_16x16x32_bf16 v[156:159], a[60:63], v[92:95], v[156:159]
s_waitcnt lgkmcnt(9) vmcnt(12)
s_nop 0
s_add_u32 m0, s27, 136304
ds_read_b128 v[76:79], v2 offset:50080
v_mfma_f32_16x16x32_bf16 v[128:131], a[64:67], v[32:35], v[128:131]
buffer_load_dwordx4 v1, s[8:11], s29 offen offset:3072 sc1 lds
v_mfma_f32_16x16x32_bf16 v[132:135], a[68:71], v[32:35], v[132:135]
s_add_u32 s47, s46, 1073152
ds_read_b128 v[80:83], v2 offset:176
v_mfma_f32_16x16x32_bf16 v[144:147], a[64:67], v[36:39], v[144:147]
buffer_load_dwordx4 a[96:99], v1, s[12:15], s47 offen offset:0 sc1
v_mfma_f32_16x16x32_bf16 v[148:151], a[68:71], v[36:39], v[148:151]
s_waitcnt lgkmcnt(9)
s_nop 0
ds_read_b128 v[84:87], v2 offset:33456
v_mfma_f32_16x16x32_bf16 v[136:139], a[64:67], v[40:43], v[136:139]
v_mfma_f32_16x16x32_bf16 v[140:143], a[68:71], v[40:43], v[140:143]
ds_read_b128 v[88:91], v2 offset:16816
v_mfma_f32_16x16x32_bf16 v[152:155], a[64:67], v[44:47], v[152:155]
buffer_load_dwordx4 a[100:103], v1, s[12:15], s47 offen offset:1024 sc1
v_mfma_f32_16x16x32_bf16 v[156:159], a[68:71], v[44:47], v[156:159]
s_waitcnt lgkmcnt(9) vmcnt(11)
s_nop 0
ds_read_b128 v[92:95], v2 offset:50096
v_mfma_f32_16x16x32_bf16 v[128:131], a[72:75], v[48:51], v[128:131]
v_mfma_f32_16x16x32_bf16 v[132:135], a[76:79], v[48:51], v[132:135]
ds_read_b128 v[32:35], v2 offset:192
v_mfma_f32_16x16x32_bf16 v[144:147], a[72:75], v[52:55], v[144:147]
buffer_load_dwordx4 a[104:107], v1, s[12:15], s47 offen offset:2048 sc1
v_mfma_f32_16x16x32_bf16 v[148:151], a[76:79], v[52:55], v[148:151]
s_waitcnt lgkmcnt(9)
s_nop 0
ds_read_b128 v[36:39], v2 offset:33472
v_mfma_f32_16x16x32_bf16 v[136:139], a[72:75], v[56:59], v[136:139]
v_mfma_f32_16x16x32_bf16 v[140:143], a[76:79], v[56:59], v[140:143]
ds_read_b128 v[40:43], v2 offset:16832
v_mfma_f32_16x16x32_bf16 v[152:155], a[72:75], v[60:63], v[152:155]
buffer_load_dwordx4 a[108:111], v1, s[12:15], s47 offen offset:3072 sc1
v_mfma_f32_16x16x32_bf16 v[156:159], a[76:79], v[60:63], v[156:159]
s_waitcnt lgkmcnt(9) vmcnt(9)
s_nop 0
ds_read_b128 v[44:47], v2 offset:50112
v_mfma_f32_16x16x32_bf16 v[128:131], a[80:83], v[64:67], v[128:131]
v_mfma_f32_16x16x32_bf16 v[132:135], a[84:87], v[64:67], v[132:135]
s_add_u32 s47, s46, 1077248
ds_read_b128 v[48:51], v2 offset:208
v_mfma_f32_16x16x32_bf16 v[144:147], a[80:83], v[68:71], v[144:147]
buffer_load_dwordx4 a[112:115], v1, s[12:15], s47 offen offset:0 sc1
v_mfma_f32_16x16x32_bf16 v[148:151], a[84:87], v[68:71], v[148:151]
s_waitcnt lgkmcnt(9)
s_nop 0
ds_read_b128 v[52:55], v2 offset:33488
v_mfma_f32_16x16x32_bf16 v[136:139], a[80:83], v[72:75], v[136:139]
v_mfma_f32_16x16x32_bf16 v[140:143], a[84:87], v[72:75], v[140:143]
ds_read_b128 v[56:59], v2 offset:16848
v_mfma_f32_16x16x32_bf16 v[152:155], a[80:83], v[76:79], v[152:155]
buffer_load_dwordx4 a[116:119], v1, s[12:15], s47 offen offset:1024 sc1
v_mfma_f32_16x16x32_bf16 v[156:159], a[84:87], v[76:79], v[156:159]
s_waitcnt lgkmcnt(9) vmcnt(7)
s_nop 0
ds_read_b128 v[60:63], v2 offset:50128
v_mfma_f32_16x16x32_bf16 v[128:131], a[88:91], v[80:83], v[128:131]
v_mfma_f32_16x16x32_bf16 v[132:135], a[92:95], v[80:83], v[132:135]
ds_read_b128 v[64:67], v2 offset:224
v_mfma_f32_16x16x32_bf16 v[144:147], a[88:91], v[84:87], v[144:147]
buffer_load_dwordx4 a[120:123], v1, s[12:15], s47 offen offset:2048 sc1
v_mfma_f32_16x16x32_bf16 v[148:151], a[92:95], v[84:87], v[148:151]
s_waitcnt lgkmcnt(9)
s_nop 0
ds_read_b128 v[68:71], v2 offset:33504
v_mfma_f32_16x16x32_bf16 v[136:139], a[88:91], v[88:91], v[136:139]
v_mfma_f32_16x16x32_bf16 v[140:143], a[92:95], v[88:91], v[140:143]
ds_read_b128 v[72:75], v2 offset:16864
v_mfma_f32_16x16x32_bf16 v[152:155], a[88:91], v[92:95], v[152:155]
buffer_load_dwordx4 a[124:127], v1, s[12:15], s47 offen offset:3072 sc1
v_mfma_f32_16x16x32_bf16 v[156:159], a[92:95], v[92:95], v[156:159]
s_waitcnt lgkmcnt(9) vmcnt(6)
s_nop 0
s_add_u32 m0, s28, 65536
s_add_u32 s29, s25, 4096
ds_read_b128 v[76:79], v2 offset:50144
v_mfma_f32_16x16x32_bf16 v[128:131], a[96:99], v[32:35], v[128:131]
buffer_load_dwordx4 v1, s[8:11], s25 offen offset:0 sc1 lds
v_mfma_f32_16x16x32_bf16 v[132:135], a[100:103], v[32:35], v[132:135]
ds_read_b128 v[80:83], v2 offset:240
v_mfma_f32_16x16x32_bf16 v[144:147], a[96:99], v[36:39], v[144:147]
v_mfma_f32_16x16x32_bf16 v[148:151], a[100:103], v[36:39], v[148:151]
s_waitcnt lgkmcnt(9)
s_nop 0
s_add_u32 m0, s28, 65552
ds_read_b128 v[84:87], v2 offset:33520
v_mfma_f32_16x16x32_bf16 v[136:139], a[96:99], v[40:43], v[136:139]
buffer_load_dwordx4 v1, s[8:11], s25 offen offset:1024 sc1 lds
v_mfma_f32_16x16x32_bf16 v[140:143], a[100:103], v[40:43], v[140:143]
ds_read_b128 v[88:91], v2 offset:16880
v_mfma_f32_16x16x32_bf16 v[152:155], a[96:99], v[44:47], v[152:155]
v_mfma_f32_16x16x32_bf16 v[156:159], a[100:103], v[44:47], v[156:159]
s_waitcnt lgkmcnt(9) vmcnt(6)
s_add_u32 m0, s28, 65568
ds_read_b128 v[92:95], v2 offset:50160
v_mfma_f32_16x16x32_bf16 v[128:131], a[104:107], v[48:51], v[128:131]
buffer_load_dwordx4 v1, s[8:11], s25 offen offset:2048 sc1 lds
v_mfma_f32_16x16x32_bf16 v[132:135], a[108:111], v[48:51], v[132:135]
s_barrier
ds_read_b128 v[32:35], v3 offset:0
v_mfma_f32_16x16x32_bf16 v[144:147], a[104:107], v[52:55], v[144:147]
v_mfma_f32_16x16x32_bf16 v[148:151], a[108:111], v[52:55], v[148:151]
s_waitcnt lgkmcnt(9)
s_nop 0
s_add_u32 m0, s28, 65584
ds_read_b128 v[36:39], v3 offset:16640
v_mfma_f32_16x16x32_bf16 v[136:139], a[104:107], v[56:59], v[136:139]
buffer_load_dwordx4 v1, s[8:11], s25 offen offset:3072 sc1 lds
v_mfma_f32_16x16x32_bf16 v[140:143], a[108:111], v[56:59], v[140:143]
ds_read_b128 v[40:43], v3 offset:16
v_mfma_f32_16x16x32_bf16 v[152:155], a[104:107], v[60:63], v[152:155]
v_mfma_f32_16x16x32_bf16 v[156:159], a[108:111], v[60:63], v[156:159]
s_waitcnt lgkmcnt(9) vmcnt(6)
s_nop 0
s_add_u32 m0, s28, 69696
s_add_u32 s25, s25, 32768
ds_read_b128 v[44:47], v3 offset:16656
v_mfma_f32_16x16x32_bf16 v[128:131], a[112:115], v[64:67], v[128:131]
buffer_load_dwordx4 v1, s[8:11], s29 offen offset:0 sc1 lds
v_mfma_f32_16x16x32_bf16 v[132:135], a[116:119], v[64:67], v[132:135]
ds_read_b128 v[48:51], v3 offset:32
v_mfma_f32_16x16x32_bf16 v[144:147], a[112:115], v[68:71], v[144:147]
v_mfma_f32_16x16x32_bf16 v[148:151], a[116:119], v[68:71], v[148:151]
s_waitcnt lgkmcnt(9)
s_nop 0
s_add_u32 m0, s28, 69712
ds_read_b128 v[52:55], v3 offset:16672
v_mfma_f32_16x16x32_bf16 v[136:139], a[112:115], v[72:75], v[136:139]
buffer_load_dwordx4 v1, s[8:11], s29 offen offset:1024 sc1 lds
v_mfma_f32_16x16x32_bf16 v[140:143], a[116:119], v[72:75], v[140:143]
ds_read_b128 v[56:59], v3 offset:48
v_mfma_f32_16x16x32_bf16 v[152:155], a[112:115], v[76:79], v[152:155]
v_mfma_f32_16x16x32_bf16 v[156:159], a[116:119], v[76:79], v[156:159]
s_waitcnt lgkmcnt(9) vmcnt(6)
s_nop 0
s_add_u32 m0, s28, 69728
ds_read_b128 v[60:63], v3 offset:16688
v_mfma_f32_16x16x32_bf16 v[128:131], a[120:123], v[80:83], v[128:131]
buffer_load_dwordx4 v1, s[8:11], s29 offen offset:2048 sc1 lds
v_mfma_f32_16x16x32_bf16 v[132:135], a[124:127], v[80:83], v[132:135]
ds_read_b128 v[64:67], v3 offset:64
v_mfma_f32_16x16x32_bf16 v[144:147], a[120:123], v[84:87], v[144:147]
v_mfma_f32_16x16x32_bf16 v[148:151], a[124:127], v[84:87], v[148:151]
s_waitcnt lgkmcnt(9)
s_nop 0
s_add_u32 m0, s28, 69744
ds_read_b128 v[68:71], v3 offset:16704
v_mfma_f32_16x16x32_bf16 v[136:139], a[120:123], v[88:91], v[136:139]
buffer_load_dwordx4 v1, s[8:11], s29 offen offset:3072 sc1 lds
v_mfma_f32_16x16x32_bf16 v[140:143], a[124:127], v[88:91], v[140:143]
ds_read_b128 v[72:75], v3 offset:80
v_mfma_f32_16x16x32_bf16 v[152:155], a[120:123], v[92:95], v[152:155]
v_mfma_f32_16x16x32_bf16 v[156:159], a[124:127], v[92:95], v[156:159]
s_waitcnt lgkmcnt(9)
s_nop 0
ds_read_b128 v[76:79], v3 offset:16720
v_mfma_f32_16x16x32_bf16 v[96:99], a[0:3], v[32:35], 0
v_mfma_f32_16x16x32_bf16 v[100:103], a[4:7], v[32:35], 0
ds_read_b128 v[80:83], v3 offset:96
v_mfma_f32_16x16x32_bf16 v[104:107], a[0:3], v[36:39], 0
v_mfma_f32_16x16x32_bf16 v[108:111], a[4:7], v[36:39], 0
s_waitcnt lgkmcnt(9)
s_nop 0
ds_read_b128 v[84:87], v3 offset:16736
v_mfma_f32_16x16x32_bf16 v[96:99], a[8:11], v[40:43], v[96:99]
v_mfma_f32_16x16x32_bf16 v[100:103], a[12:15], v[40:43], v[100:103]
ds_read_b128 v[88:91], v3 offset:112
v_pk_mul_f32 v[16:17], v[128:129], v[128:129]
v_pk_mul_f32 v[18:19], v[130:131], v[130:131]
v_pk_mul_f32 v[20:21], v[132:133], v[132:133]
v_pk_mul_f32 v[22:23], v[134:135], v[134:135]
v_pk_mul_f32 v[24:25], v[136:137], v[136:137]
v_pk_mul_f32 v[26:27], v[138:139], v[138:139]
v_pk_mul_f32 v[28:29], v[140:141], v[140:141]
v_pk_mul_f32 v[30:31], v[142:143], v[142:143]
v_pk_fma_f32 v[16:17], v[16:17], v[12:13], v[12:13] op_sel:[0,1,0] op_sel_hi:[1,1,0]
v_pk_fma_f32 v[18:19], v[18:19], v[12:13], v[12:13] op_sel:[0,1,0] op_sel_hi:[1,1,0]
v_pk_fma_f32 v[20:21], v[20:21], v[12:13], v[12:13] op_sel:[0,1,0] op_sel_hi:[1,1,0]
v_pk_fma_f32 v[22:23], v[22:23], v[12:13], v[12:13] op_sel:[0,1,0] op_sel_hi:[1,1,0]
v_pk_fma_f32 v[24:25], v[24:25], v[12:13], v[12:13] op_sel:[0,1,0] op_sel_hi:[1,1,0]
v_pk_fma_f32 v[26:27], v[26:27], v[12:13], v[12:13] op_sel:[0,1,0] op_sel_hi:[1,1,0]
v_pk_fma_f32 v[28:29], v[28:29], v[12:13], v[12:13] op_sel:[0,1,0] op_sel_hi:[1,1,0]
v_pk_fma_f32 v[30:31], v[30:31], v[12:13], v[12:13] op_sel:[0,1,0] op_sel_hi:[1,1,0]
v_pk_mul_f32 v[16:17], v[16:17], v[128:129]
v_pk_mul_f32 v[18:19], v[18:19], v[130:131]
v_pk_mul_f32 v[20:21], v[20:21], v[132:133]
v_pk_mul_f32 v[22:23], v[22:23], v[134:135]
v_pk_mul_f32 v[24:25], v[24:25], v[136:137]
v_pk_mul_f32 v[26:27], v[26:27], v[138:139]
v_pk_mul_f32 v[28:29], v[28:29], v[140:141]
v_pk_mul_f32 v[30:31], v[30:31], v[142:143]
v_mfma_f32_16x16x32_bf16 v[104:107], a[8:11], v[44:47], v[104:107]
v_mfma_f32_16x16x32_bf16 v[108:111], a[12:15], v[44:47], v[108:111]
s_waitcnt lgkmcnt(9)
ds_read_b128 v[92:95], v3 offset:16752
v_exp_f32 v16, v16
v_exp_f32 v17, v17
v_add_f32 v16, 1.0, v16
v_exp_f32 v18, v18
v_add_f32 v17, 1.0, v17
v_mfma_f32_16x16x32_bf16 v[96:99], a[16:19], v[48:51], v[96:99]
v_rcp_f32_e64 v16, v16
v_mfma_f32_16x16x32_bf16 v[100:103], a[20:23], v[48:51], v[100:103]
ds_read_b128 v[32:35], v3 offset:128
v_exp_f32 v19, v19
v_add_f32 v18, 1.0, v18
v_mfma_f32_16x16x32_bf16 v[104:107], a[16:19], v[52:55], v[104:107]
buffer_load_dword v9, v15, s[72:75], s7 offen sc1
v_mfma_f32_16x16x32_bf16 v[108:111], a[20:23], v[52:55], v[108:111]
s_waitcnt lgkmcnt(9)
ds_read_b128 v[36:39], v3 offset:16768
v_rcp_f32 v17, v17
v_mul_f32_e64 v128, v128, v16
v_mfma_f32_16x16x32_bf16 v[96:99], a[24:27], v[56:59], v[96:99]
v_exp_f32_e64 v20, v20
v_mfma_f32_16x16x32_bf16 v[100:103], a[28:31], v[56:59], v[100:103]
ds_read_b128 v[40:43], v3 offset:144
v_add_f32 v19, 1.0, v19
v_rcp_f32 v18, v18
v_mfma_f32_16x16x32_bf16 v[104:107], a[24:27], v[60:63], v[104:107]
v_mfma_f32_16x16x32_bf16 v[108:111], a[28:31], v[60:63], v[108:111]
s_waitcnt lgkmcnt(9)
ds_read_b128 v[44:47], v3 offset:16784
v_mul_f32 v129, v129, v17
v_mfma_f32_16x16x32_bf16 v[96:99], a[32:35], v[64:67], v[96:99]
v_exp_f32_e64 v21, v21
v_mfma_f32_16x16x32_bf16 v[100:103], a[36:39], v[64:67], v[100:103]
ds_read_b128 v[48:51], v3 offset:160
v_add_f32 v20, 1.0, v20
v_rcp_f32 v19, v19
v_mul_f32_e64 v130, v130, v18
v_mfma_f32_16x16x32_bf16 v[104:107], a[32:35], v[68:71], v[104:107]
v_mfma_f32_16x16x32_bf16 v[108:111], a[36:39], v[68:71], v[108:111]
s_waitcnt lgkmcnt(9)
ds_read_b128 v[52:55], v3 offset:16800
v_exp_f32 v22, v22
v_add_f32_e64 v21, 1.0, v21
v_mfma_f32_16x16x32_bf16 v[96:99], a[40:43], v[72:75], v[96:99]
v_mfma_f32_16x16x32_bf16 v[100:103], a[44:47], v[72:75], v[100:103]
ds_read_b128 v[56:59], v3 offset:176
v_rcp_f32 v20, v20
v_mul_f32 v131, v131, v19
v_mfma_f32_16x16x32_bf16 v[104:107], a[40:43], v[76:79], v[104:107]
v_exp_f32_e64 v23, v23
v_mfma_f32_16x16x32_bf16 v[108:111], a[44:47], v[76:79], v[108:111]
s_waitcnt lgkmcnt(9)
ds_read_b128 v[60:63], v3 offset:16816
v_add_f32 v22, 1.0, v22
v_rcp_f32_e64 v21, v21
v_mfma_f32_16x16x32_bf16 v[96:99], a[48:51], v[80:83], v[96:99]
v_mfma_f32_16x16x32_bf16 v[100:103], a[52:55], v[80:83], v[100:103]
ds_read_b128 v[64:67], v3 offset:192
v_mul_f32 v132, v132, v20
v_exp_f32 v24, v24
v_mfma_f32_16x16x32_bf16 v[104:107], a[48:51], v[84:87], v[104:107]
v_add_f32_e64 v23, 1.0, v23
v_mfma_f32_16x16x32_bf16 v[108:111], a[52:55], v[84:87], v[108:111]
s_waitcnt lgkmcnt(9)
ds_read_b128 v[68:71], v3 offset:16832
v_rcp_f32 v22, v22
v_mul_f32_e64 v133, v133, v21
v_mfma_f32_16x16x32_bf16 v[96:99], a[56:59], v[88:91], v[96:99]
v_mfma_f32_16x16x32_bf16 v[100:103], a[60:63], v[88:91], v[100:103]
ds_read_b128 v[72:75], v3 offset:208
v_exp_f32 v25, v25
v_add_f32 v24, 1.0, v24
v_mfma_f32_16x16x32_bf16 v[104:107], a[56:59], v[92:95], v[104:107]
v_rcp_f32_e64 v23, v23
v_mfma_f32_16x16x32_bf16 v[108:111], a[60:63], v[92:95], v[108:111]
s_waitcnt lgkmcnt(9)
ds_read_b128 v[76:79], v3 offset:16848
v_mul_f32 v134, v134, v22
v_exp_f32 v26, v26
v_add_f32 v25, 1.0, v25
v_mfma_f32_16x16x32_bf16 v[96:99], a[64:67], v[32:35], v[96:99]
s_waitcnt vmcnt(0)
v_cmp_ne_u32_e64 vcc, v7, v9
s_cbranch_vccnz L_sp_10
L_bk_11:
v_mfma_f32_16x16x32_bf16 v[100:103], a[68:71], v[32:35], v[100:103]
s_add_u32 s47, s46, 0
ds_read_b128 v[80:83], v3 offset:224
v_rcp_f32 v24, v24
v_mul_f32_e64 v135, v135, v23
v_mfma_f32_16x16x32_bf16 v[104:107], a[64:67], v[36:39], v[104:107]
buffer_load_dwordx4 a[128:131], v1, s[12:15], s47 offen offset:0 sc1
v_mfma_f32_16x16x32_bf16 v[108:111], a[68:71], v[36:39], v[108:111]
s_waitcnt lgkmcnt(9)
s_nop 0
ds_read_b128 v[84:87], v3 offset:16864
v_cvt_pk_bf16_f32 v16, v128, v129
v_cvt_pk_bf16_f32 v17, v130, v131
v_mfma_f32_16x16x32_bf16 v[96:99], a[72:75], v[40:43], v[96:99]
v_cvt_pk_bf16_f32 v18, v132, v133
v_cvt_pk_bf16_f32 v19, v134, v135
v_mfma_f32_16x16x32_bf16 v[100:103], a[76:79], v[40:43], v[100:103]
ds_read_b128 v[88:91], v3 offset:240
v_exp_f32 v27, v27
v_add_f32 v26, 1.0, v26
v_mfma_f32_16x16x32_bf16 v[104:107], a[72:75], v[44:47], v[104:107]
buffer_load_dwordx4 a[132:135], v1, s[12:15], s47 offen offset:1024 sc1
v_mfma_f32_16x16x32_bf16 v[108:111], a[76:79], v[44:47], v[108:111]
s_waitcnt lgkmcnt(9)
s_add_u32 s49, s50, 0
ds_read_b128 v[92:95], v3 offset:16880
v_rcp_f32 v25, v25
v_mul_f32 v136, v136, v24
v_mfma_f32_16x16x32_bf16 v[96:99], a[80:83], v[48:51], v[96:99]
buffer_store_dwordx4 v[16:19], v1, s[60:63], s49 offen offset:0 sc1
v_mfma_f32_16x16x32_bf16 v[100:103], a[84:87], v[48:51], v[100:103]
s_barrier
ds_read_b128 v[32:35], v10 offset:0
v_exp_f32 v28, v28
v_add_f32_e64 v27, 1.0, v27
v_mfma_f32_16x16x32_bf16 v[104:107], a[80:83], v[52:55], v[104:107]
buffer_load_dwordx4 a[136:139], v1, s[12:15], s47 offen offset:2048 sc1
v_mfma_f32_16x16x32_bf16 v[108:111], a[84:87], v[52:55], v[108:111]
s_waitcnt lgkmcnt(9)
ds_read_b128 v[36:39], v10 offset:16640
v_rcp_f32 v26, v26
v_mul_f32_e64 v137, v137, v25
v_mfma_f32_16x16x32_bf16 v[96:99], a[88:91], v[56:59], v[96:99]
v_exp_f32_e64 v29, v29
v_mfma_f32_16x16x32_bf16 v[100:103], a[92:95], v[56:59], v[100:103]
ds_read_b128 v[40:43], v10 offset:16
v_add_f32 v28, 1.0, v28
v_rcp_f32 v27, v27
v_mfma_f32_16x16x32_bf16 v[104:107], a[88:91], v[60:63], v[104:107]
buffer_load_dwordx4 a[140:143], v1, s[12:15], s47 offen offset:3072 sc1
v_mfma_f32_16x16x32_bf16 v[108:111], a[92:95], v[60:63], v[108:111]
s_waitcnt lgkmcnt(9)
s_add_u32 s47, s46, 4096
ds_read_b128 v[44:47], v10 offset:16656
v_mul_f32 v138, v138, v26
v_exp_f32_e64 v30, v30
v_mfma_f32_16x16x32_bf16 v[96:99], a[96:99], v[64:67], v[96:99]
buffer_load_dwordx4 a[144:147], v1, s[12:15], s47 offen offset:0 sc1
v_mfma_f32_16x16x32_bf16 v[100:103], a[100:103], v[64:67], v[100:103]
ds_read_b128 v[48:51], v10 offset:32
v_add_f32 v29, 1.0, v29
v_rcp_f32 v28, v28
v_mfma_f32_16x16x32_bf16 v[104:107], a[96:99], v[68:71], v[104:107]
v_mul_f32_e64 v139, v139, v27
v_mfma_f32_16x16x32_bf16 v[108:111], a[100:103], v[68:71], v[108:111]
s_waitcnt lgkmcnt(9)
ds_read_b128 v[52:55], v10 offset:16672
v_exp_f32 v31, v31
v_add_f32_e64 v30, 1.0, v30
v_mfma_f32_16x16x32_bf16 v[96:99], a[104:107], v[72:75], v[96:99]
buffer_load_dwordx4 a[148:151], v1, s[12:15], s47 offen offset:1024 sc1
v_mfma_f32_16x16x32_bf16 v[100:103], a[108:111], v[72:75], v[100:103]
ds_read_b128 v[56:59], v10 offset:48
v_rcp_f32 v29, v29
v_mul_f32 v140, v140, v28
v_add_f32_e64 v31, 1.0, v31
v_mfma_f32_16x16x32_bf16 v[104:107], a[104:107], v[76:79], v[104:107]
v_rcp_f32_e64 v30, v30
v_mfma_f32_16x16x32_bf16 v[108:111], a[108:111], v[76:79], v[108:111]
s_waitcnt lgkmcnt(9)
ds_read_b128 v[60:63], v10 offset:16688
v_mul_f32 v141, v141, v29
v_mfma_f32_16x16x32_bf16 v[96:99], a[112:115], v[80:83], v[96:99]
buffer_load_dwordx4 a[152:155], v1, s[12:15], s47 offen offset:2048 sc1
v_mfma_f32_16x16x32_bf16 v[100:103], a[116:119], v[80:83], v[100:103]
ds_read_b128 v[64:67], v10 offset:64
v_rcp_f32 v31, v31
v_mul_f32 v142, v142, v30
v_mul_f32_e64 v143, v143, v31
v_mfma_f32_16x16x32_bf16 v[104:107], a[112:115], v[84:87], v[104:107]
v_cvt_pk_bf16_f32 v24, v136, v137
v_cvt_pk_bf16_f32 v25, v138, v139
v_mfma_f32_16x16x32_bf16 v[108:111], a[116:119], v[84:87], v[108:111]
s_waitcnt lgkmcnt(9)
s_nop 0
ds_read_b128 v[68:71], v10 offset:16704
v_cvt_pk_bf16_f32 v26, v140, v141
v_cvt_pk_bf16_f32 v27, v142, v143
v_mfma_f32_16x16x32_bf16 v[96:99], a[120:123], v[88:91], v[96:99]
buffer_load_dwordx4 a[156:159], v1, s[12:15], s47 offen offset:3072 sc1
v_mfma_f32_16x16x32_bf16 v[100:103], a[124:127], v[88:91], v[100:103]
ds_read_b128 v[72:75], v10 offset:80
v_mfma_f32_16x16x32_bf16 v[104:107], a[120:123], v[92:95], v[104:107]
v_mfma_f32_16x16x32_bf16 v[108:111], a[124:127], v[92:95], v[108:111]
s_waitcnt lgkmcnt(9)
s_nop 0
ds_read_b128 v[76:79], v10 offset:16720
s_add_u32 s49, s50, 16384
buffer_store_dwordx4 v[24:27], v1, s[60:63], s49 offen offset:0 sc1
v_mfma_f32_16x16x32_bf16 v[112:115], a[0:3], v[32:35], 0
v_mfma_f32_16x16x32_bf16 v[116:119], a[4:7], v[32:35], 0
s_add_u32 s47, s46, 8192
ds_read_b128 v[80:83], v10 offset:96
v_mfma_f32_16x16x32_bf16 v[120:123], a[0:3], v[36:39], 0
buffer_load_dwordx4 a[160:163], v1, s[12:15], s47 offen offset:0 sc1
v_mfma_f32_16x16x32_bf16 v[124:127], a[4:7], v[36:39], 0
s_waitcnt lgkmcnt(9)
s_nop 0
ds_read_b128 v[84:87], v10 offset:16736
v_mfma_f32_16x16x32_bf16 v[112:115], a[8:11], v[40:43], v[112:115]
v_mfma_f32_16x16x32_bf16 v[116:119], a[12:15], v[40:43], v[116:119]
ds_read_b128 v[88:91], v10 offset:112
v_pk_mul_f32 v[16:17], v[144:145], v[144:145]
v_pk_mul_f32 v[18:19], v[146:147], v[146:147]
v_pk_mul_f32 v[20:21], v[148:149], v[148:149]
v_pk_mul_f32 v[22:23], v[150:151], v[150:151]
v_pk_mul_f32 v[24:25], v[152:153], v[152:153]
v_pk_mul_f32 v[26:27], v[154:155], v[154:155]
v_pk_mul_f32 v[28:29], v[156:157], v[156:157]
v_pk_mul_f32 v[30:31], v[158:159], v[158:159]
v_pk_fma_f32 v[16:17], v[16:17], v[12:13], v[12:13] op_sel:[0,1,0] op_sel_hi:[1,1,0]
v_pk_fma_f32 v[18:19], v[18:19], v[12:13], v[12:13] op_sel:[0,1,0] op_sel_hi:[1,1,0]
v_pk_fma_f32 v[20:21], v[20:21], v[12:13], v[12:13] op_sel:[0,1,0] op_sel_hi:[1,1,0]
v_pk_fma_f32 v[22:23], v[22:23], v[12:13], v[12:13] op_sel:[0,1,0] op_sel_hi:[1,1,0]
v_pk_fma_f32 v[24:25], v[24:25], v[12:13], v[12:13] op_sel:[0,1,0] op_sel_hi:[1,1,0]
v_pk_fma_f32 v[26:27], v[26:27], v[12:13], v[12:13] op_sel:[0,1,0] op_sel_hi:[1,1,0]
v_pk_fma_f32 v[28:29], v[28:29], v[12:13], v[12:13] op_sel:[0,1,0] op_sel_hi:[1,1,0]
v_pk_fma_f32 v[30:31], v[30:31], v[12:13], v[12:13] op_sel:[0,1,0] op_sel_hi:[1,1,0]
v_pk_mul_f32 v[16:17], v[16:17], v[144:145]
v_pk_mul_f32 v[18:19], v[18:19], v[146:147]
v_pk_mul_f32 v[20:21], v[20:21], v[148:149]
v_pk_mul_f32 v[22:23], v[22:23], v[150:151]
v_pk_mul_f32 v[24:25], v[24:25], v[152:153]
v_pk_mul_f32 v[26:27], v[26:27], v[154:155]
v_pk_mul_f32 v[28:29], v[28:29], v[156:157]
v_pk_mul_f32 v[30:31], v[30:31], v[158:159]
v_mfma_f32_16x16x32_bf16 v[120:123], a[8:11], v[44:47], v[120:123]
buffer_load_dwordx4 a[164:167], v1, s[12:15], s47 offen offset:1024 sc1
v_mfma_f32_16x16x32_bf16 v[124:127], a[12:15], v[44:47], v[124:127]
s_waitcnt lgkmcnt(9)
ds_read_b128 v[92:95], v10 offset:16752
v_exp_f32 v16, v16
v_exp_f32 v17, v17
v_add_f32 v16, 1.0, v16
v_exp_f32 v18, v18
v_add_f32 v17, 1.0, v17
v_mfma_f32_16x16x32_bf16 v[112:115], a[16:19], v[48:51], v[112:115]
buffer_load_dwordx4 a[168:171], v1, s[12:15], s47 offen offset:2048 sc1
v_mfma_f32_16x16x32_bf16 v[116:119], a[20:23], v[48:51], v[116:119]
ds_read_b128 v[32:35], v10 offset:128
v_rcp_f32_e64 v16, v16
v_mfma_f32_16x16x32_bf16 v[120:123], a[16:19], v[52:55], v[120:123]
v_exp_f32_e64 v19, v19
v_mfma_f32_16x16x32_bf16 v[124:127], a[20:23], v[52:55], v[124:127]
s_waitcnt lgkmcnt(9)
ds_read_b128 v[36:39], v10 offset:16768
v_add_f32 v18, 1.0, v18
v_rcp_f32 v17, v17
v_mul_f32 v144, v144, v16
v_mfma_f32_16x16x32_bf16 v[112:115], a[24:27], v[56:59], v[112:115]
buffer_load_dwordx4 a[172:175], v1, s[12:15], s47 offen offset:3072 sc1
v_mfma_f32_16x16x32_bf16 v[116:119], a[28:31], v[56:59], v[116:119]
s_add_u32 s47, s46, 12288
ds_read_b128 v[40:43], v10 offset:144
v_exp_f32 v20, v20
v_add_f32 v19, 1.0, v19
v_mfma_f32_16x16x32_bf16 v[120:123], a[24:27], v[60:63], v[120:123]
buffer_load_dwordx4 a[176:179], v1, s[12:15], s47 offen offset:0 sc1
v_mfma_f32_16x16x32_bf16 v[124:127], a[28:31], v[60:63], v[124:127]
s_waitcnt lgkmcnt(9)
ds_read_b128 v[44:47], v10 offset:16784
v_rcp_f32 v18, v18
v_mul_f32_e64 v145, v145, v17
v_mfma_f32_16x16x32_bf16 v[112:115], a[32:35], v[64:67], v[112:115]
v_exp_f32_e64 v21, v21
v_mfma_f32_16x16x32_bf16 v[116:119], a[36:39], v[64:67], v[116:119]
ds_read_b128 v[48:51], v10 offset:160
v_add_f32 v20, 1.0, v20
v_rcp_f32 v19, v19
v_mul_f32_e64 v146, v146, v18
v_mfma_f32_16x16x32_bf16 v[120:123], a[32:35], v[68:71], v[120:123]
buffer_load_dwordx4 a[180:183], v1, s[12:15], s47 offen offset:1024 sc1
v_mfma_f32_16x16x32_bf16 v[124:127], a[36:39], v[68:71], v[124:127]
s_waitcnt lgkmcnt(9)
ds_read_b128 v[52:55], v10 offset:16800
v_exp_f32 v22, v22
v_add_f32_e64 v21, 1.0, v21
v_mfma_f32_16x16x32_bf16 v[112:115], a[40:43], v[72:75], v[112:115]
buffer_load_dwordx4 a[184:187], v1, s[12:15], s47 offen offset:2048 sc1
v_mfma_f32_16x16x32_bf16 v[116:119], a[44:47], v[72:75], v[116:119]
ds_read_b128 v[56:59], v10 offset:176
v_rcp_f32 v20, v20
v_mul_f32 v147, v147, v19
v_mfma_f32_16x16x32_bf16 v[120:123], a[40:43], v[76:79], v[120:123]
v_exp_f32_e64 v23, v23
v_mfma_f32_16x16x32_bf16 v[124:127], a[44:47], v[76:79], v[124:127]
s_waitcnt lgkmcnt(9)
ds_read_b128 v[60:63], v10 offset:16816
v_add_f32 v22, 1.0, v22
v_rcp_f32_e64 v21, v21
v_mfma_f32_16x16x32_bf16 v[112:115], a[48:51], v[80:83], v[112:115]
buffer_load_dwordx4 a[188:191], v1, s[12:15], s47 offen offset:3072 sc1
v_mfma_f32_16x16x32_bf16 v[116:119], a[52:55], v[80:83], v[116:119]
s_add_u32 s47, s46, 16384
ds_read_b128 v[64:67], v10 offset:192
v_mul_f32 v148, v148, v20
v_exp_f32 v24, v24
v_mfma_f32_16x16x32_bf16 v[120:123], a[48:51], v[84:87], v[120:123]
buffer_load_dwordx4 a[192:195], v1, s[12:15], s47 offen offset:0 sc1
v_mfma_f32_16x16x32_bf16 v[124:127], a[52:55], v[84:87], v[124:127]
s_waitcnt lgkmcnt(9)
ds_read_b128 v[68:71], v10 offset:16832
v_add_f32 v23, 1.0, v23
v_rcp_f32_e64 v22, v22
v_mfma_f32_16x16x32_bf16 v[112:115], a[56:59], v[88:91], v[112:115]
v_mul_f32_e64 v149, v149, v21
v_mfma_f32_16x16x32_bf16 v[116:119], a[60:63], v[88:91], v[116:119]
ds_read_b128 v[72:75], v10 offset:208
v_exp_f32 v25, v25
v_add_f32 v24, 1.0, v24
v_mfma_f32_16x16x32_bf16 v[120:123], a[56:59], v[92:95], v[120:123]
buffer_load_dwordx4 a[196:199], v1, s[12:15], s47 offen offset:1024 sc1
v_mfma_f32_16x16x32_bf16 v[124:127], a[60:63], v[92:95], v[124:127]
s_waitcnt lgkmcnt(9)
ds_read_b128 v[76:79], v10 offset:16848
v_rcp_f32 v23, v23
v_mul_f32_e64 v150, v150, v22
v_mfma_f32_16x16x32_bf16 v[112:115], a[64:67], v[32:35], v[112:115]
buffer_load_dwordx4 a[200:203], v1, s[12:15], s47 offen offset:2048 sc1
v_mfma_f32_16x16x32_bf16 v[116:119], a[68:71], v[32:35], v[116:119]
ds_read_b128 v[80:83], v10 offset:224
v_exp_f32 v26, v26
v_add_f32 v25, 1.0, v25
v_mfma_f32_16x16x32_bf16 v[120:123], a[64:67], v[36:39], v[120:123]
v_rcp_f32_e64 v24, v24
v_mfma_f32_16x16x32_bf16 v[124:127], a[68:71], v[36:39], v[124:127]
s_waitcnt lgkmcnt(9)
ds_read_b128 v[84:87], v10 offset:16864
v_mul_f32 v151, v151, v23
v_cvt_pk_bf16_f32 v16, v144, v145
v_cvt_pk_bf16_f32 v17, v146, v147
v_cvt_pk_bf16_f32 v18, v148, v149
v_mfma_f32_16x16x32_bf16 v[112:115], a[72:75], v[40:43], v[112:115]
buffer_load_dwordx4 a[204:207], v1, s[12:15], s47 offen offset:3072 sc1
v_mfma_f32_16x16x32_bf16 v[116:119], a[76:79], v[40:43], v[116:119]
s_add_u32 s47, s46, 20480
ds_read_b128 v[88:91], v10 offset:240
v_cvt_pk_bf16_f32 v19, v150, v151
v_exp_f32 v27, v27
v_add_f32 v26, 1.0, v26
v_mfma_f32_16x16x32_bf16 v[120:123], a[72:75], v[44:47], v[120:123]
buffer_load_dwordx4 a[208:211], v1, s[12:15], s47 offen offset:0 sc1
v_mfma_f32_16x16x32_bf16 v[124:127], a[76:79], v[44:47], v[124:127]
s_waitcnt lgkmcnt(9)
s_add_u32 s49, s50, 32768
ds_read_b128 v[92:95], v10 offset:16880
v_rcp_f32 v25, v25
v_mul_f32_e64 v152, v152, v24
v_mfma_f32_16x16x32_bf16 v[112:115], a[80:83], v[48:51], v[112:115]
buffer_store_dwordx4 v[16:19], v1, s[60:63], s49 offen offset:0 sc1
v_mfma_f32_16x16x32_bf16 v[116:119], a[84:87], v[48:51], v[116:119]
ds_read_b128 v[32:35], v2 offset:0
v_exp_f32 v28, v28
v_add_f32 v27, 1.0, v27
v_mfma_f32_16x16x32_bf16 v[120:123], a[80:83], v[52:55], v[120:123]
buffer_load_dwordx4 a[212:215], v1, s[12:15], s47 offen offset:1024 sc1
v_mfma_f32_16x16x32_bf16 v[124:127], a[84:87], v[52:55], v[124:127]
s_waitcnt lgkmcnt(9)
ds_read_b128 v[36:39], v2 offset:16640
v_rcp_f32 v26, v26
v_mul_f32_e64 v153, v153, v25
v_mfma_f32_16x16x32_bf16 v[112:115], a[88:91], v[56:59], v[112:115]
buffer_load_dwordx4 a[216:219], v1, s[12:15], s47 offen offset:2048 sc1
v_mfma_f32_16x16x32_bf16 v[116:119], a[92:95], v[56:59], v[116:119]
ds_read_b128 v[40:43], v2 offset:16
v_exp_f32 v29, v29
v_add_f32 v28, 1.0, v28
v_mfma_f32_16x16x32_bf16 v[120:123], a[88:91], v[60:63], v[120:123]
v_rcp_f32_e64 v27, v27
v_mfma_f32_16x16x32_bf16 v[124:127], a[92:95], v[60:63], v[124:127]
s_waitcnt lgkmcnt(9)
ds_read_b128 v[44:47], v2 offset:16656
v_mul_f32 v154, v154, v26
v_exp_f32_e64 v30, v30
v_mfma_f32_16x16x32_bf16 v[112:115], a[96:99], v[64:67], v[112:115]
buffer_load_dwordx4 a[220:223], v1, s[12:15], s47 offen offset:3072 sc1
v_mfma_f32_16x16x32_bf16 v[116:119], a[100:103], v[64:67], v[116:119]
s_add_u32 s47, s46, 24576
ds_read_b128 v[48:51], v2 offset:32
v_add_f32 v29, 1.0, v29
v_rcp_f32 v28, v28
v_mfma_f32_16x16x32_bf16 v[120:123], a[96:99], v[68:71], v[120:123]
buffer_load_dwordx4 a[224:227], v1, s[12:15], s47 offen offset:0 sc1
v_mfma_f32_16x16x32_bf16 v[124:127], a[100:103], v[68:71], v[124:127]
s_waitcnt lgkmcnt(9)
ds_read_b128 v[52:55], v2 offset:16672
v_mul_f32 v155, v155, v27
v_exp_f32_e64 v31, v31
v_mfma_f32_16x16x32_bf16 v[112:115], a[104:107], v[72:75], v[112:115]
v_add_f32_e64 v30, 1.0, v30
v_mfma_f32_16x16x32_bf16 v[116:119], a[108:111], v[72:75], v[116:119]
ds_read_b128 v[56:59], v2 offset:48
v_rcp_f32 v29, v29
v_mul_f32 v156, v156, v28
v_add_f32_e64 v31, 1.0, v31
v_mfma_f32_16x16x32_bf16 v[120:123], a[104:107], v[76:79], v[120:123]
buffer_load_dwordx4 a[228:231], v1, s[12:15], s47 offen offset:1024 sc1
v_mfma_f32_16x16x32_bf16 v[124:127], a[108:111], v[76:79], v[124:127]
s_waitcnt lgkmcnt(9)
ds_read_b128 v[60:63], v2 offset:16688
v_rcp_f32 v30, v30
v_mul_f32_e64 v157, v157, v29
v_mfma_f32_16x16x32_bf16 v[112:115], a[112:115], v[80:83], v[112:115]
buffer_load_dwordx4 a[232:235], v1, s[12:15], s47 offen offset:2048 sc1
v_mfma_f32_16x16x32_bf16 v[116:119], a[116:119], v[80:83], v[116:119]
ds_read_b128 v[64:67], v2 offset:64
v_rcp_f32 v31, v31
v_mul_f32 v158, v158, v30
v_mfma_f32_16x16x32_bf16 v[120:123], a[112:115], v[84:87], v[120:123]
v_mul_f32_e64 v159, v159, v31
v_cvt_pk_bf16_f32 v24, v152, v153
v_mfma_f32_16x16x32_bf16 v[124:127], a[116:119], v[84:87], v[124:127]
s_waitcnt lgkmcnt(9)
s_nop 0
ds_read_b128 v[68:71], v2 offset:16704
v_cvt_pk_bf16_f32 v25, v154, v155
v_cvt_pk_bf16_f32 v26, v156, v157
v_cvt_pk_bf16_f32 v27, v158, v159
v_mfma_f32_16x16x32_bf16 v[112:115], a[120:123], v[88:91], v[112:115]
buffer_load_dwordx4 a[236:239], v1, s[12:15], s47 offen offset:3072 sc1
v_mfma_f32_16x16x32_bf16 v[116:119], a[124:127], v[88:91], v[116:119]
ds_read_b128 v[72:75], v2 offset:80
v_mfma_f32_16x16x32_bf16 v[120:123], a[120:123], v[92:95], v[120:123]
v_mfma_f32_16x16x32_bf16 v[124:127], a[124:127], v[92:95], v[124:127]
s_waitcnt lgkmcnt(9) vmcnt(29)
s_nop 0
ds_read_b128 v[76:79], v2 offset:16720
s_add_u32 s49, s50, 49152
buffer_store_dwordx4 v[24:27], v1, s[60:63], s49 offen offset:0 sc1
v_mfma_f32_16x16x32_bf16 v[128:131], a[128:131], v[32:35], 0
v_mfma_f32_16x16x32_bf16 v[132:135], a[132:135], v[32:35], 0
s_add_u32 s47, s46, 28672
ds_read_b128 v[80:83], v2 offset:96
v_mfma_f32_16x16x32_bf16 v[136:139], a[128:131], v[36:39], 0
buffer_load_dwordx4 a[240:243], v1, s[12:15], s47 offen offset:0 sc1
v_mfma_f32_16x16x32_bf16 v[140:143], a[132:135], v[36:39], 0
s_waitcnt lgkmcnt(9) vmcnt(28)
s_nop 0
ds_read_b128 v[84:87], v2 offset:16736
v_mfma_f32_16x16x32_bf16 v[128:131], a[136:139], v[40:43], v[128:131]
v_mfma_f32_16x16x32_bf16 v[132:135], a[140:143], v[40:43], v[132:135]
ds_read_b128 v[88:91], v2 offset:112
v_pk_mul_f32 v[16:17], v[96:97], v[96:97]
v_pk_mul_f32 v[18:19], v[98:99], v[98:99]
v_pk_mul_f32 v[20:21], v[100:101], v[100:101]
v_pk_mul_f32 v[22:23], v[102:103], v[102:103]
v_pk_mul_f32 v[24:25], v[104:105], v[104:105]
v_pk_mul_f32 v[26:27], v[106:107], v[106:107]
v_pk_mul_f32 v[28:29], v[108:109], v[108:109]
v_pk_mul_f32 v[30:31], v[110:111], v[110:111]
v_pk_fma_f32 v[16:17], v[16:17], v[12:13], v[12:13] op_sel:[0,1,0] op_sel_hi:[1,1,0]
v_pk_fma_f32 v[18:19], v[18:19], v[12:13], v[12:13] op_sel:[0,1,0] op_sel_hi:[1,1,0]
v_pk_fma_f32 v[20:21], v[20:21], v[12:13], v[12:13] op_sel:[0,1,0] op_sel_hi:[1,1,0]
v_pk_fma_f32 v[22:23], v[22:23], v[12:13], v[12:13] op_sel:[0,1,0] op_sel_hi:[1,1,0]
v_pk_fma_f32 v[24:25], v[24:25], v[12:13], v[12:13] op_sel:[0,1,0] op_sel_hi:[1,1,0]
v_pk_fma_f32 v[26:27], v[26:27], v[12:13], v[12:13] op_sel:[0,1,0] op_sel_hi:[1,1,0]
v_pk_fma_f32 v[28:29], v[28:29], v[12:13], v[12:13] op_sel:[0,1,0] op_sel_hi:[1,1,0]
v_pk_fma_f32 v[30:31], v[30:31], v[12:13], v[12:13] op_sel:[0,1,0] op_sel_hi:[1,1,0]
v_pk_mul_f32 v[16:17], v[16:17], v[96:97]
v_pk_mul_f32 v[18:19], v[18:19], v[98:99]
v_pk_mul_f32 v[20:21], v[20:21], v[100:101]
v_pk_mul_f32 v[22:23], v[22:23], v[102:103]
v_pk_mul_f32 v[24:25], v[24:25], v[104:105]
v_pk_mul_f32 v[26:27], v[26:27], v[106:107]
v_pk_mul_f32 v[28:29], v[28:29], v[108:109]
v_pk_mul_f32 v[30:31], v[30:31], v[110:111]
v_mfma_f32_16x16x32_bf16 v[136:139], a[136:139], v[44:47], v[136:139]
buffer_load_dwordx4 a[244:247], v1, s[12:15], s47 offen offset:1024 sc1
v_mfma_f32_16x16x32_bf16 v[140:143], a[140:143], v[44:47], v[140:143]
s_waitcnt lgkmcnt(9) vmcnt(27)
ds_read_b128 v[92:95], v2 offset:16752
v_exp_f32 v16, v16
v_exp_f32 v17, v17
v_add_f32 v16, 1.0, v16
v_exp_f32 v18, v18
v_add_f32 v17, 1.0, v17
v_mfma_f32_16x16x32_bf16 v[128:131], a[144:147], v[48:51], v[128:131]
v_rcp_f32_e64 v16, v16
v_mfma_f32_16x16x32_bf16 v[132:135], a[148:151], v[48:51], v[132:135]
ds_read_b128 v[32:35], v2 offset:128
v_exp_f32 v19, v19
v_add_f32 v18, 1.0, v18
v_mfma_f32_16x16x32_bf16 v[136:139], a[144:147], v[52:55], v[136:139]
buffer_load_dwordx4 a[248:251], v1, s[12:15], s47 offen offset:2048 sc1
v_mfma_f32_16x16x32_bf16 v[140:143], a[148:151], v[52:55], v[140:143]
s_waitcnt lgkmcnt(9) vmcnt(26)
ds_read_b128 v[36:39], v2 offset:16768
v_rcp_f32 v17, v17
v_mfma_f32_16x16x32_bf16 v[128:131], a[152:155], v[56:59], v[128:131]
v_mul_f32_e64 v96, v96, v16
v_mfma_f32_16x16x32_bf16 v[132:135], a[156:159], v[56:59], v[132:135]
ds_read_b128 v[40:43], v2 offset:144
v_exp_f32 v20, v20
v_add_f32 v19, 1.0, v19
v_mfma_f32_16x16x32_bf16 v[136:139], a[152:155], v[60:63], v[136:139]
buffer_load_dwordx4 a[252:255], v1, s[12:15], s47 offen offset:3072 sc1
v_mfma_f32_16x16x32_bf16 v[140:143], a[156:159], v[60:63], v[140:143]
s_waitcnt lgkmcnt(9) vmcnt(24)
ds_read_b128 v[44:47], v2 offset:16784
v_rcp_f32 v18, v18
v_mul_f32_e64 v97, v97, v17
v_mfma_f32_16x16x32_bf16 v[128:131], a[160:163], v[64:67], v[128:131]
v_exp_f32_e64 v21, v21
v_mfma_f32_16x16x32_bf16 v[132:135], a[164:167], v[64:67], v[132:135]
ds_read_b128 v[48:51], v2 offset:160
v_add_f32 v20, 1.0, v20
v_rcp_f32 v19, v19
v_mul_f32_e64 v98, v98, v18
v_mfma_f32_16x16x32_bf16 v[136:139], a[160:163], v[68:71], v[136:139]
v_mfma_f32_16x16x32_bf16 v[140:143], a[164:167], v[68:71], v[140:143]
s_waitcnt lgkmcnt(9) vmcnt(22)
ds_read_b128 v[52:55], v2 offset:16800
v_exp_f32 v22, v22
v_add_f32_e64 v21, 1.0, v21
v_mfma_f32_16x16x32_bf16 v[128:131], a[168:171], v[72:75], v[128:131]
v_rcp_f32_e64 v20, v20
v_mfma_f32_16x16x32_bf16 v[132:135], a[172:175], v[72:75], v[132:135]
ds_read_b128 v[56:59], v2 offset:176
v_mul_f32 v99, v99, v19
v_exp_f32 v23, v23
v_mfma_f32_16x16x32_bf16 v[136:139], a[168:171], v[76:79], v[136:139]
v_mfma_f32_16x16x32_bf16 v[140:143], a[172:175], v[76:79], v[140:143]
s_waitcnt lgkmcnt(9) vmcnt(20)
ds_read_b128 v[60:63], v2 offset:16816
v_add_f32 v22, 1.0, v22
v_mfma_f32_16x16x32_bf16 v[128:131], a[176:179], v[80:83], v[128:131]
v_rcp_f32_e64 v21, v21
v_mfma_f32_16x16x32_bf16 v[132:135], a[180:183], v[80:83], v[132:135]
ds_read_b128 v[64:67], v2 offset:192
v_mul_f32 v100, v100, v20
v_exp_f32 v24, v24
v_add_f32_e64 v23, 1.0, v23
v_mfma_f32_16x16x32_bf16 v[136:139], a[176:179], v[84:87], v[136:139]
v_mfma_f32_16x16x32_bf16 v[140:143], a[180:183], v[84:87], v[140:143]
s_waitcnt lgkmcnt(9) vmcnt(18)
ds_read_b128 v[68:71], v2 offset:16832
v_rcp_f32 v22, v22
v_mul_f32_e64 v101, v101, v21
v_mfma_f32_16x16x32_bf16 v[128:131], a[184:187], v[88:91], v[128:131]
v_exp_f32_e64 v25, v25
v_mfma_f32_16x16x32_bf16 v[132:135], a[188:191], v[88:91], v[132:135]
ds_read_b128 v[72:75], v2 offset:208
v_add_f32 v24, 1.0, v24
v_rcp_f32 v23, v23
v_mfma_f32_16x16x32_bf16 v[136:139], a[184:187], v[92:95], v[136:139]
v_mfma_f32_16x16x32_bf16 v[140:143], a[188:191], v[92:95], v[140:143]
s_waitcnt lgkmcnt(9) vmcnt(16)
ds_read_b128 v[76:79], v2 offset:16848
v_mul_f32 v102, v102, v22
v_exp_f32_e64 v26, v26
v_mfma_f32_16x16x32_bf16 v[128:131], a[192:195], v[32:35], v[128:131]
v_mfma_f32_16x16x32_bf16 v[132:135], a[196:199], v[32:35], v[132:135]
ds_read_b128 v[80:83], v2 offset:224
v_add_f32 v25, 1.0, v25
v_rcp_f32 v24, v24
v_mfma_f32_16x16x32_bf16 v[136:139], a[192:195], v[36:39], v[136:139]
v_mul_f32_e64 v103, v103, v23
v_cvt_pk_bf16_f32 v16, v96, v97
v_mfma_f32_16x16x32_bf16 v[140:143], a[196:199], v[36:39], v[140:143]
s_waitcnt lgkmcnt(9) vmcnt(14)
s_nop 0
ds_read_b128 v[84:87], v2 offset:16864
v_cvt_pk_bf16_f32 v17, v98, v99
v_cvt_pk_bf16_f32 v18, v100, v101
v_mfma_f32_16x16x32_bf16 v[128:131], a[200:203], v[40:43], v[128:131]
v_mfma_f32_16x16x32_bf16 v[132:135], a[204:207], v[40:43], v[132:135]
ds_read_b128 v[88:91], v2 offset:240
v_cvt_pk_bf16_f32 v19, v102, v103
v_exp_f32_e64 v27, v27
v_mfma_f32_16x16x32_bf16 v[136:139], a[200:203], v[44:47], v[136:139]
v_add_f32_e64 v26, 1.0, v26
v_mfma_f32_16x16x32_bf16 v[140:143], a[204:207], v[44:47], v[140:143]
s_waitcnt lgkmcnt(9) vmcnt(11)
s_add_u32 s49, s50, 65536
ds_read_b128 v[92:95], v2 offset:16880
v_rcp_f32 v25, v25
v_mul_f32_e64 v104, v104, v24
v_mfma_f32_16x16x32_bf16 v[128:131], a[208:211], v[48:51], v[128:131]
buffer_store_dwordx4 v[16:19], v1, s[60:63], s49 offen offset:0 sc1
v_mfma_f32_16x16x32_bf16 v[132:135], a[212:215], v[48:51], v[132:135]
ds_read_b128 v[32:35], v2 offset:33280
v_exp_f32 v28, v28
v_add_f32 v27, 1.0, v27
v_mfma_f32_16x16x32_bf16 v[136:139], a[208:211], v[52:55], v[136:139]
v_mfma_f32_16x16x32_bf16 v[140:143], a[212:215], v[52:55], v[140:143]
s_waitcnt lgkmcnt(9) vmcnt(10)
ds_read_b128 v[36:39], v2 offset:49920
v_rcp_f32 v26, v26
v_mul_f32_e64 v105, v105, v25
v_mfma_f32_16x16x32_bf16 v[128:131], a[216:219], v[56:59], v[128:131]
v_mfma_f32_16x16x32_bf16 v[132:135], a[220:223], v[56:59], v[132:135]
ds_read_b128 v[40:43], v2 offset:33296
v_exp_f32 v29, v29
v_add_f32 v28, 1.0, v28
v_mfma_f32_16x16x32_bf16 v[136:139], a[216:219], v[60:63], v[136:139]
v_rcp_f32_e64 v27, v27
v_mfma_f32_16x16x32_bf16 v[140:143], a[220:223], v[60:63], v[140:143]
s_waitcnt lgkmcnt(9) vmcnt(8)
s_add_u32 s47, s46, 524288
ds_read_b128 v[44:47], v2 offset:49936
v_mul_f32 v106, v106, v26
v_exp_f32_e64 v30, v30
v_mfma_f32_16x16x32_bf16 v[128:131], a[224:227], v[64:67], v[128:131]
buffer_load_dwordx4 a[0:3], v1, s[12:15], s47 offen offset:0 sc1
v_mfma_f32_16x16x32_bf16 v[132:135], a[228:231], v[64:67], v[132:135]
ds_read_b128 v[48:51], v2 offset:33312
v_add_f32 v29, 1.0, v29
v_rcp_f32 v28, v28
v_mfma_f32_16x16x32_bf16 v[136:139], a[224:227], v[68:71], v[136:139]
v_mul_f32_e64 v107, v107, v27
v_mfma_f32_16x16x32_bf16 v[140:143], a[228:231], v[68:71], v[140:143]
s_waitcnt lgkmcnt(9) vmcnt(7)
ds_read_b128 v[52:55], v2 offset:49952
v_exp_f32 v31, v31
v_add_f32_e64 v30, 1.0, v30
v_mfma_f32_16x16x32_bf16 v[128:131], a[232:235], v[72:75], v[128:131]
buffer_load_dwordx4 a[4:7], v1, s[12:15], s47 offen offset:1024 sc1
v_mfma_f32_16x16x32_bf16 v[132:135], a[236:239], v[72:75], v[132:135]
ds_read_b128 v[56:59], v2 offset:33328
v_rcp_f32 v29, v29
v_mul_f32 v108, v108, v28
v_add_f32_e64 v31, 1.0, v31
v_mfma_f32_16x16x32_bf16 v[136:139], a[232:235], v[76:79], v[136:139]
v_rcp_f32_e64 v30, v30
v_mfma_f32_16x16x32_bf16 v[140:143], a[236:239], v[76:79], v[140:143]
s_waitcnt lgkmcnt(9) vmcnt(5)
ds_read_b128 v[60:63], v2 offset:49968
v_mul_f32 v109, v109, v29
v_rcp_f32_e64 v31, v31
v_mfma_f32_16x16x32_bf16 v[128:131], a[240:243], v[80:83], v[128:131]
buffer_load_dwordx4 a[8:11], v1, s[12:15], s47 offen offset:2048 sc1
v_mfma_f32_16x16x32_bf16 v[132:135], a[244:247], v[80:83], v[132:135]
ds_read_b128 v[64:67], v2 offset:33344
v_mul_f32 v110, v110, v30
v_mul_f32 v111, v111, v31
v_cvt_pk_bf16_f32 v24, v104, v105
v_mfma_f32_16x16x32_bf16 v[136:139], a[240:243], v[84:87], v[136:139]
v_cvt_pk_bf16_f32 v25, v106, v107
v_cvt_pk_bf16_f32 v26, v108, v109
v_mfma_f32_16x16x32_bf16 v[140:143], a[244:247], v[84:87], v[140:143]
s_waitcnt lgkmcnt(9) vmcnt(4)
s_nop 0
ds_read_b128 v[68:71], v2 offset:49984
v_cvt_pk_bf16_f32 v27, v110, v111
v_mfma_f32_16x16x32_bf16 v[128:131], a[248:251], v[88:91], v[128:131]
buffer_load_dwordx4 a[12:15], v1, s[12:15], s47 offen offset:3072 sc1
v_mfma_f32_16x16x32_bf16 v[132:135], a[252:255], v[88:91], v[132:135]
ds_read_b128 v[72:75], v2 offset:33360
v_mfma_f32_16x16x32_bf16 v[136:139], a[248:251], v[92:95], v[136:139]
v_mfma_f32_16x16x32_bf16 v[140:143], a[252:255], v[92:95], v[140:143]
s_waitcnt lgkmcnt(9)
s_nop 0
ds_read_b128 v[76:79], v2 offset:50000
s_add_u32 s49, s50, 81920
buffer_store_dwordx4 v[24:27], v1, s[60:63], s49 offen offset:0 sc1
v_mfma_f32_16x16x32_bf16 v[144:147], a[128:131], v[32:35], 0
v_mfma_f32_16x16x32_bf16 v[148:151], a[132:135], v[32:35], 0
s_add_u32 s47, s46, 528384
ds_read_b128 v[80:83], v2 offset:33376
v_mfma_f32_16x16x32_bf16 v[152:155], a[128:131], v[36:39], 0
buffer_load_dwordx4 a[16:19], v1, s[12:15], s47 offen offset:0 sc1
v_mfma_f32_16x16x32_bf16 v[156:159], a[132:135], v[36:39], 0
s_waitcnt lgkmcnt(9)
s_nop 0
ds_read_b128 v[84:87], v2 offset:50016
v_mfma_f32_16x16x32_bf16 v[144:147], a[136:139], v[40:43], v[144:147]
v_mfma_f32_16x16x32_bf16 v[148:151], a[140:143], v[40:43], v[148:151]
ds_read_b128 v[88:91], v2 offset:33392
v_pk_mul_f32 v[16:17], v[112:113], v[112:113]
v_pk_mul_f32 v[18:19], v[114:115], v[114:115]
v_pk_mul_f32 v[20:21], v[116:117], v[116:117]
v_pk_mul_f32 v[22:23], v[118:119], v[118:119]
v_pk_mul_f32 v[24:25], v[120:121], v[120:121]
v_pk_mul_f32 v[26:27], v[122:123], v[122:123]
v_pk_mul_f32 v[28:29], v[124:125], v[124:125]
v_pk_mul_f32 v[30:31], v[126:127], v[126:127]
v_pk_fma_f32 v[16:17], v[16:17], v[12:13], v[12:13] op_sel:[0,1,0] op_sel_hi:[1,1,0]
v_pk_fma_f32 v[18:19], v[18:19], v[12:13], v[12:13] op_sel:[0,1,0] op_sel_hi:[1,1,0]
v_pk_fma_f32 v[20:21], v[20:21], v[12:13], v[12:13] op_sel:[0,1,0] op_sel_hi:[1,1,0]
v_pk_fma_f32 v[22:23], v[22:23], v[12:13], v[12:13] op_sel:[0,1,0] op_sel_hi:[1,1,0]
v_pk_fma_f32 v[24:25], v[24:25], v[12:13], v[12:13] op_sel:[0,1,0] op_sel_hi:[1,1,0]
v_pk_fma_f32 v[26:27], v[26:27], v[12:13], v[12:13] op_sel:[0,1,0] op_sel_hi:[1,1,0]
v_pk_fma_f32 v[28:29], v[28:29], v[12:13], v[12:13] op_sel:[0,1,0] op_sel_hi:[1,1,0]
v_pk_fma_f32 v[30:31], v[30:31], v[12:13], v[12:13] op_sel:[0,1,0] op_sel_hi:[1,1,0]
v_pk_mul_f32 v[16:17], v[16:17], v[112:113]
v_pk_mul_f32 v[18:19], v[18:19], v[114:115]
v_pk_mul_f32 v[20:21], v[20:21], v[116:117]
v_pk_mul_f32 v[22:23], v[22:23], v[118:119]
v_pk_mul_f32 v[24:25], v[24:25], v[120:121]
v_pk_mul_f32 v[26:27], v[26:27], v[122:123]
v_pk_mul_f32 v[28:29], v[28:29], v[124:125]
v_pk_mul_f32 v[30:31], v[30:31], v[126:127]
v_mfma_f32_16x16x32_bf16 v[152:155], a[136:139], v[44:47], v[152:155]
v_exp_f32_e64 v16, v16
v_mfma_f32_16x16x32_bf16 v[156:159], a[140:143], v[44:47], v[156:159]
s_waitcnt lgkmcnt(9)
ds_read_b128 v[92:95], v2 offset:50032
v_exp_f32 v17, v17
v_add_f32 v16, 1.0, v16
v_exp_f32 v18, v18
v_add_f32_e64 v17, 1.0, v17
v_mfma_f32_16x16x32_bf16 v[144:147], a[144:147], v[48:51], v[144:147]
v_rcp_f32_e64 v16, v16
v_mfma_f32_16x16x32_bf16 v[148:151], a[148:151], v[48:51], v[148:151]
ds_read_b128 v[32:35], v2 offset:33408
v_exp_f32 v19, v19
v_add_f32 v18, 1.0, v18
v_mfma_f32_16x16x32_bf16 v[152:155], a[144:147], v[52:55], v[152:155]
v_rcp_f32_e64 v17, v17
v_mfma_f32_16x16x32_bf16 v[156:159], a[148:151], v[52:55], v[156:159]
s_waitcnt lgkmcnt(9)
ds_read_b128 v[36:39], v2 offset:50048
v_mul_f32 v112, v112, v16
v_exp_f32_e64 v20, v20
v_mfma_f32_16x16x32_bf16 v[144:147], a[152:155], v[56:59], v[144:147]
buffer_load_dwordx4 a[20:23], v1, s[12:15], s47 offen offset:1024 sc1
v_mfma_f32_16x16x32_bf16 v[148:151], a[156:159], v[56:59], v[148:151]
ds_read_b128 v[40:43], v2 offset:33424
v_add_f32 v19, 1.0, v19
v_rcp_f32 v18, v18
v_mfma_f32_16x16x32_bf16 v[152:155], a[152:155], v[60:63], v[152:155]
v_mul_f32_e64 v113, v113, v17
v_mfma_f32_16x16x32_bf16 v[156:159], a[156:159], v[60:63], v[156:159]
s_waitcnt lgkmcnt(9)
ds_read_b128 v[44:47], v2 offset:50064
v_exp_f32 v21, v21
v_add_f32_e64 v20, 1.0, v20
v_mfma_f32_16x16x32_bf16 v[144:147], a[160:163], v[64:67], v[144:147]
v_rcp_f32_e64 v19, v19
v_mfma_f32_16x16x32_bf16 v[148:151], a[164:167], v[64:67], v[148:151]
ds_read_b128 v[48:51], v2 offset:33440
v_mul_f32 v114, v114, v18
v_exp_f32 v22, v22
v_mfma_f32_16x16x32_bf16 v[152:155], a[160:163], v[68:71], v[152:155]
v_add_f32_e64 v21, 1.0, v21
v_mfma_f32_16x16x32_bf16 v[156:159], a[164:167], v[68:71], v[156:159]
s_waitcnt lgkmcnt(9)
ds_read_b128 v[52:55], v2 offset:50080
v_rcp_f32 v20, v20
v_mul_f32_e64 v115, v115, v19
v_mfma_f32_16x16x32_bf16 v[144:147], a[168:171], v[72:75], v[144:147]
v_exp_f32_e64 v23, v23
v_mfma_f32_16x16x32_bf16 v[148:151], a[172:175], v[72:75], v[148:151]
ds_read_b128 v[56:59], v2 offset:33456
v_add_f32 v22, 1.0, v22
v_rcp_f32 v21, v21
v_mfma_f32_16x16x32_bf16 v[152:155], a[168:171], v[76:79], v[152:155]
buffer_load_dwordx4 a[24:27], v1, s[12:15], s47 offen offset:2048 sc1
v_mfma_f32_16x16x32_bf16 v[156:159], a[172:175], v[76:79], v[156:159]
s_waitcnt lgkmcnt(9)
ds_read_b128 v[60:63], v2 offset:50096
v_mul_f32 v116, v116, v20
v_mfma_f32_16x16x32_bf16 v[144:147], a[176:179], v[80:83], v[144:147]
v_exp_f32_e64 v24, v24
v_mfma_f32_16x16x32_bf16 v[148:151], a[180:183], v[80:83], v[148:151]
ds_read_b128 v[64:67], v2 offset:33472
v_add_f32 v23, 1.0, v23
v_rcp_f32 v22, v22
v_mul_f32_e64 v117, v117, v21
v_mfma_f32_16x16x32_bf16 v[152:155], a[176:179], v[84:87], v[152:155]
v_exp_f32_e64 v25, v25
v_mfma_f32_16x16x32_bf16 v[156:159], a[180:183], v[84:87], v[156:159]
s_waitcnt lgkmcnt(9)
ds_read_b128 v[68:71], v2 offset:50112
v_add_f32 v24, 1.0, v24
v_mfma_f32_16x16x32_bf16 v[144:147], a[184:187], v[88:91], v[144:147]
v_rcp_f32_e64 v23, v23
v_mfma_f32_16x16x32_bf16 v[148:151], a[188:191], v[88:91], v[148:151]
ds_read_b128 v[72:75], v2 offset:33488
v_mul_f32 v118, v118, v22
v_exp_f32 v26, v26
v_add_f32_e64 v25, 1.0, v25
v_mfma_f32_16x16x32_bf16 v[152:155], a[184:187], v[92:95], v[152:155]
v_rcp_f32_e64 v24, v24
v_mfma_f32_16x16x32_bf16 v[156:159], a[188:191], v[92:95], v[156:159]
s_waitcnt lgkmcnt(9)
ds_read_b128 v[76:79], v2 offset:50128
v_mul_f32 v119, v119, v23
v_cvt_pk_bf16_f32 v16, v112, v113
v_mfma_f32_16x16x32_bf16 v[144:147], a[192:195], v[32:35], v[144:147]
buffer_load_dwordx4 a[28:31], v1, s[12:15], s47 offen offset:3072 sc1
v_mfma_f32_16x16x32_bf16 v[148:151], a[196:199], v[32:35], v[148:151]
ds_read_b128 v[80:83], v2 offset:33504
v_cvt_pk_bf16_f32 v17, v114, v115
v_cvt_pk_bf16_f32 v18, v116, v117
v_cvt_pk_bf16_f32 v19, v118, v119
v_mfma_f32_16x16x32_bf16 v[152:155], a[192:195], v[36:39], v[152:155]
v_exp_f32_e64 v27, v27
v_mfma_f32_16x16x32_bf16 v[156:159], a[196:199], v[36:39], v[156:159]
s_waitcnt lgkmcnt(9)
s_add_u32 s49, s50, 98304
ds_read_b128 v[84:87], v2 offset:50144
v_add_f32 v26, 1.0, v26
v_mfma_f32_16x16x32_bf16 v[144:147], a[200:203], v[40:43], v[144:147]
buffer_store_dwordx4 v[16:19], v1, s[60:63], s49 offen offset:0 sc1
v_mfma_f32_16x16x32_bf16 v[148:151], a[204:207], v[40:43], v[148:151]
ds_read_b128 v[88:91], v2 offset:33520
v_rcp_f32 v25, v25
v_mul_f32 v120, v120, v24
v_mfma_f32_16x16x32_bf16 v[152:155], a[200:203], v[44:47], v[152:155]
v_exp_f32_e64 v28, v28
v_mfma_f32_16x16x32_bf16 v[156:159], a[204:207], v[44:47], v[156:159]
s_waitcnt lgkmcnt(9)
ds_read_b128 v[92:95], v2 offset:50160
v_add_f32 v27, 1.0, v27
v_rcp_f32_e64 v26, v26
v_mfma_f32_16x16x32_bf16 v[144:147], a[208:211], v[48:51], v[144:147]
v_mul_f32_e64 v121, v121, v25
v_mfma_f32_16x16x32_bf16 v[148:151], a[212:215], v[48:51], v[148:151]
s_add_u32 s47, s46, 532480
ds_read_b128 v[32:35], v3 offset:0
v_exp_f32 v29, v29
v_add_f32 v28, 1.0, v28
v_mfma_f32_16x16x32_bf16 v[152:155], a[208:211], v[52:55], v[152:155]
buffer_load_dwordx4 a[32:35], v1, s[12:15], s47 offen offset:0 sc1
v_mfma_f32_16x16x32_bf16 v[156:159], a[212:215], v[52:55], v[156:159]
s_waitcnt lgkmcnt(9)
ds_read_b128 v[36:39], v3 offset:16640
v_rcp_f32 v27, v27
v_mul_f32_e64 v122, v122, v26
v_mfma_f32_16x16x32_bf16 v[144:147], a[216:219], v[56:59], v[144:147]
v_exp_f32_e64 v30, v30
v_mfma_f32_16x16x32_bf16 v[148:151], a[220:223], v[56:59], v[148:151]
ds_read_b128 v[40:43], v3 offset:16
v_add_f32 v29, 1.0, v29
v_rcp_f32 v28, v28
v_mfma_f32_16x16x32_bf16 v[152:155], a[216:219], v[60:63], v[152:155]
v_mul_f32_e64 v123, v123, v27
v_mfma_f32_16x16x32_bf16 v[156:159], a[220:223], v[60:63], v[156:159]
s_waitcnt lgkmcnt(9)
ds_read_b128 v[44:47], v3 offset:16656
v_exp_f32 v31, v31
v_add_f32_e64 v30, 1.0, v30
v_mfma_f32_16x16x32_bf16 v[144:147], a[224:227], v[64:67], v[144:147]
v_rcp_f32_e64 v29, v29
v_mfma_f32_16x16x32_bf16 v[148:151], a[228:231], v[64:67], v[148:151]
ds_read_b128 v[48:51], v3 offset:32
v_mul_f32 v124, v124, v28
v_add_f32 v31, 1.0, v31
v_mfma_f32_16x16x32_bf16 v[152:155], a[224:227], v[68:71], v[152:155]
v_rcp_f32_e64 v30, v30
v_mfma_f32_16x16x32_bf16 v[156:159], a[228:231], v[68:71], v[156:159]
s_waitcnt lgkmcnt(9)
ds_read_b128 v[52:55], v3 offset:16672
v_mul_f32 v125, v125, v29
v_rcp_f32_e64 v31, v31
v_mfma_f32_16x16x32_bf16 v[144:147], a[232:235], v[72:75], v[144:147]
buffer_load_dwordx4 a[36:39], v1, s[12:15], s47 offen offset:1024 sc1
v_mfma_f32_16x16x32_bf16 v[148:151], a[236:239], v[72:75], v[148:151]
ds_read_b128 v[56:59], v3 offset:48
v_mul_f32 v126, v126, v30
v_mul_f32 v127, v127, v31
v_cvt_pk_bf16_f32 v24, v120, v121
v_mfma_f32_16x16x32_bf16 v[152:155], a[232:235], v[76:79], v[152:155]
v_cvt_pk_bf16_f32 v25, v122, v123
v_cvt_pk_bf16_f32 v26, v124, v125
v_mfma_f32_16x16x32_bf16 v[156:159], a[236:239], v[76:79], v[156:159]
s_waitcnt lgkmcnt(9)
s_nop 0
ds_read_b128 v[60:63], v3 offset:16688
v_cvt_pk_bf16_f32 v27, v126, v127
v_cvt_pk_bf16_f32 v160, v128, v129
v_mfma_f32_16x16x32_bf16 v[144:147], a[240:243], v[80:83], v[144:147]
v_cvt_pk_bf16_f32 v161, v130, v131
v_cvt_pk_bf16_f32 v162, v132, v133
v_mfma_f32_16x16x32_bf16 v[148:151], a[244:247], v[80:83], v[148:151]
s_add_u32 s49, s50, 114688
ds_read_b128 v[64:67], v3 offset:64
v_cvt_pk_bf16_f32 v163, v134, v135
v_cvt_pk_bf16_f32 v164, v136, v137
v_cvt_pk_bf16_f32 v165, v138, v139
v_mfma_f32_16x16x32_bf16 v[152:155], a[240:243], v[84:87], v[152:155]
buffer_store_dwordx4 v[24:27], v1, s[60:63], s49 offen offset:0 sc1
v_mfma_f32_16x16x32_bf16 v[156:159], a[244:247], v[84:87], v[156:159]
s_waitcnt lgkmcnt(9)
s_nop 0
ds_read_b128 v[68:71], v3 offset:16704
v_cvt_pk_bf16_f32 v166, v140, v141
v_cvt_pk_bf16_f32 v167, v142, v143
v_mfma_f32_16x16x32_bf16 v[144:147], a[248:251], v[88:91], v[144:147]
v_mfma_f32_16x16x32_bf16 v[148:151], a[252:255], v[88:91], v[148:151]
ds_read_b128 v[72:75], v3 offset:80
v_mfma_f32_16x16x32_bf16 v[152:155], a[248:251], v[92:95], v[152:155]
v_mfma_f32_16x16x32_bf16 v[156:159], a[252:255], v[92:95], v[156:159]
s_waitcnt lgkmcnt(9)
ds_read_b128 v[76:79], v3 offset:16720
s_add_u32 s49, s51, 0
buffer_store_dwordx4 v[160:163], v1, s[52:55], s49 offen offset:0 sc1
s_add_u32 s49, s51, 1024
buffer_store_dwordx4 v[164:167], v1, s[52:55], s49 offen offset:0 sc1
v_mfma_f32_16x16x32_bf16 v[96:99], a[128:131], v[32:35], 0
v_mfma_f32_16x16x32_bf16 v[100:103], a[132:135], v[32:35], 0
ds_read_b128 v[80:83], v3 offset:96
v_mfma_f32_16x16x32_bf16 v[104:107], a[128:131], v[36:39], 0
buffer_load_dwordx4 a[40:43], v1, s[12:15], s47 offen offset:2048 sc1
v_mfma_f32_16x16x32_bf16 v[108:111], a[132:135], v[36:39], 0
s_waitcnt lgkmcnt(9)
s_nop 0
ds_read_b128 v[84:87], v3 offset:16736
v_mfma_f32_16x16x32_bf16 v[96:99], a[136:139], v[40:43], v[96:99]
v_cvt_pk_bf16_f32 v24, v144, v145
v_cvt_pk_bf16_f32 v25, v146, v147
v_mfma_f32_16x16x32_bf16 v[100:103], a[140:143], v[40:43], v[100:103]
ds_read_b128 v[88:91], v3 offset:112
v_mfma_f32_16x16x32_bf16 v[104:107], a[136:139], v[44:47], v[104:107]
v_cvt_pk_bf16_f32 v26, v148, v149
v_cvt_pk_bf16_f32 v27, v150, v151
v_mfma_f32_16x16x32_bf16 v[108:111], a[140:143], v[44:47], v[108:111]
s_waitcnt lgkmcnt(9)
s_nop 0
ds_read_b128 v[92:95], v3 offset:16752
v_mfma_f32_16x16x32_bf16 v[96:99], a[144:147], v[48:51], v[96:99]
buffer_load_dwordx4 a[44:47], v1, s[12:15], s47 offen offset:3072 sc1
v_mfma_f32_16x16x32_bf16 v[100:103], a[148:151], v[48:51], v[100:103]
s_add_u32 s49, s51, 32768
ds_read_b128 v[32:35], v3 offset:128
v_mfma_f32_16x16x32_bf16 v[104:107], a[144:147], v[52:55], v[104:107]
buffer_store_dwordx4 v[24:27], v1, s[52:55], s49 offen offset:0 sc1
v_mfma_f32_16x16x32_bf16 v[108:111], a[148:151], v[52:55], v[108:111]
s_waitcnt lgkmcnt(9)
s_nop 0
s_add_u32 s47, s46, 536576
ds_read_b128 v[36:39], v3 offset:16768
v_mfma_f32_16x16x32_bf16 v[96:99], a[152:155], v[56:59], v[96:99]
buffer_load_dwordx4 a[48:51], v1, s[12:15], s47 offen offset:0 sc1
v_mfma_f32_16x16x32_bf16 v[100:103], a[156:159], v[56:59], v[100:103]
ds_read_b128 v[40:43], v3 offset:144
v_mfma_f32_16x16x32_bf16 v[104:107], a[152:155], v[60:63], v[104:107]
v_cvt_pk_bf16_f32 v28, v152, v153
v_cvt_pk_bf16_f32 v29, v154, v155
v_mfma_f32_16x16x32_bf16 v[108:111], a[156:159], v[60:63], v[108:111]
s_waitcnt lgkmcnt(9)
s_nop 0
ds_read_b128 v[44:47], v3 offset:16784
v_mfma_f32_16x16x32_bf16 v[96:99], a[160:163], v[64:67], v[96:99]
v_cvt_pk_bf16_f32 v30, v156, v157
v_cvt_pk_bf16_f32 v31, v158, v159
v_mfma_f32_16x16x32_bf16 v[100:103], a[164:167], v[64:67], v[100:103]
ds_read_b128 v[48:51], v3 offset:160
v_mfma_f32_16x16x32_bf16 v[104:107], a[160:163], v[68:71], v[104:107]
buffer_load_dwordx4 a[52:55], v1, s[12:15], s47 offen offset:1024 sc1
v_mfma_f32_16x16x32_bf16 v[108:111], a[164:167], v[68:71], v[108:111]
s_waitcnt lgkmcnt(9)
s_nop 0
ds_read_b128 v[52:55], v3 offset:16800
v_mfma_f32_16x16x32_bf16 v[96:99], a[168:171], v[72:75], v[96:99]
v_mfma_f32_16x16x32_bf16 v[100:103], a[172:175], v[72:75], v[100:103]
ds_read_b128 v[56:59], v3 offset:176
v_mfma_f32_16x16x32_bf16 v[104:107], a[168:171], v[76:79], v[104:107]
buffer_load_dwordx4 a[56:59], v1, s[12:15], s47 offen offset:2048 sc1
v_mfma_f32_16x16x32_bf16 v[108:111], a[172:175], v[76:79], v[108:111]
s_waitcnt lgkmcnt(9)
s_nop 0
ds_read_b128 v[60:63], v3 offset:16816
v_mfma_f32_16x16x32_bf16 v[96:99], a[176:179], v[80:83], v[96:99]
v_mfma_f32_16x16x32_bf16 v[100:103], a[180:183], v[80:83], v[100:103]
ds_read_b128 v[64:67], v3 offset:192
v_mfma_f32_16x16x32_bf16 v[104:107], a[176:179], v[84:87], v[104:107]
v_mfma_f32_16x16x32_bf16 v[108:111], a[180:183], v[84:87], v[108:111]
s_waitcnt lgkmcnt(9)
s_nop 0
ds_read_b128 v[68:71], v3 offset:16832
v_mfma_f32_16x16x32_bf16 v[96:99], a[184:187], v[88:91], v[96:99]
buffer_load_dwordx4 a[60:63], v1, s[12:15], s47 offen offset:3072 sc1
v_mfma_f32_16x16x32_bf16 v[100:103], a[188:191], v[88:91], v[100:103]
ds_read_b128 v[72:75], v3 offset:208
v_mfma_f32_16x16x32_bf16 v[104:107], a[184:187], v[92:95], v[104:107]
v_mfma_f32_16x16x32_bf16 v[108:111], a[188:191], v[92:95], v[108:111]
s_waitcnt lgkmcnt(9)
s_nop 0
s_add_u32 s47, s46, 540672
ds_read_b128 v[76:79], v3 offset:16848
v_mfma_f32_16x16x32_bf16 v[96:99], a[192:195], v[32:35], v[96:99]
buffer_load_dwordx4 a[64:67], v1, s[12:15], s47 offen offset:0 sc1
v_mfma_f32_16x16x32_bf16 v[100:103], a[196:199], v[32:35], v[100:103]
ds_read_b128 v[80:83], v3 offset:224
v_mfma_f32_16x16x32_bf16 v[104:107], a[192:195], v[36:39], v[104:107]
v_mfma_f32_16x16x32_bf16 v[108:111], a[196:199], v[36:39], v[108:111]
s_waitcnt lgkmcnt(9)
s_nop 0
s_add_u32 s49, s51, 33792
ds_read_b128 v[84:87], v3 offset:16864
v_mfma_f32_16x16x32_bf16 v[96:99], a[200:203], v[40:43], v[96:99]
buffer_store_dwordx4 v[28:31], v1, s[52:55], s49 offen offset:0 sc1
v_mfma_f32_16x16x32_bf16 v[100:103], a[204:207], v[40:43], v[100:103]
ds_read_b128 v[88:91], v3 offset:240
v_mfma_f32_16x16x32_bf16 v[104:107], a[200:203], v[44:47], v[104:107]
buffer_load_dwordx4 a[68:71], v1, s[12:15], s47 offen offset:1024 sc1
v_mfma_f32_16x16x32_bf16 v[108:111], a[204:207], v[44:47], v[108:111]
s_waitcnt lgkmcnt(9)
s_nop 0
ds_read_b128 v[92:95], v3 offset:16880
v_mfma_f32_16x16x32_bf16 v[96:99], a[208:211], v[48:51], v[96:99]
v_mfma_f32_16x16x32_bf16 v[100:103], a[212:215], v[48:51], v[100:103]
ds_read_b128 v[32:35], v10 offset:0
v_mfma_f32_16x16x32_bf16 v[104:107], a[208:211], v[52:55], v[104:107]
buffer_load_dwordx4 a[72:75], v1, s[12:15], s47 offen offset:2048 sc1
v_mfma_f32_16x16x32_bf16 v[108:111], a[212:215], v[52:55], v[108:111]
s_waitcnt lgkmcnt(9)
s_nop 0
ds_read_b128 v[36:39], v10 offset:16640
v_mfma_f32_16x16x32_bf16 v[96:99], a[216:219], v[56:59], v[96:99]
v_mfma_f32_16x16x32_bf16 v[100:103], a[220:223], v[56:59], v[100:103]
ds_read_b128 v[40:43], v10 offset:16
v_mfma_f32_16x16x32_bf16 v[104:107], a[216:219], v[60:63], v[104:107]
v_mfma_f32_16x16x32_bf16 v[108:111], a[220:223], v[60:63], v[108:111]
s_waitcnt lgkmcnt(9)
s_nop 0
ds_read_b128 v[44:47], v10 offset:16656
v_mfma_f32_16x16x32_bf16 v[96:99], a[224:227], v[64:67], v[96:99]
buffer_load_dwordx4 a[76:79], v1, s[12:15], s47 offen offset:3072 sc1
v_mfma_f32_16x16x32_bf16 v[100:103], a[228:231], v[64:67], v[100:103]
ds_read_b128 v[48:51], v10 offset:32
v_mfma_f32_16x16x32_bf16 v[104:107], a[224:227], v[68:71], v[104:107]
v_mfma_f32_16x16x32_bf16 v[108:111], a[228:231], v[68:71], v[108:111]
s_waitcnt lgkmcnt(9)
s_nop 0
s_add_u32 s47, s46, 544768
ds_read_b128 v[52:55], v10 offset:16672
v_mfma_f32_16x16x32_bf16 v[96:99], a[232:235], v[72:75], v[96:99]
buffer_load_dwordx4 a[80:83], v1, s[12:15], s47 offen offset:0 sc1
v_mfma_f32_16x16x32_bf16 v[100:103], a[236:239], v[72:75], v[100:103]
ds_read_b128 v[56:59], v10 offset:48
v_mfma_f32_16x16x32_bf16 v[104:107], a[232:235], v[76:79], v[104:107]
v_mfma_f32_16x16x32_bf16 v[108:111], a[236:239], v[76:79], v[108:111]
s_waitcnt lgkmcnt(9)
s_nop 0
ds_read_b128 v[60:63], v10 offset:16688
v_mfma_f32_16x16x32_bf16 v[96:99], a[240:243], v[80:83], v[96:99]
v_mfma_f32_16x16x32_bf16 v[100:103], a[244:247], v[80:83], v[100:103]
ds_read_b128 v[64:67], v10 offset:64
v_mfma_f32_16x16x32_bf16 v[104:107], a[240:243], v[84:87], v[104:107]
buffer_load_dwordx4 a[84:87], v1, s[12:15], s47 offen offset:1024 sc1
v_mfma_f32_16x16x32_bf16 v[108:111], a[244:247], v[84:87], v[108:111]
s_waitcnt lgkmcnt(9)
s_nop 0
ds_read_b128 v[68:71], v10 offset:16704
v_mfma_f32_16x16x32_bf16 v[96:99], a[248:251], v[88:91], v[96:99]
v_mfma_f32_16x16x32_bf16 v[100:103], a[252:255], v[88:91], v[100:103]
ds_read_b128 v[72:75], v10 offset:80
v_mfma_f32_16x16x32_bf16 v[104:107], a[248:251], v[92:95], v[104:107]
v_mfma_f32_16x16x32_bf16 v[108:111], a[252:255], v[92:95], v[108:111]
s_waitcnt lgkmcnt(9)
s_nop 0
ds_read_b128 v[76:79], v10 offset:16720
v_mfma_f32_16x16x32_bf16 v[112:115], a[128:131], v[32:35], 0
v_mfma_f32_16x16x32_bf16 v[116:119], a[132:135], v[32:35], 0
ds_read_b128 v[80:83], v10 offset:96
v_mfma_f32_16x16x32_bf16 v[120:123], a[128:131], v[36:39], 0
buffer_load_dwordx4 a[88:91], v1, s[12:15], s47 offen offset:2048 sc1
v_mfma_f32_16x16x32_bf16 v[124:127], a[132:135], v[36:39], 0
s_waitcnt lgkmcnt(9)
s_nop 0
ds_read_b128 v[84:87], v10 offset:16736
v_mfma_f32_16x16x32_bf16 v[112:115], a[136:139], v[40:43], v[112:115]
v_cvt_pk_bf16_f32 v24, v96, v97
v_cvt_pk_bf16_f32 v25, v98, v99
v_mfma_f32_16x16x32_bf16 v[116:119], a[140:143], v[40:43], v[116:119]
ds_read_b128 v[88:91], v10 offset:112
v_mfma_f32_16x16x32_bf16 v[120:123], a[136:139], v[44:47], v[120:123]
v_cvt_pk_bf16_f32 v26, v100, v101
v_cvt_pk_bf16_f32 v27, v102, v103
v_mfma_f32_16x16x32_bf16 v[124:127], a[140:143], v[44:47], v[124:127]
s_waitcnt lgkmcnt(9)
s_nop 0
ds_read_b128 v[92:95], v10 offset:16752
v_mfma_f32_16x16x32_bf16 v[112:115], a[144:147], v[48:51], v[112:115]
buffer_load_dwordx4 a[92:95], v1, s[12:15], s47 offen offset:3072 sc1
v_mfma_f32_16x16x32_bf16 v[116:119], a[148:151], v[48:51], v[116:119]
s_add_u32 s49, s51, 65536
ds_read_b128 v[32:35], v10 offset:128
v_mfma_f32_16x16x32_bf16 v[120:123], a[144:147], v[52:55], v[120:123]
buffer_store_dwordx4 v[24:27], v1, s[52:55], s49 offen offset:0 sc1
v_mfma_f32_16x16x32_bf16 v[124:127], a[148:151], v[52:55], v[124:127]
s_waitcnt lgkmcnt(9)
s_nop 0
ds_read_b128 v[36:39], v10 offset:16768
v_mfma_f32_16x16x32_bf16 v[112:115], a[152:155], v[56:59], v[112:115]
v_cvt_pk_bf16_f32 v28, v104, v105
v_cvt_pk_bf16_f32 v29, v106, v107
v_mfma_f32_16x16x32_bf16 v[116:119], a[156:159], v[56:59], v[116:119]
s_add_u32 s47, s46, 548864
ds_read_b128 v[40:43], v10 offset:144
v_mfma_f32_16x16x32_bf16 v[120:123], a[152:155], v[60:63], v[120:123]
buffer_load_dwordx4 a[96:99], v1, s[12:15], s47 offen offset:0 sc1
v_mfma_f32_16x16x32_bf16 v[124:127], a[156:159], v[60:63], v[124:127]
s_waitcnt lgkmcnt(9)
s_nop 0
ds_read_b128 v[44:47], v10 offset:16784
v_mfma_f32_16x16x32_bf16 v[112:115], a[160:163], v[64:67], v[112:115]
v_cvt_pk_bf16_f32 v30, v108, v109
v_cvt_pk_bf16_f32 v31, v110, v111
v_mfma_f32_16x16x32_bf16 v[116:119], a[164:167], v[64:67], v[116:119]
ds_read_b128 v[48:51], v10 offset:160
v_mfma_f32_16x16x32_bf16 v[120:123], a[160:163], v[68:71], v[120:123]
v_mfma_f32_16x16x32_bf16 v[124:127], a[164:167], v[68:71], v[124:127]
s_waitcnt lgkmcnt(9)
s_nop 0
ds_read_b128 v[52:55], v10 offset:16800
v_mfma_f32_16x16x32_bf16 v[112:115], a[168:171], v[72:75], v[112:115]
buffer_load_dwordx4 a[100:103], v1, s[12:15], s47 offen offset:1024 sc1
v_mfma_f32_16x16x32_bf16 v[116:119], a[172:175], v[72:75], v[116:119]
ds_read_b128 v[56:59], v10 offset:176
v_mfma_f32_16x16x32_bf16 v[120:123], a[168:171], v[76:79], v[120:123]
v_mfma_f32_16x16x32_bf16 v[124:127], a[172:175], v[76:79], v[124:127]
s_waitcnt lgkmcnt(9)
s_nop 0
ds_read_b128 v[60:63], v10 offset:16816
v_mfma_f32_16x16x32_bf16 v[112:115], a[176:179], v[80:83], v[112:115]
v_mfma_f32_16x16x32_bf16 v[116:119], a[180:183], v[80:83], v[116:119]
ds_read_b128 v[64:67], v10 offset:192
v_mfma_f32_16x16x32_bf16 v[120:123], a[176:179], v[84:87], v[120:123]
buffer_load_dwordx4 a[104:107], v1, s[12:15], s47 offen offset:2048 sc1
v_mfma_f32_16x16x32_bf16 v[124:127], a[180:183], v[84:87], v[124:127]
s_waitcnt lgkmcnt(9)
s_nop 0
ds_read_b128 v[68:71], v10 offset:16832
v_mfma_f32_16x16x32_bf16 v[112:115], a[184:187], v[88:91], v[112:115]
v_mfma_f32_16x16x32_bf16 v[116:119], a[188:191], v[88:91], v[116:119]
ds_read_b128 v[72:75], v10 offset:208
v_mfma_f32_16x16x32_bf16 v[120:123], a[184:187], v[92:95], v[120:123]
v_mfma_f32_16x16x32_bf16 v[124:127], a[188:191], v[92:95], v[124:127]
s_waitcnt lgkmcnt(9)
s_nop 0
ds_read_b128 v[76:79], v10 offset:16848
v_mfma_f32_16x16x32_bf16 v[112:115], a[192:195], v[32:35], v[112:115]
buffer_load_dwordx4 a[108:111], v1, s[12:15], s47 offen offset:3072 sc1
v_mfma_f32_16x16x32_bf16 v[116:119], a[196:199], v[32:35], v[116:119]
ds_read_b128 v[80:83], v10 offset:224
v_mfma_f32_16x16x32_bf16 v[120:123], a[192:195], v[36:39], v[120:123]
v_mfma_f32_16x16x32_bf16 v[124:127], a[196:199], v[36:39], v[124:127]
s_waitcnt lgkmcnt(9)
s_nop 0
s_add_u32 s49, s51, 66560
ds_read_b128 v[84:87], v10 offset:16864
v_mfma_f32_16x16x32_bf16 v[112:115], a[200:203], v[40:43], v[112:115]
buffer_store_dwordx4 v[28:31], v1, s[52:55], s49 offen offset:0 sc1
v_mfma_f32_16x16x32_bf16 v[116:119], a[204:207], v[40:43], v[116:119]
s_add_u32 s47, s46, 552960
ds_read_b128 v[88:91], v10 offset:240
v_mfma_f32_16x16x32_bf16 v[120:123], a[200:203], v[44:47], v[120:123]
buffer_load_dwordx4 a[112:115], v1, s[12:15], s47 offen offset:0 sc1
v_mfma_f32_16x16x32_bf16 v[124:127], a[204:207], v[44:47], v[124:127]
s_waitcnt lgkmcnt(9)
s_nop 0
ds_read_b128 v[92:95], v10 offset:16880
v_mfma_f32_16x16x32_bf16 v[112:115], a[208:211], v[48:51], v[112:115]
v_mfma_f32_16x16x32_bf16 v[116:119], a[212:215], v[48:51], v[116:119]
ds_read_b128 v[32:35], v2 offset:0
v_mfma_f32_16x16x32_bf16 v[120:123], a[208:211], v[52:55], v[120:123]
v_mfma_f32_16x16x32_bf16 v[124:127], a[212:215], v[52:55], v[124:127]
s_waitcnt lgkmcnt(9)
s_nop 0
ds_read_b128 v[36:39], v2 offset:16640
v_mfma_f32_16x16x32_bf16 v[112:115], a[216:219], v[56:59], v[112:115]
buffer_load_dwordx4 a[116:119], v1, s[12:15], s47 offen offset:1024 sc1
v_mfma_f32_16x16x32_bf16 v[116:119], a[220:223], v[56:59], v[116:119]
ds_read_b128 v[40:43], v2 offset:16
v_mfma_f32_16x16x32_bf16 v[120:123], a[216:219], v[60:63], v[120:123]
v_mfma_f32_16x16x32_bf16 v[124:127], a[220:223], v[60:63], v[124:127]
s_waitcnt lgkmcnt(9)
s_nop 0
ds_read_b128 v[44:47], v2 offset:16656
v_mfma_f32_16x16x32_bf16 v[112:115], a[224:227], v[64:67], v[112:115]
v_mfma_f32_16x16x32_bf16 v[116:119], a[228:231], v[64:67], v[116:119]
ds_read_b128 v[48:51], v2 offset:32
v_mfma_f32_16x16x32_bf16 v[120:123], a[224:227], v[68:71], v[120:123]
buffer_load_dwordx4 a[120:123], v1, s[12:15], s47 offen offset:2048 sc1
v_mfma_f32_16x16x32_bf16 v[124:127], a[228:231], v[68:71], v[124:127]
s_waitcnt lgkmcnt(9)
s_nop 0
ds_read_b128 v[52:55], v2 offset:16672
v_mfma_f32_16x16x32_bf16 v[112:115], a[232:235], v[72:75], v[112:115]
v_mfma_f32_16x16x32_bf16 v[116:119], a[236:239], v[72:75], v[116:119]
ds_read_b128 v[56:59], v2 offset:48
v_mfma_f32_16x16x32_bf16 v[120:123], a[232:235], v[76:79], v[120:123]
v_mfma_f32_16x16x32_bf16 v[124:127], a[236:239], v[76:79], v[124:127]
s_waitcnt lgkmcnt(9)
s_nop 0
ds_read_b128 v[60:63], v2 offset:16688
v_mfma_f32_16x16x32_bf16 v[112:115], a[240:243], v[80:83], v[112:115]
buffer_load_dwordx4 a[124:127], v1, s[12:15], s47 offen offset:3072 sc1
v_mfma_f32_16x16x32_bf16 v[116:119], a[244:247], v[80:83], v[116:119]
ds_read_b128 v[64:67], v2 offset:64
v_mfma_f32_16x16x32_bf16 v[120:123], a[240:243], v[84:87], v[120:123]
v_mfma_f32_16x16x32_bf16 v[124:127], a[244:247], v[84:87], v[124:127]
s_waitcnt lgkmcnt(9)
s_nop 0
ds_read_b128 v[68:71], v2 offset:16704
v_mfma_f32_16x16x32_bf16 v[112:115], a[248:251], v[88:91], v[112:115]
v_mfma_f32_16x16x32_bf16 v[116:119], a[252:255], v[88:91], v[116:119]
ds_read_b128 v[72:75], v2 offset:80
v_mfma_f32_16x16x32_bf16 v[120:123], a[248:251], v[92:95], v[120:123]
v_mfma_f32_16x16x32_bf16 v[124:127], a[252:255], v[92:95], v[124:127]
s_waitcnt lgkmcnt(9) vmcnt(39)
s_nop 0
ds_read_b128 v[76:79], v2 offset:16720
v_mfma_f32_16x16x32_bf16 v[96:99], a[0:3], v[32:35], 0
v_mfma_f32_16x16x32_bf16 v[100:103], a[4:7], v[32:35], 0
s_mov_b32 s6, 28672
ds_read_b128 v[80:83], v2 offset:96
v_mfma_f32_16x16x32_bf16 v[104:107], a[0:3], v[36:39], 0
buffer_load_dwordx4 v[192:195], v1, s[72:75], s6 offen offset:0 sc1
v_mfma_f32_16x16x32_bf16 v[108:111], a[4:7], v[36:39], 0
s_waitcnt lgkmcnt(9) vmcnt(38)
s_nop 0
ds_read_b128 v[84:87], v2 offset:16736
v_mfma_f32_16x16x32_bf16 v[96:99], a[8:11], v[40:43], v[96:99]
v_cvt_pk_bf16_f32 v24, v112, v113
v_cvt_pk_bf16_f32 v25, v114, v115
v_mfma_f32_16x16x32_bf16 v[100:103], a[12:15], v[40:43], v[100:103]
ds_read_b128 v[88:91], v2 offset:112
v_mfma_f32_16x16x32_bf16 v[104:107], a[8:11], v[44:47], v[104:107]
v_cvt_pk_bf16_f32 v26, v116, v117
v_cvt_pk_bf16_f32 v27, v118, v119
v_mfma_f32_16x16x32_bf16 v[108:111], a[12:15], v[44:47], v[108:111]
s_waitcnt lgkmcnt(9) vmcnt(35)
s_nop 0
ds_read_b128 v[92:95], v2 offset:16752
v_mfma_f32_16x16x32_bf16 v[96:99], a[16:19], v[48:51], v[96:99]
v_cvt_pk_bf16_f32 v28, v120, v121
v_cvt_pk_bf16_f32 v29, v122, v123
v_mfma_f32_16x16x32_bf16 v[100:103], a[20:23], v[48:51], v[100:103]
s_add_u32 s49, s51, 98304
ds_read_b128 v[32:35], v2 offset:128
v_mfma_f32_16x16x32_bf16 v[104:107], a[16:19], v[52:55], v[104:107]
buffer_store_dwordx4 v[24:27], v1, s[52:55], s49 offen offset:0 sc1
v_mfma_f32_16x16x32_bf16 v[108:111], a[20:23], v[52:55], v[108:111]
s_waitcnt lgkmcnt(9) vmcnt(34)
s_nop 0
ds_read_b128 v[36:39], v2 offset:16768
v_mfma_f32_16x16x32_bf16 v[96:99], a[24:27], v[56:59], v[96:99]
buffer_load_dwordx4 v[196:199], v1, s[72:75], s6 offen offset:1024 sc1
v_mfma_f32_16x16x32_bf16 v[100:103], a[28:31], v[56:59], v[100:103]
ds_read_b128 v[40:43], v2 offset:144
v_mfma_f32_16x16x32_bf16 v[104:107], a[24:27], v[60:63], v[104:107]
v_cvt_pk_bf16_f32 v30, v124, v125
v_cvt_pk_bf16_f32 v31, v126, v127
v_mfma_f32_16x16x32_bf16 v[108:111], a[28:31], v[60:63], v[108:111]
s_waitcnt lgkmcnt(9) vmcnt(32)
s_nop 0
ds_read_b128 v[44:47], v2 offset:16784
v_mfma_f32_16x16x32_bf16 v[96:99], a[32:35], v[64:67], v[96:99]
buffer_load_dwordx4 v[200:203], v1, s[72:75], s6 offen offset:2048 sc1
v_mfma_f32_16x16x32_bf16 v[100:103], a[36:39], v[64:67], v[100:103]
ds_read_b128 v[48:51], v2 offset:160
v_mfma_f32_16x16x32_bf16 v[104:107], a[32:35], v[68:71], v[104:107]
v_mfma_f32_16x16x32_bf16 v[108:111], a[36:39], v[68:71], v[108:111]
s_waitcnt lgkmcnt(9) vmcnt(28)
s_nop 0
ds_read_b128 v[52:55], v2 offset:16800
v_mfma_f32_16x16x32_bf16 v[96:99], a[40:43], v[72:75], v[96:99]
v_mfma_f32_16x16x32_bf16 v[100:103], a[44:47], v[72:75], v[100:103]
ds_read_b128 v[56:59], v2 offset:176
v_mfma_f32_16x16x32_bf16 v[104:107], a[40:43], v[76:79], v[104:107]
buffer_load_dwordx4 v[204:207], v1, s[72:75], s6 offen offset:3072 sc1
v_mfma_f32_16x16x32_bf16 v[108:111], a[44:47], v[76:79], v[108:111]
s_waitcnt lgkmcnt(9) vmcnt(26)
s_nop 0
ds_read_b128 v[60:63], v2 offset:16816
v_mfma_f32_16x16x32_bf16 v[96:99], a[48:51], v[80:83], v[96:99]
v_mfma_f32_16x16x32_bf16 v[100:103], a[52:55], v[80:83], v[100:103]
ds_read_b128 v[64:67], v2 offset:192
v_mfma_f32_16x16x32_bf16 v[104:107], a[48:51], v[84:87], v[104:107]
v_mfma_f32_16x16x32_bf16 v[108:111], a[52:55], v[84:87], v[108:111]
s_waitcnt lgkmcnt(9) vmcnt(24)
s_nop 0
ds_read_b128 v[68:71], v2 offset:16832
v_mfma_f32_16x16x32_bf16 v[96:99], a[56:59], v[88:91], v[96:99]
v_mfma_f32_16x16x32_bf16 v[100:103], a[60:63], v[88:91], v[100:103]
ds_read_b128 v[72:75], v2 offset:208
v_mfma_f32_16x16x32_bf16 v[104:107], a[56:59], v[92:95], v[104:107]
v_mfma_f32_16x16x32_bf16 v[108:111], a[60:63], v[92:95], v[108:111]
s_waitcnt lgkmcnt(9) vmcnt(21)
s_nop 0
ds_read_b128 v[76:79], v2 offset:16848
v_mfma_f32_16x16x32_bf16 v[96:99], a[64:67], v[32:35], v[96:99]
v_mfma_f32_16x16x32_bf16 v[100:103], a[68:71], v[32:35], v[100:103]
ds_read_b128 v[80:83], v2 offset:224
v_mfma_f32_16x16x32_bf16 v[104:107], a[64:67], v[36:39], v[104:107]
v_mfma_f32_16x16x32_bf16 v[108:111], a[68:71], v[36:39], v[108:111]
s_waitcnt lgkmcnt(9) vmcnt(19)
s_nop 0
s_add_u32 s49, s51, 99328
ds_read_b128 v[84:87], v2 offset:16864
v_mfma_f32_16x16x32_bf16 v[96:99], a[72:75], v[40:43], v[96:99]
buffer_store_dwordx4 v[28:31], v1, s[52:55], s49 offen offset:0 sc1
v_mfma_f32_16x16x32_bf16 v[100:103], a[76:79], v[40:43], v[100:103]
ds_read_b128 v[88:91], v2 offset:240
v_mfma_f32_16x16x32_bf16 v[104:107], a[72:75], v[44:47], v[104:107]
v_mfma_f32_16x16x32_bf16 v[108:111], a[76:79], v[44:47], v[108:111]
s_waitcnt lgkmcnt(9) vmcnt(18)
s_nop 0
ds_read_b128 v[92:95], v2 offset:16880
v_mfma_f32_16x16x32_bf16 v[96:99], a[80:83], v[48:51], v[96:99]
v_mfma_f32_16x16x32_bf16 v[100:103], a[84:87], v[48:51], v[100:103]
ds_read_b128 v[32:35], v2 offset:33280
v_mfma_f32_16x16x32_bf16 v[104:107], a[80:83], v[52:55], v[104:107]
v_mfma_f32_16x16x32_bf16 v[108:111], a[84:87], v[52:55], v[108:111]
s_waitcnt lgkmcnt(9) vmcnt(16)
s_nop 0
ds_read_b128 v[36:39], v2 offset:49920
v_mfma_f32_16x16x32_bf16 v[96:99], a[88:91], v[56:59], v[96:99]
v_mfma_f32_16x16x32_bf16 v[100:103], a[92:95], v[56:59], v[100:103]
ds_read_b128 v[40:43], v2 offset:33296
v_mfma_f32_16x16x32_bf16 v[104:107], a[88:91], v[60:63], v[104:107]
v_mfma_f32_16x16x32_bf16 v[108:111], a[92:95], v[60:63], v[108:111]
s_waitcnt lgkmcnt(9) vmcnt(13)
ds_read_b128 v[44:47], v2 offset:49936
v_mfma_f32_16x16x32_bf16 v[96:99], a[96:99], v[64:67], v[96:99]
v_mfma_f32_16x16x32_bf16 v[100:103], a[100:103], v[64:67], v[100:103]
ds_read_b128 v[48:51], v2 offset:33312
v_mfma_f32_16x16x32_bf16 v[104:107], a[96:99], v[68:71], v[104:107]
s_waitcnt vmcnt(0)
s_mov_b64 exec, 1
buffer_store_dword v7, off, s[72:75], s41 offset:0 sc1
s_mov_b64 exec, -1
v_mfma_f32_16x16x32_bf16 v[108:111], a[100:103], v[68:71], v[108:111]
s_waitcnt lgkmcnt(9)
s_nop 0
ds_read_b128 v[52:55], v2 offset:49952
v_mfma_f32_16x16x32_bf16 v[96:99], a[104:107], v[72:75], v[96:99]
v_mfma_f32_16x16x32_bf16 v[100:103], a[108:111], v[72:75], v[100:103]
ds_read_b128 v[56:59], v2 offset:33328
v_mfma_f32_16x16x32_bf16 v[104:107], a[104:107], v[76:79], v[104:107]
v_mfma_f32_16x16x32_bf16 v[108:111], a[108:111], v[76:79], v[108:111]
s_waitcnt lgkmcnt(9)
ds_read_b128 v[60:63], v2 offset:49968
v_mfma_f32_16x16x32_bf16 v[96:99], a[112:115], v[80:83], v[96:99]
v_xor_b32 v192, v192, v7
v_bitop3_b32 v192, v193, v7, v192 bitop3:0xbe
v_bitop3_b32 v192, v194, v7, v192 bitop3:0xbe
v_bitop3_b32 v192, v195, v7, v192 bitop3:0xbe
v_bitop3_b32 v192, v196, v7, v192 bitop3:0xbe
v_bitop3_b32 v192, v197, v7, v192 bitop3:0xbe
v_bitop3_b32 v192, v198, v7, v192 bitop3:0xbe
v_bitop3_b32 v192, v199, v7, v192 bitop3:0xbe
v_bitop3_b32 v192, v200, v7, v192 bitop3:0xbe
v_bitop3_b32 v192, v201, v7, v192 bitop3:0xbe
v_bitop3_b32 v192, v202, v7, v192 bitop3:0xbe
v_bitop3_b32 v192, v203, v7, v192 bitop3:0xbe
v_bitop3_b32 v192, v204, v7, v192 bitop3:0xbe
v_bitop3_b32 v192, v205, v7, v192 bitop3:0xbe
v_bitop3_b32 v192, v206, v7, v192 bitop3:0xbe
v_bitop3_b32 v192, v207, v7, v192 bitop3:0xbe
v_cmp_ne_u32 vcc, 0, v192
s_cbranch_vccnz L_sp_12
L_bk_13:
v_mfma_f32_16x16x32_bf16 v[100:103], a[116:119], v[80:83], v[100:103]
ds_read_b128 v[64:67], v2 offset:33344
v_mfma_f32_16x16x32_bf16 v[104:107], a[112:115], v[84:87], v[104:107]
v_mfma_f32_16x16x32_bf16 v[108:111], a[116:119], v[84:87], v[108:111]
s_waitcnt lgkmcnt(9)
s_nop 0
ds_read_b128 v[68:71], v2 offset:49984
v_mfma_f32_16x16x32_bf16 v[96:99], a[120:123], v[88:91], v[96:99]
v_mfma_f32_16x16x32_bf16 v[100:103], a[124:127], v[88:91], v[100:103]
ds_read_b128 v[72:75], v2 offset:33360
v_mfma_f32_16x16x32_bf16 v[104:107], a[120:123], v[92:95], v[104:107]
v_mfma_f32_16x16x32_bf16 v[108:111], a[124:127], v[92:95], v[108:111]
s_waitcnt lgkmcnt(9)
ds_read_b128 v[76:79], v2 offset:50000
v_mfma_f32_16x16x32_bf16 v[112:115], a[0:3], v[32:35], 0
v_mfma_f32_16x16x32_bf16 v[116:119], a[4:7], v[32:35], 0
s_barrier
ds_read_b128 v[80:83], v2 offset:33376
v_mfma_f32_16x16x32_bf16 v[120:123], a[0:3], v[36:39], 0
v_mfma_f32_16x16x32_bf16 v[124:127], a[4:7], v[36:39], 0
s_waitcnt lgkmcnt(9)
s_nop 0
ds_read_b128 v[84:87], v2 offset:50016
v_mfma_f32_16x16x32_bf16 v[112:115], a[8:11], v[40:43], v[112:115]
v_mfma_f32_16x16x32_bf16 v[116:119], a[12:15], v[40:43], v[116:119]
ds_read_b128 v[88:91], v2 offset:33392
v_pk_mul_f32 v[16:17], v[96:97], v[96:97]
v_pk_mul_f32 v[18:19], v[98:99], v[98:99]
v_pk_mul_f32 v[20:21], v[100:101], v[100:101]
v_pk_mul_f32 v[22:23], v[102:103], v[102:103]
v_pk_mul_f32 v[24:25], v[104:105], v[104:105]
v_pk_mul_f32 v[26:27], v[106:107], v[106:107]
v_pk_mul_f32 v[28:29], v[108:109], v[108:109]
v_pk_mul_f32 v[30:31], v[110:111], v[110:111]
v_pk_fma_f32 v[16:17], v[16:17], v[12:13], v[12:13] op_sel:[0,1,0] op_sel_hi:[1,1,0]
v_pk_fma_f32 v[18:19], v[18:19], v[12:13], v[12:13] op_sel:[0,1,0] op_sel_hi:[1,1,0]
v_pk_fma_f32 v[20:21], v[20:21], v[12:13], v[12:13] op_sel:[0,1,0] op_sel_hi:[1,1,0]
v_pk_fma_f32 v[22:23], v[22:23], v[12:13], v[12:13] op_sel:[0,1,0] op_sel_hi:[1,1,0]
v_pk_fma_f32 v[24:25], v[24:25], v[12:13], v[12:13] op_sel:[0,1,0] op_sel_hi:[1,1,0]
v_pk_fma_f32 v[26:27], v[26:27], v[12:13], v[12:13] op_sel:[0,1,0] op_sel_hi:[1,1,0]
v_pk_fma_f32 v[28:29], v[28:29], v[12:13], v[12:13] op_sel:[0,1,0] op_sel_hi:[1,1,0]
v_pk_fma_f32 v[30:31], v[30:31], v[12:13], v[12:13] op_sel:[0,1,0] op_sel_hi:[1,1,0]
v_pk_mul_f32 v[16:17], v[16:17], v[96:97]
v_pk_mul_f32 v[18:19], v[18:19], v[98:99]
v_pk_mul_f32 v[20:21], v[20:21], v[100:101]
v_pk_mul_f32 v[22:23], v[22:23], v[102:103]
v_pk_mul_f32 v[24:25], v[24:25], v[104:105]
v_pk_mul_f32 v[26:27], v[26:27], v[106:107]
v_pk_mul_f32 v[28:29], v[28:29], v[108:109]
v_pk_mul_f32 v[30:31], v[30:31], v[110:111]
v_mfma_f32_16x16x32_bf16 v[120:123], a[8:11], v[44:47], v[120:123]
v_exp_f32_e64 v16, v16
v_mfma_f32_16x16x32_bf16 v[124:127], a[12:15], v[44:47], v[124:127]
s_waitcnt lgkmcnt(9)
s_add_u32 m0, s27, 65536
s_add_u32 s29, s26, 4096
ds_read_b128 v[92:95], v2 offset:50032
v_exp_f32 v17, v17
v_add_f32 v16, 1.0, v16
v_exp_f32 v18, v18
v_add_f32_e64 v17, 1.0, v17
v_mfma_f32_16x16x32_bf16 v[112:115], a[16:19], v[48:51], v[112:115]
buffer_load_dwordx4 v1, s[8:11], s26 offen offset:0 sc1 lds
v_mfma_f32_16x16x32_bf16 v[116:119], a[20:23], v[48:51], v[116:119]
ds_read_b128 v[32:35], v2 offset:33408
v_rcp_f32 v16, v16
v_exp_f32 v19, v19
v_mfma_f32_16x16x32_bf16 v[120:123], a[16:19], v[52:55], v[120:123]
v_add_f32_e64 v18, 1.0, v18
v_mfma_f32_16x16x32_bf16 v[124:127], a[20:23], v[52:55], v[124:127]
s_waitcnt lgkmcnt(9)
s_add_u32 m0, s27, 65552
ds_read_b128 v[36:39], v2 offset:50048
v_rcp_f32 v17, v17
v_mul_f32_e64 v96, v96, v16
v_mfma_f32_16x16x32_bf16 v[112:115], a[24:27], v[56:59], v[112:115]
buffer_load_dwordx4 v1, s[8:11], s26 offen offset:1024 sc1 lds
v_mfma_f32_16x16x32_bf16 v[116:119], a[28:31], v[56:59], v[116:119]
ds_read_b128 v[40:43], v2 offset:33424
v_exp_f32 v20, v20
v_add_f32 v19, 1.0, v19
v_mfma_f32_16x16x32_bf16 v[120:123], a[24:27], v[60:63], v[120:123]
v_rcp_f32_e64 v18, v18
v_mfma_f32_16x16x32_bf16 v[124:127], a[28:31], v[60:63], v[124:127]
s_waitcnt lgkmcnt(9)
ds_read_b128 v[44:47], v2 offset:50064
v_mul_f32 v97, v97, v17
v_exp_f32_e64 v21, v21
v_mfma_f32_16x16x32_bf16 v[112:115], a[32:35], v[64:67], v[112:115]
v_add_f32_e64 v20, 1.0, v20
v_mfma_f32_16x16x32_bf16 v[116:119], a[36:39], v[64:67], v[116:119]
s_add_u32 m0, s27, 65568
ds_read_b128 v[48:51], v2 offset:33440
v_rcp_f32 v19, v19
v_mul_f32 v98, v98, v18
v_mfma_f32_16x16x32_bf16 v[120:123], a[32:35], v[68:71], v[120:123]
buffer_load_dwordx4 v1, s[8:11], s26 offen offset:2048 sc1 lds
v_mfma_f32_16x16x32_bf16 v[124:127], a[36:39], v[68:71], v[124:127]
s_waitcnt lgkmcnt(9)
ds_read_b128 v[52:55], v2 offset:50080
v_exp_f32 v22, v22
v_add_f32_e64 v21, 1.0, v21
v_mfma_f32_16x16x32_bf16 v[112:115], a[40:43], v[72:75], v[112:115]
v_rcp_f32_e64 v20, v20
v_mfma_f32_16x16x32_bf16 v[116:119], a[44:47], v[72:75], v[116:119]
s_add_u32 m0, s27, 65584
ds_read_b128 v[56:59], v2 offset:33456
v_mul_f32_e64 v99, v99, v19
v_mfma_f32_16x16x32_bf16 v[120:123], a[40:43], v[76:79], v[120:123]
buffer_load_dwordx4 v1, s[8:11], s26 offen offset:3072 sc1 lds
v_mfma_f32_16x16x32_bf16 v[124:127], a[44:47], v[76:79], v[124:127]
s_waitcnt lgkmcnt(9)
ds_read_b128 v[60:63], v2 offset:50096
v_exp_f32 v23, v23
v_add_f32_e64 v22, 1.0, v22
v_mfma_f32_16x16x32_bf16 v[112:115], a[48:51], v[80:83], v[112:115]
v_rcp_f32_e64 v21, v21
v_mfma_f32_16x16x32_bf16 v[116:119], a[52:55], v[80:83], v[116:119]
ds_read_b128 v[64:67], v2 offset:33472
v_mul_f32 v100, v100, v20
v_exp_f32 v24, v24
v_mfma_f32_16x16x32_bf16 v[120:123], a[48:51], v[84:87], v[120:123]
v_add_f32_e64 v23, 1.0, v23
v_mfma_f32_16x16x32_bf16 v[124:127], a[52:55], v[84:87], v[124:127]
s_waitcnt lgkmcnt(9)
s_add_u32 m0, s27, 69696
s_add_u32 s26, s26, 32768
ds_read_b128 v[68:71], v2 offset:50112
v_rcp_f32 v22, v22
v_mul_f32_e64 v101, v101, v21
v_mfma_f32_16x16x32_bf16 v[112:115], a[56:59], v[88:91], v[112:115]
buffer_load_dwordx4 v1, s[8:11], s29 offen offset:0 sc1 lds
v_mfma_f32_16x16x32_bf16 v[116:119], a[60:63], v[88:91], v[116:119]
ds_read_b128 v[72:75], v2 offset:33488
v_exp_f32 v25, v25
v_add_f32 v24, 1.0, v24
v_mfma_f32_16x16x32_bf16 v[120:123], a[56:59], v[92:95], v[120:123]
v_rcp_f32_e64 v23, v23
v_mfma_f32_16x16x32_bf16 v[124:127], a[60:63], v[92:95], v[124:127]
s_waitcnt lgkmcnt(9)
s_add_u32 m0, s27, 69712
ds_read_b128 v[76:79], v2 offset:50128
v_mul_f32 v102, v102, v22
v_exp_f32_e64 v26, v26
v_mfma_f32_16x16x32_bf16 v[112:115], a[64:67], v[32:35], v[112:115]
buffer_load_dwordx4 v1, s[8:11], s29 offen offset:1024 sc1 lds
v_mfma_f32_16x16x32_bf16 v[116:119], a[68:71], v[32:35], v[116:119]
ds_read_b128 v[80:83], v2 offset:33504
v_add_f32 v25, 1.0, v25
v_rcp_f32 v24, v24
v_mfma_f32_16x16x32_bf16 v[120:123], a[64:67], v[36:39], v[120:123]
v_mul_f32_e64 v103, v103, v23
v_cvt_pk_bf16_f32 v16, v96, v97
v_mfma_f32_16x16x32_bf16 v[124:127], a[68:71], v[36:39], v[124:127]
s_waitcnt lgkmcnt(9)
s_nop 0
ds_read_b128 v[84:87], v2 offset:50144
v_cvt_pk_bf16_f32 v17, v98, v99
v_cvt_pk_bf16_f32 v18, v100, v101
v_mfma_f32_16x16x32_bf16 v[112:115], a[72:75], v[40:43], v[112:115]
v_cvt_pk_bf16_f32 v19, v102, v103
v_mfma_f32_16x16x32_bf16 v[116:119], a[76:79], v[40:43], v[116:119]
s_add_u32 m0, s27, 69728
ds_read_b128 v[88:91], v2 offset:33520
v_exp_f32 v27, v27
v_add_f32 v26, 1.0, v26
v_mfma_f32_16x16x32_bf16 v[120:123], a[72:75], v[44:47], v[120:123]
buffer_load_dwordx4 v1, s[8:11], s29 offen offset:2048 sc1 lds
v_mfma_f32_16x16x32_bf16 v[124:127], a[76:79], v[44:47], v[124:127]
s_waitcnt lgkmcnt(9)
s_add_u32 s49, s50, 0
ds_read_b128 v[92:95], v2 offset:50160
v_rcp_f32 v25, v25
v_mul_f32 v104, v104, v24
v_mfma_f32_16x16x32_bf16 v[112:115], a[80:83], v[48:51], v[112:115]
buffer_store_dwordx4 v[16:19], v1, s[56:59], s49 offen offset:0 sc1
v_mfma_f32_16x16x32_bf16 v[116:119], a[84:87], v[48:51], v[116:119]
s_add_u32 m0, s27, 69744
ds_read_b128 v[32:35], v3 offset:0
v_exp_f32 v28, v28
v_add_f32 v27, 1.0, v27
v_mfma_f32_16x16x32_bf16 v[120:123], a[80:83], v[52:55], v[120:123]
buffer_load_dwordx4 v1, s[8:11], s29 offen offset:3072 sc1 lds
v_mfma_f32_16x16x32_bf16 v[124:127], a[84:87], v[52:55], v[124:127]
s_waitcnt lgkmcnt(9)
ds_read_b128 v[36:39], v3 offset:16640
v_rcp_f32 v26, v26
v_mul_f32_e64 v105, v105, v25
v_mfma_f32_16x16x32_bf16 v[112:115], a[88:91], v[56:59], v[112:115]
v_exp_f32_e64 v29, v29
v_mfma_f32_16x16x32_bf16 v[116:119], a[92:95], v[56:59], v[116:119]
ds_read_b128 v[40:43], v3 offset:16
v_add_f32_e64 v28, 1.0, v28
v_mfma_f32_16x16x32_bf16 v[120:123], a[88:91], v[60:63], v[120:123]
v_rcp_f32_e64 v27, v27
v_mfma_f32_16x16x32_bf16 v[124:127], a[92:95], v[60:63], v[124:127]
s_waitcnt lgkmcnt(9)
ds_read_b128 v[44:47], v3 offset:16656
v_mul_f32 v106, v106, v26
v_exp_f32 v30, v30
v_add_f32 v29, 1.0, v29
v_mfma_f32_16x16x32_bf16 v[112:115], a[96:99], v[64:67], v[112:115]
v_mfma_f32_16x16x32_bf16 v[116:119], a[100:103], v[64:67], v[116:119]
ds_read_b128 v[48:51], v3 offset:32
v_rcp_f32 v28, v28
v_mul_f32 v107, v107, v27
v_mfma_f32_16x16x32_bf16 v[120:123], a[96:99], v[68:71], v[120:123]
v_exp_f32_e64 v31, v31
v_mfma_f32_16x16x32_bf16 v[124:127], a[100:103], v[68:71], v[124:127]
s_waitcnt lgkmcnt(9)
ds_read_b128 v[52:55], v3 offset:16672
v_add_f32 v30, 1.0, v30
v_mfma_f32_16x16x32_bf16 v[112:115], a[104:107], v[72:75], v[112:115]
buffer_load_dword v9, v8, s[72:75], s40 offen offset:0 sc1
v_mfma_f32_16x16x32_bf16 v[116:119], a[108:111], v[72:75], v[116:119]
ds_read_b128 v[56:59], v3 offset:48
v_rcp_f32 v29, v29
v_mul_f32 v108, v108, v28
v_add_f32_e64 v31, 1.0, v31
v_mfma_f32_16x16x32_bf16 v[120:123], a[104:107], v[76:79], v[120:123]
v_rcp_f32_e64 v30, v30
v_mfma_f32_16x16x32_bf16 v[124:127], a[108:111], v[76:79], v[124:127]
s_waitcnt lgkmcnt(9)
ds_read_b128 v[60:63], v3 offset:16688
v_mul_f32 v109, v109, v29
v_mfma_f32_16x16x32_bf16 v[112:115], a[112:115], v[80:83], v[112:115]
v_rcp_f32_e64 v31, v31
v_mfma_f32_16x16x32_bf16 v[116:119], a[116:119], v[80:83], v[116:119]
ds_read_b128 v[64:67], v3 offset:64
v_mul_f32 v110, v110, v30
v_mul_f32 v111, v111, v31
v_cvt_pk_bf16_f32 v24, v104, v105
v_cvt_pk_bf16_f32 v25, v106, v107
v_mfma_f32_16x16x32_bf16 v[120:123], a[112:115], v[84:87], v[120:123]
v_mfma_f32_16x16x32_bf16 v[124:127], a[116:119], v[84:87], v[124:127]
s_waitcnt lgkmcnt(9)
s_nop 0
ds_read_b128 v[68:71], v3 offset:16704
v_cvt_pk_bf16_f32 v26, v108, v109
v_cvt_pk_bf16_f32 v27, v110, v111
v_mfma_f32_16x16x32_bf16 v[112:115], a[120:123], v[88:91], v[112:115]
v_mfma_f32_16x16x32_bf16 v[116:119], a[124:127], v[88:91], v[116:119]
ds_read_b128 v[72:75], v3 offset:80
v_mfma_f32_16x16x32_bf16 v[120:123], a[120:123], v[92:95], v[120:123]
v_mfma_f32_16x16x32_bf16 v[124:127], a[124:127], v[92:95], v[124:127]
s_waitcnt lgkmcnt(9)
ds_read_b128 v[76:79], v3 offset:16720
s_add_u32 s49, s50, 16384
buffer_store_dwordx4 v[24:27], v1, s[56:59], s49 offen offset:0 sc1
v_mfma_f32_16x16x32_bf16 v[96:99], a[0:3], v[32:35], 0
v_mfma_f32_16x16x32_bf16 v[100:103], a[4:7], v[32:35], 0
s_barrier
ds_read_b128 v[80:83], v3 offset:96
v_mfma_f32_16x16x32_bf16 v[104:107], a[0:3], v[36:39], 0
v_mfma_f32_16x16x32_bf16 v[108:111], a[4:7], v[36:39], 0
s_waitcnt lgkmcnt(9)
s_nop 0
ds_read_b128 v[84:87], v3 offset:16736
v_mfma_f32_16x16x32_bf16 v[96:99], a[8:11], v[40:43], v[96:99]
v_mfma_f32_16x16x32_bf16 v[100:103], a[12:15], v[40:43], v[100:103]
s_add_u32 m0, s27, 98816
s_add_u32 s29, s26, 4096
ds_read_b128 v[88:91], v3 offset:112
v_pk_mul_f32 v[16:17], v[112:113], v[112:113]
v_pk_mul_f32 v[18:19], v[114:115], v[114:115]
v_pk_mul_f32 v[20:21], v[116:117], v[116:117]
v_pk_mul_f32 v[22:23], v[118:119], v[118:119]
v_pk_mul_f32 v[24:25], v[120:121], v[120:121]
v_pk_mul_f32 v[26:27], v[122:123], v[122:123]
v_pk_mul_f32 v[28:29], v[124:125], v[124:125]
v_pk_mul_f32 v[30:31], v[126:127], v[126:127]
v_pk_fma_f32 v[16:17], v[16:17], v[12:13], v[12:13] op_sel:[0,1,0] op_sel_hi:[1,1,0]
v_pk_fma_f32 v[18:19], v[18:19], v[12:13], v[12:13] op_sel:[0,1,0] op_sel_hi:[1,1,0]
v_pk_fma_f32 v[20:21], v[20:21], v[12:13], v[12:13] op_sel:[0,1,0] op_sel_hi:[1,1,0]
v_pk_fma_f32 v[22:23], v[22:23], v[12:13], v[12:13] op_sel:[0,1,0] op_sel_hi:[1,1,0]
v_pk_fma_f32 v[24:25], v[24:25], v[12:13], v[12:13] op_sel:[0,1,0] op_sel_hi:[1,1,0]
v_pk_fma_f32 v[26:27], v[26:27], v[12:13], v[12:13] op_sel:[0,1,0] op_sel_hi:[1,1,0]
v_pk_fma_f32 v[28:29], v[28:29], v[12:13], v[12:13] op_sel:[0,1,0] op_sel_hi:[1,1,0]
v_pk_fma_f32 v[30:31], v[30:31], v[12:13], v[12:13] op_sel:[0,1,0] op_sel_hi:[1,1,0]
v_pk_mul_f32 v[16:17], v[16:17], v[112:113]
v_pk_mul_f32 v[18:19], v[18:19], v[114:115]
v_pk_mul_f32 v[20:21], v[20:21], v[116:117]
v_pk_mul_f32 v[22:23], v[22:23], v[118:119]
v_pk_mul_f32 v[24:25], v[24:25], v[120:121]
v_pk_mul_f32 v[26:27], v[26:27], v[122:123]
v_pk_mul_f32 v[28:29], v[28:29], v[124:125]
v_pk_mul_f32 v[30:31], v[30:31], v[126:127]
v_mfma_f32_16x16x32_bf16 v[104:107], a[8:11], v[44:47], v[104:107]
buffer_load_dwordx4 v1, s[8:11], s26 offen offset:0 sc1 lds
v_mfma_f32_16x16x32_bf16 v[108:111], a[12:15], v[44:47], v[108:111]
s_waitcnt lgkmcnt(9)
s_add_u32 m0, s27, 98832
ds_read_b128 v[92:95], v3 offset:16752
v_exp_f32 v16, v16
v_exp_f32 v17, v17
v_add_f32 v16, 1.0, v16
v_exp_f32 v18, v18
v_add_f32 v17, 1.0, v17
v_mfma_f32_16x16x32_bf16 v[96:99], a[16:19], v[48:51], v[96:99]
buffer_load_dwordx4 v1, s[8:11], s26 offen offset:1024 sc1 lds
v_mfma_f32_16x16x32_bf16 v[100:103], a[20:23], v[48:51], v[100:103]
ds_read_b128 v[32:35], v3 offset:128
v_rcp_f32 v16, v16
v_exp_f32 v19, v19
v_mfma_f32_16x16x32_bf16 v[104:107], a[16:19], v[52:55], v[104:107]
v_add_f32_e64 v18, 1.0, v18
v_mfma_f32_16x16x32_bf16 v[108:111], a[20:23], v[52:55], v[108:111]
s_waitcnt lgkmcnt(9)
s_add_u32 m0, s27, 98848
ds_read_b128 v[36:39], v3 offset:16768
v_rcp_f32 v17, v17
v_mul_f32_e64 v112, v112, v16
v_mfma_f32_16x16x32_bf16 v[96:99], a[24:27], v[56:59], v[96:99]
buffer_load_dwordx4 v1, s[8:11], s26 offen offset:2048 sc1 lds
v_mfma_f32_16x16x32_bf16 v[100:103], a[28:31], v[56:59], v[100:103]
s_add_u32 m0, s27, 98864
ds_read_b128 v[40:43], v3 offset:144
v_exp_f32 v20, v20
v_add_f32 v19, 1.0, v19
v_mfma_f32_16x16x32_bf16 v[104:107], a[24:27], v[60:63], v[104:107]
buffer_load_dwordx4 v1, s[8:11], s26 offen offset:3072 sc1 lds
v_mfma_f32_16x16x32_bf16 v[108:111], a[28:31], v[60:63], v[108:111]
s_waitcnt lgkmcnt(9)
ds_read_b128 v[44:47], v3 offset:16784
v_rcp_f32 v18, v18
v_mul_f32_e64 v113, v113, v17
v_mfma_f32_16x16x32_bf16 v[96:99], a[32:35], v[64:67], v[96:99]
s_waitcnt vmcnt(5)
v_cmp_ne_u32_e64 vcc, v7, v9
s_cbranch_vccnz L_sp_14
L_bk_15:
v_mfma_f32_16x16x32_bf16 v[100:103], a[36:39], v[64:67], v[100:103]
ds_read_b128 v[48:51], v3 offset:160
v_exp_f32 v21, v21
v_add_f32 v20, 1.0, v20
v_rcp_f32_e64 v19, v19
v_mfma_f32_16x16x32_bf16 v[104:107], a[32:35], v[68:71], v[104:107]
v_mul_f32_e64 v114, v114, v18
v_mfma_f32_16x16x32_bf16 v[108:111], a[36:39], v[68:71], v[108:111]
s_waitcnt lgkmcnt(9)
s_add_u32 m0, s27, 102976
s_add_u32 s26, s26, 32768
ds_read_b128 v[52:55], v3 offset:16800
v_exp_f32 v22, v22
v_add_f32_e64 v21, 1.0, v21
v_mfma_f32_16x16x32_bf16 v[96:99], a[40:43], v[72:75], v[96:99]
buffer_load_dwordx4 v1, s[8:11], s29 offen offset:0 sc1 lds
v_mfma_f32_16x16x32_bf16 v[100:103], a[44:47], v[72:75], v[100:103]
s_add_u32 m0, s27, 102992
ds_read_b128 v[56:59], v3 offset:176
v_rcp_f32 v20, v20
v_mul_f32 v115, v115, v19
v_mfma_f32_16x16x32_bf16 v[104:107], a[40:43], v[76:79], v[104:107]
buffer_load_dwordx4 v1, s[8:11], s29 offen offset:1024 sc1 lds
v_mfma_f32_16x16x32_bf16 v[108:111], a[44:47], v[76:79], v[108:111]
s_waitcnt lgkmcnt(9)
s_add_u32 m0, s27, 103008
ds_read_b128 v[60:63], v3 offset:16816
v_exp_f32 v23, v23
v_add_f32_e64 v22, 1.0, v22
v_mfma_f32_16x16x32_bf16 v[96:99], a[48:51], v[80:83], v[96:99]
buffer_load_dwordx4 v1, s[8:11], s29 offen offset:2048 sc1 lds
v_mfma_f32_16x16x32_bf16 v[100:103], a[52:55], v[80:83], v[100:103]
ds_read_b128 v[64:67], v3 offset:192
v_rcp_f32 v21, v21
v_mul_f32 v116, v116, v20
v_mfma_f32_16x16x32_bf16 v[104:107], a[48:51], v[84:87], v[104:107]
v_exp_f32_e64 v24, v24
v_mfma_f32_16x16x32_bf16 v[108:111], a[52:55], v[84:87], v[108:111]
s_waitcnt lgkmcnt(9)
s_add_u32 m0, s27, 103024
ds_read_b128 v[68:71], v3 offset:16832
v_add_f32 v23, 1.0, v23
v_rcp_f32 v22, v22
v_mul_f32 v117, v117, v21
v_mfma_f32_16x16x32_bf16 v[96:99], a[56:59], v[88:91], v[96:99]
buffer_load_dwordx4 v1, s[8:11], s29 offen offset:3072 sc1 lds
v_mfma_f32_16x16x32_bf16 v[100:103], a[60:63], v[88:91], v[100:103]
ds_read_b128 v[72:75], v3 offset:208
v_exp_f32 v25, v25
v_add_f32 v24, 1.0, v24
v_mfma_f32_16x16x32_bf16 v[104:107], a[56:59], v[92:95], v[104:107]
buffer_load_dwordx4 v[128:131], v1, s[52:55], s48 offen offset:0 sc1
v_mfma_f32_16x16x32_bf16 v[108:111], a[60:63], v[92:95], v[108:111]
s_waitcnt lgkmcnt(9)
ds_read_b128 v[76:79], v3 offset:16848
v_rcp_f32 v23, v23
v_mul_f32_e64 v118, v118, v22
v_mfma_f32_16x16x32_bf16 v[96:99], a[64:67], v[32:35], v[96:99]
buffer_load_dwordx4 v[132:135], v1, s[52:55], s48 offen offset:1024 sc1
v_mfma_f32_16x16x32_bf16 v[100:103], a[68:71], v[32:35], v[100:103]
ds_read_b128 v[80:83], v3 offset:224
v_exp_f32 v26, v26
v_add_f32 v25, 1.0, v25
v_mfma_f32_16x16x32_bf16 v[104:107], a[64:67], v[36:39], v[104:107]
v_rcp_f32_e64 v24, v24
v_mfma_f32_16x16x32_bf16 v[108:111], a[68:71], v[36:39], v[108:111]
s_waitcnt lgkmcnt(9)
ds_read_b128 v[84:87], v3 offset:16864
v_mul_f32 v119, v119, v23
v_cvt_pk_bf16_f32 v16, v112, v113
v_cvt_pk_bf16_f32 v17, v114, v115
v_cvt_pk_bf16_f32 v18, v116, v117
v_mfma_f32_16x16x32_bf16 v[96:99], a[72:75], v[40:43], v[96:99]
buffer_load_dwordx4 v[136:139], v1, s[52:55], s48 offen offset:2048 sc1
v_mfma_f32_16x16x32_bf16 v[100:103], a[76:79], v[40:43], v[100:103]
ds_read_b128 v[88:91], v3 offset:240
v_cvt_pk_bf16_f32 v19, v118, v119
v_exp_f32 v27, v27
v_add_f32 v26, 1.0, v26
v_mfma_f32_16x16x32_bf16 v[104:107], a[72:75], v[44:47], v[104:107]
buffer_load_dwordx4 v[140:143], v1, s[52:55], s48 offen offset:3072 sc1
v_mfma_f32_16x16x32_bf16 v[108:111], a[76:79], v[44:47], v[108:111]
s_waitcnt lgkmcnt(9)
s_add_u32 s49, s50, 32768
ds_read_b128 v[92:95], v3 offset:16880
v_rcp_f32 v25, v25
v_mul_f32_e64 v120, v120, v24
v_mfma_f32_16x16x32_bf16 v[96:99], a[80:83], v[48:51], v[96:99]
buffer_store_dwordx4 v[16:19], v1, s[56:59], s49 offen offset:0 sc1
v_mfma_f32_16x16x32_bf16 v[100:103], a[84:87], v[48:51], v[100:103]
s_add_u32 s48, s48, 4096
ds_read_b128 v[32:35], v10 offset:0
v_exp_f32 v28, v28
v_add_f32 v27, 1.0, v27
v_mfma_f32_16x16x32_bf16 v[104:107], a[80:83], v[52:55], v[104:107]
buffer_load_dwordx4 v[144:147], v1, s[52:55], s48 offen offset:0 sc1
v_mfma_f32_16x16x32_bf16 v[108:111], a[84:87], v[52:55], v[108:111]
s_waitcnt lgkmcnt(9)
ds_read_b128 v[36:39], v10 offset:16640
v_rcp_f32 v26, v26
v_mul_f32_e64 v121, v121, v25
v_mfma_f32_16x16x32_bf16 v[96:99], a[88:91], v[56:59], v[96:99]
buffer_load_dwordx4 v[148:151], v1, s[52:55], s48 offen offset:1024 sc1
v_mfma_f32_16x16x32_bf16 v[100:103], a[92:95], v[56:59], v[100:103]
ds_read_b128 v[40:43], v10 offset:16
v_exp_f32 v29, v29
v_add_f32 v28, 1.0, v28
v_mfma_f32_16x16x32_bf16 v[104:107], a[88:91], v[60:63], v[104:107]
buffer_load_dwordx4 v[152:155], v1, s[52:55], s48 offen offset:2048 sc1
v_mfma_f32_16x16x32_bf16 v[108:111], a[92:95], v[60:63], v[108:111]
s_waitcnt lgkmcnt(9)
ds_read_b128 v[44:47], v10 offset:16656
v_rcp_f32 v27, v27
v_mul_f32_e64 v122, v122, v26
v_mfma_f32_16x16x32_bf16 v[96:99], a[96:99], v[64:67], v[96:99]
v_exp_f32_e64 v30, v30
v_mfma_f32_16x16x32_bf16 v[100:103], a[100:103], v[64:67], v[100:103]
ds_read_b128 v[48:51], v10 offset:32
v_add_f32 v29, 1.0, v29
v_rcp_f32 v28, v28
v_mul_f32_e64 v123, v123, v27
v_mfma_f32_16x16x32_bf16 v[104:107], a[96:99], v[68:71], v[104:107]
buffer_load_dwordx4 v[156:159], v1, s[52:55], s48 offen offset:3072 sc1
v_mfma_f32_16x16x32_bf16 v[108:111], a[100:103], v[68:71], v[108:111]
s_waitcnt lgkmcnt(9)
s_add_u32 s48, s48, 4096
ds_read_b128 v[52:55], v10 offset:16672
v_exp_f32 v31, v31
v_add_f32_e64 v30, 1.0, v30
v_mfma_f32_16x16x32_bf16 v[96:99], a[104:107], v[72:75], v[96:99]
buffer_load_dwordx4 v[160:163], v1, s[52:55], s48 offen offset:0 sc1
v_mfma_f32_16x16x32_bf16 v[100:103], a[108:111], v[72:75], v[100:103]
ds_read_b128 v[56:59], v10 offset:48
v_rcp_f32 v29, v29
v_mul_f32 v124, v124, v28
v_mfma_f32_16x16x32_bf16 v[104:107], a[104:107], v[76:79], v[104:107]
buffer_load_dwordx4 v[164:167], v1, s[52:55], s48 offen offset:1024 sc1
v_mfma_f32_16x16x32_bf16 v[108:111], a[108:111], v[76:79], v[108:111]
s_waitcnt lgkmcnt(9)
ds_read_b128 v[60:63], v10 offset:16688
v_add_f32 v31, 1.0, v31
v_rcp_f32 v30, v30
v_mul_f32 v125, v125, v29
v_mfma_f32_16x16x32_bf16 v[96:99], a[112:115], v[80:83], v[96:99]
v_rcp_f32_e64 v31, v31
v_mfma_f32_16x16x32_bf16 v[100:103], a[116:119], v[80:83], v[100:103]
ds_read_b128 v[64:67], v10 offset:64
v_mul_f32 v126, v126, v30
v_mul_f32 v127, v127, v31
v_cvt_pk_bf16_f32 v24, v120, v121
v_mfma_f32_16x16x32_bf16 v[104:107], a[112:115], v[84:87], v[104:107]
buffer_load_dwordx4 v[168:171], v1, s[52:55], s48 offen offset:2048 sc1
v_mfma_f32_16x16x32_bf16 v[108:111], a[116:119], v[84:87], v[108:111]
s_waitcnt lgkmcnt(9)
s_nop 0
ds_read_b128 v[68:71], v10 offset:16704
v_cvt_pk_bf16_f32 v25, v122, v123
v_cvt_pk_bf16_f32 v26, v124, v125
v_cvt_pk_bf16_f32 v27, v126, v127
v_mfma_f32_16x16x32_bf16 v[96:99], a[120:123], v[88:91], v[96:99]
buffer_load_dwordx4 v[172:175], v1, s[52:55], s48 offen offset:3072 sc1
v_mfma_f32_16x16x32_bf16 v[100:103], a[124:127], v[88:91], v[100:103]
ds_read_b128 v[72:75], v10 offset:80
v_mfma_f32_16x16x32_bf16 v[104:107], a[120:123], v[92:95], v[104:107]
v_mfma_f32_16x16x32_bf16 v[108:111], a[124:127], v[92:95], v[108:111]
s_waitcnt lgkmcnt(9)
s_nop 0
ds_read_b128 v[76:79], v10 offset:16720
s_add_u32 s49, s50, 49152
buffer_store_dwordx4 v[24:27], v1, s[56:59], s49 offen offset:0 sc1
v_mfma_f32_16x16x32_bf16 v[112:115], a[0:3], v[32:35], 0
v_mfma_f32_16x16x32_bf16 v[116:119], a[4:7], v[32:35], 0
s_add_u32 s48, s48, 4096
ds_read_b128 v[80:83], v10 offset:96
v_mfma_f32_16x16x32_bf16 v[120:123], a[0:3], v[36:39], 0
buffer_load_dwordx4 v[176:179], v1, s[52:55], s48 offen offset:0 sc1
v_mfma_f32_16x16x32_bf16 v[124:127], a[4:7], v[36:39], 0
s_waitcnt lgkmcnt(9)
s_nop 0
ds_read_b128 v[84:87], v10 offset:16736
v_mfma_f32_16x16x32_bf16 v[112:115], a[8:11], v[40:43], v[112:115]
v_mfma_f32_16x16x32_bf16 v[116:119], a[12:15], v[40:43], v[116:119]
ds_read_b128 v[88:91], v10 offset:112
v_pk_mul_f32 v[16:17], v[96:97], v[96:97]
v_pk_mul_f32 v[18:19], v[98:99], v[98:99]
v_pk_mul_f32 v[20:21], v[100:101], v[100:101]
v_pk_mul_f32 v[22:23], v[102:103], v[102:103]
v_pk_mul_f32 v[24:25], v[104:105], v[104:105]
v_pk_mul_f32 v[26:27], v[106:107], v[106:107]
v_pk_mul_f32 v[28:29], v[108:109], v[108:109]
v_pk_mul_f32 v[30:31], v[110:111], v[110:111]
v_pk_fma_f32 v[16:17], v[16:17], v[12:13], v[12:13] op_sel:[0,1,0] op_sel_hi:[1,1,0]
v_pk_fma_f32 v[18:19], v[18:19], v[12:13], v[12:13] op_sel:[0,1,0] op_sel_hi:[1,1,0]
v_pk_fma_f32 v[20:21], v[20:21], v[12:13], v[12:13] op_sel:[0,1,0] op_sel_hi:[1,1,0]
v_pk_fma_f32 v[22:23], v[22:23], v[12:13], v[12:13] op_sel:[0,1,0] op_sel_hi:[1,1,0]
v_pk_fma_f32 v[24:25], v[24:25], v[12:13], v[12:13] op_sel:[0,1,0] op_sel_hi:[1,1,0]
v_pk_fma_f32 v[26:27], v[26:27], v[12:13], v[12:13] op_sel:[0,1,0] op_sel_hi:[1,1,0]
v_pk_fma_f32 v[28:29], v[28:29], v[12:13], v[12:13] op_sel:[0,1,0] op_sel_hi:[1,1,0]
v_pk_fma_f32 v[30:31], v[30:31], v[12:13], v[12:13] op_sel:[0,1,0] op_sel_hi:[1,1,0]
v_pk_mul_f32 v[16:17], v[16:17], v[96:97]
v_pk_mul_f32 v[18:19], v[18:19], v[98:99]
v_pk_mul_f32 v[20:21], v[20:21], v[100:101]
v_pk_mul_f32 v[22:23], v[22:23], v[102:103]
v_pk_mul_f32 v[24:25], v[24:25], v[104:105]
v_pk_mul_f32 v[26:27], v[26:27], v[106:107]
v_pk_mul_f32 v[28:29], v[28:29], v[108:109]
v_pk_mul_f32 v[30:31], v[30:31], v[110:111]
v_mfma_f32_16x16x32_bf16 v[120:123], a[8:11], v[44:47], v[120:123]
buffer_load_dwordx4 v[180:183], v1, s[52:55], s48 offen offset:1024 sc1
v_mfma_f32_16x16x32_bf16 v[124:127], a[12:15], v[44:47], v[124:127]
s_waitcnt lgkmcnt(9)
ds_read_b128 v[92:95], v10 offset:16752
v_exp_f32 v16, v16
v_exp_f32 v17, v17
v_add_f32 v16, 1.0, v16
v_exp_f32 v18, v18
v_add_f32 v17, 1.0, v17
v_mfma_f32_16x16x32_bf16 v[112:115], a[16:19], v[48:51], v[112:115]
buffer_load_dwordx4 v[184:187], v1, s[52:55], s48 offen offset:2048 sc1
v_mfma_f32_16x16x32_bf16 v[116:119], a[20:23], v[48:51], v[116:119]
ds_read_b128 v[32:35], v10 offset:128
v_rcp_f32 v16, v16
v_exp_f32 v19, v19
v_add_f32_e64 v18, 1.0, v18
v_mfma_f32_16x16x32_bf16 v[120:123], a[16:19], v[52:55], v[120:123]
v_rcp_f32_e64 v17, v17
v_mfma_f32_16x16x32_bf16 v[124:127], a[20:23], v[52:55], v[124:127]
s_waitcnt lgkmcnt(9)
ds_read_b128 v[36:39], v10 offset:16768
v_mul_f32 v96, v96, v16
v_exp_f32 v20, v20
v_add_f32 v19, 1.0, v19
v_mfma_f32_16x16x32_bf16 v[112:115], a[24:27], v[56:59], v[112:115]
buffer_load_dwordx4 v[188:191], v1, s[52:55], s48 offen offset:3072 sc1
v_mfma_f32_16x16x32_bf16 v[116:119], a[28:31], v[56:59], v[116:119]
s_add_u32 s48, s48, 4096
ds_read_b128 v[40:43], v10 offset:144
v_rcp_f32 v18, v18
v_mul_f32 v97, v97, v17
v_mfma_f32_16x16x32_bf16 v[120:123], a[24:27], v[60:63], v[120:123]
buffer_load_dwordx4 v[192:195], v1, s[52:55], s48 offen offset:0 sc1
v_mfma_f32_16x16x32_bf16 v[124:127], a[28:31], v[60:63], v[124:127]
s_waitcnt lgkmcnt(9)
ds_read_b128 v[44:47], v10 offset:16784
v_exp_f32 v21, v21
v_add_f32_e64 v20, 1.0, v20
v_mfma_f32_16x16x32_bf16 v[112:115], a[32:35], v[64:67], v[112:115]
v_rcp_f32_e64 v19, v19
v_mfma_f32_16x16x32_bf16 v[116:119], a[36:39], v[64:67], v[116:119]
ds_read_b128 v[48:51], v10 offset:160
v_mul_f32 v98, v98, v18
v_exp_f32 v22, v22
v_add_f32_e64 v21, 1.0, v21
v_mfma_f32_16x16x32_bf16 v[120:123], a[32:35], v[68:71], v[120:123]
buffer_load_dwordx4 v[196:199], v1, s[52:55], s48 offen offset:1024 sc1
v_mfma_f32_16x16x32_bf16 v[124:127], a[36:39], v[68:71], v[124:127]
s_waitcnt lgkmcnt(9)
ds_read_b128 v[52:55], v10 offset:16800
v_rcp_f32 v20, v20
v_mul_f32 v99, v99, v19
v_exp_f32 v23, v23
v_mfma_f32_16x16x32_bf16 v[112:115], a[40:43], v[72:75], v[112:115]
buffer_load_dwordx4 v[200:203], v1, s[52:55], s48 offen offset:2048 sc1
v_mfma_f32_16x16x32_bf16 v[116:119], a[44:47], v[72:75], v[116:119]
ds_read_b128 v[56:59], v10 offset:176
v_add_f32 v22, 1.0, v22
v_rcp_f32 v21, v21
v_mul_f32_e64 v100, v100, v20
v_mfma_f32_16x16x32_bf16 v[120:123], a[40:43], v[76:79], v[120:123]
v_exp_f32_e64 v24, v24
v_mfma_f32_16x16x32_bf16 v[124:127], a[44:47], v[76:79], v[124:127]
s_waitcnt lgkmcnt(9)
ds_read_b128 v[60:63], v10 offset:16816
v_add_f32 v23, 1.0, v23
v_rcp_f32_e64 v22, v22
v_mfma_f32_16x16x32_bf16 v[112:115], a[48:51], v[80:83], v[112:115]
buffer_load_dwordx4 v[204:207], v1, s[52:55], s48 offen offset:3072 sc1
v_mfma_f32_16x16x32_bf16 v[116:119], a[52:55], v[80:83], v[116:119]
s_add_u32 s48, s48, 4096
ds_read_b128 v[64:67], v10 offset:192
v_mul_f32 v101, v101, v21
v_exp_f32 v25, v25
v_add_f32_e64 v24, 1.0, v24
v_mfma_f32_16x16x32_bf16 v[120:123], a[48:51], v[84:87], v[120:123]
buffer_load_dwordx4 v[208:211], v1, s[52:55], s48 offen offset:0 sc1
v_mfma_f32_16x16x32_bf16 v[124:127], a[52:55], v[84:87], v[124:127]
s_waitcnt lgkmcnt(9)
ds_read_b128 v[68:71], v10 offset:16832
v_rcp_f32 v23, v23
v_mul_f32_e64 v102, v102, v22
v_mfma_f32_16x16x32_bf16 v[112:115], a[56:59], v[88:91], v[112:115]
v_exp_f32_e64 v26, v26
v_mfma_f32_16x16x32_bf16 v[116:119], a[60:63], v[88:91], v[116:119]
ds_read_b128 v[72:75], v10 offset:208
v_add_f32 v25, 1.0, v25
v_rcp_f32 v24, v24
v_mul_f32_e64 v103, v103, v23
v_cvt_pk_bf16_f32 v16, v96, v97
v_mfma_f32_16x16x32_bf16 v[120:123], a[56:59], v[92:95], v[120:123]
buffer_load_dwordx4 v[212:215], v1, s[52:55], s48 offen offset:1024 sc1
v_mfma_f32_16x16x32_bf16 v[124:127], a[60:63], v[92:95], v[124:127]
s_waitcnt lgkmcnt(9)
s_nop 0
ds_read_b128 v[76:79], v10 offset:16848
v_cvt_pk_bf16_f32 v17, v98, v99
v_cvt_pk_bf16_f32 v18, v100, v101
v_cvt_pk_bf16_f32 v19, v102, v103
v_mfma_f32_16x16x32_bf16 v[112:115], a[64:67], v[32:35], v[112:115]
buffer_load_dwordx4 v[216:219], v1, s[52:55], s48 offen offset:2048 sc1
v_mfma_f32_16x16x32_bf16 v[116:119], a[68:71], v[32:35], v[116:119]
s_add_u32 s49, s50, 65536
ds_read_b128 v[80:83], v10 offset:224
v_exp_f32 v27, v27
v_add_f32 v26, 1.0, v26
v_mfma_f32_16x16x32_bf16 v[120:123], a[64:67], v[36:39], v[120:123]
buffer_store_dwordx4 v[16:19], v1, s[56:59], s49 offen offset:0 sc1
v_mfma_f32_16x16x32_bf16 v[124:127], a[68:71], v[36:39], v[124:127]
s_waitcnt lgkmcnt(9)
ds_read_b128 v[84:87], v10 offset:16864
v_rcp_f32 v25, v25
v_mul_f32 v104, v104, v24
v_exp_f32 v28, v28
v_mfma_f32_16x16x32_bf16 v[112:115], a[72:75], v[40:43], v[112:115]
buffer_load_dwordx4 v[220:223], v1, s[52:55], s48 offen offset:3072 sc1
v_mfma_f32_16x16x32_bf16 v[116:119], a[76:79], v[40:43], v[116:119]
s_add_u32 s48, s48, 4096
ds_read_b128 v[88:91], v10 offset:240
v_add_f32 v27, 1.0, v27
v_rcp_f32 v26, v26
v_mfma_f32_16x16x32_bf16 v[120:123], a[72:75], v[44:47], v[120:123]
buffer_load_dwordx4 v[224:227], v1, s[52:55], s48 offen offset:0 sc1
v_mfma_f32_16x16x32_bf16 v[124:127], a[76:79], v[44:47], v[124:127]
s_waitcnt lgkmcnt(9)
ds_read_b128 v[92:95], v10 offset:16880
v_mul_f32 v105, v105, v25
v_exp_f32 v29, v29
v_add_f32 v28, 1.0, v28
v_mfma_f32_16x16x32_bf16 v[112:115], a[80:83], v[48:51], v[112:115]
v_rcp_f32_e64 v27, v27
v_mfma_f32_16x16x32_bf16 v[116:119], a[84:87], v[48:51], v[116:119]
v_mul_f32 v106, v106, v26
v_exp_f32 v30, v30
v_add_f32_e64 v29, 1.0, v29
v_mfma_f32_16x16x32_bf16 v[120:123], a[80:83], v[52:55], v[120:123]
buffer_load_dwordx4 v[228:231], v1, s[52:55], s48 offen offset:1024 sc1
v_mfma_f32_16x16x32_bf16 v[124:127], a[84:87], v[52:55], v[124:127]
s_waitcnt lgkmcnt(8)
v_rcp_f32 v28, v28
v_mul_f32_e64 v107, v107, v27
v_mfma_f32_16x16x32_bf16 v[112:115], a[88:91], v[56:59], v[112:115]
buffer_load_dwordx4 v[232:235], v1, s[52:55], s48 offen offset:2048 sc1
v_mfma_f32_16x16x32_bf16 v[116:119], a[92:95], v[56:59], v[116:119]
v_exp_f32 v31, v31
v_add_f32 v30, 1.0, v30
v_mfma_f32_16x16x32_bf16 v[120:123], a[88:91], v[60:63], v[120:123]
v_rcp_f32_e64 v29, v29
v_mfma_f32_16x16x32_bf16 v[124:127], a[92:95], v[60:63], v[124:127]
s_waitcnt lgkmcnt(6)
v_mul_f32 v108, v108, v28
v_add_f32 v31, 1.0, v31
v_rcp_f32 v30, v30
v_mul_f32_e64 v109, v109, v29
v_mfma_f32_16x16x32_bf16 v[112:115], a[96:99], v[64:67], v[112:115]
buffer_load_dwordx4 v[236:239], v1, s[52:55], s48 offen offset:3072 sc1
v_mfma_f32_16x16x32_bf16 v[116:119], a[100:103], v[64:67], v[116:119]
s_add_u32 s48, s48, 4096
v_rcp_f32 v31, v31
v_mul_f32 v110, v110, v30
v_mul_f32_e64 v111, v111, v31
v_mfma_f32_16x16x32_bf16 v[120:123], a[96:99], v[68:71], v[120:123]
buffer_load_dwordx4 v[240:243], v1, s[52:55], s48 offen offset:0 sc1
v_mfma_f32_16x16x32_bf16 v[124:127], a[100:103], v[68:71], v[124:127]
s_waitcnt lgkmcnt(4)
v_cvt_pk_bf16_f32 v24, v104, v105
v_cvt_pk_bf16_f32 v25, v106, v107
v_cvt_pk_bf16_f32 v26, v108, v109
v_cvt_pk_bf16_f32 v27, v110, v111
v_mfma_f32_16x16x32_bf16 v[112:115], a[104:107], v[72:75], v[112:115]
v_and_b32 v14, 7, v0
v_lshlrev_b32_e64 v14, 1, v14
v_mfma_f32_16x16x32_bf16 v[116:119], a[108:111], v[72:75], v[116:119]
v_bfe_u32 v15, v0, 3, 1
v_add_u32_e64 v14, v14, v15
v_mul_u32_u24 v14, 1040, v14
v_mfma_f32_16x16x32_bf16 v[120:123], a[104:107], v[76:79], v[120:123]
buffer_load_dwordx4 v[244:247], v1, s[52:55], s48 offen offset:1024 sc1
v_mfma_f32_16x16x32_bf16 v[124:127], a[108:111], v[76:79], v[124:127]
s_waitcnt lgkmcnt(2)
v_lshrrev_b32 v15, 4, v0
v_lshl_add_u32 v2, v15, 8, v14
v_bfe_u32 v14, v0, 2, 3
v_lshlrev_b32_e64 v14, 1, v14
v_mfma_f32_16x16x32_bf16 v[112:115], a[112:115], v[80:83], v[112:115]
buffer_load_dwordx4 v[248:251], v1, s[52:55], s48 offen offset:2048 sc1
v_mfma_f32_16x16x32_bf16 v[116:119], a[116:119], v[80:83], v[116:119]
v_lshrrev_b32 v15, 5, v0
v_add_u32 v14, v14, v15
v_mul_u32_u24 v14, 1040, v14
v_and_b32_e64 v15, 3, v0
v_mfma_f32_16x16x32_bf16 v[120:123], a[112:115], v[84:87], v[120:123]
v_lshl_add_u32 v3, v15, 3, v14
v_add_u32 v4, 66560, v2
v_mfma_f32_16x16x32_bf16 v[124:127], a[116:119], v[84:87], v[124:127]
s_waitcnt lgkmcnt(0)
s_add_u32 s49, s50, 81920
v_add_u32 v5, 66560, v3
v_mov_b32 v8, 0
v_mov_b32_e64 v9, 0
v_mfma_f32_16x16x32_bf16 v[112:115], a[120:123], v[88:91], v[112:115]
buffer_store_dwordx4 v[24:27], v1, s[56:59], s49 offen offset:0 sc1
v_mfma_f32_16x16x32_bf16 v[116:119], a[124:127], v[88:91], v[116:119]
v_mfma_f32_16x16x32_bf16 v[120:123], a[120:123], v[92:95], v[120:123]
buffer_load_dwordx4 v[252:255], v1, s[52:55], s48 offen offset:3072 sc1
v_mfma_f32_16x16x32_bf16 v[124:127], a[124:127], v[92:95], v[124:127]
s_mov_b32 s45, 1106247680
s_mov_b32 s31, 7
s_waitcnt vmcnt(36)
s_barrier
s_cmp_eq_u32 s38, 0
s_cbranch_scc1 L_q0
s_nop 0
ds_read_b128 v[64:67], v2 offset:33280
ds_read_b128 v[68:71], v2 offset:49920
ds_read_b128 v[72:75], v2 offset:33296
ds_read_b128 v[76:79], v2 offset:49936
ds_read_b128 v[80:83], v2 offset:33312
ds_read_b128 v[84:87], v2 offset:49952
ds_read_b128 v[88:91], v2 offset:33328
v_pk_mul_f32 v[96:97], v[112:113], v[112:113]
v_pk_mul_f32 v[98:99], v[114:115], v[114:115]
v_pk_mul_f32 v[100:101], v[116:117], v[116:117]
v_pk_mul_f32 v[102:103], v[118:119], v[118:119]
v_pk_mul_f32 v[104:105], v[120:121], v[120:121]
v_pk_mul_f32 v[106:107], v[122:123], v[122:123]
v_pk_mul_f32 v[108:109], v[124:125], v[124:125]
v_pk_mul_f32 v[110:111], v[126:127], v[126:127]
v_pk_fma_f32 v[96:97], v[96:97], v[12:13], v[12:13] op_sel:[0,1,0] op_sel_hi:[1,1,0]
v_pk_fma_f32 v[98:99], v[98:99], v[12:13], v[12:13] op_sel:[0,1,0] op_sel_hi:[1,1,0]
v_pk_fma_f32 v[100:101], v[100:101], v[12:13], v[12:13] op_sel:[0,1,0] op_sel_hi:[1,1,0]
v_pk_fma_f32 v[102:103], v[102:103], v[12:13], v[12:13] op_sel:[0,1,0] op_sel_hi:[1,1,0]
v_pk_fma_f32 v[104:105], v[104:105], v[12:13], v[12:13] op_sel:[0,1,0] op_sel_hi:[1,1,0]
v_pk_fma_f32 v[106:107], v[106:107], v[12:13], v[12:13] op_sel:[0,1,0] op_sel_hi:[1,1,0]
v_pk_fma_f32 v[108:109], v[108:109], v[12:13], v[12:13] op_sel:[0,1,0] op_sel_hi:[1,1,0]
v_pk_fma_f32 v[110:111], v[110:111], v[12:13], v[12:13] op_sel:[0,1,0] op_sel_hi:[1,1,0]
v_pk_mul_f32 v[96:97], v[96:97], v[112:113]
v_pk_mul_f32 v[98:99], v[98:99], v[114:115]
v_pk_mul_f32 v[100:101], v[100:101], v[116:117]
v_pk_mul_f32 v[102:103], v[102:103], v[118:119]
v_pk_mul_f32 v[104:105], v[104:105], v[120:121]
v_pk_mul_f32 v[106:107], v[106:107], v[122:123]
v_pk_mul_f32 v[108:109], v[108:109], v[124:125]
v_pk_mul_f32 v[110:111], v[110:111], v[126:127]
s_waitcnt lgkmcnt(5) vmcnt(34)
v_mfma_f32_16x16x32_bf16 v[32:35], v[64:67], v[128:131], 0
v_exp_f32 v96, v96
v_mfma_f32_16x16x32_bf16 v[40:43], v[64:67], v[132:135], 0
s_add_u32 m0, s27, 132096
s_add_u32 s29, s26, 4096
ds_read_b128 v[92:95], v2 offset:49968
v_exp_f32_e64 v97, v97
v_mfma_f32_16x16x32_bf16 v[36:39], v[68:71], v[128:131], 0
buffer_load_dwordx4 v1, s[8:11], s26 offen offset:0 sc1 lds
v_mfma_f32_16x16x32_bf16 v[44:47], v[68:71], v[132:135], 0
s_waitcnt lgkmcnt(4) vmcnt(33)
ds_read_b128 v[64:67], v2 offset:33344
v_add_f32 v96, 1.0, v96
v_mfma_f32_16x16x32_bf16 v[32:35], v[72:75], v[136:139], v[32:35]
v_exp_f32_e64 v98, v98
v_mfma_f32_16x16x32_bf16 v[40:43], v[72:75], v[140:143], v[40:43]
s_add_u32 m0, s27, 132112
ds_read_b128 v[68:71], v2 offset:49984
v_add_f32_e64 v97, 1.0, v97
v_mfma_f32_16x16x32_bf16 v[36:39], v[76:79], v[136:139], v[36:39]
buffer_load_dwordx4 v1, s[8:11], s26 offen offset:1024 sc1 lds
v_mfma_f32_16x16x32_bf16 v[44:47], v[76:79], v[140:143], v[44:47]
s_waitcnt lgkmcnt(4) vmcnt(31)
s_add_u32 m0, s27, 132128
ds_read_b128 v[72:75], v2 offset:33360
v_rcp_f32 v96, v96
v_mfma_f32_16x16x32_bf16 v[32:35], v[80:83], v[144:147], v[32:35]
buffer_load_dwordx4 v1, s[8:11], s26 offen offset:2048 sc1 lds
v_mfma_f32_16x16x32_bf16 v[40:43], v[80:83], v[148:151], v[40:43]
s_add_u32 m0, s27, 132144
ds_read_b128 v[76:79], v2 offset:50000
v_exp_f32_e64 v99, v99
v_mfma_f32_16x16x32_bf16 v[36:39], v[84:87], v[144:147], v[36:39]
buffer_load_dwordx4 v1, s[8:11], s26 offen offset:3072 sc1 lds
v_mfma_f32_16x16x32_bf16 v[44:47], v[84:87], v[148:151], v[44:47]
s_waitcnt lgkmcnt(4) vmcnt(31)
s_add_u32 m0, s27, 136256
s_add_u32 s26, s26, 32768
ds_read_b128 v[80:83], v2 offset:33376
v_add_f32 v98, 1.0, v98
v_mfma_f32_16x16x32_bf16 v[32:35], v[88:91], v[152:155], v[32:35]
buffer_load_dwordx4 v1, s[8:11], s29 offen offset:0 sc1 lds
v_mfma_f32_16x16x32_bf16 v[40:43], v[88:91], v[156:159], v[40:43]
s_add_u32 m0, s27, 136272
ds_read_b128 v[84:87], v2 offset:50016
v_rcp_f32_e64 v97, v97
v_mfma_f32_16x16x32_bf16 v[36:39], v[92:95], v[152:155], v[36:39]
buffer_load_dwordx4 v1, s[8:11], s29 offen offset:1024 sc1 lds
v_mfma_f32_16x16x32_bf16 v[44:47], v[92:95], v[156:159], v[44:47]
s_waitcnt lgkmcnt(4) vmcnt(31)
s_add_u32 m0, s27, 136288
ds_read_b128 v[88:91], v2 offset:33392
v_mul_f32 v112, v112, v96
v_mfma_f32_16x16x32_bf16 v[32:35], v[64:67], v[160:163], v[32:35]
buffer_load_dwordx4 v1, s[8:11], s29 offen offset:2048 sc1 lds
v_mfma_f32_16x16x32_bf16 v[40:43], v[64:67], v[164:167], v[40:43]
s_add_u32 m0, s27, 136304
ds_read_b128 v[92:95], v2 offset:50032
v_exp_f32_e64 v100, v100
v_mfma_f32_16x16x32_bf16 v[36:39], v[68:71], v[160:163], v[36:39]
buffer_load_dwordx4 v1, s[8:11], s29 offen offset:3072 sc1 lds
v_mfma_f32_16x16x32_bf16 v[44:47], v[68:71], v[164:167], v[44:47]
s_waitcnt lgkmcnt(4) vmcnt(31)
ds_read_b128 v[64:67], v2 offset:33408
v_add_f32 v99, 1.0, v99
v_mfma_f32_16x16x32_bf16 v[32:35], v[72:75], v[168:171], v[32:35]
buffer_load_dwordx4 a[0:3], v1, s[12:15], s43 offen offset:0 sc1
v_mfma_f32_16x16x32_bf16 v[40:43], v[72:75], v[172:175], v[40:43]
s_add_u32 s47, s43, 16384
ds_read_b128 v[68:71], v2 offset:50048
v_rcp_f32_e64 v98, v98
v_mfma_f32_16x16x32_bf16 v[36:39], v[76:79], v[168:171], v[36:39]
buffer_load_dwordx4 a[4:7], v1, s[12:15], s47 offen offset:0 sc1
v_mfma_f32_16x16x32_bf16 v[44:47], v[76:79], v[172:175], v[44:47]
s_waitcnt lgkmcnt(4) vmcnt(30)
ds_read_b128 v[72:75], v2 offset:33424
v_mul_f32 v113, v113, v97
v_mfma_f32_16x16x32_bf16 v[32:35], v[80:83], v[176:179], v[32:35]
buffer_load_dwordx4 a[8:11], v1, s[12:15], s44 offen offset:0 sc1
v_mfma_f32_16x16x32_bf16 v[40:43], v[80:83], v[180:183], v[40:43]
ds_read_b128 v[76:79], v2 offset:50064
v_exp_f32_e64 v101, v101
v_mfma_f32_16x16x32_bf16 v[36:39], v[84:87], v[176:179], v[36:39]
buffer_load_dwordx4 a[12:15], v1, s[12:15], s43 offen offset:1024 sc1
v_mfma_f32_16x16x32_bf16 v[44:47], v[84:87], v[180:183], v[44:47]
s_waitcnt lgkmcnt(4) vmcnt(30)
ds_read_b128 v[80:83], v2 offset:33440
v_add_f32 v100, 1.0, v100
v_mfma_f32_16x16x32_bf16 v[32:35], v[88:91], v[184:187], v[32:35]
buffer_load_dwordx4 a[16:19], v1, s[12:15], s47 offen offset:1024 sc1
v_mfma_f32_16x16x32_bf16 v[40:43], v[88:91], v[188:191], v[40:43]
ds_read_b128 v[84:87], v2 offset:50080
v_rcp_f32_e64 v99, v99
v_mfma_f32_16x16x32_bf16 v[36:39], v[92:95], v[184:187], v[36:39]
buffer_load_dwordx4 a[20:23], v1, s[12:15], s44 offen offset:1024 sc1
v_mfma_f32_16x16x32_bf16 v[44:47], v[92:95], v[188:191], v[44:47]
s_waitcnt lgkmcnt(4) vmcnt(30)
ds_read_b128 v[88:91], v2 offset:33456
v_mul_f32 v114, v114, v98
v_mfma_f32_16x16x32_bf16 v[32:35], v[64:67], v[192:195], v[32:35]
buffer_load_dwordx4 a[24:27], v1, s[12:15], s43 offen offset:2048 sc1
v_mfma_f32_16x16x32_bf16 v[40:43], v[64:67], v[196:199], v[40:43]
ds_read_b128 v[92:95], v2 offset:50096
v_exp_f32_e64 v102, v102
v_mfma_f32_16x16x32_bf16 v[36:39], v[68:71], v[192:195], v[36:39]
v_add_f32_e64 v101, 1.0, v101
v_mfma_f32_16x16x32_bf16 v[44:47], v[68:71], v[196:199], v[44:47]
s_waitcnt lgkmcnt(4) vmcnt(29)
ds_read_b128 v[64:67], v2 offset:33472
v_rcp_f32 v100, v100
v_mfma_f32_16x16x32_bf16 v[32:35], v[72:75], v[200:203], v[32:35]
buffer_load_dwordx4 a[28:31], v1, s[12:15], s47 offen offset:2048 sc1
v_mfma_f32_16x16x32_bf16 v[40:43], v[72:75], v[204:207], v[40:43]
ds_read_b128 v[68:71], v2 offset:50112
v_mul_f32_e64 v115, v115, v99
v_mfma_f32_16x16x32_bf16 v[36:39], v[76:79], v[200:203], v[36:39]
buffer_load_dwordx4 a[32:35], v1, s[12:15], s44 offen offset:2048 sc1
v_mfma_f32_16x16x32_bf16 v[44:47], v[76:79], v[204:207], v[44:47]
s_waitcnt lgkmcnt(4) vmcnt(29)
ds_read_b128 v[72:75], v2 offset:33488
v_exp_f32 v103, v103
v_mfma_f32_16x16x32_bf16 v[32:35], v[80:83], v[208:211], v[32:35]
buffer_load_dwordx4 a[36:39], v1, s[12:15], s43 offen offset:3072 sc1
v_mfma_f32_16x16x32_bf16 v[40:43], v[80:83], v[212:215], v[40:43]
ds_read_b128 v[76:79], v2 offset:50128
v_add_f32_e64 v102, 1.0, v102
v_mfma_f32_16x16x32_bf16 v[36:39], v[84:87], v[208:211], v[36:39]
buffer_load_dwordx4 a[40:43], v1, s[12:15], s47 offen offset:3072 sc1
v_mfma_f32_16x16x32_bf16 v[44:47], v[84:87], v[212:215], v[44:47]
s_waitcnt lgkmcnt(4) vmcnt(28)
ds_read_b128 v[80:83], v2 offset:33504
v_rcp_f32 v101, v101
v_mfma_f32_16x16x32_bf16 v[32:35], v[88:91], v[216:219], v[32:35]
buffer_load_dwordx4 a[44:47], v1, s[12:15], s44 offen offset:3072 sc1
v_mfma_f32_16x16x32_bf16 v[40:43], v[88:91], v[220:223], v[40:43]
s_add_u32 s43, s43, 4096
ds_read_b128 v[84:87], v2 offset:50144
v_mul_f32_e64 v116, v116, v100
v_mfma_f32_16x16x32_bf16 v[36:39], v[92:95], v[216:219], v[36:39]
buffer_load_dwordx4 a[48:51], v1, s[12:15], s43 offen offset:0 sc1
v_mfma_f32_16x16x32_bf16 v[44:47], v[92:95], v[220:223], v[44:47]
s_waitcnt lgkmcnt(4) vmcnt(28)
s_add_u32 s47, s43, 16384
ds_read_b128 v[88:91], v2 offset:33520
v_exp_f32 v104, v104
v_mfma_f32_16x16x32_bf16 v[32:35], v[64:67], v[224:227], v[32:35]
buffer_load_dwordx4 a[52:55], v1, s[12:15], s47 offen offset:0 sc1
v_mfma_f32_16x16x32_bf16 v[40:43], v[64:67], v[228:231], v[40:43]
s_add_u32 s44, s44, 4096
ds_read_b128 v[92:95], v2 offset:50160
v_add_f32_e64 v103, 1.0, v103
v_mfma_f32_16x16x32_bf16 v[36:39], v[68:71], v[224:227], v[36:39]
buffer_load_dwordx4 a[56:59], v1, s[12:15], s44 offen offset:0 sc1
v_mfma_f32_16x16x32_bf16 v[44:47], v[68:71], v[228:231], v[44:47]
s_waitcnt lgkmcnt(4) vmcnt(28)
ds_read_b128 v[64:67], v4 offset:0
v_rcp_f32 v102, v102
v_mfma_f32_16x16x32_bf16 v[32:35], v[72:75], v[232:235], v[32:35]
buffer_load_dwordx4 a[60:63], v1, s[12:15], s43 offen offset:1024 sc1
v_mfma_f32_16x16x32_bf16 v[40:43], v[72:75], v[236:239], v[40:43]
ds_read_b128 v[68:71], v4 offset:16640
v_mul_f32_e64 v117, v117, v101
v_mfma_f32_16x16x32_bf16 v[36:39], v[76:79], v[232:235], v[36:39]
buffer_load_dwordx4 a[64:67], v1, s[12:15], s47 offen offset:1024 sc1
v_mfma_f32_16x16x32_bf16 v[44:47], v[76:79], v[236:239], v[44:47]
s_waitcnt lgkmcnt(4) vmcnt(28)
ds_read_b128 v[72:75], v4 offset:16
v_exp_f32 v105, v105
v_mfma_f32_16x16x32_bf16 v[32:35], v[80:83], v[240:243], v[32:35]
buffer_load_dwordx4 a[68:71], v1, s[12:15], s44 offen offset:1024 sc1
v_mfma_f32_16x16x32_bf16 v[40:43], v[80:83], v[244:247], v[40:43]
ds_read_b128 v[76:79], v4 offset:16656
v_add_f32_e64 v104, 1.0, v104
v_mfma_f32_16x16x32_bf16 v[36:39], v[84:87], v[240:243], v[36:39]
buffer_load_dwordx4 a[72:75], v1, s[12:15], s43 offen offset:2048 sc1
v_mfma_f32_16x16x32_bf16 v[44:47], v[84:87], v[244:247], v[44:47]
s_waitcnt lgkmcnt(4) vmcnt(27)
ds_read_b128 v[80:83], v4 offset:32
v_rcp_f32 v103, v103
v_mfma_f32_16x16x32_bf16 v[32:35], v[88:91], v[248:251], v[32:35]
buffer_load_dwordx4 a[76:79], v1, s[12:15], s47 offen offset:2048 sc1
v_mfma_f32_16x16x32_bf16 v[40:43], v[88:91], v[252:255], v[40:43]
ds_read_b128 v[84:87], v4 offset:16672
v_mul_f32_e64 v118, v118, v102
v_mfma_f32_16x16x32_bf16 v[36:39], v[92:95], v[248:251], v[36:39]
v_exp_f32_e64 v106, v106
v_mfma_f32_16x16x32_bf16 v[44:47], v[92:95], v[252:255], v[44:47]
ds_read_b128 v[88:91], v4 offset:48
v_add_f32 v105, 1.0, v105
v_rcp_f32 v104, v104
v_mul_f32_e64 v119, v119, v103
v_cvt_pk_bf16_f32 v96, v112, v113
v_cvt_pk_bf16_f32 v97, v114, v115
v_cvt_pk_bf16_f32 v98, v116, v117
v_cvt_pk_bf16_f32 v99, v118, v119
s_add_u32 s49, s50, 98304
buffer_store_dwordx4 v[96:99], v1, s[56:59], s49 offen offset:0 sc1
v_exp_f32 v107, v107
v_add_f32 v106, 1.0, v106
v_rcp_f32 v105, v105
v_mul_f32 v120, v120, v104
v_exp_f32 v108, v108
v_add_f32 v107, 1.0, v107
v_rcp_f32 v106, v106
v_mul_f32 v121, v121, v105
v_exp_f32 v109, v109
v_add_f32 v108, 1.0, v108
v_rcp_f32 v107, v107
v_mul_f32 v122, v122, v106
v_exp_f32 v110, v110
v_add_f32 v109, 1.0, v109
v_rcp_f32 v108, v108
v_mul_f32 v123, v123, v107
v_exp_f32 v111, v111
v_add_f32 v110, 1.0, v110
v_rcp_f32 v109, v109
v_mul_f32 v124, v124, v108
v_add_f32 v111, 1.0, v111
v_rcp_f32 v110, v110
v_mul_f32 v125, v125, v109
v_rcp_f32 v111, v111
v_mul_f32 v126, v126, v110
v_mul_f32 v127, v127, v111
v_cvt_pk_bf16_f32 v104, v120, v121
v_cvt_pk_bf16_f32 v105, v122, v123
v_cvt_pk_bf16_f32 v106, v124, v125
v_cvt_pk_bf16_f32 v107, v126, v127
s_add_u32 s49, s50, 114688
buffer_store_dwordx4 v[104:107], v1, s[56:59], s49 offen offset:0 sc1
s_nop 5
s_nop 0
s_add_u32 s29, s26, 4096
v_max3_f32 v10, v32, v33, v34
v_max3_f32 v11, v40, v41, v42
v_max3_f32 v10, v10, v35, v36
v_max3_f32 v11, v11, v43, v44
v_max3_f32 v10, v10, v37, v38
v_max3_f32 v11, v11, v45, v46
v_max_f32 v10, v10, v39
v_max_f32 v11, v11, v47
v_mov_b32 v12, v10
v_mov_b32 v13, v11
s_nop 1
v_permlane32_swap_b32 v12, v10
v_permlane32_swap_b32 v13, v11
s_nop 1
v_max_f32 v10, v10, v12
v_max_f32 v11, v11, v13
v_mov_b32 v12, v10
v_mov_b32 v13, v11
s_nop 1
v_permlane16_swap_b32 v12, v10
v_permlane16_swap_b32 v13, v11
s_nop 1
v_max_f32 v10, v10, v12
v_max_f32 v11, v11, v13
v_sub_f32 v48, 0, v10
v_sub_f32 v49, 0, v10
v_sub_f32 v50, 0, v10
v_sub_f32 v51, 0, v10
v_sub_f32 v32, v32, v10
v_sub_f32 v33, v33, v10
v_sub_f32 v34, v34, v10
v_sub_f32 v35, v35, v10
v_sub_f32 v36, v36, v10
v_sub_f32 v37, v37, v10
v_sub_f32 v38, v38, v10
v_sub_f32 v39, v39, v10
v_sub_f32 v52, 0, v11
v_sub_f32 v53, 0, v11
v_sub_f32 v54, 0, v11
v_sub_f32 v55, 0, v11
v_sub_f32 v40, v40, v11
v_sub_f32 v41, v41, v11
v_sub_f32 v42, v42, v11
v_sub_f32 v43, v43, v11
v_sub_f32 v44, v44, v11
v_sub_f32 v45, v45, v11
v_sub_f32 v46, v46, v11
v_sub_f32 v47, v47, v11
s_add_u32 s41, s41, 4096
s_waitcnt lgkmcnt(0)
s_nop 0
v_mfma_f32_16x16x32_bf16 v[16:19], v[64:67], v[128:131], v[48:51]
s_add_u32 m0, s35, 65536
ds_read_b128 v[92:95], v4 offset:16688
buffer_load_dwordx4 a[84:87], v1, s[12:15], s43 offen offset:3072 sc1
buffer_load_dwordx4 a[80:83], v1, s[12:15], s44 offen offset:2048 sc1
v_mfma_f32_16x16x32_bf16 v[24:27], v[64:67], v[132:135], v[52:55]
buffer_load_dwordx4 v1, s[8:11], s26 offen offset:0 sc1 lds
v_mfma_f32_16x16x32_bf16 v[20:23], v[68:71], v[128:131], v[48:51]
ds_read_b128 v[64:67], v4 offset:64
buffer_load_dwordx4 a[88:91], v1, s[12:15], s47 offen offset:3072 sc1
v_mfma_f32_16x16x32_bf16 v[28:31], v[68:71], v[132:135], v[52:55]
s_waitcnt lgkmcnt(5)
v_exp_f32 v32, v32
v_mfma_f32_16x16x32_bf16 v[16:19], v[72:75], v[136:139], v[16:19]
s_add_u32 m0, s35, 65552
ds_read_b128 v[68:71], v4 offset:16704
buffer_load_dwordx4 a[92:95], v1, s[12:15], s44 offen offset:3072 sc1
v_mfma_f32_16x16x32_bf16 v[24:27], v[72:75], v[140:143], v[24:27]
buffer_load_dwordx4 v1, s[8:11], s26 offen offset:1024 sc1 lds
v_mfma_f32_16x16x32_bf16 v[20:23], v[76:79], v[136:139], v[20:23]
s_add_u32 s43, s43, 4096
s_add_u32 s47, s43, 16384
ds_read_b128 v[72:75], v4 offset:80
buffer_load_dwordx4 a[100:103], v1, s[12:15], s47 offen offset:0 sc1
buffer_load_dwordx4 a[96:99], v1, s[12:15], s43 offen offset:0 sc1
v_mfma_f32_16x16x32_bf16 v[28:31], v[76:79], v[140:143], v[28:31]
s_waitcnt lgkmcnt(5)
v_exp_f32 v33, v33
v_mfma_f32_16x16x32_bf16 v[16:19], v[80:83], v[144:147], v[16:19]
s_add_u32 m0, s35, 65568
s_add_u32 s44, s44, 4096
ds_read_b128 v[76:79], v4 offset:16720
buffer_load_dwordx4 a[104:107], v1, s[12:15], s44 offen offset:0 sc1
v_cvt_pk_bf16_f32 v56, v32, v33
v_mfma_f32_16x16x32_bf16 v[24:27], v[80:83], v[148:151], v[24:27]
buffer_load_dwordx4 v1, s[8:11], s26 offen offset:2048 sc1 lds
v_mfma_f32_16x16x32_bf16 v[20:23], v[84:87], v[144:147], v[20:23]
ds_read_b128 v[80:83], v4 offset:96
buffer_load_dwordx4 a[108:111], v1, s[12:15], s43 offen offset:1024 sc1
v_mfma_f32_16x16x32_bf16 v[28:31], v[84:87], v[148:151], v[28:31]
s_waitcnt lgkmcnt(5)
v_exp_f32 v34, v34
v_mfma_f32_16x16x32_bf16 v[16:19], v[88:91], v[152:155], v[16:19]
s_add_u32 m0, s35, 65584
ds_read_b128 v[84:87], v4 offset:16736
buffer_load_dwordx4 a[112:115], v1, s[12:15], s47 offen offset:1024 sc1
v_mfma_f32_16x16x32_bf16 v[24:27], v[88:91], v[156:159], v[24:27]
buffer_load_dwordx4 v1, s[8:11], s26 offen offset:3072 sc1 lds
v_mfma_f32_16x16x32_bf16 v[20:23], v[92:95], v[152:155], v[20:23]
ds_read_b128 v[88:91], v4 offset:112
buffer_load_dwordx4 a[120:123], v1, s[12:15], s43 offen offset:2048 sc1
buffer_load_dwordx4 a[116:119], v1, s[12:15], s44 offen offset:1024 sc1
v_mfma_f32_16x16x32_bf16 v[28:31], v[92:95], v[156:159], v[28:31]
s_waitcnt lgkmcnt(5)
v_exp_f32 v35, v35
v_mfma_f32_16x16x32_bf16 v[16:19], v[64:67], v[160:163], v[16:19]
s_add_u32 m0, s35, 69696
ds_read_b128 v[92:95], v4 offset:16752
buffer_load_dwordx4 a[124:127], v1, s[12:15], s47 offen offset:2048 sc1
v_cvt_pk_bf16_f32 v57, v34, v35
v_mfma_f32_16x16x32_bf16 v[24:27], v[64:67], v[164:167], v[24:27]
buffer_load_dwordx4 v1, s[8:11], s29 offen offset:0 sc1 lds
v_mfma_f32_16x16x32_bf16 v[20:23], v[68:71], v[160:163], v[20:23]
ds_read_b128 v[64:67], v4 offset:128
buffer_load_dwordx4 a[128:131], v1, s[12:15], s44 offen offset:2048 sc1
v_mfma_f32_16x16x32_bf16 v[28:31], v[68:71], v[164:167], v[28:31]
s_waitcnt lgkmcnt(5)
v_exp_f32 v36, v36
v_mfma_f32_16x16x32_bf16 v[16:19], v[72:75], v[168:171], v[16:19]
s_add_u32 m0, s35, 69712
ds_read_b128 v[68:71], v4 offset:16768
buffer_load_dwordx4 a[132:135], v1, s[12:15], s43 offen offset:3072 sc1
v_mfma_f32_16x16x32_bf16 v[24:27], v[72:75], v[172:175], v[24:27]
buffer_load_dwordx4 v1, s[8:11], s29 offen offset:1024 sc1 lds
v_mfma_f32_16x16x32_bf16 v[20:23], v[76:79], v[168:171], v[20:23]
ds_read_b128 v[72:75], v4 offset:144
buffer_load_dwordx4 a[140:143], v1, s[12:15], s44 offen offset:3072 sc1
buffer_load_dwordx4 a[136:139], v1, s[12:15], s47 offen offset:3072 sc1
v_mfma_f32_16x16x32_bf16 v[28:31], v[76:79], v[172:175], v[28:31]
s_waitcnt lgkmcnt(5)
v_exp_f32 v37, v37
v_mfma_f32_16x16x32_bf16 v[16:19], v[80:83], v[176:179], v[16:19]
s_add_u32 m0, s35, 69728
s_add_u32 s43, s43, 4096
ds_read_b128 v[76:79], v4 offset:16784
buffer_load_dwordx4 a[144:147], v1, s[12:15], s43 offen offset:0 sc1
v_cvt_pk_bf16_f32 v58, v36, v37
v_mfma_f32_16x16x32_bf16 v[24:27], v[80:83], v[180:183], v[24:27]
buffer_load_dwordx4 v1, s[8:11], s29 offen offset:2048 sc1 lds
v_mfma_f32_16x16x32_bf16 v[20:23], v[84:87], v[176:179], v[20:23]
s_add_u32 s47, s43, 16384
ds_read_b128 v[80:83], v4 offset:160
buffer_load_dwordx4 a[148:151], v1, s[12:15], s47 offen offset:0 sc1
v_mfma_f32_16x16x32_bf16 v[28:31], v[84:87], v[180:183], v[28:31]
s_waitcnt lgkmcnt(5)
v_exp_f32 v38, v38
v_mfma_f32_16x16x32_bf16 v[16:19], v[88:91], v[184:187], v[16:19]
s_add_u32 m0, s35, 69744
s_add_u32 s44, s44, 4096
ds_read_b128 v[84:87], v4 offset:16800
buffer_load_dwordx4 a[156:159], v1, s[12:15], s43 offen offset:1024 sc1
buffer_load_dwordx4 a[152:155], v1, s[12:15], s44 offen offset:0 sc1
v_mfma_f32_16x16x32_bf16 v[24:27], v[88:91], v[188:191], v[24:27]
buffer_load_dwordx4 v1, s[8:11], s29 offen offset:3072 sc1 lds
v_mfma_f32_16x16x32_bf16 v[20:23], v[92:95], v[184:187], v[20:23]
ds_read_b128 v[88:91], v4 offset:176
buffer_load_dwordx4 a[160:163], v1, s[12:15], s47 offen offset:1024 sc1
v_mfma_f32_16x16x32_bf16 v[28:31], v[92:95], v[188:191], v[28:31]
s_waitcnt lgkmcnt(5)
v_exp_f32 v39, v39
v_mfma_f32_16x16x32_bf16 v[16:19], v[64:67], v[192:195], v[16:19]
ds_read_b128 v[92:95], v4 offset:16816
buffer_load_dwordx4 a[164:167], v1, s[12:15], s44 offen offset:1024 sc1
v_cvt_pk_bf16_f32 v59, v38, v39
v_mfma_f32_16x16x32_bf16 v[24:27], v[64:67], v[196:199], v[24:27]
v_exp_f32_e64 v40, v40
v_mfma_f32_16x16x32_bf16 v[20:23], v[68:71], v[192:195], v[20:23]
ds_read_b128 v[64:67], v4 offset:192
buffer_load_dwordx4 a[168:171], v1, s[12:15], s43 offen offset:2048 sc1
v_mfma_f32_16x16x32_bf16 v[28:31], v[68:71], v[196:199], v[28:31]
s_waitcnt lgkmcnt(5)
v_exp_f32 v41, v41
v_mfma_f32_16x16x32_bf16 v[16:19], v[72:75], v[200:203], v[16:19]
ds_read_b128 v[68:71], v4 offset:16832
buffer_load_dwordx4 a[176:179], v1, s[12:15], s44 offen offset:2048 sc1
buffer_load_dwordx4 a[172:175], v1, s[12:15], s47 offen offset:2048 sc1
v_cvt_pk_bf16_f32 v60, v40, v41
v_mfma_f32_16x16x32_bf16 v[24:27], v[72:75], v[204:207], v[24:27]
v_exp_f32_e64 v42, v42
v_mfma_f32_16x16x32_bf16 v[20:23], v[76:79], v[200:203], v[20:23]
ds_read_b128 v[72:75], v4 offset:208
s_waitcnt vmcnt(62)
buffer_load_dwordx4 a[180:183], v1, s[12:15], s43 offen offset:3072 sc1
v_mfma_f32_16x16x32_bf16 v[28:31], v[76:79], v[204:207], v[28:31]
s_waitcnt lgkmcnt(5)
v_exp_f32_e64 v43, v43
v_mfma_f32_16x16x32_bf16 v[16:19], v[80:83], v[208:211], v[16:19]
ds_read_b128 v[76:79], v4 offset:16848
s_waitcnt vmcnt(62)
buffer_load_dwordx4 a[184:187], v1, s[12:15], s47 offen offset:3072 sc1
v_cvt_pk_bf16_f32 v61, v42, v43
v_mfma_f32_16x16x32_bf16 v[24:27], v[80:83], v[212:215], v[24:27]
v_exp_f32 v44, v44
v_mfma_f32_16x16x32_bf16 v[20:23], v[84:87], v[208:211], v[20:23]
ds_read_b128 v[80:83], v4 offset:224
s_waitcnt vmcnt(62)
buffer_load_dwordx4 a[188:191], v1, s[12:15], s44 offen offset:3072 sc1
v_mfma_f32_16x16x32_bf16 v[28:31], v[84:87], v[212:215], v[28:31]
s_waitcnt lgkmcnt(5)
v_exp_f32_e64 v45, v45
v_mfma_f32_16x16x32_bf16 v[16:19], v[88:91], v[216:219], v[16:19]
ds_read_b128 v[84:87], v4 offset:16864
v_cvt_pk_bf16_f32 v62, v44, v45
v_mfma_f32_16x16x32_bf16 v[24:27], v[88:91], v[220:223], v[24:27]
v_exp_f32_e64 v46, v46
v_mfma_f32_16x16x32_bf16 v[20:23], v[92:95], v[216:219], v[20:23]
ds_read_b128 v[88:91], v4 offset:240
v_mfma_f32_16x16x32_bf16 v[28:31], v[92:95], v[220:223], v[28:31]
s_waitcnt lgkmcnt(5)
v_exp_f32 v47, v47
v_mfma_f32_16x16x32_bf16 v[16:19], v[64:67], v[224:227], v[16:19]
ds_read_b128 v[92:95], v4 offset:16880
v_cvt_pk_bf16_f32 v63, v46, v47
v_mfma_f32_16x16x32_bf16 v[24:27], v[64:67], v[228:231], v[24:27]
v_add_f32 v8, v8, v32
v_add_f32 v8, v8, v33
v_mfma_f32_16x16x32_bf16 v[20:23], v[68:71], v[224:227], v[20:23]
ds_read_b64_tr_b16 v[64:65], v3 offset:33280
v_add_f32_e64 v8, v8, v34
v_mfma_f32_16x16x32_bf16 v[28:31], v[68:71], v[228:231], v[28:31]
s_waitcnt lgkmcnt(5)
s_nop 0
ds_read_b64_tr_b16 v[66:67], v3 offset:49920
v_mfma_f32_16x16x32_bf16 v[16:19], v[72:75], v[232:235], v[16:19]
ds_read_b64_tr_b16 v[68:69], v3 offset:33312
v_add_f32_e64 v8, v8, v35
v_mfma_f32_16x16x32_bf16 v[24:27], v[72:75], v[236:239], v[24:27]
ds_read_b64_tr_b16 v[70:71], v3 offset:49952
v_add_f32_e64 v8, v8, v36
v_mfma_f32_16x16x32_bf16 v[20:23], v[76:79], v[232:235], v[20:23]
ds_read_b64_tr_b16 v[72:73], v3 offset:33344
v_add_f32_e64 v8, v8, v37
v_mfma_f32_16x16x32_bf16 v[28:31], v[76:79], v[236:239], v[28:31]
s_waitcnt lgkmcnt(7)
s_nop 0
ds_read_b64_tr_b16 v[74:75], v3 offset:49984
v_mfma_f32_16x16x32_bf16 v[16:19], v[80:83], v[240:243], v[16:19]
ds_read_b64_tr_b16 v[76:77], v3 offset:33376
v_add_f32_e64 v8, v8, v38
v_mfma_f32_16x16x32_bf16 v[24:27], v[80:83], v[244:247], v[24:27]
ds_read_b64_tr_b16 v[78:79], v3 offset:50016
v_add_f32_e64 v8, v8, v39
v_mfma_f32_16x16x32_bf16 v[20:23], v[84:87], v[240:243], v[20:23]
ds_read_b64_tr_b16 v[80:81], v3 offset:33408
v_add_f32_e64 v9, v9, v40
v_mfma_f32_16x16x32_bf16 v[28:31], v[84:87], v[244:247], v[28:31]
s_waitcnt lgkmcnt(9)
s_nop 0
ds_read_b64_tr_b16 v[82:83], v3 offset:50048
v_mfma_f32_16x16x32_bf16 v[16:19], v[88:91], v[248:251], v[16:19]
ds_read_b64_tr_b16 v[84:85], v3 offset:33440
v_add_f32_e64 v9, v9, v41
v_mfma_f32_16x16x32_bf16 v[24:27], v[88:91], v[252:255], v[24:27]
ds_read_b64_tr_b16 v[86:87], v3 offset:50080
v_add_f32_e64 v9, v9, v42
v_mfma_f32_16x16x32_bf16 v[20:23], v[92:95], v[248:251], v[20:23]
ds_read_b64_tr_b16 v[88:89], v3 offset:33472
v_add_f32_e64 v9, v9, v43
v_mfma_f32_16x16x32_bf16 v[28:31], v[92:95], v[252:255], v[28:31]
s_waitcnt lgkmcnt(9)
s_nop 0
ds_read_b64_tr_b16 v[90:91], v3 offset:50112
s_waitcnt vmcnt(55)
v_mfma_f32_16x16x32_bf16 v[96:99], a[0:3], a[8:11], 0
v_mfma_f32_16x16x32_bf16 v[100:103], a[4:7], a[8:11], 0
s_waitcnt vmcnt(52)
v_mfma_f32_16x16x32_bf16 v[96:99], a[12:15], a[20:23], v[96:99]
v_mfma_f32_16x16x32_bf16 v[100:103], a[16:19], a[20:23], v[100:103]
s_waitcnt vmcnt(49)
v_mfma_f32_16x16x32_bf16 v[96:99], a[24:27], a[32:35], v[96:99]
v_mfma_f32_16x16x32_bf16 v[100:103], a[28:31], a[32:35], v[100:103]
s_waitcnt vmcnt(46)
v_mfma_f32_16x16x32_bf16 v[96:99], a[36:39], a[44:47], v[96:99]
v_mfma_f32_16x16x32_bf16 v[100:103], a[40:43], a[44:47], v[100:103]
s_waitcnt vmcnt(43)
v_mfma_f32_16x16x32_bf16 v[96:99], a[48:51], a[56:59], v[96:99]
v_mfma_f32_16x16x32_bf16 v[100:103], a[52:55], a[56:59], v[100:103]
s_waitcnt vmcnt(40)
v_mfma_f32_16x16x32_bf16 v[96:99], a[60:63], a[68:71], v[96:99]
v_mfma_f32_16x16x32_bf16 v[100:103], a[64:67], a[68:71], v[100:103]
s_waitcnt vmcnt(34)
v_mfma_f32_16x16x32_bf16 v[96:99], a[72:75], a[80:83], v[96:99]
v_mfma_f32_16x16x32_bf16 v[100:103], a[76:79], a[80:83], v[100:103]
s_waitcnt vmcnt(31)
v_mfma_f32_16x16x32_bf16 v[96:99], a[84:87], a[92:95], v[96:99]
v_mfma_f32_16x16x32_bf16 v[100:103], a[88:91], a[92:95], v[100:103]
s_waitcnt vmcnt(27)
v_mfma_f32_16x16x32_bf16 v[96:99], a[96:99], a[104:107], v[96:99]
v_mfma_f32_16x16x32_bf16 v[100:103], a[100:103], a[104:107], v[100:103]
s_waitcnt vmcnt(21)
v_mfma_f32_16x16x32_bf16 v[96:99], a[108:111], a[116:119], v[96:99]
v_mfma_f32_16x16x32_bf16 v[100:103], a[112:115], a[116:119], v[100:103]
s_waitcnt vmcnt(18)
v_mfma_f32_16x16x32_bf16 v[96:99], a[120:123], a[128:131], v[96:99]
v_mfma_f32_16x16x32_bf16 v[100:103], a[124:127], a[128:131], v[100:103]
s_waitcnt vmcnt(14)
v_mfma_f32_16x16x32_bf16 v[96:99], a[132:135], a[140:143], v[96:99]
v_mfma_f32_16x16x32_bf16 v[100:103], a[136:139], a[140:143], v[100:103]
s_waitcnt vmcnt(9)
v_mfma_f32_16x16x32_bf16 v[96:99], a[144:147], a[152:155], v[96:99]
v_mfma_f32_16x16x32_bf16 v[100:103], a[148:151], a[152:155], v[100:103]
s_waitcnt vmcnt(6)
v_mfma_f32_16x16x32_bf16 v[96:99], a[156:159], a[164:167], v[96:99]
v_mfma_f32_16x16x32_bf16 v[100:103], a[160:163], a[164:167], v[100:103]
s_waitcnt vmcnt(3)
v_mfma_f32_16x16x32_bf16 v[96:99], a[168:171], a[176:179], v[96:99]
v_mfma_f32_16x16x32_bf16 v[100:103], a[172:175], a[176:179], v[100:103]
s_waitcnt vmcnt(0)
v_mfma_f32_16x16x32_bf16 v[96:99], a[180:183], a[188:191], v[96:99]
v_mfma_f32_16x16x32_bf16 v[100:103], a[184:187], a[188:191], v[100:103]
v_mfma_f32_16x16x32_bf16 a[0:3], v[64:67], v[56:59], 0
ds_read_b64_tr_b16 v[92:93], v3 offset:33504
v_add_f32_e64 v9, v9, v44
v_mfma_f32_16x16x32_bf16 a[4:7], v[64:67], v[60:63], 0
ds_read_b64_tr_b16 v[94:95], v3 offset:50144
v_add_f32_e64 v9, v9, v45
v_mfma_f32_16x16x32_bf16 a[8:11], v[68:71], v[56:59], 0
ds_read_b64_tr_b16 v[64:65], v3 offset:33536
v_add_f32_e64 v9, v9, v46
v_mfma_f32_16x16x32_bf16 a[12:15], v[68:71], v[60:63], 0
s_waitcnt lgkmcnt(9)
s_nop 0
ds_read_b64_tr_b16 v[66:67], v3 offset:50176
v_mfma_f32_16x16x32_bf16 a[16:19], v[72:75], v[56:59], 0
ds_read_b64_tr_b16 v[68:69], v3 offset:33568
v_add_f32_e64 v9, v9, v47
v_mfma_f32_16x16x32_bf16 a[20:23], v[72:75], v[60:63], 0
ds_read_b64_tr_b16 v[70:71], v3 offset:50208
v_mfma_f32_16x16x32_bf16 a[24:27], v[76:79], v[56:59], 0
s_add_u32 s26, s26, 32768
ds_read_b64_tr_b16 v[72:73], v3 offset:33600
v_mfma_f32_16x16x32_bf16 a[28:31], v[76:79], v[60:63], 0
s_waitcnt lgkmcnt(9)
s_nop 0
ds_read_b64_tr_b16 v[74:75], v3 offset:50240
v_mfma_f32_16x16x32_bf16 a[32:35], v[80:83], v[56:59], 0
ds_read_b64_tr_b16 v[76:77], v3 offset:33632
v_max3_f32 v10, v16, v17, v18
v_mfma_f32_16x16x32_bf16 a[36:39], v[80:83], v[60:63], 0
ds_read_b64_tr_b16 v[78:79], v3 offset:50272
v_max3_f32 v11, v24, v25, v26
v_mfma_f32_16x16x32_bf16 a[40:43], v[84:87], v[56:59], 0
ds_read_b64_tr_b16 v[80:81], v3 offset:33664
v_max3_f32 v10, v10, v19, v20
v_mfma_f32_16x16x32_bf16 a[44:47], v[84:87], v[60:63], 0
s_waitcnt lgkmcnt(9)
s_nop 0
ds_read_b64_tr_b16 v[82:83], v3 offset:50304
v_mfma_f32_16x16x32_bf16 a[48:51], v[88:91], v[56:59], 0
s_add_u32 s29, s26, 4096
ds_read_b64_tr_b16 v[84:85], v3 offset:33696
v_max3_f32 v11, v11, v27, v28
v_mfma_f32_16x16x32_bf16 a[52:55], v[88:91], v[60:63], 0
ds_read_b64_tr_b16 v[86:87], v3 offset:50336
v_max3_f32 v10, v10, v21, v22
v_mfma_f32_16x16x32_bf16 a[56:59], v[92:95], v[56:59], 0
ds_read_b64_tr_b16 v[88:89], v3 offset:33728
v_max3_f32 v11, v11, v29, v30
v_mfma_f32_16x16x32_bf16 a[60:63], v[92:95], v[60:63], 0
s_waitcnt lgkmcnt(9)
s_nop 0
ds_read_b64_tr_b16 v[90:91], v3 offset:50368
v_mfma_f32_16x16x32_bf16 a[64:67], v[64:67], v[56:59], 0
ds_read_b64_tr_b16 v[92:93], v3 offset:33760
v_max_f32_e64 v10, v10, v23
v_mfma_f32_16x16x32_bf16 a[68:71], v[64:67], v[60:63], 0
ds_read_b64_tr_b16 v[94:95], v3 offset:50400
v_max_f32_e64 v11, v11, v31
v_mfma_f32_16x16x32_bf16 a[72:75], v[68:71], v[56:59], 0
ds_read_b64_tr_b16 v[64:65], v3 offset:33792
v_max_f32_e64 v15, v10, v11
v_mfma_f32_16x16x32_bf16 a[76:79], v[68:71], v[60:63], 0
s_waitcnt lgkmcnt(9)
s_nop 0
ds_read_b64_tr_b16 v[66:67], v3 offset:50432
v_mfma_f32_16x16x32_bf16 a[80:83], v[72:75], v[56:59], 0
ds_read_b64_tr_b16 v[68:69], v3 offset:33824
v_mfma_f32_16x16x32_bf16 a[84:87], v[72:75], v[60:63], 0
ds_read_b64_tr_b16 v[70:71], v3 offset:50464
v_mfma_f32_16x16x32_bf16 a[88:91], v[76:79], v[56:59], 0
ds_read_b64_tr_b16 v[72:73], v3 offset:33856
v_mfma_f32_16x16x32_bf16 a[92:95], v[76:79], v[60:63], 0
s_waitcnt lgkmcnt(9)
s_nop 0
ds_read_b64_tr_b16 v[74:75], v3 offset:50496
v_mfma_f32_16x16x32_bf16 a[96:99], v[80:83], v[56:59], 0
ds_read_b64_tr_b16 v[76:77], v3 offset:33888
v_mfma_f32_16x16x32_bf16 a[100:103], v[80:83], v[60:63], 0
ds_read_b64_tr_b16 v[78:79], v3 offset:50528
v_mfma_f32_16x16x32_bf16 a[104:107], v[84:87], v[56:59], 0
ds_read_b64_tr_b16 v[80:81], v3 offset:33920
v_cvt_pk_bf16_f32 v104, v96, v97
v_mfma_f32_16x16x32_bf16 a[108:111], v[84:87], v[60:63], 0
s_waitcnt lgkmcnt(9)
s_nop 0
ds_read_b64_tr_b16 v[82:83], v3 offset:50560
v_cvt_pk_bf16_f32 v105, v98, v99
v_mfma_f32_16x16x32_bf16 a[112:115], v[88:91], v[56:59], 0
ds_read_b64_tr_b16 v[84:85], v3 offset:33952
v_cvt_pk_bf16_f32 v106, v100, v101
v_mfma_f32_16x16x32_bf16 a[116:119], v[88:91], v[60:63], 0
ds_read_b64_tr_b16 v[86:87], v3 offset:50592
v_cvt_pk_bf16_f32 v107, v102, v103
v_mfma_f32_16x16x32_bf16 a[120:123], v[92:95], v[56:59], 0
ds_read_b64_tr_b16 v[88:89], v3 offset:33984
v_mfma_f32_16x16x32_bf16 a[124:127], v[92:95], v[60:63], 0
s_waitcnt lgkmcnt(9)
s_nop 0
ds_read_b64_tr_b16 v[90:91], v3 offset:50624
v_mfma_f32_16x16x32_bf16 a[128:131], v[64:67], v[56:59], 0
ds_read_b64_tr_b16 v[92:93], v3 offset:34016
v_mfma_f32_16x16x32_bf16 a[132:135], v[64:67], v[60:63], 0
ds_read_b64_tr_b16 v[94:95], v3 offset:50656
v_mfma_f32_16x16x32_bf16 a[136:139], v[68:71], v[56:59], 0
ds_read_b64_tr_b16 v[64:65], v3 offset:34048
v_mfma_f32_16x16x32_bf16 a[140:143], v[68:71], v[60:63], 0
s_waitcnt lgkmcnt(9)
s_nop 0
ds_read_b64_tr_b16 v[66:67], v3 offset:50688
v_mfma_f32_16x16x32_bf16 a[144:147], v[72:75], v[56:59], 0
ds_read_b64_tr_b16 v[68:69], v3 offset:34080
v_mfma_f32_16x16x32_bf16 a[148:151], v[72:75], v[60:63], 0
ds_read_b64_tr_b16 v[70:71], v3 offset:50720
v_mfma_f32_16x16x32_bf16 a[152:155], v[76:79], v[56:59], 0
ds_read_b64_tr_b16 v[72:73], v3 offset:34112
v_mfma_f32_16x16x32_bf16 a[156:159], v[76:79], v[60:63], 0
s_waitcnt lgkmcnt(9)
s_nop 0
ds_read_b64_tr_b16 v[74:75], v3 offset:50752
v_mfma_f32_16x16x32_bf16 a[160:163], v[80:83], v[56:59], 0
ds_read_b64_tr_b16 v[76:77], v3 offset:34144
v_mfma_f32_16x16x32_bf16 a[164:167], v[80:83], v[60:63], 0
ds_read_b64_tr_b16 v[78:79], v3 offset:50784
v_mfma_f32_16x16x32_bf16 a[168:171], v[84:87], v[56:59], 0
ds_read_b64_tr_b16 v[80:81], v3 offset:34176
v_mfma_f32_16x16x32_bf16 a[172:175], v[84:87], v[60:63], 0
s_waitcnt lgkmcnt(9)
s_nop 0
ds_read_b64_tr_b16 v[82:83], v3 offset:50816
v_mfma_f32_16x16x32_bf16 a[176:179], v[88:91], v[56:59], 0
ds_read_b64_tr_b16 v[84:85], v3 offset:34208
v_mfma_f32_16x16x32_bf16 a[180:183], v[88:91], v[60:63], 0
ds_read_b64_tr_b16 v[86:87], v3 offset:50848
v_mfma_f32_16x16x32_bf16 a[184:187], v[92:95], v[56:59], 0
ds_read_b64_tr_b16 v[88:89], v3 offset:34240
v_mfma_f32_16x16x32_bf16 a[188:191], v[92:95], v[60:63], 0
s_waitcnt lgkmcnt(9)
s_nop 0
ds_read_b64_tr_b16 v[90:91], v3 offset:50880
v_mfma_f32_16x16x32_bf16 a[192:195], v[64:67], v[56:59], 0
ds_read_b64_tr_b16 v[92:93], v3 offset:34272
v_mfma_f32_16x16x32_bf16 a[196:199], v[64:67], v[60:63], 0
ds_read_b64_tr_b16 v[94:95], v3 offset:50912
v_mfma_f32_16x16x32_bf16 a[200:203], v[68:71], v[56:59], 0
s_waitcnt vmcnt(8)
s_barrier
ds_read_b128 v[64:67], v4 offset:33280
v_mfma_f32_16x16x32_bf16 a[204:207], v[68:71], v[60:63], 0
s_waitcnt lgkmcnt(9)
s_nop 0
v_mfma_f32_16x16x32_bf16 a[208:211], v[72:75], v[56:59], 0
ds_read_b128 v[68:71], v4 offset:49920
v_mfma_f32_16x16x32_bf16 a[212:215], v[72:75], v[60:63], 0
buffer_store_dwordx4 v[104:107], v1, s[12:15], s36 offen sc1
v_mfma_f32_16x16x32_bf16 a[216:219], v[76:79], v[56:59], 0
ds_read_b128 v[72:75], v4 offset:33296
v_mfma_f32_16x16x32_bf16 a[220:223], v[76:79], v[60:63], 0
s_waitcnt lgkmcnt(7)
s_nop 0
v_mfma_f32_16x16x32_bf16 a[224:227], v[80:83], v[56:59], 0
ds_read_b128 v[76:79], v4 offset:49936
v_mfma_f32_16x16x32_bf16 a[228:231], v[80:83], v[60:63], 0
v_mfma_f32_16x16x32_bf16 a[232:235], v[84:87], v[56:59], 0
ds_read_b128 v[80:83], v4 offset:33312
v_mfma_f32_16x16x32_bf16 a[236:239], v[84:87], v[60:63], 0
s_waitcnt lgkmcnt(5)
s_nop 0
v_mfma_f32_16x16x32_bf16 a[240:243], v[88:91], v[56:59], 0
ds_read_b128 v[84:87], v4 offset:49952
v_mfma_f32_16x16x32_bf16 a[244:247], v[88:91], v[60:63], 0
v_cmp_lt_f32_e64 vcc, s45, v15
v_mfma_f32_16x16x32_bf16 a[248:251], v[92:95], v[56:59], 0
ds_read_b128 v[88:91], v4 offset:33328
v_mfma_f32_16x16x32_bf16 a[252:255], v[92:95], v[60:63], 0
s_waitcnt lgkmcnt(5)
s_cbranch_vccnz L_R1
L_B1:
s_branch L_B1v0
L_q0:
s_nop 0
ds_read_b128 v[64:67], v2 offset:0
ds_read_b128 v[68:71], v2 offset:16640
ds_read_b128 v[72:75], v2 offset:16
ds_read_b128 v[76:79], v2 offset:16656
ds_read_b128 v[80:83], v2 offset:32
ds_read_b128 v[84:87], v2 offset:16672
ds_read_b128 v[88:91], v2 offset:48
v_pk_mul_f32 v[96:97], v[112:113], v[112:113]
v_pk_mul_f32 v[98:99], v[114:115], v[114:115]
v_pk_mul_f32 v[100:101], v[116:117], v[116:117]
v_pk_mul_f32 v[102:103], v[118:119], v[118:119]
v_pk_mul_f32 v[104:105], v[120:121], v[120:121]
v_pk_mul_f32 v[106:107], v[122:123], v[122:123]
v_pk_mul_f32 v[108:109], v[124:125], v[124:125]
v_pk_mul_f32 v[110:111], v[126:127], v[126:127]
v_pk_fma_f32 v[96:97], v[96:97], v[12:13], v[12:13] op_sel:[0,1,0] op_sel_hi:[1,1,0]
v_pk_fma_f32 v[98:99], v[98:99], v[12:13], v[12:13] op_sel:[0,1,0] op_sel_hi:[1,1,0]
v_pk_fma_f32 v[100:101], v[100:101], v[12:13], v[12:13] op_sel:[0,1,0] op_sel_hi:[1,1,0]
v_pk_fma_f32 v[102:103], v[102:103], v[12:13], v[12:13] op_sel:[0,1,0] op_sel_hi:[1,1,0]
v_pk_fma_f32 v[104:105], v[104:105], v[12:13], v[12:13] op_sel:[0,1,0] op_sel_hi:[1,1,0]
v_pk_fma_f32 v[106:107], v[106:107], v[12:13], v[12:13] op_sel:[0,1,0] op_sel_hi:[1,1,0]
v_pk_fma_f32 v[108:109], v[108:109], v[12:13], v[12:13] op_sel:[0,1,0] op_sel_hi:[1,1,0]
v_pk_fma_f32 v[110:111], v[110:111], v[12:13], v[12:13] op_sel:[0,1,0] op_sel_hi:[1,1,0]
v_pk_mul_f32 v[96:97], v[96:97], v[112:113]
v_pk_mul_f32 v[98:99], v[98:99], v[114:115]
v_pk_mul_f32 v[100:101], v[100:101], v[116:117]
v_pk_mul_f32 v[102:103], v[102:103], v[118:119]
v_pk_mul_f32 v[104:105], v[104:105], v[120:121]
v_pk_mul_f32 v[106:107], v[106:107], v[122:123]
v_pk_mul_f32 v[108:109], v[108:109], v[124:125]
v_pk_mul_f32 v[110:111], v[110:111], v[126:127]
s_waitcnt lgkmcnt(5) vmcnt(34)
v_mfma_f32_16x16x32_bf16 v[16:19], v[64:67], v[128:131], 0
v_exp_f32 v96, v96
v_mfma_f32_16x16x32_bf16 v[24:27], v[64:67], v[132:135], 0
s_add_u32 m0, s27, 132096
s_add_u32 s29, s26, 4096
ds_read_b128 v[92:95], v2 offset:16688
v_exp_f32_e64 v97, v97
v_mfma_f32_16x16x32_bf16 v[20:23], v[68:71], v[128:131], 0
buffer_load_dwordx4 v1, s[8:11], s26 offen offset:0 sc1 lds
v_mfma_f32_16x16x32_bf16 v[28:31], v[68:71], v[132:135], 0
s_waitcnt lgkmcnt(4) vmcnt(33)
ds_read_b128 v[64:67], v2 offset:64
v_add_f32 v96, 1.0, v96
v_mfma_f32_16x16x32_bf16 v[16:19], v[72:75], v[136:139], v[16:19]
v_exp_f32_e64 v98, v98
v_mfma_f32_16x16x32_bf16 v[24:27], v[72:75], v[140:143], v[24:27]
ds_read_b128 v[68:71], v2 offset:16704
v_add_f32_e64 v97, 1.0, v97
v_mfma_f32_16x16x32_bf16 v[20:23], v[76:79], v[136:139], v[20:23]
v_rcp_f32_e64 v96, v96
v_mfma_f32_16x16x32_bf16 v[28:31], v[76:79], v[140:143], v[28:31]
s_waitcnt lgkmcnt(4) vmcnt(30)
ds_read_b128 v[72:75], v2 offset:80
v_exp_f32 v99, v99
v_mfma_f32_16x16x32_bf16 v[16:19], v[80:83], v[144:147], v[16:19]
v_add_f32_e64 v98, 1.0, v98
v_mfma_f32_16x16x32_bf16 v[24:27], v[80:83], v[148:151], v[24:27]
s_add_u32 m0, s27, 132112
ds_read_b128 v[76:79], v2 offset:16720
v_rcp_f32_e64 v97, v97
v_mfma_f32_16x16x32_bf16 v[20:23], v[84:87], v[144:147], v[20:23]
buffer_load_dwordx4 v1, s[8:11], s26 offen offset:1024 sc1 lds
v_mfma_f32_16x16x32_bf16 v[28:31], v[84:87], v[148:151], v[28:31]
s_waitcnt lgkmcnt(4) vmcnt(29)
ds_read_b128 v[80:83], v2 offset:96
v_mul_f32 v112, v112, v96
v_mfma_f32_16x16x32_bf16 v[16:19], v[88:91], v[152:155], v[16:19]
v_exp_f32_e64 v100, v100
v_mfma_f32_16x16x32_bf16 v[24:27], v[88:91], v[156:159], v[24:27]
ds_read_b128 v[84:87], v2 offset:16736
v_add_f32_e64 v99, 1.0, v99
v_mfma_f32_16x16x32_bf16 v[20:23], v[92:95], v[152:155], v[20:23]
v_rcp_f32_e64 v98, v98
v_mfma_f32_16x16x32_bf16 v[28:31], v[92:95], v[156:159], v[28:31]
s_waitcnt lgkmcnt(4) vmcnt(27)
ds_read_b128 v[88:91], v2 offset:112
v_mul_f32 v113, v113, v97
v_mfma_f32_16x16x32_bf16 v[16:19], v[64:67], v[160:163], v[16:19]
v_exp_f32_e64 v101, v101
v_mfma_f32_16x16x32_bf16 v[24:27], v[64:67], v[164:167], v[24:27]
s_add_u32 m0, s27, 132128
ds_read_b128 v[92:95], v2 offset:16752
v_add_f32_e64 v100, 1.0, v100
v_mfma_f32_16x16x32_bf16 v[20:23], v[68:71], v[160:163], v[20:23]
buffer_load_dwordx4 v1, s[8:11], s26 offen offset:2048 sc1 lds
v_mfma_f32_16x16x32_bf16 v[28:31], v[68:71], v[164:167], v[28:31]
s_waitcnt lgkmcnt(4) vmcnt(26)
ds_read_b128 v[64:67], v2 offset:128
v_rcp_f32 v99, v99
v_mfma_f32_16x16x32_bf16 v[16:19], v[72:75], v[168:171], v[16:19]
v_mul_f32_e64 v114, v114, v98
v_mfma_f32_16x16x32_bf16 v[24:27], v[72:75], v[172:175], v[24:27]
ds_read_b128 v[68:71], v2 offset:16768
v_exp_f32_e64 v102, v102
v_mfma_f32_16x16x32_bf16 v[20:23], v[76:79], v[168:171], v[20:23]
v_add_f32_e64 v101, 1.0, v101
v_mfma_f32_16x16x32_bf16 v[28:31], v[76:79], v[172:175], v[28:31]
s_waitcnt lgkmcnt(4) vmcnt(23)
ds_read_b128 v[72:75], v2 offset:144
v_rcp_f32 v100, v100
v_mfma_f32_16x16x32_bf16 v[16:19], v[80:83], v[176:179], v[16:19]
v_mul_f32_e64 v115, v115, v99
v_mfma_f32_16x16x32_bf16 v[24:27], v[80:83], v[180:183], v[24:27]
s_add_u32 m0, s27, 132144
ds_read_b128 v[76:79], v2 offset:16784
v_exp_f32_e64 v103, v103
v_mfma_f32_16x16x32_bf16 v[20:23], v[84:87], v[176:179], v[20:23]
buffer_load_dwordx4 v1, s[8:11], s26 offen offset:3072 sc1 lds
v_mfma_f32_16x16x32_bf16 v[28:31], v[84:87], v[180:183], v[28:31]
s_waitcnt lgkmcnt(4) vmcnt(22)
ds_read_b128 v[80:83], v2 offset:160
v_add_f32 v102, 1.0, v102
v_mfma_f32_16x16x32_bf16 v[16:19], v[88:91], v[184:187], v[16:19]
v_rcp_f32_e64 v101, v101
v_mfma_f32_16x16x32_bf16 v[24:27], v[88:91], v[188:191], v[24:27]
ds_read_b128 v[84:87], v2 offset:16800
v_mul_f32_e64 v116, v116, v100
v_mfma_f32_16x16x32_bf16 v[20:23], v[92:95], v[184:187], v[20:23]
v_exp_f32_e64 v104, v104
v_mfma_f32_16x16x32_bf16 v[28:31], v[92:95], v[188:191], v[28:31]
s_waitcnt lgkmcnt(4) vmcnt(20)
s_add_u32 m0, s27, 136256
s_add_u32 s26, s26, 32768
ds_read_b128 v[88:91], v2 offset:176
v_add_f32 v103, 1.0, v103
v_mfma_f32_16x16x32_bf16 v[16:19], v[64:67], v[192:195], v[16:19]
buffer_load_dwordx4 v1, s[8:11], s29 offen offset:0 sc1 lds
v_mfma_f32_16x16x32_bf16 v[24:27], v[64:67], v[196:199], v[24:27]
ds_read_b128 v[92:95], v2 offset:16816
v_rcp_f32_e64 v102, v102
v_mfma_f32_16x16x32_bf16 v[20:23], v[68:71], v[192:195], v[20:23]
v_mul_f32_e64 v117, v117, v101
v_mfma_f32_16x16x32_bf16 v[28:31], v[68:71], v[196:199], v[28:31]
s_waitcnt lgkmcnt(4) vmcnt(19)
ds_read_b128 v[64:67], v2 offset:192
v_exp_f32 v105, v105
v_mfma_f32_16x16x32_bf16 v[16:19], v[72:75], v[200:203], v[16:19]
v_add_f32_e64 v104, 1.0, v104
v_mfma_f32_16x16x32_bf16 v[24:27], v[72:75], v[204:207], v[24:27]
ds_read_b128 v[68:71], v2 offset:16832
v_rcp_f32_e64 v103, v103
v_mfma_f32_16x16x32_bf16 v[20:23], v[76:79], v[200:203], v[20:23]
v_mul_f32_e64 v118, v118, v102
v_mfma_f32_16x16x32_bf16 v[28:31], v[76:79], v[204:207], v[28:31]
s_waitcnt lgkmcnt(4) vmcnt(17)
s_add_u32 m0, s27, 136272
ds_read_b128 v[72:75], v2 offset:208
v_exp_f32 v106, v106
v_mfma_f32_16x16x32_bf16 v[16:19], v[80:83], v[208:211], v[16:19]
buffer_load_dwordx4 v1, s[8:11], s29 offen offset:1024 sc1 lds
v_mfma_f32_16x16x32_bf16 v[24:27], v[80:83], v[212:215], v[24:27]
ds_read_b128 v[76:79], v2 offset:16848
v_add_f32_e64 v105, 1.0, v105
v_mfma_f32_16x16x32_bf16 v[20:23], v[84:87], v[208:211], v[20:23]
v_rcp_f32_e64 v104, v104
v_mfma_f32_16x16x32_bf16 v[28:31], v[84:87], v[212:215], v[28:31]
s_waitcnt lgkmcnt(4) vmcnt(15)
ds_read_b128 v[80:83], v2 offset:224
v_mul_f32 v119, v119, v103
v_cvt_pk_bf16_f32 v96, v112, v113
v_mfma_f32_16x16x32_bf16 v[16:19], v[88:91], v[216:219], v[16:19]
v_cvt_pk_bf16_f32 v97, v114, v115
v_cvt_pk_bf16_f32 v98, v116, v117
v_mfma_f32_16x16x32_bf16 v[24:27], v[88:91], v[220:223], v[24:27]
ds_read_b128 v[84:87], v2 offset:16864
v_cvt_pk_bf16_f32 v99, v118, v119
v_mfma_f32_16x16x32_bf16 v[20:23], v[92:95], v[216:219], v[20:23]
v_mfma_f32_16x16x32_bf16 v[28:31], v[92:95], v[220:223], v[28:31]
s_waitcnt lgkmcnt(4) vmcnt(13)
s_add_u32 s49, s50, 98304
ds_read_b128 v[88:91], v2 offset:240
v_exp_f32 v107, v107
v_mfma_f32_16x16x32_bf16 v[16:19], v[64:67], v[224:227], v[16:19]
buffer_store_dwordx4 v[96:99], v1, s[56:59], s49 offen offset:0 sc1
v_mfma_f32_16x16x32_bf16 v[24:27], v[64:67], v[228:231], v[24:27]
s_add_u32 m0, s27, 136288
ds_read_b128 v[92:95], v2 offset:16880
v_add_f32_e64 v106, 1.0, v106
v_mfma_f32_16x16x32_bf16 v[20:23], v[68:71], v[224:227], v[20:23]
buffer_load_dwordx4 v1, s[8:11], s29 offen offset:2048 sc1 lds
v_mfma_f32_16x16x32_bf16 v[28:31], v[68:71], v[228:231], v[28:31]
s_waitcnt lgkmcnt(4) vmcnt(13)
ds_read_b128 v[64:67], v2 offset:33280
v_rcp_f32 v105, v105
v_mfma_f32_16x16x32_bf16 v[16:19], v[72:75], v[232:235], v[16:19]
v_mul_f32_e64 v120, v120, v104
v_mfma_f32_16x16x32_bf16 v[24:27], v[72:75], v[236:239], v[24:27]
ds_read_b128 v[68:71], v2 offset:49920
v_exp_f32_e64 v108, v108
v_mfma_f32_16x16x32_bf16 v[20:23], v[76:79], v[232:235], v[20:23]
v_add_f32_e64 v107, 1.0, v107
v_mfma_f32_16x16x32_bf16 v[28:31], v[76:79], v[236:239], v[28:31]
s_waitcnt lgkmcnt(4) vmcnt(11)
s_add_u32 m0, s27, 136304
ds_read_b128 v[72:75], v2 offset:33296
v_rcp_f32 v106, v106
v_mfma_f32_16x16x32_bf16 v[16:19], v[80:83], v[240:243], v[16:19]
buffer_load_dwordx4 v1, s[8:11], s29 offen offset:3072 sc1 lds
v_mfma_f32_16x16x32_bf16 v[24:27], v[80:83], v[244:247], v[24:27]
ds_read_b128 v[76:79], v2 offset:49936
v_mul_f32_e64 v121, v121, v105
v_mfma_f32_16x16x32_bf16 v[20:23], v[84:87], v[240:243], v[20:23]
v_exp_f32_e64 v109, v109
v_mfma_f32_16x16x32_bf16 v[28:31], v[84:87], v[244:247], v[28:31]
s_waitcnt lgkmcnt(4) vmcnt(9)
ds_read_b128 v[80:83], v2 offset:33312
v_add_f32 v108, 1.0, v108
v_mfma_f32_16x16x32_bf16 v[16:19], v[88:91], v[248:251], v[16:19]
v_rcp_f32_e64 v107, v107
v_mfma_f32_16x16x32_bf16 v[24:27], v[88:91], v[252:255], v[24:27]
ds_read_b128 v[84:87], v2 offset:49952
v_mul_f32_e64 v122, v122, v106
v_mfma_f32_16x16x32_bf16 v[20:23], v[92:95], v[248:251], v[20:23]
v_exp_f32_e64 v110, v110
v_mfma_f32_16x16x32_bf16 v[28:31], v[92:95], v[252:255], v[28:31]
ds_read_b128 v[88:91], v2 offset:33328
v_add_f32 v109, 1.0, v109
v_rcp_f32 v108, v108
v_mul_f32 v123, v123, v107
v_exp_f32 v111, v111
v_add_f32 v110, 1.0, v110
v_rcp_f32 v109, v109
v_mul_f32 v124, v124, v108
v_add_f32 v111, 1.0, v111
v_rcp_f32 v110, v110
v_mul_f32 v125, v125, v109
v_rcp_f32 v111, v111
v_mul_f32 v126, v126, v110
v_mul_f32_e64 v127, v127, v111
v_cvt_pk_bf16_f32 v104, v120, v121
v_cvt_pk_bf16_f32 v105, v122, v123
v_cvt_pk_bf16_f32 v106, v124, v125
v_cvt_pk_bf16_f32 v107, v126, v127
s_add_u32 s49, s50, 114688
buffer_store_dwordx4 v[104:107], v1, s[56:59], s49 offen offset:0 sc1
s_nop 5
s_nop 0
s_add_u32 s29, s26, 4096
v_max3_f32 v10, v16, v17, v18
v_max3_f32 v11, v24, v25, v26
v_max3_f32 v10, v10, v19, v20
v_max3_f32 v11, v11, v27, v28
v_max3_f32 v10, v10, v21, v22
v_max3_f32 v11, v11, v29, v30
v_max_f32 v10, v10, v23
v_max_f32 v11, v11, v31
v_mov_b32 v12, v10
v_mov_b32 v13, v11
s_nop 1
v_permlane32_swap_b32 v12, v10
v_permlane32_swap_b32 v13, v11
s_nop 1
v_max_f32 v10, v10, v12
v_max_f32 v11, v11, v13
v_mov_b32 v12, v10
v_mov_b32 v13, v11
s_nop 1
v_permlane16_swap_b32 v12, v10
v_permlane16_swap_b32 v13, v11
s_nop 1
v_max_f32 v10, v10, v12
v_max_f32 v11, v11, v13
v_sub_f32 v48, 0, v10
v_sub_f32 v49, 0, v10
v_sub_f32 v50, 0, v10
v_sub_f32 v51, 0, v10
v_sub_f32 v16, v16, v10
v_sub_f32 v17, v17, v10
v_sub_f32 v18, v18, v10
v_sub_f32 v19, v19, v10
v_sub_f32 v20, v20, v10
v_sub_f32 v21, v21, v10
v_sub_f32 v22, v22, v10
v_sub_f32 v23, v23, v10
v_sub_f32 v52, 0, v11
v_sub_f32 v53, 0, v11
v_sub_f32 v54, 0, v11
v_sub_f32 v55, 0, v11
v_sub_f32 v24, v24, v11
v_sub_f32 v25, v25, v11
v_sub_f32 v26, v26, v11
v_sub_f32 v27, v27, v11
v_sub_f32 v28, v28, v11
v_sub_f32 v29, v29, v11
v_sub_f32 v30, v30, v11
v_sub_f32 v31, v31, v11
s_add_u32 s41, s41, 4096
s_waitcnt lgkmcnt(0)
s_nop 0
v_mfma_f32_16x16x32_bf16 v[32:35], v[64:67], v[128:131], v[48:51]
s_add_u32 m0, s35, 165376
ds_read_b128 v[92:95], v2 offset:49968
v_mfma_f32_16x16x32_bf16 v[40:43], v[64:67], v[132:135], v[52:55]
buffer_load_dwordx4 v1, s[8:11], s26 offen offset:0 sc1 lds
v_mfma_f32_16x16x32_bf16 v[36:39], v[68:71], v[128:131], v[48:51]
ds_read_b128 v[64:67], v2 offset:33344
v_mfma_f32_16x16x32_bf16 v[44:47], v[68:71], v[132:135], v[52:55]
s_waitcnt lgkmcnt(5)
v_exp_f32 v16, v16
v_mfma_f32_16x16x32_bf16 v[32:35], v[72:75], v[136:139], v[32:35]
s_add_u32 m0, s35, 165392
ds_read_b128 v[68:71], v2 offset:49984
v_mfma_f32_16x16x32_bf16 v[40:43], v[72:75], v[140:143], v[40:43]
buffer_load_dwordx4 v1, s[8:11], s26 offen offset:1024 sc1 lds
v_mfma_f32_16x16x32_bf16 v[36:39], v[76:79], v[136:139], v[36:39]
ds_read_b128 v[72:75], v2 offset:33360
v_mfma_f32_16x16x32_bf16 v[44:47], v[76:79], v[140:143], v[44:47]
s_waitcnt lgkmcnt(5)
v_exp_f32 v17, v17
v_mfma_f32_16x16x32_bf16 v[32:35], v[80:83], v[144:147], v[32:35]
s_add_u32 m0, s35, 165408
ds_read_b128 v[76:79], v2 offset:50000
v_cvt_pk_bf16_f32 v56, v16, v17
v_mfma_f32_16x16x32_bf16 v[40:43], v[80:83], v[148:151], v[40:43]
buffer_load_dwordx4 v1, s[8:11], s26 offen offset:2048 sc1 lds
v_mfma_f32_16x16x32_bf16 v[36:39], v[84:87], v[144:147], v[36:39]
ds_read_b128 v[80:83], v2 offset:33376
v_mfma_f32_16x16x32_bf16 v[44:47], v[84:87], v[148:151], v[44:47]
s_waitcnt lgkmcnt(5)
v_exp_f32 v18, v18
v_mfma_f32_16x16x32_bf16 v[32:35], v[88:91], v[152:155], v[32:35]
s_add_u32 m0, s35, 165424
ds_read_b128 v[84:87], v2 offset:50016
v_mfma_f32_16x16x32_bf16 v[40:43], v[88:91], v[156:159], v[40:43]
buffer_load_dwordx4 v1, s[8:11], s26 offen offset:3072 sc1 lds
v_mfma_f32_16x16x32_bf16 v[36:39], v[92:95], v[152:155], v[36:39]
ds_read_b128 v[88:91], v2 offset:33392
v_mfma_f32_16x16x32_bf16 v[44:47], v[92:95], v[156:159], v[44:47]
s_waitcnt lgkmcnt(5)
v_exp_f32 v19, v19
v_mfma_f32_16x16x32_bf16 v[32:35], v[64:67], v[160:163], v[32:35]
s_add_u32 m0, s35, 169536
ds_read_b128 v[92:95], v2 offset:50032
v_cvt_pk_bf16_f32 v57, v18, v19
v_mfma_f32_16x16x32_bf16 v[40:43], v[64:67], v[164:167], v[40:43]
buffer_load_dwordx4 v1, s[8:11], s29 offen offset:0 sc1 lds
v_mfma_f32_16x16x32_bf16 v[36:39], v[68:71], v[160:163], v[36:39]
ds_read_b128 v[64:67], v2 offset:33408
v_mfma_f32_16x16x32_bf16 v[44:47], v[68:71], v[164:167], v[44:47]
s_waitcnt lgkmcnt(5)
v_exp_f32 v20, v20
v_mfma_f32_16x16x32_bf16 v[32:35], v[72:75], v[168:171], v[32:35]
s_add_u32 m0, s35, 169552
ds_read_b128 v[68:71], v2 offset:50048
v_mfma_f32_16x16x32_bf16 v[40:43], v[72:75], v[172:175], v[40:43]
buffer_load_dwordx4 v1, s[8:11], s29 offen offset:1024 sc1 lds
v_mfma_f32_16x16x32_bf16 v[36:39], v[76:79], v[168:171], v[36:39]
ds_read_b128 v[72:75], v2 offset:33424
v_mfma_f32_16x16x32_bf16 v[44:47], v[76:79], v[172:175], v[44:47]
s_waitcnt lgkmcnt(5)
v_exp_f32 v21, v21
v_mfma_f32_16x16x32_bf16 v[32:35], v[80:83], v[176:179], v[32:35]
s_add_u32 m0, s35, 169568
ds_read_b128 v[76:79], v2 offset:50064
v_cvt_pk_bf16_f32 v58, v20, v21
v_mfma_f32_16x16x32_bf16 v[40:43], v[80:83], v[180:183], v[40:43]
buffer_load_dwordx4 v1, s[8:11], s29 offen offset:2048 sc1 lds
v_mfma_f32_16x16x32_bf16 v[36:39], v[84:87], v[176:179], v[36:39]
ds_read_b128 v[80:83], v2 offset:33440
v_mfma_f32_16x16x32_bf16 v[44:47], v[84:87], v[180:183], v[44:47]
s_waitcnt lgkmcnt(5)
v_exp_f32 v22, v22
v_mfma_f32_16x16x32_bf16 v[32:35], v[88:91], v[184:187], v[32:35]
s_add_u32 m0, s35, 169584
ds_read_b128 v[84:87], v2 offset:50080
v_mfma_f32_16x16x32_bf16 v[40:43], v[88:91], v[188:191], v[40:43]
buffer_load_dwordx4 v1, s[8:11], s29 offen offset:3072 sc1 lds
v_mfma_f32_16x16x32_bf16 v[36:39], v[92:95], v[184:187], v[36:39]
ds_read_b128 v[88:91], v2 offset:33456
v_mfma_f32_16x16x32_bf16 v[44:47], v[92:95], v[188:191], v[44:47]
s_waitcnt lgkmcnt(5)
v_exp_f32 v23, v23
v_mfma_f32_16x16x32_bf16 v[32:35], v[64:67], v[192:195], v[32:35]
ds_read_b128 v[92:95], v2 offset:50096
v_cvt_pk_bf16_f32 v59, v22, v23
v_mfma_f32_16x16x32_bf16 v[40:43], v[64:67], v[196:199], v[40:43]
v_exp_f32_e64 v24, v24
v_mfma_f32_16x16x32_bf16 v[36:39], v[68:71], v[192:195], v[36:39]
ds_read_b128 v[64:67], v2 offset:33472
v_mfma_f32_16x16x32_bf16 v[44:47], v[68:71], v[196:199], v[44:47]
s_waitcnt lgkmcnt(5)
v_exp_f32 v25, v25
v_mfma_f32_16x16x32_bf16 v[32:35], v[72:75], v[200:203], v[32:35]
ds_read_b128 v[68:71], v2 offset:50112
v_cvt_pk_bf16_f32 v60, v24, v25
v_mfma_f32_16x16x32_bf16 v[40:43], v[72:75], v[204:207], v[40:43]
v_exp_f32_e64 v26, v26
v_mfma_f32_16x16x32_bf16 v[36:39], v[76:79], v[200:203], v[36:39]
ds_read_b128 v[72:75], v2 offset:33488
v_mfma_f32_16x16x32_bf16 v[44:47], v[76:79], v[204:207], v[44:47]
s_waitcnt lgkmcnt(5)
v_exp_f32 v27, v27
v_mfma_f32_16x16x32_bf16 v[32:35], v[80:83], v[208:211], v[32:35]
ds_read_b128 v[76:79], v2 offset:50128
v_cvt_pk_bf16_f32 v61, v26, v27
v_mfma_f32_16x16x32_bf16 v[40:43], v[80:83], v[212:215], v[40:43]
v_exp_f32_e64 v28, v28
v_mfma_f32_16x16x32_bf16 v[36:39], v[84:87], v[208:211], v[36:39]
ds_read_b128 v[80:83], v2 offset:33504
v_mfma_f32_16x16x32_bf16 v[44:47], v[84:87], v[212:215], v[44:47]
s_waitcnt lgkmcnt(5)
v_exp_f32 v29, v29
v_mfma_f32_16x16x32_bf16 v[32:35], v[88:91], v[216:219], v[32:35]
ds_read_b128 v[84:87], v2 offset:50144
v_cvt_pk_bf16_f32 v62, v28, v29
v_mfma_f32_16x16x32_bf16 v[40:43], v[88:91], v[220:223], v[40:43]
v_exp_f32_e64 v30, v30
v_mfma_f32_16x16x32_bf16 v[36:39], v[92:95], v[216:219], v[36:39]
ds_read_b128 v[88:91], v2 offset:33520
v_mfma_f32_16x16x32_bf16 v[44:47], v[92:95], v[220:223], v[44:47]
s_waitcnt lgkmcnt(5)
v_exp_f32 v31, v31
v_mfma_f32_16x16x32_bf16 v[32:35], v[64:67], v[224:227], v[32:35]
ds_read_b128 v[92:95], v2 offset:50160
v_cvt_pk_bf16_f32 v63, v30, v31
v_mfma_f32_16x16x32_bf16 v[40:43], v[64:67], v[228:231], v[40:43]
v_add_f32 v8, v8, v16
v_add_f32 v8, v8, v17
v_mfma_f32_16x16x32_bf16 v[36:39], v[68:71], v[224:227], v[36:39]
ds_read_b64_tr_b16 v[64:65], v3 offset:0
v_add_f32_e64 v8, v8, v18
v_mfma_f32_16x16x32_bf16 v[44:47], v[68:71], v[228:231], v[44:47]
s_waitcnt lgkmcnt(5)
s_nop 0
ds_read_b64_tr_b16 v[66:67], v3 offset:16640
v_mfma_f32_16x16x32_bf16 v[32:35], v[72:75], v[232:235], v[32:35]
ds_read_b64_tr_b16 v[68:69], v3 offset:32
v_add_f32_e64 v8, v8, v19
v_mfma_f32_16x16x32_bf16 v[40:43], v[72:75], v[236:239], v[40:43]
ds_read_b64_tr_b16 v[70:71], v3 offset:16672
v_add_f32_e64 v8, v8, v20
v_mfma_f32_16x16x32_bf16 v[36:39], v[76:79], v[232:235], v[36:39]
ds_read_b64_tr_b16 v[72:73], v3 offset:64
v_add_f32_e64 v8, v8, v21
v_mfma_f32_16x16x32_bf16 v[44:47], v[76:79], v[236:239], v[44:47]
s_waitcnt lgkmcnt(7)
s_nop 0
ds_read_b64_tr_b16 v[74:75], v3 offset:16704
v_mfma_f32_16x16x32_bf16 v[32:35], v[80:83], v[240:243], v[32:35]
ds_read_b64_tr_b16 v[76:77], v3 offset:96
v_add_f32_e64 v8, v8, v22
v_mfma_f32_16x16x32_bf16 v[40:43], v[80:83], v[244:247], v[40:43]
ds_read_b64_tr_b16 v[78:79], v3 offset:16736
v_add_f32_e64 v8, v8, v23
v_mfma_f32_16x16x32_bf16 v[36:39], v[84:87], v[240:243], v[36:39]
ds_read_b64_tr_b16 v[80:81], v3 offset:128
v_add_f32_e64 v9, v9, v24
v_mfma_f32_16x16x32_bf16 v[44:47], v[84:87], v[244:247], v[44:47]
s_waitcnt lgkmcnt(9)
s_nop 0
ds_read_b64_tr_b16 v[82:83], v3 offset:16768
v_mfma_f32_16x16x32_bf16 v[32:35], v[88:91], v[248:251], v[32:35]
ds_read_b64_tr_b16 v[84:85], v3 offset:160
v_add_f32_e64 v9, v9, v25
v_mfma_f32_16x16x32_bf16 v[40:43], v[88:91], v[252:255], v[40:43]
ds_read_b64_tr_b16 v[86:87], v3 offset:16800
v_add_f32_e64 v9, v9, v26
v_mfma_f32_16x16x32_bf16 v[36:39], v[92:95], v[248:251], v[36:39]
ds_read_b64_tr_b16 v[88:89], v3 offset:192
v_add_f32_e64 v9, v9, v27
v_mfma_f32_16x16x32_bf16 v[44:47], v[92:95], v[252:255], v[44:47]
s_waitcnt lgkmcnt(9)
s_nop 0
ds_read_b64_tr_b16 v[90:91], v3 offset:16832
v_mfma_f32_16x16x32_bf16 a[0:3], v[64:67], v[56:59], 0
ds_read_b64_tr_b16 v[92:93], v3 offset:224
v_add_f32_e64 v9, v9, v28
v_mfma_f32_16x16x32_bf16 a[4:7], v[64:67], v[60:63], 0
ds_read_b64_tr_b16 v[94:95], v3 offset:16864
v_add_f32_e64 v9, v9, v29
v_mfma_f32_16x16x32_bf16 a[8:11], v[68:71], v[56:59], 0
ds_read_b64_tr_b16 v[64:65], v3 offset:256
v_add_f32_e64 v9, v9, v30
v_mfma_f32_16x16x32_bf16 a[12:15], v[68:71], v[60:63], 0
s_waitcnt lgkmcnt(9)
s_nop 0
ds_read_b64_tr_b16 v[66:67], v3 offset:16896
v_mfma_f32_16x16x32_bf16 a[16:19], v[72:75], v[56:59], 0
ds_read_b64_tr_b16 v[68:69], v3 offset:288
v_add_f32_e64 v9, v9, v31
v_mfma_f32_16x16x32_bf16 a[20:23], v[72:75], v[60:63], 0
ds_read_b64_tr_b16 v[70:71], v3 offset:16928
v_mfma_f32_16x16x32_bf16 a[24:27], v[76:79], v[56:59], 0
s_add_u32 s26, s26, 32768
ds_read_b64_tr_b16 v[72:73], v3 offset:320
v_mfma_f32_16x16x32_bf16 a[28:31], v[76:79], v[60:63], 0
s_waitcnt lgkmcnt(9)
s_nop 0
ds_read_b64_tr_b16 v[74:75], v3 offset:16960
v_mfma_f32_16x16x32_bf16 a[32:35], v[80:83], v[56:59], 0
s_cmp_eq_u32 s31, 0
ds_read_b64_tr_b16 v[76:77], v3 offset:352
v_max3_f32 v10, v32, v33, v34
v_mfma_f32_16x16x32_bf16 a[36:39], v[80:83], v[60:63], 0
s_cselect_b64 s[8:9], s[16:17], s[8:9]
ds_read_b64_tr_b16 v[78:79], v3 offset:16992
v_max3_f32 v11, v40, v41, v42
v_mfma_f32_16x16x32_bf16 a[40:43], v[84:87], v[56:59], 0
s_cselect_b32 s26, s28, s26
s_nop 0
ds_read_b64_tr_b16 v[80:81], v3 offset:384
v_max3_f32 v10, v10, v35, v36
v_mfma_f32_16x16x32_bf16 a[44:47], v[84:87], v[60:63], 0
s_waitcnt lgkmcnt(9)
s_nop 0
ds_read_b64_tr_b16 v[82:83], v3 offset:17024
v_mfma_f32_16x16x32_bf16 a[48:51], v[88:91], v[56:59], 0
s_add_u32 s29, s26, 4096
ds_read_b64_tr_b16 v[84:85], v3 offset:416
v_max3_f32 v11, v11, v43, v44
v_mfma_f32_16x16x32_bf16 a[52:55], v[88:91], v[60:63], 0
ds_read_b64_tr_b16 v[86:87], v3 offset:17056
v_max3_f32 v10, v10, v37, v38
v_mfma_f32_16x16x32_bf16 a[56:59], v[92:95], v[56:59], 0
ds_read_b64_tr_b16 v[88:89], v3 offset:448
v_max3_f32 v11, v11, v45, v46
v_mfma_f32_16x16x32_bf16 a[60:63], v[92:95], v[60:63], 0
s_waitcnt lgkmcnt(9)
s_nop 0
ds_read_b64_tr_b16 v[90:91], v3 offset:17088
v_mfma_f32_16x16x32_bf16 a[64:67], v[64:67], v[56:59], 0
ds_read_b64_tr_b16 v[92:93], v3 offset:480
v_max_f32_e64 v10, v10, v39
v_mfma_f32_16x16x32_bf16 a[68:71], v[64:67], v[60:63], 0
ds_read_b64_tr_b16 v[94:95], v3 offset:17120
v_max_f32_e64 v11, v11, v47
v_mfma_f32_16x16x32_bf16 a[72:75], v[68:71], v[56:59], 0
ds_read_b64_tr_b16 v[64:65], v3 offset:512
v_max_f32_e64 v15, v10, v11
v_mfma_f32_16x16x32_bf16 a[76:79], v[68:71], v[60:63], 0
s_waitcnt lgkmcnt(9)
s_nop 0
ds_read_b64_tr_b16 v[66:67], v3 offset:17152
v_mfma_f32_16x16x32_bf16 a[80:83], v[72:75], v[56:59], 0
ds_read_b64_tr_b16 v[68:69], v3 offset:544
v_mfma_f32_16x16x32_bf16 a[84:87], v[72:75], v[60:63], 0
ds_read_b64_tr_b16 v[70:71], v3 offset:17184
v_mfma_f32_16x16x32_bf16 a[88:91], v[76:79], v[56:59], 0
ds_read_b64_tr_b16 v[72:73], v3 offset:576
v_mfma_f32_16x16x32_bf16 a[92:95], v[76:79], v[60:63], 0
s_waitcnt lgkmcnt(9)
s_nop 0
ds_read_b64_tr_b16 v[74:75], v3 offset:17216
v_mfma_f32_16x16x32_bf16 a[96:99], v[80:83], v[56:59], 0
ds_read_b64_tr_b16 v[76:77], v3 offset:608
v_mfma_f32_16x16x32_bf16 a[100:103], v[80:83], v[60:63], 0
ds_read_b64_tr_b16 v[78:79], v3 offset:17248
v_mfma_f32_16x16x32_bf16 a[104:107], v[84:87], v[56:59], 0
ds_read_b64_tr_b16 v[80:81], v3 offset:640
v_mfma_f32_16x16x32_bf16 a[108:111], v[84:87], v[60:63], 0
s_waitcnt lgkmcnt(9)
s_nop 0
ds_read_b64_tr_b16 v[82:83], v3 offset:17280
v_mfma_f32_16x16x32_bf16 a[112:115], v[88:91], v[56:59], 0
ds_read_b64_tr_b16 v[84:85], v3 offset:672
v_mfma_f32_16x16x32_bf16 a[116:119], v[88:91], v[60:63], 0
ds_read_b64_tr_b16 v[86:87], v3 offset:17312
v_mfma_f32_16x16x32_bf16 a[120:123], v[92:95], v[56:59], 0
ds_read_b64_tr_b16 v[88:89], v3 offset:704
v_mfma_f32_16x16x32_bf16 a[124:127], v[92:95], v[60:63], 0
s_waitcnt lgkmcnt(9)
s_nop 0
ds_read_b64_tr_b16 v[90:91], v3 offset:17344
v_mfma_f32_16x16x32_bf16 a[128:131], v[64:67], v[56:59], 0
ds_read_b64_tr_b16 v[92:93], v3 offset:736
v_mfma_f32_16x16x32_bf16 a[132:135], v[64:67], v[60:63], 0
ds_read_b64_tr_b16 v[94:95], v3 offset:17376
v_mfma_f32_16x16x32_bf16 a[136:139], v[68:71], v[56:59], 0
ds_read_b64_tr_b16 v[64:65], v3 offset:768
v_mfma_f32_16x16x32_bf16 a[140:143], v[68:71], v[60:63], 0
s_waitcnt lgkmcnt(9)
s_nop 0
ds_read_b64_tr_b16 v[66:67], v3 offset:17408
v_mfma_f32_16x16x32_bf16 a[144:147], v[72:75], v[56:59], 0
ds_read_b64_tr_b16 v[68:69], v3 offset:800
v_mfma_f32_16x16x32_bf16 a[148:151], v[72:75], v[60:63], 0
ds_read_b64_tr_b16 v[70:71], v3 offset:17440
v_mfma_f32_16x16x32_bf16 a[152:155], v[76:79], v[56:59], 0
ds_read_b64_tr_b16 v[72:73], v3 offset:832
v_mfma_f32_16x16x32_bf16 a[156:159], v[76:79], v[60:63], 0
s_waitcnt lgkmcnt(9)
s_nop 0
ds_read_b64_tr_b16 v[74:75], v3 offset:17472
v_mfma_f32_16x16x32_bf16 a[160:163], v[80:83], v[56:59], 0
ds_read_b64_tr_b16 v[76:77], v3 offset:864
v_mfma_f32_16x16x32_bf16 a[164:167], v[80:83], v[60:63], 0
ds_read_b64_tr_b16 v[78:79], v3 offset:17504
v_mfma_f32_16x16x32_bf16 a[168:171], v[84:87], v[56:59], 0
ds_read_b64_tr_b16 v[80:81], v3 offset:896
v_mfma_f32_16x16x32_bf16 a[172:175], v[84:87], v[60:63], 0
s_waitcnt lgkmcnt(9)
s_nop 0
ds_read_b64_tr_b16 v[82:83], v3 offset:17536
v_mfma_f32_16x16x32_bf16 a[176:179], v[88:91], v[56:59], 0
ds_read_b64_tr_b16 v[84:85], v3 offset:928
v_mfma_f32_16x16x32_bf16 a[180:183], v[88:91], v[60:63], 0
ds_read_b64_tr_b16 v[86:87], v3 offset:17568
v_mfma_f32_16x16x32_bf16 a[184:187], v[92:95], v[56:59], 0
ds_read_b64_tr_b16 v[88:89], v3 offset:960
v_mfma_f32_16x16x32_bf16 a[188:191], v[92:95], v[60:63], 0
s_waitcnt lgkmcnt(9)
s_nop 0
ds_read_b64_tr_b16 v[90:91], v3 offset:17600
v_mfma_f32_16x16x32_bf16 a[192:195], v[64:67], v[56:59], 0
ds_read_b64_tr_b16 v[92:93], v3 offset:992
v_mfma_f32_16x16x32_bf16 a[196:199], v[64:67], v[60:63], 0
ds_read_b64_tr_b16 v[94:95], v3 offset:17632
v_mfma_f32_16x16x32_bf16 a[200:203], v[68:71], v[56:59], 0
s_waitcnt vmcnt(8)
s_barrier
ds_read_b128 v[64:67], v4 offset:0
v_mfma_f32_16x16x32_bf16 a[204:207], v[68:71], v[60:63], 0
s_waitcnt lgkmcnt(9)
s_nop 0
v_mfma_f32_16x16x32_bf16 a[208:211], v[72:75], v[56:59], 0
ds_read_b128 v[68:71], v4 offset:16640
v_mfma_f32_16x16x32_bf16 a[212:215], v[72:75], v[60:63], 0
v_mfma_f32_16x16x32_bf16 a[216:219], v[76:79], v[56:59], 0
ds_read_b128 v[72:75], v4 offset:16
v_mfma_f32_16x16x32_bf16 a[220:223], v[76:79], v[60:63], 0
s_waitcnt lgkmcnt(7)
s_nop 0
v_mfma_f32_16x16x32_bf16 a[224:227], v[80:83], v[56:59], 0
ds_read_b128 v[76:79], v4 offset:16656
v_mfma_f32_16x16x32_bf16 a[228:231], v[80:83], v[60:63], 0
v_mfma_f32_16x16x32_bf16 a[232:235], v[84:87], v[56:59], 0
ds_read_b128 v[80:83], v4 offset:32
v_mfma_f32_16x16x32_bf16 a[236:239], v[84:87], v[60:63], 0
s_waitcnt lgkmcnt(5)
s_nop 0
v_mfma_f32_16x16x32_bf16 a[240:243], v[88:91], v[56:59], 0
ds_read_b128 v[84:87], v4 offset:16672
v_mfma_f32_16x16x32_bf16 a[244:247], v[88:91], v[60:63], 0
v_cmp_lt_f32_e64 vcc, s45, v15
v_mfma_f32_16x16x32_bf16 a[248:251], v[92:95], v[56:59], 0
ds_read_b128 v[88:91], v4 offset:48
v_mfma_f32_16x16x32_bf16 a[252:255], v[92:95], v[60:63], 0
s_waitcnt lgkmcnt(5)
s_cbranch_vccnz L_R0
L_B0:
s_branch L_B0v0
L_B2:
s_branch L_B2v0
L_B3:
s_branch L_B3v0
L_L0:
s_branch L_L0v0
L_L0v0:
v_mfma_f32_16x16x32_bf16 v[32:35], v[64:67], v[128:131], v[48:51]
s_add_u32 m0, s35, 165376
ds_read_b128 v[92:95], v2 offset:49968
v_mfma_f32_16x16x32_bf16 v[40:43], v[64:67], v[132:135], v[52:55]
buffer_load_dwordx4 v1, s[8:11], s26 offen offset:0 sc1 lds
v_mfma_f32_16x16x32_bf16 v[36:39], v[68:71], v[128:131], v[48:51]
ds_read_b128 v[64:67], v2 offset:33344
v_mfma_f32_16x16x32_bf16 v[44:47], v[68:71], v[132:135], v[52:55]
s_waitcnt lgkmcnt(5)
v_exp_f32 v16, v16
v_mfma_f32_16x16x32_bf16 v[32:35], v[72:75], v[136:139], v[32:35]
s_add_u32 m0, s35, 165392
ds_read_b128 v[68:71], v2 offset:49984
v_mfma_f32_16x16x32_bf16 v[40:43], v[72:75], v[140:143], v[40:43]
buffer_load_dwordx4 v1, s[8:11], s26 offen offset:1024 sc1 lds
v_mfma_f32_16x16x32_bf16 v[36:39], v[76:79], v[136:139], v[36:39]
ds_read_b128 v[72:75], v2 offset:33360
v_mfma_f32_16x16x32_bf16 v[44:47], v[76:79], v[140:143], v[44:47]
s_waitcnt lgkmcnt(5)
v_exp_f32 v17, v17
v_mfma_f32_16x16x32_bf16 v[32:35], v[80:83], v[144:147], v[32:35]
s_add_u32 m0, s35, 165408
ds_read_b128 v[76:79], v2 offset:50000
v_cvt_pk_bf16_f32 v56, v16, v17
v_mfma_f32_16x16x32_bf16 v[40:43], v[80:83], v[148:151], v[40:43]
buffer_load_dwordx4 v1, s[8:11], s26 offen offset:2048 sc1 lds
v_mfma_f32_16x16x32_bf16 v[36:39], v[84:87], v[144:147], v[36:39]
ds_read_b128 v[80:83], v2 offset:33376
v_mfma_f32_16x16x32_bf16 v[44:47], v[84:87], v[148:151], v[44:47]
s_waitcnt lgkmcnt(5)
v_exp_f32 v18, v18
v_mfma_f32_16x16x32_bf16 v[32:35], v[88:91], v[152:155], v[32:35]
s_add_u32 m0, s35, 165424
ds_read_b128 v[84:87], v2 offset:50016
v_mfma_f32_16x16x32_bf16 v[40:43], v[88:91], v[156:159], v[40:43]
buffer_load_dwordx4 v1, s[8:11], s26 offen offset:3072 sc1 lds
v_mfma_f32_16x16x32_bf16 v[36:39], v[92:95], v[152:155], v[36:39]
ds_read_b128 v[88:91], v2 offset:33392
v_mfma_f32_16x16x32_bf16 v[44:47], v[92:95], v[156:159], v[44:47]
s_waitcnt lgkmcnt(5)
v_exp_f32 v19, v19
v_mfma_f32_16x16x32_bf16 v[32:35], v[64:67], v[160:163], v[32:35]
s_add_u32 m0, s35, 169536
ds_read_b128 v[92:95], v2 offset:50032
v_cvt_pk_bf16_f32 v57, v18, v19
v_mfma_f32_16x16x32_bf16 v[40:43], v[64:67], v[164:167], v[40:43]
buffer_load_dwordx4 v1, s[8:11], s29 offen offset:0 sc1 lds
v_mfma_f32_16x16x32_bf16 v[36:39], v[68:71], v[160:163], v[36:39]
ds_read_b128 v[64:67], v2 offset:33408
v_mfma_f32_16x16x32_bf16 v[44:47], v[68:71], v[164:167], v[44:47]
s_waitcnt lgkmcnt(5)
v_exp_f32 v20, v20
v_mfma_f32_16x16x32_bf16 v[32:35], v[72:75], v[168:171], v[32:35]
s_add_u32 m0, s35, 169552
ds_read_b128 v[68:71], v2 offset:50048
v_mfma_f32_16x16x32_bf16 v[40:43], v[72:75], v[172:175], v[40:43]
buffer_load_dwordx4 v1, s[8:11], s29 offen offset:1024 sc1 lds
v_mfma_f32_16x16x32_bf16 v[36:39], v[76:79], v[168:171], v[36:39]
ds_read_b128 v[72:75], v2 offset:33424
v_mfma_f32_16x16x32_bf16 v[44:47], v[76:79], v[172:175], v[44:47]
s_waitcnt lgkmcnt(5)
v_exp_f32 v21, v21
v_mfma_f32_16x16x32_bf16 v[32:35], v[80:83], v[176:179], v[32:35]
s_add_u32 m0, s35, 169568
ds_read_b128 v[76:79], v2 offset:50064
v_cvt_pk_bf16_f32 v58, v20, v21
v_mfma_f32_16x16x32_bf16 v[40:43], v[80:83], v[180:183], v[40:43]
buffer_load_dwordx4 v1, s[8:11], s29 offen offset:2048 sc1 lds
v_mfma_f32_16x16x32_bf16 v[36:39], v[84:87], v[176:179], v[36:39]
ds_read_b128 v[80:83], v2 offset:33440
v_mfma_f32_16x16x32_bf16 v[44:47], v[84:87], v[180:183], v[44:47]
s_waitcnt lgkmcnt(5)
v_exp_f32 v22, v22
v_mfma_f32_16x16x32_bf16 v[32:35], v[88:91], v[184:187], v[32:35]
s_add_u32 m0, s35, 169584
ds_read_b128 v[84:87], v2 offset:50080
v_mfma_f32_16x16x32_bf16 v[40:43], v[88:91], v[188:191], v[40:43]
buffer_load_dwordx4 v1, s[8:11], s29 offen offset:3072 sc1 lds
v_mfma_f32_16x16x32_bf16 v[36:39], v[92:95], v[184:187], v[36:39]
ds_read_b128 v[88:91], v2 offset:33456
v_mfma_f32_16x16x32_bf16 v[44:47], v[92:95], v[188:191], v[44:47]
s_waitcnt lgkmcnt(5)
v_exp_f32 v23, v23
v_mfma_f32_16x16x32_bf16 v[32:35], v[64:67], v[192:195], v[32:35]
ds_read_b128 v[92:95], v2 offset:50096
v_cvt_pk_bf16_f32 v59, v22, v23
v_mfma_f32_16x16x32_bf16 v[40:43], v[64:67], v[196:199], v[40:43]
v_exp_f32_e64 v24, v24
v_mfma_f32_16x16x32_bf16 v[36:39], v[68:71], v[192:195], v[36:39]
ds_read_b128 v[64:67], v2 offset:33472
v_mfma_f32_16x16x32_bf16 v[44:47], v[68:71], v[196:199], v[44:47]
s_waitcnt lgkmcnt(5)
v_exp_f32 v25, v25
v_mfma_f32_16x16x32_bf16 v[32:35], v[72:75], v[200:203], v[32:35]
ds_read_b128 v[68:71], v2 offset:50112
v_cvt_pk_bf16_f32 v60, v24, v25
v_mfma_f32_16x16x32_bf16 v[40:43], v[72:75], v[204:207], v[40:43]
v_exp_f32_e64 v26, v26
v_mfma_f32_16x16x32_bf16 v[36:39], v[76:79], v[200:203], v[36:39]
ds_read_b128 v[72:75], v2 offset:33488
v_mfma_f32_16x16x32_bf16 v[44:47], v[76:79], v[204:207], v[44:47]
s_waitcnt lgkmcnt(5)
v_exp_f32 v27, v27
v_mfma_f32_16x16x32_bf16 v[32:35], v[80:83], v[208:211], v[32:35]
ds_read_b128 v[76:79], v2 offset:50128
v_cvt_pk_bf16_f32 v61, v26, v27
v_mfma_f32_16x16x32_bf16 v[40:43], v[80:83], v[212:215], v[40:43]
v_exp_f32_e64 v28, v28
v_mfma_f32_16x16x32_bf16 v[36:39], v[84:87], v[208:211], v[36:39]
ds_read_b128 v[80:83], v2 offset:33504
v_mfma_f32_16x16x32_bf16 v[44:47], v[84:87], v[212:215], v[44:47]
s_waitcnt lgkmcnt(5)
v_exp_f32 v29, v29
v_mfma_f32_16x16x32_bf16 v[32:35], v[88:91], v[216:219], v[32:35]
ds_read_b128 v[84:87], v2 offset:50144
v_cvt_pk_bf16_f32 v62, v28, v29
v_mfma_f32_16x16x32_bf16 v[40:43], v[88:91], v[220:223], v[40:43]
v_exp_f32_e64 v30, v30
v_mfma_f32_16x16x32_bf16 v[36:39], v[92:95], v[216:219], v[36:39]
ds_read_b128 v[88:91], v2 offset:33520
v_mfma_f32_16x16x32_bf16 v[44:47], v[92:95], v[220:223], v[44:47]
s_waitcnt lgkmcnt(5)
v_exp_f32 v31, v31
v_mfma_f32_16x16x32_bf16 v[32:35], v[64:67], v[224:227], v[32:35]
ds_read_b128 v[92:95], v2 offset:50160
v_cvt_pk_bf16_f32 v63, v30, v31
v_mfma_f32_16x16x32_bf16 v[40:43], v[64:67], v[228:231], v[40:43]
v_add_f32 v8, v8, v16
v_add_f32 v8, v8, v17
v_mfma_f32_16x16x32_bf16 v[36:39], v[68:71], v[224:227], v[36:39]
ds_read_b64_tr_b16 v[64:65], v3 offset:0
v_add_f32_e64 v8, v8, v18
v_mfma_f32_16x16x32_bf16 v[44:47], v[68:71], v[228:231], v[44:47]
s_waitcnt lgkmcnt(5)
s_nop 0
ds_read_b64_tr_b16 v[66:67], v3 offset:16640
v_mfma_f32_16x16x32_bf16 v[32:35], v[72:75], v[232:235], v[32:35]
ds_read_b64_tr_b16 v[68:69], v3 offset:32
v_add_f32_e64 v8, v8, v19
v_mfma_f32_16x16x32_bf16 v[40:43], v[72:75], v[236:239], v[40:43]
ds_read_b64_tr_b16 v[70:71], v3 offset:16672
v_add_f32_e64 v8, v8, v20
v_mfma_f32_16x16x32_bf16 v[36:39], v[76:79], v[232:235], v[36:39]
ds_read_b64_tr_b16 v[72:73], v3 offset:64
v_add_f32_e64 v8, v8, v21
v_mfma_f32_16x16x32_bf16 v[44:47], v[76:79], v[236:239], v[44:47]
s_waitcnt lgkmcnt(7)
s_nop 0
ds_read_b64_tr_b16 v[74:75], v3 offset:16704
v_mfma_f32_16x16x32_bf16 v[32:35], v[80:83], v[240:243], v[32:35]
ds_read_b64_tr_b16 v[76:77], v3 offset:96
v_add_f32_e64 v8, v8, v22
v_mfma_f32_16x16x32_bf16 v[40:43], v[80:83], v[244:247], v[40:43]
ds_read_b64_tr_b16 v[78:79], v3 offset:16736
v_add_f32_e64 v8, v8, v23
v_mfma_f32_16x16x32_bf16 v[36:39], v[84:87], v[240:243], v[36:39]
ds_read_b64_tr_b16 v[80:81], v3 offset:128
v_add_f32_e64 v9, v9, v24
v_mfma_f32_16x16x32_bf16 v[44:47], v[84:87], v[244:247], v[44:47]
s_waitcnt lgkmcnt(9)
s_nop 0
ds_read_b64_tr_b16 v[82:83], v3 offset:16768
v_mfma_f32_16x16x32_bf16 v[32:35], v[88:91], v[248:251], v[32:35]
ds_read_b64_tr_b16 v[84:85], v3 offset:160
v_add_f32_e64 v9, v9, v25
v_mfma_f32_16x16x32_bf16 v[40:43], v[88:91], v[252:255], v[40:43]
ds_read_b64_tr_b16 v[86:87], v3 offset:16800
v_add_f32_e64 v9, v9, v26
v_mfma_f32_16x16x32_bf16 v[36:39], v[92:95], v[248:251], v[36:39]
ds_read_b64_tr_b16 v[88:89], v3 offset:192
v_add_f32_e64 v9, v9, v27
v_mfma_f32_16x16x32_bf16 v[44:47], v[92:95], v[252:255], v[44:47]
s_waitcnt lgkmcnt(9)
s_nop 0
ds_read_b64_tr_b16 v[90:91], v3 offset:16832
v_mfma_f32_16x16x32_bf16 a[0:3], v[64:67], v[56:59], a[0:3]
ds_read_b64_tr_b16 v[92:93], v3 offset:224
v_add_f32_e64 v9, v9, v28
v_mfma_f32_16x16x32_bf16 a[4:7], v[64:67], v[60:63], a[4:7]
ds_read_b64_tr_b16 v[94:95], v3 offset:16864
v_add_f32_e64 v9, v9, v29
v_mfma_f32_16x16x32_bf16 a[8:11], v[68:71], v[56:59], a[8:11]
ds_read_b64_tr_b16 v[64:65], v3 offset:256
v_add_f32_e64 v9, v9, v30
v_mfma_f32_16x16x32_bf16 a[12:15], v[68:71], v[60:63], a[12:15]
s_waitcnt lgkmcnt(9)
s_nop 0
ds_read_b64_tr_b16 v[66:67], v3 offset:16896
v_mfma_f32_16x16x32_bf16 a[16:19], v[72:75], v[56:59], a[16:19]
ds_read_b64_tr_b16 v[68:69], v3 offset:288
v_add_f32_e64 v9, v9, v31
v_mfma_f32_16x16x32_bf16 a[20:23], v[72:75], v[60:63], a[20:23]
ds_read_b64_tr_b16 v[70:71], v3 offset:16928
v_mfma_f32_16x16x32_bf16 a[24:27], v[76:79], v[56:59], a[24:27]
s_add_u32 s26, s26, 32768
ds_read_b64_tr_b16 v[72:73], v3 offset:320
v_mfma_f32_16x16x32_bf16 a[28:31], v[76:79], v[60:63], a[28:31]
s_waitcnt lgkmcnt(9)
s_nop 0
ds_read_b64_tr_b16 v[74:75], v3 offset:16960
v_mfma_f32_16x16x32_bf16 a[32:35], v[80:83], v[56:59], a[32:35]
s_cmp_eq_u32 s31, 0
ds_read_b64_tr_b16 v[76:77], v3 offset:352
v_max3_f32 v10, v32, v33, v34
v_mfma_f32_16x16x32_bf16 a[36:39], v[80:83], v[60:63], a[36:39]
s_cselect_b64 s[8:9], s[16:17], s[8:9]
ds_read_b64_tr_b16 v[78:79], v3 offset:16992
v_max3_f32 v11, v40, v41, v42
v_mfma_f32_16x16x32_bf16 a[40:43], v[84:87], v[56:59], a[40:43]
s_cselect_b32 s26, s28, s26
s_nop 0
ds_read_b64_tr_b16 v[80:81], v3 offset:384
v_max3_f32 v10, v10, v35, v36
v_mfma_f32_16x16x32_bf16 a[44:47], v[84:87], v[60:63], a[44:47]
s_waitcnt lgkmcnt(9)
s_nop 0
ds_read_b64_tr_b16 v[82:83], v3 offset:17024
v_mfma_f32_16x16x32_bf16 a[48:51], v[88:91], v[56:59], a[48:51]
s_add_u32 s29, s26, 4096
ds_read_b64_tr_b16 v[84:85], v3 offset:416
v_max3_f32 v11, v11, v43, v44
v_mfma_f32_16x16x32_bf16 a[52:55], v[88:91], v[60:63], a[52:55]
ds_read_b64_tr_b16 v[86:87], v3 offset:17056
v_max3_f32 v10, v10, v37, v38
v_mfma_f32_16x16x32_bf16 a[56:59], v[92:95], v[56:59], a[56:59]
ds_read_b64_tr_b16 v[88:89], v3 offset:448
v_max3_f32 v11, v11, v45, v46
v_mfma_f32_16x16x32_bf16 a[60:63], v[92:95], v[60:63], a[60:63]
s_waitcnt lgkmcnt(9)
s_nop 0
ds_read_b64_tr_b16 v[90:91], v3 offset:17088
v_mfma_f32_16x16x32_bf16 a[64:67], v[64:67], v[56:59], a[64:67]
ds_read_b64_tr_b16 v[92:93], v3 offset:480
v_max_f32_e64 v10, v10, v39
v_mfma_f32_16x16x32_bf16 a[68:71], v[64:67], v[60:63], a[68:71]
ds_read_b64_tr_b16 v[94:95], v3 offset:17120
v_max_f32_e64 v11, v11, v47
v_mfma_f32_16x16x32_bf16 a[72:75], v[68:71], v[56:59], a[72:75]
ds_read_b64_tr_b16 v[64:65], v3 offset:512
v_max_f32_e64 v15, v10, v11
v_mfma_f32_16x16x32_bf16 a[76:79], v[68:71], v[60:63], a[76:79]
s_waitcnt lgkmcnt(9)
s_nop 0
ds_read_b64_tr_b16 v[66:67], v3 offset:17152
v_mfma_f32_16x16x32_bf16 a[80:83], v[72:75], v[56:59], a[80:83]
ds_read_b64_tr_b16 v[68:69], v3 offset:544
v_mfma_f32_16x16x32_bf16 a[84:87], v[72:75], v[60:63], a[84:87]
ds_read_b64_tr_b16 v[70:71], v3 offset:17184
v_mfma_f32_16x16x32_bf16 a[88:91], v[76:79], v[56:59], a[88:91]
ds_read_b64_tr_b16 v[72:73], v3 offset:576
v_mfma_f32_16x16x32_bf16 a[92:95], v[76:79], v[60:63], a[92:95]
s_waitcnt lgkmcnt(9)
s_nop 0
ds_read_b64_tr_b16 v[74:75], v3 offset:17216
v_mfma_f32_16x16x32_bf16 a[96:99], v[80:83], v[56:59], a[96:99]
ds_read_b64_tr_b16 v[76:77], v3 offset:608
v_mfma_f32_16x16x32_bf16 a[100:103], v[80:83], v[60:63], a[100:103]
ds_read_b64_tr_b16 v[78:79], v3 offset:17248
v_mfma_f32_16x16x32_bf16 a[104:107], v[84:87], v[56:59], a[104:107]
ds_read_b64_tr_b16 v[80:81], v3 offset:640
v_mfma_f32_16x16x32_bf16 a[108:111], v[84:87], v[60:63], a[108:111]
s_waitcnt lgkmcnt(9)
s_nop 0
ds_read_b64_tr_b16 v[82:83], v3 offset:17280
v_mfma_f32_16x16x32_bf16 a[112:115], v[88:91], v[56:59], a[112:115]
ds_read_b64_tr_b16 v[84:85], v3 offset:672
v_mfma_f32_16x16x32_bf16 a[116:119], v[88:91], v[60:63], a[116:119]
ds_read_b64_tr_b16 v[86:87], v3 offset:17312
v_mfma_f32_16x16x32_bf16 a[120:123], v[92:95], v[56:59], a[120:123]
ds_read_b64_tr_b16 v[88:89], v3 offset:704
v_mfma_f32_16x16x32_bf16 a[124:127], v[92:95], v[60:63], a[124:127]
s_waitcnt lgkmcnt(9)
s_nop 0
ds_read_b64_tr_b16 v[90:91], v3 offset:17344
v_mfma_f32_16x16x32_bf16 a[128:131], v[64:67], v[56:59], a[128:131]
ds_read_b64_tr_b16 v[92:93], v3 offset:736
v_mfma_f32_16x16x32_bf16 a[132:135], v[64:67], v[60:63], a[132:135]
ds_read_b64_tr_b16 v[94:95], v3 offset:17376
v_mfma_f32_16x16x32_bf16 a[136:139], v[68:71], v[56:59], a[136:139]
ds_read_b64_tr_b16 v[64:65], v3 offset:768
v_mfma_f32_16x16x32_bf16 a[140:143], v[68:71], v[60:63], a[140:143]
s_waitcnt lgkmcnt(9)
s_nop 0
ds_read_b64_tr_b16 v[66:67], v3 offset:17408
v_mfma_f32_16x16x32_bf16 a[144:147], v[72:75], v[56:59], a[144:147]
ds_read_b64_tr_b16 v[68:69], v3 offset:800
v_mfma_f32_16x16x32_bf16 a[148:151], v[72:75], v[60:63], a[148:151]
ds_read_b64_tr_b16 v[70:71], v3 offset:17440
v_mfma_f32_16x16x32_bf16 a[152:155], v[76:79], v[56:59], a[152:155]
ds_read_b64_tr_b16 v[72:73], v3 offset:832
v_mfma_f32_16x16x32_bf16 a[156:159], v[76:79], v[60:63], a[156:159]
s_waitcnt lgkmcnt(9)
s_nop 0
ds_read_b64_tr_b16 v[74:75], v3 offset:17472
v_mfma_f32_16x16x32_bf16 a[160:163], v[80:83], v[56:59], a[160:163]
ds_read_b64_tr_b16 v[76:77], v3 offset:864
v_mfma_f32_16x16x32_bf16 a[164:167], v[80:83], v[60:63], a[164:167]
ds_read_b64_tr_b16 v[78:79], v3 offset:17504
v_mfma_f32_16x16x32_bf16 a[168:171], v[84:87], v[56:59], a[168:171]
ds_read_b64_tr_b16 v[80:81], v3 offset:896
v_mfma_f32_16x16x32_bf16 a[172:175], v[84:87], v[60:63], a[172:175]
s_waitcnt lgkmcnt(9)
s_nop 0
ds_read_b64_tr_b16 v[82:83], v3 offset:17536
v_mfma_f32_16x16x32_bf16 a[176:179], v[88:91], v[56:59], a[176:179]
ds_read_b64_tr_b16 v[84:85], v3 offset:928
v_mfma_f32_16x16x32_bf16 a[180:183], v[88:91], v[60:63], a[180:183]
ds_read_b64_tr_b16 v[86:87], v3 offset:17568
v_mfma_f32_16x16x32_bf16 a[184:187], v[92:95], v[56:59], a[184:187]
ds_read_b64_tr_b16 v[88:89], v3 offset:960
v_mfma_f32_16x16x32_bf16 a[188:191], v[92:95], v[60:63], a[188:191]
s_waitcnt lgkmcnt(9)
s_nop 0
ds_read_b64_tr_b16 v[90:91], v3 offset:17600
v_mfma_f32_16x16x32_bf16 a[192:195], v[64:67], v[56:59], a[192:195]
ds_read_b64_tr_b16 v[92:93], v3 offset:992
v_mfma_f32_16x16x32_bf16 a[196:199], v[64:67], v[60:63], a[196:199]
ds_read_b64_tr_b16 v[94:95], v3 offset:17632
v_mfma_f32_16x16x32_bf16 a[200:203], v[68:71], v[56:59], a[200:203]
s_waitcnt vmcnt(8)
s_barrier
ds_read_b128 v[64:67], v4 offset:0
v_mfma_f32_16x16x32_bf16 a[204:207], v[68:71], v[60:63], a[204:207]
s_waitcnt lgkmcnt(9)
s_nop 0
v_mfma_f32_16x16x32_bf16 a[208:211], v[72:75], v[56:59], a[208:211]
ds_read_b128 v[68:71], v4 offset:16640
v_mfma_f32_16x16x32_bf16 a[212:215], v[72:75], v[60:63], a[212:215]
v_mfma_f32_16x16x32_bf16 a[216:219], v[76:79], v[56:59], a[216:219]
ds_read_b128 v[72:75], v4 offset:16
v_mfma_f32_16x16x32_bf16 a[220:223], v[76:79], v[60:63], a[220:223]
s_waitcnt lgkmcnt(7)
s_nop 0
v_mfma_f32_16x16x32_bf16 a[224:227], v[80:83], v[56:59], a[224:227]
ds_read_b128 v[76:79], v4 offset:16656
v_mfma_f32_16x16x32_bf16 a[228:231], v[80:83], v[60:63], a[228:231]
v_mfma_f32_16x16x32_bf16 a[232:235], v[84:87], v[56:59], a[232:235]
ds_read_b128 v[80:83], v4 offset:32
v_mfma_f32_16x16x32_bf16 a[236:239], v[84:87], v[60:63], a[236:239]
s_waitcnt lgkmcnt(5)
s_nop 0
v_mfma_f32_16x16x32_bf16 a[240:243], v[88:91], v[56:59], a[240:243]
ds_read_b128 v[84:87], v4 offset:16672
v_mfma_f32_16x16x32_bf16 a[244:247], v[88:91], v[60:63], a[244:247]
v_cmp_lt_f32_e64 vcc, s45, v15
v_mfma_f32_16x16x32_bf16 a[248:251], v[92:95], v[56:59], a[248:251]
ds_read_b128 v[88:91], v4 offset:48
v_mfma_f32_16x16x32_bf16 a[252:255], v[92:95], v[60:63], a[252:255]
s_waitcnt lgkmcnt(5)
s_cbranch_vccnz L_R0
L_B0v0:
v_mfma_f32_16x16x32_bf16 v[16:19], v[64:67], v[128:131], v[48:51]
s_add_u32 m0, s35, 65536
ds_read_b128 v[92:95], v4 offset:16688
v_mfma_f32_16x16x32_bf16 v[24:27], v[64:67], v[132:135], v[52:55]
buffer_load_dwordx4 v1, s[8:11], s26 offen offset:0 sc1 lds
v_mfma_f32_16x16x32_bf16 v[20:23], v[68:71], v[128:131], v[48:51]
ds_read_b128 v[64:67], v4 offset:64
v_mfma_f32_16x16x32_bf16 v[28:31], v[68:71], v[132:135], v[52:55]
s_waitcnt lgkmcnt(5)
v_exp_f32 v32, v32
v_mfma_f32_16x16x32_bf16 v[16:19], v[72:75], v[136:139], v[16:19]
s_add_u32 m0, s35, 65552
ds_read_b128 v[68:71], v4 offset:16704
v_mfma_f32_16x16x32_bf16 v[24:27], v[72:75], v[140:143], v[24:27]
buffer_load_dwordx4 v1, s[8:11], s26 offen offset:1024 sc1 lds
v_mfma_f32_16x16x32_bf16 v[20:23], v[76:79], v[136:139], v[20:23]
ds_read_b128 v[72:75], v4 offset:80
v_mfma_f32_16x16x32_bf16 v[28:31], v[76:79], v[140:143], v[28:31]
s_waitcnt lgkmcnt(5)
v_exp_f32 v33, v33
v_mfma_f32_16x16x32_bf16 v[16:19], v[80:83], v[144:147], v[16:19]
s_add_u32 m0, s35, 65568
ds_read_b128 v[76:79], v4 offset:16720
v_cvt_pk_bf16_f32 v56, v32, v33
v_mfma_f32_16x16x32_bf16 v[24:27], v[80:83], v[148:151], v[24:27]
buffer_load_dwordx4 v1, s[8:11], s26 offen offset:2048 sc1 lds
v_mfma_f32_16x16x32_bf16 v[20:23], v[84:87], v[144:147], v[20:23]
ds_read_b128 v[80:83], v4 offset:96
v_mfma_f32_16x16x32_bf16 v[28:31], v[84:87], v[148:151], v[28:31]
s_waitcnt lgkmcnt(5)
v_exp_f32 v34, v34
v_mfma_f32_16x16x32_bf16 v[16:19], v[88:91], v[152:155], v[16:19]
s_add_u32 m0, s35, 65584
ds_read_b128 v[84:87], v4 offset:16736
v_mfma_f32_16x16x32_bf16 v[24:27], v[88:91], v[156:159], v[24:27]
buffer_load_dwordx4 v1, s[8:11], s26 offen offset:3072 sc1 lds
v_mfma_f32_16x16x32_bf16 v[20:23], v[92:95], v[152:155], v[20:23]
ds_read_b128 v[88:91], v4 offset:112
v_mfma_f32_16x16x32_bf16 v[28:31], v[92:95], v[156:159], v[28:31]
s_waitcnt lgkmcnt(5)
v_exp_f32 v35, v35
v_mfma_f32_16x16x32_bf16 v[16:19], v[64:67], v[160:163], v[16:19]
s_add_u32 m0, s35, 69696
ds_read_b128 v[92:95], v4 offset:16752
v_cvt_pk_bf16_f32 v57, v34, v35
v_mfma_f32_16x16x32_bf16 v[24:27], v[64:67], v[164:167], v[24:27]
buffer_load_dwordx4 v1, s[8:11], s29 offen offset:0 sc1 lds
v_mfma_f32_16x16x32_bf16 v[20:23], v[68:71], v[160:163], v[20:23]
ds_read_b128 v[64:67], v4 offset:128
v_mfma_f32_16x16x32_bf16 v[28:31], v[68:71], v[164:167], v[28:31]
s_waitcnt lgkmcnt(5)
v_exp_f32 v36, v36
v_mfma_f32_16x16x32_bf16 v[16:19], v[72:75], v[168:171], v[16:19]
s_add_u32 m0, s35, 69712
ds_read_b128 v[68:71], v4 offset:16768
v_mfma_f32_16x16x32_bf16 v[24:27], v[72:75], v[172:175], v[24:27]
buffer_load_dwordx4 v1, s[8:11], s29 offen offset:1024 sc1 lds
v_mfma_f32_16x16x32_bf16 v[20:23], v[76:79], v[168:171], v[20:23]
ds_read_b128 v[72:75], v4 offset:144
v_mfma_f32_16x16x32_bf16 v[28:31], v[76:79], v[172:175], v[28:31]
s_waitcnt lgkmcnt(5)
v_exp_f32 v37, v37
v_mfma_f32_16x16x32_bf16 v[16:19], v[80:83], v[176:179], v[16:19]
s_add_u32 m0, s35, 69728
ds_read_b128 v[76:79], v4 offset:16784
v_cvt_pk_bf16_f32 v58, v36, v37
v_mfma_f32_16x16x32_bf16 v[24:27], v[80:83], v[180:183], v[24:27]
buffer_load_dwordx4 v1, s[8:11], s29 offen offset:2048 sc1 lds
v_mfma_f32_16x16x32_bf16 v[20:23], v[84:87], v[176:179], v[20:23]
ds_read_b128 v[80:83], v4 offset:160
v_mfma_f32_16x16x32_bf16 v[28:31], v[84:87], v[180:183], v[28:31]
s_waitcnt lgkmcnt(5)
v_exp_f32 v38, v38
v_mfma_f32_16x16x32_bf16 v[16:19], v[88:91], v[184:187], v[16:19]
s_add_u32 m0, s35, 69744
ds_read_b128 v[84:87], v4 offset:16800
v_mfma_f32_16x16x32_bf16 v[24:27], v[88:91], v[188:191], v[24:27]
buffer_load_dwordx4 v1, s[8:11], s29 offen offset:3072 sc1 lds
v_mfma_f32_16x16x32_bf16 v[20:23], v[92:95], v[184:187], v[20:23]
ds_read_b128 v[88:91], v4 offset:176
v_mfma_f32_16x16x32_bf16 v[28:31], v[92:95], v[188:191], v[28:31]
s_waitcnt lgkmcnt(5)
v_exp_f32 v39, v39
v_mfma_f32_16x16x32_bf16 v[16:19], v[64:67], v[192:195], v[16:19]
ds_read_b128 v[92:95], v4 offset:16816
v_cvt_pk_bf16_f32 v59, v38, v39
v_mfma_f32_16x16x32_bf16 v[24:27], v[64:67], v[196:199], v[24:27]
v_exp_f32_e64 v40, v40
v_mfma_f32_16x16x32_bf16 v[20:23], v[68:71], v[192:195], v[20:23]
ds_read_b128 v[64:67], v4 offset:192
v_mfma_f32_16x16x32_bf16 v[28:31], v[68:71], v[196:199], v[28:31]
s_waitcnt lgkmcnt(5)
v_exp_f32 v41, v41
v_mfma_f32_16x16x32_bf16 v[16:19], v[72:75], v[200:203], v[16:19]
ds_read_b128 v[68:71], v4 offset:16832
v_cvt_pk_bf16_f32 v60, v40, v41
v_mfma_f32_16x16x32_bf16 v[24:27], v[72:75], v[204:207], v[24:27]
v_exp_f32_e64 v42, v42
v_mfma_f32_16x16x32_bf16 v[20:23], v[76:79], v[200:203], v[20:23]
ds_read_b128 v[72:75], v4 offset:208
v_mfma_f32_16x16x32_bf16 v[28:31], v[76:79], v[204:207], v[28:31]
s_waitcnt lgkmcnt(5)
v_exp_f32 v43, v43
v_mfma_f32_16x16x32_bf16 v[16:19], v[80:83], v[208:211], v[16:19]
ds_read_b128 v[76:79], v4 offset:16848
v_cvt_pk_bf16_f32 v61, v42, v43
v_mfma_f32_16x16x32_bf16 v[24:27], v[80:83], v[212:215], v[24:27]
v_exp_f32_e64 v44, v44
v_mfma_f32_16x16x32_bf16 v[20:23], v[84:87], v[208:211], v[20:23]
ds_read_b128 v[80:83], v4 offset:224
v_mfma_f32_16x16x32_bf16 v[28:31], v[84:87], v[212:215], v[28:31]
s_waitcnt lgkmcnt(5)
v_exp_f32 v45, v45
v_mfma_f32_16x16x32_bf16 v[16:19], v[88:91], v[216:219], v[16:19]
ds_read_b128 v[84:87], v4 offset:16864
v_cvt_pk_bf16_f32 v62, v44, v45
v_mfma_f32_16x16x32_bf16 v[24:27], v[88:91], v[220:223], v[24:27]
v_exp_f32_e64 v46, v46
v_mfma_f32_16x16x32_bf16 v[20:23], v[92:95], v[216:219], v[20:23]
ds_read_b128 v[88:91], v4 offset:240
v_mfma_f32_16x16x32_bf16 v[28:31], v[92:95], v[220:223], v[28:31]
s_waitcnt lgkmcnt(5)
v_exp_f32 v47, v47
v_mfma_f32_16x16x32_bf16 v[16:19], v[64:67], v[224:227], v[16:19]
ds_read_b128 v[92:95], v4 offset:16880
v_cvt_pk_bf16_f32 v63, v46, v47
v_mfma_f32_16x16x32_bf16 v[24:27], v[64:67], v[228:231], v[24:27]
v_add_f32 v8, v8, v32
v_add_f32 v8, v8, v33
v_mfma_f32_16x16x32_bf16 v[20:23], v[68:71], v[224:227], v[20:23]
ds_read_b64_tr_b16 v[64:65], v3 offset:33280
v_add_f32_e64 v8, v8, v34
v_mfma_f32_16x16x32_bf16 v[28:31], v[68:71], v[228:231], v[28:31]
s_waitcnt lgkmcnt(5)
s_nop 0
ds_read_b64_tr_b16 v[66:67], v3 offset:49920
v_mfma_f32_16x16x32_bf16 v[16:19], v[72:75], v[232:235], v[16:19]
ds_read_b64_tr_b16 v[68:69], v3 offset:33312
v_add_f32_e64 v8, v8, v35
v_mfma_f32_16x16x32_bf16 v[24:27], v[72:75], v[236:239], v[24:27]
ds_read_b64_tr_b16 v[70:71], v3 offset:49952
v_add_f32_e64 v8, v8, v36
v_mfma_f32_16x16x32_bf16 v[20:23], v[76:79], v[232:235], v[20:23]
ds_read_b64_tr_b16 v[72:73], v3 offset:33344
v_add_f32_e64 v8, v8, v37
v_mfma_f32_16x16x32_bf16 v[28:31], v[76:79], v[236:239], v[28:31]
s_waitcnt lgkmcnt(7)
s_nop 0
ds_read_b64_tr_b16 v[74:75], v3 offset:49984
v_mfma_f32_16x16x32_bf16 v[16:19], v[80:83], v[240:243], v[16:19]
ds_read_b64_tr_b16 v[76:77], v3 offset:33376
v_add_f32_e64 v8, v8, v38
v_mfma_f32_16x16x32_bf16 v[24:27], v[80:83], v[244:247], v[24:27]
ds_read_b64_tr_b16 v[78:79], v3 offset:50016
v_add_f32_e64 v8, v8, v39
v_mfma_f32_16x16x32_bf16 v[20:23], v[84:87], v[240:243], v[20:23]
ds_read_b64_tr_b16 v[80:81], v3 offset:33408
v_add_f32_e64 v9, v9, v40
v_mfma_f32_16x16x32_bf16 v[28:31], v[84:87], v[244:247], v[28:31]
s_waitcnt lgkmcnt(9)
s_nop 0
ds_read_b64_tr_b16 v[82:83], v3 offset:50048
v_mfma_f32_16x16x32_bf16 v[16:19], v[88:91], v[248:251], v[16:19]
ds_read_b64_tr_b16 v[84:85], v3 offset:33440
v_add_f32_e64 v9, v9, v41
v_mfma_f32_16x16x32_bf16 v[24:27], v[88:91], v[252:255], v[24:27]
ds_read_b64_tr_b16 v[86:87], v3 offset:50080
v_add_f32_e64 v9, v9, v42
v_mfma_f32_16x16x32_bf16 v[20:23], v[92:95], v[248:251], v[20:23]
ds_read_b64_tr_b16 v[88:89], v3 offset:33472
v_add_f32_e64 v9, v9, v43
v_mfma_f32_16x16x32_bf16 v[28:31], v[92:95], v[252:255], v[28:31]
s_waitcnt lgkmcnt(9)
s_nop 0
ds_read_b64_tr_b16 v[90:91], v3 offset:50112
v_mfma_f32_16x16x32_bf16 a[0:3], v[64:67], v[56:59], a[0:3]
ds_read_b64_tr_b16 v[92:93], v3 offset:33504
v_add_f32_e64 v9, v9, v44
v_mfma_f32_16x16x32_bf16 a[4:7], v[64:67], v[60:63], a[4:7]
ds_read_b64_tr_b16 v[94:95], v3 offset:50144
v_add_f32_e64 v9, v9, v45
v_mfma_f32_16x16x32_bf16 a[8:11], v[68:71], v[56:59], a[8:11]
ds_read_b64_tr_b16 v[64:65], v3 offset:33536
v_add_f32_e64 v9, v9, v46
v_mfma_f32_16x16x32_bf16 a[12:15], v[68:71], v[60:63], a[12:15]
s_waitcnt lgkmcnt(9)
s_nop 0
ds_read_b64_tr_b16 v[66:67], v3 offset:50176
v_mfma_f32_16x16x32_bf16 a[16:19], v[72:75], v[56:59], a[16:19]
ds_read_b64_tr_b16 v[68:69], v3 offset:33568
v_add_f32_e64 v9, v9, v47
v_mfma_f32_16x16x32_bf16 a[20:23], v[72:75], v[60:63], a[20:23]
ds_read_b64_tr_b16 v[70:71], v3 offset:50208
v_mfma_f32_16x16x32_bf16 a[24:27], v[76:79], v[56:59], a[24:27]
s_add_u32 s26, s26, 32768
ds_read_b64_tr_b16 v[72:73], v3 offset:33600
v_mfma_f32_16x16x32_bf16 a[28:31], v[76:79], v[60:63], a[28:31]
s_waitcnt lgkmcnt(9)
s_nop 0
ds_read_b64_tr_b16 v[74:75], v3 offset:50240
v_mfma_f32_16x16x32_bf16 a[32:35], v[80:83], v[56:59], a[32:35]
ds_read_b64_tr_b16 v[76:77], v3 offset:33632
v_max3_f32 v10, v16, v17, v18
v_mfma_f32_16x16x32_bf16 a[36:39], v[80:83], v[60:63], a[36:39]
ds_read_b64_tr_b16 v[78:79], v3 offset:50272
v_max3_f32 v11, v24, v25, v26
v_mfma_f32_16x16x32_bf16 a[40:43], v[84:87], v[56:59], a[40:43]
ds_read_b64_tr_b16 v[80:81], v3 offset:33664
v_max3_f32 v10, v10, v19, v20
v_mfma_f32_16x16x32_bf16 a[44:47], v[84:87], v[60:63], a[44:47]
s_waitcnt lgkmcnt(9)
s_nop 0
ds_read_b64_tr_b16 v[82:83], v3 offset:50304
v_mfma_f32_16x16x32_bf16 a[48:51], v[88:91], v[56:59], a[48:51]
s_add_u32 s29, s26, 4096
ds_read_b64_tr_b16 v[84:85], v3 offset:33696
v_max3_f32 v11, v11, v27, v28
v_mfma_f32_16x16x32_bf16 a[52:55], v[88:91], v[60:63], a[52:55]
ds_read_b64_tr_b16 v[86:87], v3 offset:50336
v_max3_f32 v10, v10, v21, v22
v_mfma_f32_16x16x32_bf16 a[56:59], v[92:95], v[56:59], a[56:59]
ds_read_b64_tr_b16 v[88:89], v3 offset:33728
v_max3_f32 v11, v11, v29, v30
v_mfma_f32_16x16x32_bf16 a[60:63], v[92:95], v[60:63], a[60:63]
s_waitcnt lgkmcnt(9)
s_nop 0
ds_read_b64_tr_b16 v[90:91], v3 offset:50368
v_mfma_f32_16x16x32_bf16 a[64:67], v[64:67], v[56:59], a[64:67]
ds_read_b64_tr_b16 v[92:93], v3 offset:33760
v_max_f32_e64 v10, v10, v23
v_mfma_f32_16x16x32_bf16 a[68:71], v[64:67], v[60:63], a[68:71]
ds_read_b64_tr_b16 v[94:95], v3 offset:50400
v_max_f32_e64 v11, v11, v31
v_mfma_f32_16x16x32_bf16 a[72:75], v[68:71], v[56:59], a[72:75]
ds_read_b64_tr_b16 v[64:65], v3 offset:33792
v_max_f32_e64 v15, v10, v11
v_mfma_f32_16x16x32_bf16 a[76:79], v[68:71], v[60:63], a[76:79]
s_waitcnt lgkmcnt(9)
s_nop 0
ds_read_b64_tr_b16 v[66:67], v3 offset:50432
v_mfma_f32_16x16x32_bf16 a[80:83], v[72:75], v[56:59], a[80:83]
ds_read_b64_tr_b16 v[68:69], v3 offset:33824
v_mfma_f32_16x16x32_bf16 a[84:87], v[72:75], v[60:63], a[84:87]
ds_read_b64_tr_b16 v[70:71], v3 offset:50464
v_mfma_f32_16x16x32_bf16 a[88:91], v[76:79], v[56:59], a[88:91]
ds_read_b64_tr_b16 v[72:73], v3 offset:33856
v_mfma_f32_16x16x32_bf16 a[92:95], v[76:79], v[60:63], a[92:95]
s_waitcnt lgkmcnt(9)
s_nop 0
ds_read_b64_tr_b16 v[74:75], v3 offset:50496
v_mfma_f32_16x16x32_bf16 a[96:99], v[80:83], v[56:59], a[96:99]
ds_read_b64_tr_b16 v[76:77], v3 offset:33888
v_mfma_f32_16x16x32_bf16 a[100:103], v[80:83], v[60:63], a[100:103]
ds_read_b64_tr_b16 v[78:79], v3 offset:50528
v_mfma_f32_16x16x32_bf16 a[104:107], v[84:87], v[56:59], a[104:107]
ds_read_b64_tr_b16 v[80:81], v3 offset:33920
v_mfma_f32_16x16x32_bf16 a[108:111], v[84:87], v[60:63], a[108:111]
s_waitcnt lgkmcnt(9)
s_nop 0
ds_read_b64_tr_b16 v[82:83], v3 offset:50560
v_mfma_f32_16x16x32_bf16 a[112:115], v[88:91], v[56:59], a[112:115]
ds_read_b64_tr_b16 v[84:85], v3 offset:33952
v_mfma_f32_16x16x32_bf16 a[116:119], v[88:91], v[60:63], a[116:119]
ds_read_b64_tr_b16 v[86:87], v3 offset:50592
v_mfma_f32_16x16x32_bf16 a[120:123], v[92:95], v[56:59], a[120:123]
ds_read_b64_tr_b16 v[88:89], v3 offset:33984
v_mfma_f32_16x16x32_bf16 a[124:127], v[92:95], v[60:63], a[124:127]
s_waitcnt lgkmcnt(9)
s_nop 0
ds_read_b64_tr_b16 v[90:91], v3 offset:50624
v_mfma_f32_16x16x32_bf16 a[128:131], v[64:67], v[56:59], a[128:131]
ds_read_b64_tr_b16 v[92:93], v3 offset:34016
v_mfma_f32_16x16x32_bf16 a[132:135], v[64:67], v[60:63], a[132:135]
ds_read_b64_tr_b16 v[94:95], v3 offset:50656
v_mfma_f32_16x16x32_bf16 a[136:139], v[68:71], v[56:59], a[136:139]
ds_read_b64_tr_b16 v[64:65], v3 offset:34048
v_mfma_f32_16x16x32_bf16 a[140:143], v[68:71], v[60:63], a[140:143]
s_waitcnt lgkmcnt(9)
s_nop 0
ds_read_b64_tr_b16 v[66:67], v3 offset:50688
v_mfma_f32_16x16x32_bf16 a[144:147], v[72:75], v[56:59], a[144:147]
ds_read_b64_tr_b16 v[68:69], v3 offset:34080
v_mfma_f32_16x16x32_bf16 a[148:151], v[72:75], v[60:63], a[148:151]
ds_read_b64_tr_b16 v[70:71], v3 offset:50720
v_mfma_f32_16x16x32_bf16 a[152:155], v[76:79], v[56:59], a[152:155]
ds_read_b64_tr_b16 v[72:73], v3 offset:34112
v_mfma_f32_16x16x32_bf16 a[156:159], v[76:79], v[60:63], a[156:159]
s_waitcnt lgkmcnt(9)
s_nop 0
ds_read_b64_tr_b16 v[74:75], v3 offset:50752
v_mfma_f32_16x16x32_bf16 a[160:163], v[80:83], v[56:59], a[160:163]
ds_read_b64_tr_b16 v[76:77], v3 offset:34144
v_mfma_f32_16x16x32_bf16 a[164:167], v[80:83], v[60:63], a[164:167]
ds_read_b64_tr_b16 v[78:79], v3 offset:50784
v_mfma_f32_16x16x32_bf16 a[168:171], v[84:87], v[56:59], a[168:171]
ds_read_b64_tr_b16 v[80:81], v3 offset:34176
v_mfma_f32_16x16x32_bf16 a[172:175], v[84:87], v[60:63], a[172:175]
s_waitcnt lgkmcnt(9)
s_nop 0
ds_read_b64_tr_b16 v[82:83], v3 offset:50816
v_mfma_f32_16x16x32_bf16 a[176:179], v[88:91], v[56:59], a[176:179]
ds_read_b64_tr_b16 v[84:85], v3 offset:34208
v_mfma_f32_16x16x32_bf16 a[180:183], v[88:91], v[60:63], a[180:183]
ds_read_b64_tr_b16 v[86:87], v3 offset:50848
v_mfma_f32_16x16x32_bf16 a[184:187], v[92:95], v[56:59], a[184:187]
ds_read_b64_tr_b16 v[88:89], v3 offset:34240
v_mfma_f32_16x16x32_bf16 a[188:191], v[92:95], v[60:63], a[188:191]
s_waitcnt lgkmcnt(9)
s_nop 0
ds_read_b64_tr_b16 v[90:91], v3 offset:50880
v_mfma_f32_16x16x32_bf16 a[192:195], v[64:67], v[56:59], a[192:195]
ds_read_b64_tr_b16 v[92:93], v3 offset:34272
v_mfma_f32_16x16x32_bf16 a[196:199], v[64:67], v[60:63], a[196:199]
ds_read_b64_tr_b16 v[94:95], v3 offset:50912
v_mfma_f32_16x16x32_bf16 a[200:203], v[68:71], v[56:59], a[200:203]
s_waitcnt vmcnt(8)
s_barrier
ds_read_b128 v[64:67], v4 offset:33280
v_mfma_f32_16x16x32_bf16 a[204:207], v[68:71], v[60:63], a[204:207]
s_waitcnt lgkmcnt(9)
s_nop 0
v_mfma_f32_16x16x32_bf16 a[208:211], v[72:75], v[56:59], a[208:211]
ds_read_b128 v[68:71], v4 offset:49920
v_mfma_f32_16x16x32_bf16 a[212:215], v[72:75], v[60:63], a[212:215]
v_mfma_f32_16x16x32_bf16 a[216:219], v[76:79], v[56:59], a[216:219]
ds_read_b128 v[72:75], v4 offset:33296
v_mfma_f32_16x16x32_bf16 a[220:223], v[76:79], v[60:63], a[220:223]
s_waitcnt lgkmcnt(7)
s_nop 0
v_mfma_f32_16x16x32_bf16 a[224:227], v[80:83], v[56:59], a[224:227]
ds_read_b128 v[76:79], v4 offset:49936
v_mfma_f32_16x16x32_bf16 a[228:231], v[80:83], v[60:63], a[228:231]
v_mfma_f32_16x16x32_bf16 a[232:235], v[84:87], v[56:59], a[232:235]
ds_read_b128 v[80:83], v4 offset:33312
v_mfma_f32_16x16x32_bf16 a[236:239], v[84:87], v[60:63], a[236:239]
s_waitcnt lgkmcnt(5)
s_nop 0
v_mfma_f32_16x16x32_bf16 a[240:243], v[88:91], v[56:59], a[240:243]
ds_read_b128 v[84:87], v4 offset:49952
v_mfma_f32_16x16x32_bf16 a[244:247], v[88:91], v[60:63], a[244:247]
v_cmp_lt_f32_e64 vcc, s45, v15
v_mfma_f32_16x16x32_bf16 a[248:251], v[92:95], v[56:59], a[248:251]
ds_read_b128 v[88:91], v4 offset:33328
v_mfma_f32_16x16x32_bf16 a[252:255], v[92:95], v[60:63], a[252:255]
s_waitcnt lgkmcnt(5)
s_cbranch_vccnz L_R1
L_B1v0:
s_cmp_eq_u32 s31, 0
s_cbranch_scc1 L_sp2
v_mfma_f32_16x16x32_bf16 v[32:35], v[64:67], v[128:131], v[48:51]
s_add_u32 m0, s35, 98816
ds_read_b128 v[92:95], v4 offset:49968
v_mfma_f32_16x16x32_bf16 v[40:43], v[64:67], v[132:135], v[52:55]
buffer_load_dwordx4 v1, s[8:11], s26 offen offset:0 sc1 lds
v_mfma_f32_16x16x32_bf16 v[36:39], v[68:71], v[128:131], v[48:51]
ds_read_b128 v[64:67], v4 offset:33344
v_mfma_f32_16x16x32_bf16 v[44:47], v[68:71], v[132:135], v[52:55]
s_waitcnt lgkmcnt(5)
v_exp_f32 v16, v16
v_mfma_f32_16x16x32_bf16 v[32:35], v[72:75], v[136:139], v[32:35]
s_add_u32 m0, s35, 98832
ds_read_b128 v[68:71], v4 offset:49984
v_mfma_f32_16x16x32_bf16 v[40:43], v[72:75], v[140:143], v[40:43]
buffer_load_dwordx4 v1, s[8:11], s26 offen offset:1024 sc1 lds
v_mfma_f32_16x16x32_bf16 v[36:39], v[76:79], v[136:139], v[36:39]
ds_read_b128 v[72:75], v4 offset:33360
v_mfma_f32_16x16x32_bf16 v[44:47], v[76:79], v[140:143], v[44:47]
s_waitcnt lgkmcnt(5)
v_exp_f32 v17, v17
v_mfma_f32_16x16x32_bf16 v[32:35], v[80:83], v[144:147], v[32:35]
s_add_u32 m0, s35, 98848
ds_read_b128 v[76:79], v4 offset:50000
v_cvt_pk_bf16_f32 v56, v16, v17
v_mfma_f32_16x16x32_bf16 v[40:43], v[80:83], v[148:151], v[40:43]
buffer_load_dwordx4 v1, s[8:11], s26 offen offset:2048 sc1 lds
v_mfma_f32_16x16x32_bf16 v[36:39], v[84:87], v[144:147], v[36:39]
ds_read_b128 v[80:83], v4 offset:33376
v_mfma_f32_16x16x32_bf16 v[44:47], v[84:87], v[148:151], v[44:47]
s_waitcnt lgkmcnt(5)
v_exp_f32 v18, v18
v_mfma_f32_16x16x32_bf16 v[32:35], v[88:91], v[152:155], v[32:35]
s_add_u32 m0, s35, 98864
ds_read_b128 v[84:87], v4 offset:50016
v_mfma_f32_16x16x32_bf16 v[40:43], v[88:91], v[156:159], v[40:43]
buffer_load_dwordx4 v1, s[8:11], s26 offen offset:3072 sc1 lds
v_mfma_f32_16x16x32_bf16 v[36:39], v[92:95], v[152:155], v[36:39]
ds_read_b128 v[88:91], v4 offset:33392
v_mfma_f32_16x16x32_bf16 v[44:47], v[92:95], v[156:159], v[44:47]
s_waitcnt lgkmcnt(5)
v_exp_f32 v19, v19
v_mfma_f32_16x16x32_bf16 v[32:35], v[64:67], v[160:163], v[32:35]
s_add_u32 m0, s35, 102976
ds_read_b128 v[92:95], v4 offset:50032
v_cvt_pk_bf16_f32 v57, v18, v19
v_mfma_f32_16x16x32_bf16 v[40:43], v[64:67], v[164:167], v[40:43]
buffer_load_dwordx4 v1, s[8:11], s29 offen offset:0 sc1 lds
v_mfma_f32_16x16x32_bf16 v[36:39], v[68:71], v[160:163], v[36:39]
ds_read_b128 v[64:67], v4 offset:33408
v_mfma_f32_16x16x32_bf16 v[44:47], v[68:71], v[164:167], v[44:47]
s_waitcnt lgkmcnt(5)
v_exp_f32 v20, v20
v_mfma_f32_16x16x32_bf16 v[32:35], v[72:75], v[168:171], v[32:35]
s_add_u32 m0, s35, 102992
ds_read_b128 v[68:71], v4 offset:50048
v_mfma_f32_16x16x32_bf16 v[40:43], v[72:75], v[172:175], v[40:43]
buffer_load_dwordx4 v1, s[8:11], s29 offen offset:1024 sc1 lds
v_mfma_f32_16x16x32_bf16 v[36:39], v[76:79], v[168:171], v[36:39]
ds_read_b128 v[72:75], v4 offset:33424
v_mfma_f32_16x16x32_bf16 v[44:47], v[76:79], v[172:175], v[44:47]
s_waitcnt lgkmcnt(5)
v_exp_f32 v21, v21
v_mfma_f32_16x16x32_bf16 v[32:35], v[80:83], v[176:179], v[32:35]
s_add_u32 m0, s35, 103008
ds_read_b128 v[76:79], v4 offset:50064
v_cvt_pk_bf16_f32 v58, v20, v21
v_mfma_f32_16x16x32_bf16 v[40:43], v[80:83], v[180:183], v[40:43]
buffer_load_dwordx4 v1, s[8:11], s29 offen offset:2048 sc1 lds
v_mfma_f32_16x16x32_bf16 v[36:39], v[84:87], v[176:179], v[36:39]
ds_read_b128 v[80:83], v4 offset:33440
v_mfma_f32_16x16x32_bf16 v[44:47], v[84:87], v[180:183], v[44:47]
s_waitcnt lgkmcnt(5)
v_exp_f32 v22, v22
v_mfma_f32_16x16x32_bf16 v[32:35], v[88:91], v[184:187], v[32:35]
s_add_u32 m0, s35, 103024
ds_read_b128 v[84:87], v4 offset:50080
v_mfma_f32_16x16x32_bf16 v[40:43], v[88:91], v[188:191], v[40:43]
buffer_load_dwordx4 v1, s[8:11], s29 offen offset:3072 sc1 lds
v_mfma_f32_16x16x32_bf16 v[36:39], v[92:95], v[184:187], v[36:39]
ds_read_b128 v[88:91], v4 offset:33456
v_mfma_f32_16x16x32_bf16 v[44:47], v[92:95], v[188:191], v[44:47]
s_waitcnt lgkmcnt(5)
v_exp_f32 v23, v23
v_mfma_f32_16x16x32_bf16 v[32:35], v[64:67], v[192:195], v[32:35]
ds_read_b128 v[92:95], v4 offset:50096
v_cvt_pk_bf16_f32 v59, v22, v23
v_mfma_f32_16x16x32_bf16 v[40:43], v[64:67], v[196:199], v[40:43]
v_exp_f32_e64 v24, v24
v_mfma_f32_16x16x32_bf16 v[36:39], v[68:71], v[192:195], v[36:39]
ds_read_b128 v[64:67], v4 offset:33472
v_mfma_f32_16x16x32_bf16 v[44:47], v[68:71], v[196:199], v[44:47]
s_waitcnt lgkmcnt(5)
v_exp_f32 v25, v25
v_mfma_f32_16x16x32_bf16 v[32:35], v[72:75], v[200:203], v[32:35]
ds_read_b128 v[68:71], v4 offset:50112
v_cvt_pk_bf16_f32 v60, v24, v25
v_mfma_f32_16x16x32_bf16 v[40:43], v[72:75], v[204:207], v[40:43]
v_exp_f32_e64 v26, v26
v_mfma_f32_16x16x32_bf16 v[36:39], v[76:79], v[200:203], v[36:39]
ds_read_b128 v[72:75], v4 offset:33488
v_mfma_f32_16x16x32_bf16 v[44:47], v[76:79], v[204:207], v[44:47]
s_waitcnt lgkmcnt(5)
v_exp_f32 v27, v27
v_mfma_f32_16x16x32_bf16 v[32:35], v[80:83], v[208:211], v[32:35]
ds_read_b128 v[76:79], v4 offset:50128
v_cvt_pk_bf16_f32 v61, v26, v27
v_mfma_f32_16x16x32_bf16 v[40:43], v[80:83], v[212:215], v[40:43]
v_exp_f32_e64 v28, v28
v_mfma_f32_16x16x32_bf16 v[36:39], v[84:87], v[208:211], v[36:39]
ds_read_b128 v[80:83], v4 offset:33504
v_mfma_f32_16x16x32_bf16 v[44:47], v[84:87], v[212:215], v[44:47]
s_waitcnt lgkmcnt(5)
v_exp_f32 v29, v29
v_mfma_f32_16x16x32_bf16 v[32:35], v[88:91], v[216:219], v[32:35]
ds_read_b128 v[84:87], v4 offset:50144
v_cvt_pk_bf16_f32 v62, v28, v29
v_mfma_f32_16x16x32_bf16 v[40:43], v[88:91], v[220:223], v[40:43]
v_exp_f32_e64 v30, v30
v_mfma_f32_16x16x32_bf16 v[36:39], v[92:95], v[216:219], v[36:39]
ds_read_b128 v[88:91], v4 offset:33520
v_mfma_f32_16x16x32_bf16 v[44:47], v[92:95], v[220:223], v[44:47]
s_waitcnt lgkmcnt(5)
v_exp_f32 v31, v31
v_mfma_f32_16x16x32_bf16 v[32:35], v[64:67], v[224:227], v[32:35]
ds_read_b128 v[92:95], v4 offset:50160
v_cvt_pk_bf16_f32 v63, v30, v31
v_mfma_f32_16x16x32_bf16 v[40:43], v[64:67], v[228:231], v[40:43]
v_add_f32 v8, v8, v16
v_add_f32 v8, v8, v17
v_mfma_f32_16x16x32_bf16 v[36:39], v[68:71], v[224:227], v[36:39]
ds_read_b64_tr_b16 v[64:65], v5 offset:0
v_add_f32_e64 v8, v8, v18
v_mfma_f32_16x16x32_bf16 v[44:47], v[68:71], v[228:231], v[44:47]
s_waitcnt lgkmcnt(5)
s_nop 0
ds_read_b64_tr_b16 v[66:67], v5 offset:16640
v_mfma_f32_16x16x32_bf16 v[32:35], v[72:75], v[232:235], v[32:35]
ds_read_b64_tr_b16 v[68:69], v5 offset:32
v_add_f32_e64 v8, v8, v19
v_mfma_f32_16x16x32_bf16 v[40:43], v[72:75], v[236:239], v[40:43]
ds_read_b64_tr_b16 v[70:71], v5 offset:16672
v_add_f32_e64 v8, v8, v20
v_mfma_f32_16x16x32_bf16 v[36:39], v[76:79], v[232:235], v[36:39]
ds_read_b64_tr_b16 v[72:73], v5 offset:64
v_add_f32_e64 v8, v8, v21
v_mfma_f32_16x16x32_bf16 v[44:47], v[76:79], v[236:239], v[44:47]
s_waitcnt lgkmcnt(7)
s_nop 0
ds_read_b64_tr_b16 v[74:75], v5 offset:16704
v_mfma_f32_16x16x32_bf16 v[32:35], v[80:83], v[240:243], v[32:35]
ds_read_b64_tr_b16 v[76:77], v5 offset:96
v_add_f32_e64 v8, v8, v22
v_mfma_f32_16x16x32_bf16 v[40:43], v[80:83], v[244:247], v[40:43]
ds_read_b64_tr_b16 v[78:79], v5 offset:16736
v_add_f32_e64 v8, v8, v23
v_mfma_f32_16x16x32_bf16 v[36:39], v[84:87], v[240:243], v[36:39]
ds_read_b64_tr_b16 v[80:81], v5 offset:128
v_add_f32_e64 v9, v9, v24
v_mfma_f32_16x16x32_bf16 v[44:47], v[84:87], v[244:247], v[44:47]
s_waitcnt lgkmcnt(9)
s_nop 0
ds_read_b64_tr_b16 v[82:83], v5 offset:16768
v_mfma_f32_16x16x32_bf16 v[32:35], v[88:91], v[248:251], v[32:35]
ds_read_b64_tr_b16 v[84:85], v5 offset:160
v_add_f32_e64 v9, v9, v25
v_mfma_f32_16x16x32_bf16 v[40:43], v[88:91], v[252:255], v[40:43]
ds_read_b64_tr_b16 v[86:87], v5 offset:16800
v_add_f32_e64 v9, v9, v26
v_mfma_f32_16x16x32_bf16 v[36:39], v[92:95], v[248:251], v[36:39]
ds_read_b64_tr_b16 v[88:89], v5 offset:192
v_add_f32_e64 v9, v9, v27
v_mfma_f32_16x16x32_bf16 v[44:47], v[92:95], v[252:255], v[44:47]
s_waitcnt lgkmcnt(9)
s_nop 0
ds_read_b64_tr_b16 v[90:91], v5 offset:16832
v_mfma_f32_16x16x32_bf16 a[0:3], v[64:67], v[56:59], a[0:3]
ds_read_b64_tr_b16 v[92:93], v5 offset:224
v_add_f32_e64 v9, v9, v28
v_mfma_f32_16x16x32_bf16 a[4:7], v[64:67], v[60:63], a[4:7]
ds_read_b64_tr_b16 v[94:95], v5 offset:16864
v_add_f32_e64 v9, v9, v29
v_mfma_f32_16x16x32_bf16 a[8:11], v[68:71], v[56:59], a[8:11]
ds_read_b64_tr_b16 v[64:65], v5 offset:256
v_add_f32_e64 v9, v9, v30
v_mfma_f32_16x16x32_bf16 a[12:15], v[68:71], v[60:63], a[12:15]
s_waitcnt lgkmcnt(9)
s_nop 0
ds_read_b64_tr_b16 v[66:67], v5 offset:16896
v_mfma_f32_16x16x32_bf16 a[16:19], v[72:75], v[56:59], a[16:19]
ds_read_b64_tr_b16 v[68:69], v5 offset:288
v_add_f32_e64 v9, v9, v31
v_mfma_f32_16x16x32_bf16 a[20:23], v[72:75], v[60:63], a[20:23]
ds_read_b64_tr_b16 v[70:71], v5 offset:16928
v_mfma_f32_16x16x32_bf16 a[24:27], v[76:79], v[56:59], a[24:27]
s_add_u32 s26, s26, 32768
ds_read_b64_tr_b16 v[72:73], v5 offset:320
v_mfma_f32_16x16x32_bf16 a[28:31], v[76:79], v[60:63], a[28:31]
s_waitcnt lgkmcnt(9)
s_nop 0
ds_read_b64_tr_b16 v[74:75], v5 offset:16960
v_mfma_f32_16x16x32_bf16 a[32:35], v[80:83], v[56:59], a[32:35]
ds_read_b64_tr_b16 v[76:77], v5 offset:352
v_max3_f32 v10, v32, v33, v34
v_mfma_f32_16x16x32_bf16 a[36:39], v[80:83], v[60:63], a[36:39]
ds_read_b64_tr_b16 v[78:79], v5 offset:16992
v_max3_f32 v11, v40, v41, v42
v_mfma_f32_16x16x32_bf16 a[40:43], v[84:87], v[56:59], a[40:43]
ds_read_b64_tr_b16 v[80:81], v5 offset:384
v_max3_f32 v10, v10, v35, v36
v_mfma_f32_16x16x32_bf16 a[44:47], v[84:87], v[60:63], a[44:47]
s_waitcnt lgkmcnt(9)
s_nop 0
ds_read_b64_tr_b16 v[82:83], v5 offset:17024
v_mfma_f32_16x16x32_bf16 a[48:51], v[88:91], v[56:59], a[48:51]
s_add_u32 s29, s26, 4096
ds_read_b64_tr_b16 v[84:85], v5 offset:416
v_max3_f32 v11, v11, v43, v44
v_mfma_f32_16x16x32_bf16 a[52:55], v[88:91], v[60:63], a[52:55]
ds_read_b64_tr_b16 v[86:87], v5 offset:17056
v_max3_f32 v10, v10, v37, v38
v_mfma_f32_16x16x32_bf16 a[56:59], v[92:95], v[56:59], a[56:59]
ds_read_b64_tr_b16 v[88:89], v5 offset:448
v_max3_f32 v11, v11, v45, v46
v_mfma_f32_16x16x32_bf16 a[60:63], v[92:95], v[60:63], a[60:63]
s_waitcnt lgkmcnt(9)
s_nop 0
ds_read_b64_tr_b16 v[90:91], v5 offset:17088
v_mfma_f32_16x16x32_bf16 a[64:67], v[64:67], v[56:59], a[64:67]
ds_read_b64_tr_b16 v[92:93], v5 offset:480
v_max_f32_e64 v10, v10, v39
v_mfma_f32_16x16x32_bf16 a[68:71], v[64:67], v[60:63], a[68:71]
ds_read_b64_tr_b16 v[94:95], v5 offset:17120
v_max_f32_e64 v11, v11, v47
v_mfma_f32_16x16x32_bf16 a[72:75], v[68:71], v[56:59], a[72:75]
ds_read_b64_tr_b16 v[64:65], v5 offset:512
v_max_f32_e64 v15, v10, v11
v_mfma_f32_16x16x32_bf16 a[76:79], v[68:71], v[60:63], a[76:79]
s_waitcnt lgkmcnt(9)
s_nop 0
ds_read_b64_tr_b16 v[66:67], v5 offset:17152
v_mfma_f32_16x16x32_bf16 a[80:83], v[72:75], v[56:59], a[80:83]
ds_read_b64_tr_b16 v[68:69], v5 offset:544
v_mfma_f32_16x16x32_bf16 a[84:87], v[72:75], v[60:63], a[84:87]
ds_read_b64_tr_b16 v[70:71], v5 offset:17184
v_mfma_f32_16x16x32_bf16 a[88:91], v[76:79], v[56:59], a[88:91]
ds_read_b64_tr_b16 v[72:73], v5 offset:576
v_mfma_f32_16x16x32_bf16 a[92:95], v[76:79], v[60:63], a[92:95]
s_waitcnt lgkmcnt(9)
s_nop 0
ds_read_b64_tr_b16 v[74:75], v5 offset:17216
v_mfma_f32_16x16x32_bf16 a[96:99], v[80:83], v[56:59], a[96:99]
ds_read_b64_tr_b16 v[76:77], v5 offset:608
v_mfma_f32_16x16x32_bf16 a[100:103], v[80:83], v[60:63], a[100:103]
ds_read_b64_tr_b16 v[78:79], v5 offset:17248
v_mfma_f32_16x16x32_bf16 a[104:107], v[84:87], v[56:59], a[104:107]
ds_read_b64_tr_b16 v[80:81], v5 offset:640
v_mfma_f32_16x16x32_bf16 a[108:111], v[84:87], v[60:63], a[108:111]
s_waitcnt lgkmcnt(9)
s_nop 0
ds_read_b64_tr_b16 v[82:83], v5 offset:17280
v_mfma_f32_16x16x32_bf16 a[112:115], v[88:91], v[56:59], a[112:115]
ds_read_b64_tr_b16 v[84:85], v5 offset:672
v_mfma_f32_16x16x32_bf16 a[116:119], v[88:91], v[60:63], a[116:119]
ds_read_b64_tr_b16 v[86:87], v5 offset:17312
v_mfma_f32_16x16x32_bf16 a[120:123], v[92:95], v[56:59], a[120:123]
ds_read_b64_tr_b16 v[88:89], v5 offset:704
v_mfma_f32_16x16x32_bf16 a[124:127], v[92:95], v[60:63], a[124:127]
s_waitcnt lgkmcnt(9)
s_nop 0
ds_read_b64_tr_b16 v[90:91], v5 offset:17344
v_mfma_f32_16x16x32_bf16 a[128:131], v[64:67], v[56:59], a[128:131]
ds_read_b64_tr_b16 v[92:93], v5 offset:736
v_mfma_f32_16x16x32_bf16 a[132:135], v[64:67], v[60:63], a[132:135]
ds_read_b64_tr_b16 v[94:95], v5 offset:17376
v_mfma_f32_16x16x32_bf16 a[136:139], v[68:71], v[56:59], a[136:139]
ds_read_b64_tr_b16 v[64:65], v5 offset:768
v_mfma_f32_16x16x32_bf16 a[140:143], v[68:71], v[60:63], a[140:143]
s_waitcnt lgkmcnt(9)
s_nop 0
ds_read_b64_tr_b16 v[66:67], v5 offset:17408
v_mfma_f32_16x16x32_bf16 a[144:147], v[72:75], v[56:59], a[144:147]
ds_read_b64_tr_b16 v[68:69], v5 offset:800
v_mfma_f32_16x16x32_bf16 a[148:151], v[72:75], v[60:63], a[148:151]
ds_read_b64_tr_b16 v[70:71], v5 offset:17440
v_mfma_f32_16x16x32_bf16 a[152:155], v[76:79], v[56:59], a[152:155]
ds_read_b64_tr_b16 v[72:73], v5 offset:832
v_mfma_f32_16x16x32_bf16 a[156:159], v[76:79], v[60:63], a[156:159]
s_waitcnt lgkmcnt(9)
s_nop 0
ds_read_b64_tr_b16 v[74:75], v5 offset:17472
v_mfma_f32_16x16x32_bf16 a[160:163], v[80:83], v[56:59], a[160:163]
ds_read_b64_tr_b16 v[76:77], v5 offset:864
v_mfma_f32_16x16x32_bf16 a[164:167], v[80:83], v[60:63], a[164:167]
ds_read_b64_tr_b16 v[78:79], v5 offset:17504
v_mfma_f32_16x16x32_bf16 a[168:171], v[84:87], v[56:59], a[168:171]
ds_read_b64_tr_b16 v[80:81], v5 offset:896
v_mfma_f32_16x16x32_bf16 a[172:175], v[84:87], v[60:63], a[172:175]
s_waitcnt lgkmcnt(9)
s_nop 0
ds_read_b64_tr_b16 v[82:83], v5 offset:17536
v_mfma_f32_16x16x32_bf16 a[176:179], v[88:91], v[56:59], a[176:179]
ds_read_b64_tr_b16 v[84:85], v5 offset:928
v_mfma_f32_16x16x32_bf16 a[180:183], v[88:91], v[60:63], a[180:183]
ds_read_b64_tr_b16 v[86:87], v5 offset:17568
v_mfma_f32_16x16x32_bf16 a[184:187], v[92:95], v[56:59], a[184:187]
ds_read_b64_tr_b16 v[88:89], v5 offset:960
v_mfma_f32_16x16x32_bf16 a[188:191], v[92:95], v[60:63], a[188:191]
s_waitcnt lgkmcnt(9)
s_nop 0
ds_read_b64_tr_b16 v[90:91], v5 offset:17600
v_mfma_f32_16x16x32_bf16 a[192:195], v[64:67], v[56:59], a[192:195]
ds_read_b64_tr_b16 v[92:93], v5 offset:992
v_mfma_f32_16x16x32_bf16 a[196:199], v[64:67], v[60:63], a[196:199]
ds_read_b64_tr_b16 v[94:95], v5 offset:17632
v_mfma_f32_16x16x32_bf16 a[200:203], v[68:71], v[56:59], a[200:203]
s_waitcnt vmcnt(8)
s_barrier
ds_read_b128 v[64:67], v2 offset:0
v_mfma_f32_16x16x32_bf16 a[204:207], v[68:71], v[60:63], a[204:207]
s_waitcnt lgkmcnt(9)
s_nop 0
v_mfma_f32_16x16x32_bf16 a[208:211], v[72:75], v[56:59], a[208:211]
ds_read_b128 v[68:71], v2 offset:16640
v_mfma_f32_16x16x32_bf16 a[212:215], v[72:75], v[60:63], a[212:215]
v_mfma_f32_16x16x32_bf16 a[216:219], v[76:79], v[56:59], a[216:219]
ds_read_b128 v[72:75], v2 offset:16
v_mfma_f32_16x16x32_bf16 a[220:223], v[76:79], v[60:63], a[220:223]
s_waitcnt lgkmcnt(7)
s_nop 0
v_mfma_f32_16x16x32_bf16 a[224:227], v[80:83], v[56:59], a[224:227]
ds_read_b128 v[76:79], v2 offset:16656
v_mfma_f32_16x16x32_bf16 a[228:231], v[80:83], v[60:63], a[228:231]
v_mfma_f32_16x16x32_bf16 a[232:235], v[84:87], v[56:59], a[232:235]
ds_read_b128 v[80:83], v2 offset:32
v_mfma_f32_16x16x32_bf16 a[236:239], v[84:87], v[60:63], a[236:239]
s_waitcnt lgkmcnt(5)
s_nop 0
v_mfma_f32_16x16x32_bf16 a[240:243], v[88:91], v[56:59], a[240:243]
ds_read_b128 v[84:87], v2 offset:16672
v_mfma_f32_16x16x32_bf16 a[244:247], v[88:91], v[60:63], a[244:247]
v_cmp_lt_f32_e64 vcc, s45, v15
v_mfma_f32_16x16x32_bf16 a[248:251], v[92:95], v[56:59], a[248:251]
ds_read_b128 v[88:91], v2 offset:48
v_mfma_f32_16x16x32_bf16 a[252:255], v[92:95], v[60:63], a[252:255]
s_waitcnt lgkmcnt(5)
s_cbranch_vccnz L_R2
L_B2v0:
v_mfma_f32_16x16x32_bf16 v[16:19], v[64:67], v[128:131], v[48:51]
s_add_u32 m0, s35, 132096
ds_read_b128 v[92:95], v2 offset:16688
v_mfma_f32_16x16x32_bf16 v[24:27], v[64:67], v[132:135], v[52:55]
buffer_load_dwordx4 v1, s[8:11], s26 offen offset:0 sc1 lds
v_mfma_f32_16x16x32_bf16 v[20:23], v[68:71], v[128:131], v[48:51]
ds_read_b128 v[64:67], v2 offset:64
v_mfma_f32_16x16x32_bf16 v[28:31], v[68:71], v[132:135], v[52:55]
s_waitcnt lgkmcnt(5)
v_exp_f32 v32, v32
v_mfma_f32_16x16x32_bf16 v[16:19], v[72:75], v[136:139], v[16:19]
s_add_u32 m0, s35, 132112
ds_read_b128 v[68:71], v2 offset:16704
v_mfma_f32_16x16x32_bf16 v[24:27], v[72:75], v[140:143], v[24:27]
buffer_load_dwordx4 v1, s[8:11], s26 offen offset:1024 sc1 lds
v_mfma_f32_16x16x32_bf16 v[20:23], v[76:79], v[136:139], v[20:23]
ds_read_b128 v[72:75], v2 offset:80
v_mfma_f32_16x16x32_bf16 v[28:31], v[76:79], v[140:143], v[28:31]
s_waitcnt lgkmcnt(5)
v_exp_f32 v33, v33
v_mfma_f32_16x16x32_bf16 v[16:19], v[80:83], v[144:147], v[16:19]
s_add_u32 m0, s35, 132128
ds_read_b128 v[76:79], v2 offset:16720
v_cvt_pk_bf16_f32 v56, v32, v33
v_mfma_f32_16x16x32_bf16 v[24:27], v[80:83], v[148:151], v[24:27]
buffer_load_dwordx4 v1, s[8:11], s26 offen offset:2048 sc1 lds
v_mfma_f32_16x16x32_bf16 v[20:23], v[84:87], v[144:147], v[20:23]
ds_read_b128 v[80:83], v2 offset:96
v_mfma_f32_16x16x32_bf16 v[28:31], v[84:87], v[148:151], v[28:31]
s_waitcnt lgkmcnt(5)
v_exp_f32 v34, v34
v_mfma_f32_16x16x32_bf16 v[16:19], v[88:91], v[152:155], v[16:19]
s_add_u32 m0, s35, 132144
ds_read_b128 v[84:87], v2 offset:16736
v_mfma_f32_16x16x32_bf16 v[24:27], v[88:91], v[156:159], v[24:27]
buffer_load_dwordx4 v1, s[8:11], s26 offen offset:3072 sc1 lds
v_mfma_f32_16x16x32_bf16 v[20:23], v[92:95], v[152:155], v[20:23]
ds_read_b128 v[88:91], v2 offset:112
v_mfma_f32_16x16x32_bf16 v[28:31], v[92:95], v[156:159], v[28:31]
s_waitcnt lgkmcnt(5)
v_exp_f32 v35, v35
v_mfma_f32_16x16x32_bf16 v[16:19], v[64:67], v[160:163], v[16:19]
s_add_u32 m0, s35, 136256
ds_read_b128 v[92:95], v2 offset:16752
v_cvt_pk_bf16_f32 v57, v34, v35
v_mfma_f32_16x16x32_bf16 v[24:27], v[64:67], v[164:167], v[24:27]
buffer_load_dwordx4 v1, s[8:11], s29 offen offset:0 sc1 lds
v_mfma_f32_16x16x32_bf16 v[20:23], v[68:71], v[160:163], v[20:23]
ds_read_b128 v[64:67], v2 offset:128
v_mfma_f32_16x16x32_bf16 v[28:31], v[68:71], v[164:167], v[28:31]
s_waitcnt lgkmcnt(5)
v_exp_f32 v36, v36
v_mfma_f32_16x16x32_bf16 v[16:19], v[72:75], v[168:171], v[16:19]
s_add_u32 m0, s35, 136272
ds_read_b128 v[68:71], v2 offset:16768
v_mfma_f32_16x16x32_bf16 v[24:27], v[72:75], v[172:175], v[24:27]
buffer_load_dwordx4 v1, s[8:11], s29 offen offset:1024 sc1 lds
v_mfma_f32_16x16x32_bf16 v[20:23], v[76:79], v[168:171], v[20:23]
ds_read_b128 v[72:75], v2 offset:144
v_mfma_f32_16x16x32_bf16 v[28:31], v[76:79], v[172:175], v[28:31]
s_waitcnt lgkmcnt(5)
v_exp_f32 v37, v37
v_mfma_f32_16x16x32_bf16 v[16:19], v[80:83], v[176:179], v[16:19]
s_add_u32 m0, s35, 136288
ds_read_b128 v[76:79], v2 offset:16784
v_cvt_pk_bf16_f32 v58, v36, v37
v_mfma_f32_16x16x32_bf16 v[24:27], v[80:83], v[180:183], v[24:27]
buffer_load_dwordx4 v1, s[8:11], s29 offen offset:2048 sc1 lds
v_mfma_f32_16x16x32_bf16 v[20:23], v[84:87], v[176:179], v[20:23]
ds_read_b128 v[80:83], v2 offset:160
v_mfma_f32_16x16x32_bf16 v[28:31], v[84:87], v[180:183], v[28:31]
s_waitcnt lgkmcnt(5)
v_exp_f32 v38, v38
v_mfma_f32_16x16x32_bf16 v[16:19], v[88:91], v[184:187], v[16:19]
s_add_u32 m0, s35, 136304
ds_read_b128 v[84:87], v2 offset:16800
v_mfma_f32_16x16x32_bf16 v[24:27], v[88:91], v[188:191], v[24:27]
buffer_load_dwordx4 v1, s[8:11], s29 offen offset:3072 sc1 lds
v_mfma_f32_16x16x32_bf16 v[20:23], v[92:95], v[184:187], v[20:23]
ds_read_b128 v[88:91], v2 offset:176
v_mfma_f32_16x16x32_bf16 v[28:31], v[92:95], v[188:191], v[28:31]
s_waitcnt lgkmcnt(5)
v_exp_f32 v39, v39
v_mfma_f32_16x16x32_bf16 v[16:19], v[64:67], v[192:195], v[16:19]
ds_read_b128 v[92:95], v2 offset:16816
v_cvt_pk_bf16_f32 v59, v38, v39
v_mfma_f32_16x16x32_bf16 v[24:27], v[64:67], v[196:199], v[24:27]
v_exp_f32_e64 v40, v40
v_mfma_f32_16x16x32_bf16 v[20:23], v[68:71], v[192:195], v[20:23]
ds_read_b128 v[64:67], v2 offset:192
v_mfma_f32_16x16x32_bf16 v[28:31], v[68:71], v[196:199], v[28:31]
s_waitcnt lgkmcnt(5)
v_exp_f32 v41, v41
v_mfma_f32_16x16x32_bf16 v[16:19], v[72:75], v[200:203], v[16:19]
ds_read_b128 v[68:71], v2 offset:16832
v_cvt_pk_bf16_f32 v60, v40, v41
v_mfma_f32_16x16x32_bf16 v[24:27], v[72:75], v[204:207], v[24:27]
v_exp_f32_e64 v42, v42
v_mfma_f32_16x16x32_bf16 v[20:23], v[76:79], v[200:203], v[20:23]
ds_read_b128 v[72:75], v2 offset:208
v_mfma_f32_16x16x32_bf16 v[28:31], v[76:79], v[204:207], v[28:31]
s_waitcnt lgkmcnt(5)
v_exp_f32 v43, v43
v_mfma_f32_16x16x32_bf16 v[16:19], v[80:83], v[208:211], v[16:19]
ds_read_b128 v[76:79], v2 offset:16848
v_cvt_pk_bf16_f32 v61, v42, v43
v_mfma_f32_16x16x32_bf16 v[24:27], v[80:83], v[212:215], v[24:27]
v_exp_f32_e64 v44, v44
v_mfma_f32_16x16x32_bf16 v[20:23], v[84:87], v[208:211], v[20:23]
ds_read_b128 v[80:83], v2 offset:224
v_mfma_f32_16x16x32_bf16 v[28:31], v[84:87], v[212:215], v[28:31]
s_waitcnt lgkmcnt(5)
v_exp_f32 v45, v45
v_mfma_f32_16x16x32_bf16 v[16:19], v[88:91], v[216:219], v[16:19]
ds_read_b128 v[84:87], v2 offset:16864
v_cvt_pk_bf16_f32 v62, v44, v45
v_mfma_f32_16x16x32_bf16 v[24:27], v[88:91], v[220:223], v[24:27]
v_exp_f32_e64 v46, v46
v_mfma_f32_16x16x32_bf16 v[20:23], v[92:95], v[216:219], v[20:23]
ds_read_b128 v[88:91], v2 offset:240
v_mfma_f32_16x16x32_bf16 v[28:31], v[92:95], v[220:223], v[28:31]
s_waitcnt lgkmcnt(5)
v_exp_f32 v47, v47
v_mfma_f32_16x16x32_bf16 v[16:19], v[64:67], v[224:227], v[16:19]
ds_read_b128 v[92:95], v2 offset:16880
v_cvt_pk_bf16_f32 v63, v46, v47
v_mfma_f32_16x16x32_bf16 v[24:27], v[64:67], v[228:231], v[24:27]
v_add_f32 v8, v8, v32
v_add_f32 v8, v8, v33
v_mfma_f32_16x16x32_bf16 v[20:23], v[68:71], v[224:227], v[20:23]
ds_read_b64_tr_b16 v[64:65], v5 offset:33280
v_add_f32_e64 v8, v8, v34
v_mfma_f32_16x16x32_bf16 v[28:31], v[68:71], v[228:231], v[28:31]
s_waitcnt lgkmcnt(5)
s_nop 0
ds_read_b64_tr_b16 v[66:67], v5 offset:49920
v_mfma_f32_16x16x32_bf16 v[16:19], v[72:75], v[232:235], v[16:19]
ds_read_b64_tr_b16 v[68:69], v5 offset:33312
v_add_f32_e64 v8, v8, v35
v_mfma_f32_16x16x32_bf16 v[24:27], v[72:75], v[236:239], v[24:27]
ds_read_b64_tr_b16 v[70:71], v5 offset:49952
v_add_f32_e64 v8, v8, v36
v_mfma_f32_16x16x32_bf16 v[20:23], v[76:79], v[232:235], v[20:23]
ds_read_b64_tr_b16 v[72:73], v5 offset:33344
v_add_f32_e64 v8, v8, v37
v_mfma_f32_16x16x32_bf16 v[28:31], v[76:79], v[236:239], v[28:31]
s_waitcnt lgkmcnt(7)
s_nop 0
ds_read_b64_tr_b16 v[74:75], v5 offset:49984
v_mfma_f32_16x16x32_bf16 v[16:19], v[80:83], v[240:243], v[16:19]
ds_read_b64_tr_b16 v[76:77], v5 offset:33376
v_add_f32_e64 v8, v8, v38
v_mfma_f32_16x16x32_bf16 v[24:27], v[80:83], v[244:247], v[24:27]
ds_read_b64_tr_b16 v[78:79], v5 offset:50016
v_add_f32_e64 v8, v8, v39
v_mfma_f32_16x16x32_bf16 v[20:23], v[84:87], v[240:243], v[20:23]
ds_read_b64_tr_b16 v[80:81], v5 offset:33408
v_add_f32_e64 v9, v9, v40
v_mfma_f32_16x16x32_bf16 v[28:31], v[84:87], v[244:247], v[28:31]
s_waitcnt lgkmcnt(9)
s_nop 0
ds_read_b64_tr_b16 v[82:83], v5 offset:50048
v_mfma_f32_16x16x32_bf16 v[16:19], v[88:91], v[248:251], v[16:19]
ds_read_b64_tr_b16 v[84:85], v5 offset:33440
v_add_f32_e64 v9, v9, v41
v_mfma_f32_16x16x32_bf16 v[24:27], v[88:91], v[252:255], v[24:27]
ds_read_b64_tr_b16 v[86:87], v5 offset:50080
v_add_f32_e64 v9, v9, v42
v_mfma_f32_16x16x32_bf16 v[20:23], v[92:95], v[248:251], v[20:23]
ds_read_b64_tr_b16 v[88:89], v5 offset:33472
v_add_f32_e64 v9, v9, v43
v_mfma_f32_16x16x32_bf16 v[28:31], v[92:95], v[252:255], v[28:31]
s_waitcnt lgkmcnt(9)
s_nop 0
ds_read_b64_tr_b16 v[90:91], v5 offset:50112
v_mfma_f32_16x16x32_bf16 a[0:3], v[64:67], v[56:59], a[0:3]
ds_read_b64_tr_b16 v[92:93], v5 offset:33504
v_add_f32_e64 v9, v9, v44
v_mfma_f32_16x16x32_bf16 a[4:7], v[64:67], v[60:63], a[4:7]
ds_read_b64_tr_b16 v[94:95], v5 offset:50144
v_add_f32_e64 v9, v9, v45
v_mfma_f32_16x16x32_bf16 a[8:11], v[68:71], v[56:59], a[8:11]
ds_read_b64_tr_b16 v[64:65], v5 offset:33536
v_add_f32_e64 v9, v9, v46
v_mfma_f32_16x16x32_bf16 a[12:15], v[68:71], v[60:63], a[12:15]
s_waitcnt lgkmcnt(9)
s_nop 0
ds_read_b64_tr_b16 v[66:67], v5 offset:50176
v_mfma_f32_16x16x32_bf16 a[16:19], v[72:75], v[56:59], a[16:19]
ds_read_b64_tr_b16 v[68:69], v5 offset:33568
v_add_f32_e64 v9, v9, v47
v_mfma_f32_16x16x32_bf16 a[20:23], v[72:75], v[60:63], a[20:23]
ds_read_b64_tr_b16 v[70:71], v5 offset:50208
v_mfma_f32_16x16x32_bf16 a[24:27], v[76:79], v[56:59], a[24:27]
s_add_u32 s26, s26, 32768
ds_read_b64_tr_b16 v[72:73], v5 offset:33600
v_mfma_f32_16x16x32_bf16 a[28:31], v[76:79], v[60:63], a[28:31]
s_waitcnt lgkmcnt(9)
s_nop 0
ds_read_b64_tr_b16 v[74:75], v5 offset:50240
v_mfma_f32_16x16x32_bf16 a[32:35], v[80:83], v[56:59], a[32:35]
ds_read_b64_tr_b16 v[76:77], v5 offset:33632
v_max3_f32 v10, v16, v17, v18
v_mfma_f32_16x16x32_bf16 a[36:39], v[80:83], v[60:63], a[36:39]
ds_read_b64_tr_b16 v[78:79], v5 offset:50272
v_max3_f32 v11, v24, v25, v26
v_mfma_f32_16x16x32_bf16 a[40:43], v[84:87], v[56:59], a[40:43]
ds_read_b64_tr_b16 v[80:81], v5 offset:33664
v_max3_f32 v10, v10, v19, v20
v_mfma_f32_16x16x32_bf16 a[44:47], v[84:87], v[60:63], a[44:47]
s_waitcnt lgkmcnt(9)
s_nop 0
ds_read_b64_tr_b16 v[82:83], v5 offset:50304
v_mfma_f32_16x16x32_bf16 a[48:51], v[88:91], v[56:59], a[48:51]
s_add_u32 s29, s26, 4096
ds_read_b64_tr_b16 v[84:85], v5 offset:33696
v_max3_f32 v11, v11, v27, v28
v_mfma_f32_16x16x32_bf16 a[52:55], v[88:91], v[60:63], a[52:55]
ds_read_b64_tr_b16 v[86:87], v5 offset:50336
v_max3_f32 v10, v10, v21, v22
v_mfma_f32_16x16x32_bf16 a[56:59], v[92:95], v[56:59], a[56:59]
ds_read_b64_tr_b16 v[88:89], v5 offset:33728
v_max3_f32 v11, v11, v29, v30
v_mfma_f32_16x16x32_bf16 a[60:63], v[92:95], v[60:63], a[60:63]
s_waitcnt lgkmcnt(9)
s_nop 0
ds_read_b64_tr_b16 v[90:91], v5 offset:50368
v_mfma_f32_16x16x32_bf16 a[64:67], v[64:67], v[56:59], a[64:67]
ds_read_b64_tr_b16 v[92:93], v5 offset:33760
v_max_f32_e64 v10, v10, v23
v_mfma_f32_16x16x32_bf16 a[68:71], v[64:67], v[60:63], a[68:71]
ds_read_b64_tr_b16 v[94:95], v5 offset:50400
v_max_f32_e64 v11, v11, v31
v_mfma_f32_16x16x32_bf16 a[72:75], v[68:71], v[56:59], a[72:75]
ds_read_b64_tr_b16 v[64:65], v5 offset:33792
v_max_f32_e64 v15, v10, v11
v_mfma_f32_16x16x32_bf16 a[76:79], v[68:71], v[60:63], a[76:79]
s_waitcnt lgkmcnt(9)
s_nop 0
ds_read_b64_tr_b16 v[66:67], v5 offset:50432
v_mfma_f32_16x16x32_bf16 a[80:83], v[72:75], v[56:59], a[80:83]
ds_read_b64_tr_b16 v[68:69], v5 offset:33824
v_mfma_f32_16x16x32_bf16 a[84:87], v[72:75], v[60:63], a[84:87]
ds_read_b64_tr_b16 v[70:71], v5 offset:50464
v_mfma_f32_16x16x32_bf16 a[88:91], v[76:79], v[56:59], a[88:91]
ds_read_b64_tr_b16 v[72:73], v5 offset:33856
v_mfma_f32_16x16x32_bf16 a[92:95], v[76:79], v[60:63], a[92:95]
s_waitcnt lgkmcnt(9)
s_nop 0
ds_read_b64_tr_b16 v[74:75], v5 offset:50496
v_mfma_f32_16x16x32_bf16 a[96:99], v[80:83], v[56:59], a[96:99]
ds_read_b64_tr_b16 v[76:77], v5 offset:33888
v_mfma_f32_16x16x32_bf16 a[100:103], v[80:83], v[60:63], a[100:103]
ds_read_b64_tr_b16 v[78:79], v5 offset:50528
v_mfma_f32_16x16x32_bf16 a[104:107], v[84:87], v[56:59], a[104:107]
ds_read_b64_tr_b16 v[80:81], v5 offset:33920
v_mfma_f32_16x16x32_bf16 a[108:111], v[84:87], v[60:63], a[108:111]
s_waitcnt lgkmcnt(9)
s_nop 0
ds_read_b64_tr_b16 v[82:83], v5 offset:50560
v_mfma_f32_16x16x32_bf16 a[112:115], v[88:91], v[56:59], a[112:115]
ds_read_b64_tr_b16 v[84:85], v5 offset:33952
v_mfma_f32_16x16x32_bf16 a[116:119], v[88:91], v[60:63], a[116:119]
ds_read_b64_tr_b16 v[86:87], v5 offset:50592
v_mfma_f32_16x16x32_bf16 a[120:123], v[92:95], v[56:59], a[120:123]
ds_read_b64_tr_b16 v[88:89], v5 offset:33984
v_mfma_f32_16x16x32_bf16 a[124:127], v[92:95], v[60:63], a[124:127]
s_waitcnt lgkmcnt(9)
s_nop 0
ds_read_b64_tr_b16 v[90:91], v5 offset:50624
v_mfma_f32_16x16x32_bf16 a[128:131], v[64:67], v[56:59], a[128:131]
ds_read_b64_tr_b16 v[92:93], v5 offset:34016
v_mfma_f32_16x16x32_bf16 a[132:135], v[64:67], v[60:63], a[132:135]
ds_read_b64_tr_b16 v[94:95], v5 offset:50656
v_mfma_f32_16x16x32_bf16 a[136:139], v[68:71], v[56:59], a[136:139]
ds_read_b64_tr_b16 v[64:65], v5 offset:34048
v_mfma_f32_16x16x32_bf16 a[140:143], v[68:71], v[60:63], a[140:143]
s_waitcnt lgkmcnt(9)
s_nop 0
ds_read_b64_tr_b16 v[66:67], v5 offset:50688
v_mfma_f32_16x16x32_bf16 a[144:147], v[72:75], v[56:59], a[144:147]
ds_read_b64_tr_b16 v[68:69], v5 offset:34080
v_mfma_f32_16x16x32_bf16 a[148:151], v[72:75], v[60:63], a[148:151]
ds_read_b64_tr_b16 v[70:71], v5 offset:50720
v_mfma_f32_16x16x32_bf16 a[152:155], v[76:79], v[56:59], a[152:155]
ds_read_b64_tr_b16 v[72:73], v5 offset:34112
v_mfma_f32_16x16x32_bf16 a[156:159], v[76:79], v[60:63], a[156:159]
s_waitcnt lgkmcnt(9)
s_nop 0
ds_read_b64_tr_b16 v[74:75], v5 offset:50752
v_mfma_f32_16x16x32_bf16 a[160:163], v[80:83], v[56:59], a[160:163]
ds_read_b64_tr_b16 v[76:77], v5 offset:34144
v_mfma_f32_16x16x32_bf16 a[164:167], v[80:83], v[60:63], a[164:167]
ds_read_b64_tr_b16 v[78:79], v5 offset:50784
v_mfma_f32_16x16x32_bf16 a[168:171], v[84:87], v[56:59], a[168:171]
ds_read_b64_tr_b16 v[80:81], v5 offset:34176
v_mfma_f32_16x16x32_bf16 a[172:175], v[84:87], v[60:63], a[172:175]
s_waitcnt lgkmcnt(9)
s_nop 0
ds_read_b64_tr_b16 v[82:83], v5 offset:50816
v_mfma_f32_16x16x32_bf16 a[176:179], v[88:91], v[56:59], a[176:179]
ds_read_b64_tr_b16 v[84:85], v5 offset:34208
v_mfma_f32_16x16x32_bf16 a[180:183], v[88:91], v[60:63], a[180:183]
ds_read_b64_tr_b16 v[86:87], v5 offset:50848
v_mfma_f32_16x16x32_bf16 a[184:187], v[92:95], v[56:59], a[184:187]
ds_read_b64_tr_b16 v[88:89], v5 offset:34240
v_mfma_f32_16x16x32_bf16 a[188:191], v[92:95], v[60:63], a[188:191]
s_waitcnt lgkmcnt(9)
s_nop 0
ds_read_b64_tr_b16 v[90:91], v5 offset:50880
v_mfma_f32_16x16x32_bf16 a[192:195], v[64:67], v[56:59], a[192:195]
ds_read_b64_tr_b16 v[92:93], v5 offset:34272
v_mfma_f32_16x16x32_bf16 a[196:199], v[64:67], v[60:63], a[196:199]
ds_read_b64_tr_b16 v[94:95], v5 offset:50912
v_mfma_f32_16x16x32_bf16 a[200:203], v[68:71], v[56:59], a[200:203]
s_waitcnt vmcnt(8)
s_barrier
ds_read_b128 v[64:67], v2 offset:33280
v_mfma_f32_16x16x32_bf16 a[204:207], v[68:71], v[60:63], a[204:207]
s_waitcnt lgkmcnt(9)
s_nop 0
v_mfma_f32_16x16x32_bf16 a[208:211], v[72:75], v[56:59], a[208:211]
ds_read_b128 v[68:71], v2 offset:49920
v_mfma_f32_16x16x32_bf16 a[212:215], v[72:75], v[60:63], a[212:215]
v_mfma_f32_16x16x32_bf16 a[216:219], v[76:79], v[56:59], a[216:219]
ds_read_b128 v[72:75], v2 offset:33296
v_mfma_f32_16x16x32_bf16 a[220:223], v[76:79], v[60:63], a[220:223]
s_waitcnt lgkmcnt(7)
s_nop 0
v_mfma_f32_16x16x32_bf16 a[224:227], v[80:83], v[56:59], a[224:227]
ds_read_b128 v[76:79], v2 offset:49936
v_mfma_f32_16x16x32_bf16 a[228:231], v[80:83], v[60:63], a[228:231]
v_mfma_f32_16x16x32_bf16 a[232:235], v[84:87], v[56:59], a[232:235]
ds_read_b128 v[80:83], v2 offset:33312
v_mfma_f32_16x16x32_bf16 a[236:239], v[84:87], v[60:63], a[236:239]
s_waitcnt lgkmcnt(5)
s_nop 0
v_mfma_f32_16x16x32_bf16 a[240:243], v[88:91], v[56:59], a[240:243]
ds_read_b128 v[84:87], v2 offset:49952
v_mfma_f32_16x16x32_bf16 a[244:247], v[88:91], v[60:63], a[244:247]
v_cmp_lt_f32_e64 vcc, s45, v15
v_mfma_f32_16x16x32_bf16 a[248:251], v[92:95], v[56:59], a[248:251]
ds_read_b128 v[88:91], v2 offset:33328
v_mfma_f32_16x16x32_bf16 a[252:255], v[92:95], v[60:63], a[252:255]
s_waitcnt lgkmcnt(5)
s_cbranch_vccnz L_R3
L_B3v0:
s_sub_u32 s31, s31, 1
s_bitcmp1_b32 38, s31
s_cbranch_scc1 L_L0v0
L_stub:
s_cmp_eq_u32 s31, 6
s_cbranch_scc1 L_fb
s_cmp_eq_u32 s31, 4
s_cbranch_scc1 L_st4
s_cmp_eq_u32 s31, 3
s_cbranch_scc1 L_st3
s_lshl_b32 s36, s32, 2
s_add_u32 s36, s36, s24
s_and_b32 s36, s36, 7
s_getpc_b64 s[50:51]
pc_16:
s_add_u32 s50, s50, L_sp2-pc_16
s_addc_u32 s51, s51, (L_sp2-pc_16)>>32
s_mul_i32 s52, s36, 8192
v_lshlrev_b32 v113, 7, v0
v_add_u32_e64 v113, s52, v113
v_min_u32 v114, L_end-L_sp2-4, v113
global_load_dword v112, v114, s[50:51]
s_branch L_L0
L_st4:
s_mov_b32 s44, 4096
buffer_load_dwordx4 v[96:99], v1, s[72:75], s44 offen offset:0 sc1
buffer_load_dwordx4 v[100:103], v1, s[72:75], s44 offen offset:1024 sc1
buffer_load_dwordx4 v[104:107], v1, s[72:75], s44 offen offset:2048 sc1
buffer_load_dwordx4 v[108:111], v1, s[72:75], s44 offen offset:3072 sc1
s_lshl_b32 s48, s34, 2
s_add_u32 s48, s48, s32
s_mul_i32 s49, s33, 125
s_add_u32 s49, s49, s48
s_lshl_b32 s39, s48, 1
s_add_u32 s39, s39, s24
s_sub_u32 s39, s39, 1
s_and_b32 s39, s39, 0xffff
s_lshl_b32 s39, s39, 14
s_lshl_b32 s38, s24, 14
s_add_u32 s38, s38, 79691776
s_lshl_b32 s28, s49, 15
s_lshl_b32 s47, s24, 13
s_add_u32 s28, s28, s47
s_lshl_b32 s46, s49, 15
s_lshl_b32 s47, s24, 12
s_add_u32 s46, s46, s47
s_add_u32 s47, s46, 16384
v_lshlrev_b32 v113, 7, v0
s_branch L_L0
L_st3:
v_xor_b32 v96, v96, v7
v_bitop3_b32 v96, v97, v7, v96 bitop3:0xbe
v_bitop3_b32 v96, v98, v7, v96 bitop3:0xbe
v_bitop3_b32 v96, v99, v7, v96 bitop3:0xbe
v_bitop3_b32 v96, v100, v7, v96 bitop3:0xbe
v_bitop3_b32 v96, v101, v7, v96 bitop3:0xbe
v_bitop3_b32 v96, v102, v7, v96 bitop3:0xbe
v_bitop3_b32 v96, v103, v7, v96 bitop3:0xbe
v_bitop3_b32 v96, v104, v7, v96 bitop3:0xbe
v_bitop3_b32 v96, v105, v7, v96 bitop3:0xbe
v_bitop3_b32 v96, v106, v7, v96 bitop3:0xbe
v_bitop3_b32 v96, v107, v7, v96 bitop3:0xbe
v_bitop3_b32 v96, v108, v7, v96 bitop3:0xbe
v_bitop3_b32 v96, v109, v7, v96 bitop3:0xbe
v_bitop3_b32 v96, v110, v7, v96 bitop3:0xbe
v_bitop3_b32 v96, v111, v7, v96 bitop3:0xbe
v_cmp_ne_u32 vcc, 0, v96
s_cbranch_vccnz L_sp_17
L_bk_18:
s_branch L_L0
L_st2:
s_branch L_L0
L_st1:
s_branch L_L0
L_fb:
s_mov_b64 exec, 1
buffer_store_dword v7, off, s[72:75], s41 sc1
s_mov_b64 exec, -1
s_branch L_L0
L_R0:
s_mov_b32 s42, 0
s_branch L_RB0
L_R2:
s_mov_b32 s42, 2
s_branch L_RB0
L_R4:
s_mov_b32 s42, 4
L_RB0:
s_nop 7
s_nop 7
v_max_f32 v10, 0, v10
v_max_f32 v11, 0, v11
v_mov_b32 v12, v10
v_mov_b32 v13, v11
s_nop 1
v_permlane32_swap_b32 v12, v10
v_permlane32_swap_b32 v13, v11
s_nop 1
v_max_f32 v10, v10, v12
v_max_f32 v11, v11, v13
v_mov_b32 v12, v10
v_mov_b32 v13, v11
s_nop 1
v_permlane16_swap_b32 v12, v10
v_permlane16_swap_b32 v13, v11
s_nop 1
v_max_f32 v10, v10, v12
v_max_f32 v11, v11, v13
v_sub_f32 v48, v48, v10
v_sub_f32 v49, v49, v10
v_sub_f32 v50, v50, v10
v_sub_f32 v51, v51, v10
v_sub_f32 v32, v32, v10
v_sub_f32 v33, v33, v10
v_sub_f32 v34, v34, v10
v_sub_f32 v35, v35, v10
v_sub_f32 v36, v36, v10
v_sub_f32 v37, v37, v10
v_sub_f32 v38, v38, v10
v_sub_f32 v39, v39, v10
v_sub_f32 v10, 0, v10
v_exp_f32 v10, v10
s_nop 0
v_mul_f32 v8, v8, v10
v_sub_f32 v52, v52, v11
v_sub_f32 v53, v53, v11
v_sub_f32 v54, v54, v11
v_sub_f32 v55, v55, v11
v_sub_f32 v40, v40, v11
v_sub_f32 v41, v41, v11
v_sub_f32 v42, v42, v11
v_sub_f32 v43, v43, v11
v_sub_f32 v44, v44, v11
v_sub_f32 v45, v45, v11
v_sub_f32 v46, v46, v11
v_sub_f32 v47, v47, v11
v_sub_f32 v11, 0, v11
v_exp_f32 v11, v11
s_nop 0
v_mul_f32 v9, v9, v11
s_branch L_RC
L_R1:
s_mov_b32 s42, 1
s_branch L_RB1
L_R3:
s_mov_b32 s42, 3
L_RB1:
s_nop 7
s_nop 7
v_max_f32 v10, 0, v10
v_max_f32 v11, 0, v11
v_mov_b32 v12, v10
v_mov_b32 v13, v11
s_nop 1
v_permlane32_swap_b32 v12, v10
v_permlane32_swap_b32 v13, v11
s_nop 1
v_max_f32 v10, v10, v12
v_max_f32 v11, v11, v13
v_mov_b32 v12, v10
v_mov_b32 v13, v11
s_nop 1
v_permlane16_swap_b32 v12, v10
v_permlane16_swap_b32 v13, v11
s_nop 1
v_max_f32 v10, v10, v12
v_max_f32 v11, v11, v13
v_sub_f32 v48, v48, v10
v_sub_f32 v49, v49, v10
v_sub_f32 v50, v50, v10
v_sub_f32 v51, v51, v10
v_sub_f32 v16, v16, v10
v_sub_f32 v17, v17, v10
v_sub_f32 v18, v18, v10
v_sub_f32 v19, v19, v10
v_sub_f32 v20, v20, v10
v_sub_f32 v21, v21, v10
v_sub_f32 v22, v22, v10
v_sub_f32 v23, v23, v10
v_sub_f32 v10, 0, v10
v_exp_f32 v10, v10
s_nop 0
v_mul_f32 v8, v8, v10
v_sub_f32 v52, v52, v11
v_sub_f32 v53, v53, v11
v_sub_f32 v54, v54, v11
v_sub_f32 v55, v55, v11
v_sub_f32 v24, v24, v11
v_sub_f32 v25, v25, v11
v_sub_f32 v26, v26, v11
v_sub_f32 v27, v27, v11
v_sub_f32 v28, v28, v11
v_sub_f32 v29, v29, v11
v_sub_f32 v30, v30, v11
v_sub_f32 v31, v31, v11
v_sub_f32 v11, 0, v11
v_exp_f32 v11, v11
s_nop 0
v_mul_f32_e64 v9, v9, v11
L_RC:
v_accvgpr_read_b32 v13, a0
v_accvgpr_read_b32 v14, a1
v_mul_f32 v13, v13, v10
v_mul_f32 v14, v14, v10
v_accvgpr_write_b32 a0, v13
v_accvgpr_write_b32 a1, v14
v_accvgpr_read_b32 v13, a2
v_accvgpr_read_b32 v14, a3
v_mul_f32 v13, v13, v10
v_mul_f32 v14, v14, v10
v_accvgpr_write_b32 a2, v13
v_accvgpr_write_b32 a3, v14
v_accvgpr_read_b32 v13, a4
v_accvgpr_read_b32 v14, a5
v_mul_f32 v13, v13, v11
v_mul_f32 v14, v14, v11
v_accvgpr_write_b32 a4, v13
v_accvgpr_write_b32 a5, v14
v_accvgpr_read_b32 v13, a6
v_accvgpr_read_b32 v14, a7
v_mul_f32 v13, v13, v11
v_mul_f32 v14, v14, v11
v_accvgpr_write_b32 a6, v13
v_accvgpr_write_b32 a7, v14
v_accvgpr_read_b32 v13, a8
v_accvgpr_read_b32 v14, a9
v_mul_f32 v13, v13, v10
v_mul_f32 v14, v14, v10
v_accvgpr_write_b32 a8, v13
v_accvgpr_write_b32 a9, v14
v_accvgpr_read_b32 v13, a10
v_accvgpr_read_b32 v14, a11
v_mul_f32 v13, v13, v10
v_mul_f32 v14, v14, v10
v_accvgpr_write_b32 a10, v13
v_accvgpr_write_b32 a11, v14
v_accvgpr_read_b32 v13, a12
v_accvgpr_read_b32 v14, a13
v_mul_f32 v13, v13, v11
v_mul_f32 v14, v14, v11
v_accvgpr_write_b32 a12, v13
v_accvgpr_write_b32 a13, v14
v_accvgpr_read_b32 v13, a14
v_accvgpr_read_b32 v14, a15
v_mul_f32 v13, v13, v11
v_mul_f32 v14, v14, v11
v_accvgpr_write_b32 a14, v13
v_accvgpr_write_b32 a15, v14
v_accvgpr_read_b32 v13, a16
v_accvgpr_read_b32 v14, a17
v_mul_f32 v13, v13, v10
v_mul_f32 v14, v14, v10
v_accvgpr_write_b32 a16, v13
v_accvgpr_write_b32 a17, v14
v_accvgpr_read_b32 v13, a18
v_accvgpr_read_b32 v14, a19
v_mul_f32 v13, v13, v10
v_mul_f32 v14, v14, v10
v_accvgpr_write_b32 a18, v13
v_accvgpr_write_b32 a19, v14
v_accvgpr_read_b32 v13, a20
v_accvgpr_read_b32 v14, a21
v_mul_f32 v13, v13, v11
v_mul_f32 v14, v14, v11
v_accvgpr_write_b32 a20, v13
v_accvgpr_write_b32 a21, v14
v_accvgpr_read_b32 v13, a22
v_accvgpr_read_b32 v14, a23
v_mul_f32 v13, v13, v11
v_mul_f32 v14, v14, v11
v_accvgpr_write_b32 a22, v13
v_accvgpr_write_b32 a23, v14
v_accvgpr_read_b32 v13, a24
v_accvgpr_read_b32 v14, a25
v_mul_f32 v13, v13, v10
v_mul_f32 v14, v14, v10
v_accvgpr_write_b32 a24, v13
v_accvgpr_write_b32 a25, v14
v_accvgpr_read_b32 v13, a26
v_accvgpr_read_b32 v14, a27
v_mul_f32 v13, v13, v10
v_mul_f32 v14, v14, v10
v_accvgpr_write_b32 a26, v13
v_accvgpr_write_b32 a27, v14
v_accvgpr_read_b32 v13, a28
v_accvgpr_read_b32 v14, a29
v_mul_f32 v13, v13, v11
v_mul_f32 v14, v14, v11
v_accvgpr_write_b32 a28, v13
v_accvgpr_write_b32 a29, v14
v_accvgpr_read_b32 v13, a30
v_accvgpr_read_b32 v14, a31
v_mul_f32 v13, v13, v11
v_mul_f32 v14, v14, v11
v_accvgpr_write_b32 a30, v13
v_accvgpr_write_b32 a31, v14
v_accvgpr_read_b32 v13, a32
v_accvgpr_read_b32 v14, a33
v_mul_f32 v13, v13, v10
v_mul_f32 v14, v14, v10
v_accvgpr_write_b32 a32, v13
v_accvgpr_write_b32 a33, v14
v_accvgpr_read_b32 v13, a34
v_accvgpr_read_b32 v14, a35
v_mul_f32 v13, v13, v10
v_mul_f32 v14, v14, v10
v_accvgpr_write_b32 a34, v13
v_accvgpr_write_b32 a35, v14
v_accvgpr_read_b32 v13, a36
v_accvgpr_read_b32 v14, a37
v_mul_f32 v13, v13, v11
v_mul_f32 v14, v14, v11
v_accvgpr_write_b32 a36, v13
v_accvgpr_write_b32 a37, v14
v_accvgpr_read_b32 v13, a38
v_accvgpr_read_b32 v14, a39
v_mul_f32 v13, v13, v11
v_mul_f32 v14, v14, v11
v_accvgpr_write_b32 a38, v13
v_accvgpr_write_b32 a39, v14
v_accvgpr_read_b32 v13, a40
v_accvgpr_read_b32 v14, a41
v_mul_f32 v13, v13, v10
v_mul_f32 v14, v14, v10
v_accvgpr_write_b32 a40, v13
v_accvgpr_write_b32 a41, v14
v_accvgpr_read_b32 v13, a42
v_accvgpr_read_b32 v14, a43
v_mul_f32 v13, v13, v10
v_mul_f32 v14, v14, v10
v_accvgpr_write_b32 a42, v13
v_accvgpr_write_b32 a43, v14
v_accvgpr_read_b32 v13, a44
v_accvgpr_read_b32 v14, a45
v_mul_f32 v13, v13, v11
v_mul_f32 v14, v14, v11
v_accvgpr_write_b32 a44, v13
v_accvgpr_write_b32 a45, v14
v_accvgpr_read_b32 v13, a46
v_accvgpr_read_b32 v14, a47
v_mul_f32 v13, v13, v11
v_mul_f32 v14, v14, v11
v_accvgpr_write_b32 a46, v13
v_accvgpr_write_b32 a47, v14
v_accvgpr_read_b32 v13, a48
v_accvgpr_read_b32 v14, a49
v_mul_f32 v13, v13, v10
v_mul_f32 v14, v14, v10
v_accvgpr_write_b32 a48, v13
v_accvgpr_write_b32 a49, v14
v_accvgpr_read_b32 v13, a50
v_accvgpr_read_b32 v14, a51
v_mul_f32 v13, v13, v10
v_mul_f32 v14, v14, v10
v_accvgpr_write_b32 a50, v13
v_accvgpr_write_b32 a51, v14
v_accvgpr_read_b32 v13, a52
v_accvgpr_read_b32 v14, a53
v_mul_f32 v13, v13, v11
v_mul_f32 v14, v14, v11
v_accvgpr_write_b32 a52, v13
v_accvgpr_write_b32 a53, v14
v_accvgpr_read_b32 v13, a54
v_accvgpr_read_b32 v14, a55
v_mul_f32 v13, v13, v11
v_mul_f32 v14, v14, v11
v_accvgpr_write_b32 a54, v13
v_accvgpr_write_b32 a55, v14
v_accvgpr_read_b32 v13, a56
v_accvgpr_read_b32 v14, a57
v_mul_f32 v13, v13, v10
v_mul_f32 v14, v14, v10
v_accvgpr_write_b32 a56, v13
v_accvgpr_write_b32 a57, v14
v_accvgpr_read_b32 v13, a58
v_accvgpr_read_b32 v14, a59
v_mul_f32 v13, v13, v10
v_mul_f32 v14, v14, v10
v_accvgpr_write_b32 a58, v13
v_accvgpr_write_b32 a59, v14
v_accvgpr_read_b32 v13, a60
v_accvgpr_read_b32 v14, a61
v_mul_f32 v13, v13, v11
v_mul_f32 v14, v14, v11
v_accvgpr_write_b32 a60, v13
v_accvgpr_write_b32 a61, v14
v_accvgpr_read_b32 v13, a62
v_accvgpr_read_b32 v14, a63
v_mul_f32 v13, v13, v11
v_mul_f32 v14, v14, v11
v_accvgpr_write_b32 a62, v13
v_accvgpr_write_b32 a63, v14
v_accvgpr_read_b32 v13, a64
v_accvgpr_read_b32 v14, a65
v_mul_f32 v13, v13, v10
v_mul_f32 v14, v14, v10
v_accvgpr_write_b32 a64, v13
v_accvgpr_write_b32 a65, v14
v_accvgpr_read_b32 v13, a66
v_accvgpr_read_b32 v14, a67
v_mul_f32 v13, v13, v10
v_mul_f32 v14, v14, v10
v_accvgpr_write_b32 a66, v13
v_accvgpr_write_b32 a67, v14
v_accvgpr_read_b32 v13, a68
v_accvgpr_read_b32 v14, a69
v_mul_f32 v13, v13, v11
v_mul_f32 v14, v14, v11
v_accvgpr_write_b32 a68, v13
v_accvgpr_write_b32 a69, v14
v_accvgpr_read_b32 v13, a70
v_accvgpr_read_b32 v14, a71
v_mul_f32 v13, v13, v11
v_mul_f32 v14, v14, v11
v_accvgpr_write_b32 a70, v13
v_accvgpr_write_b32 a71, v14
v_accvgpr_read_b32 v13, a72
v_accvgpr_read_b32 v14, a73
v_mul_f32 v13, v13, v10
v_mul_f32 v14, v14, v10
v_accvgpr_write_b32 a72, v13
v_accvgpr_write_b32 a73, v14
v_accvgpr_read_b32 v13, a74
v_accvgpr_read_b32 v14, a75
v_mul_f32 v13, v13, v10
v_mul_f32 v14, v14, v10
v_accvgpr_write_b32 a74, v13
v_accvgpr_write_b32 a75, v14
v_accvgpr_read_b32 v13, a76
v_accvgpr_read_b32 v14, a77
v_mul_f32 v13, v13, v11
v_mul_f32 v14, v14, v11
v_accvgpr_write_b32 a76, v13
v_accvgpr_write_b32 a77, v14
v_accvgpr_read_b32 v13, a78
v_accvgpr_read_b32 v14, a79
v_mul_f32 v13, v13, v11
v_mul_f32 v14, v14, v11
v_accvgpr_write_b32 a78, v13
v_accvgpr_write_b32 a79, v14
v_accvgpr_read_b32 v13, a80
v_accvgpr_read_b32 v14, a81
v_mul_f32 v13, v13, v10
v_mul_f32 v14, v14, v10
v_accvgpr_write_b32 a80, v13
v_accvgpr_write_b32 a81, v14
v_accvgpr_read_b32 v13, a82
v_accvgpr_read_b32 v14, a83
v_mul_f32 v13, v13, v10
v_mul_f32 v14, v14, v10
v_accvgpr_write_b32 a82, v13
v_accvgpr_write_b32 a83, v14
v_accvgpr_read_b32 v13, a84
v_accvgpr_read_b32 v14, a85
v_mul_f32 v13, v13, v11
v_mul_f32 v14, v14, v11
v_accvgpr_write_b32 a84, v13
v_accvgpr_write_b32 a85, v14
v_accvgpr_read_b32 v13, a86
v_accvgpr_read_b32 v14, a87
v_mul_f32 v13, v13, v11
v_mul_f32 v14, v14, v11
v_accvgpr_write_b32 a86, v13
v_accvgpr_write_b32 a87, v14
v_accvgpr_read_b32 v13, a88
v_accvgpr_read_b32 v14, a89
v_mul_f32 v13, v13, v10
v_mul_f32 v14, v14, v10
v_accvgpr_write_b32 a88, v13
v_accvgpr_write_b32 a89, v14
v_accvgpr_read_b32 v13, a90
v_accvgpr_read_b32 v14, a91
v_mul_f32 v13, v13, v10
v_mul_f32 v14, v14, v10
v_accvgpr_write_b32 a90, v13
v_accvgpr_write_b32 a91, v14
v_accvgpr_read_b32 v13, a92
v_accvgpr_read_b32 v14, a93
v_mul_f32 v13, v13, v11
v_mul_f32 v14, v14, v11
v_accvgpr_write_b32 a92, v13
v_accvgpr_write_b32 a93, v14
v_accvgpr_read_b32 v13, a94
v_accvgpr_read_b32 v14, a95
v_mul_f32 v13, v13, v11
v_mul_f32 v14, v14, v11
v_accvgpr_write_b32 a94, v13
v_accvgpr_write_b32 a95, v14
v_accvgpr_read_b32 v13, a96
v_accvgpr_read_b32 v14, a97
v_mul_f32 v13, v13, v10
v_mul_f32 v14, v14, v10
v_accvgpr_write_b32 a96, v13
v_accvgpr_write_b32 a97, v14
v_accvgpr_read_b32 v13, a98
v_accvgpr_read_b32 v14, a99
v_mul_f32 v13, v13, v10
v_mul_f32 v14, v14, v10
v_accvgpr_write_b32 a98, v13
v_accvgpr_write_b32 a99, v14
v_accvgpr_read_b32 v13, a100
v_accvgpr_read_b32 v14, a101
v_mul_f32 v13, v13, v11
v_mul_f32 v14, v14, v11
v_accvgpr_write_b32 a100, v13
v_accvgpr_write_b32 a101, v14
v_accvgpr_read_b32 v13, a102
v_accvgpr_read_b32 v14, a103
v_mul_f32 v13, v13, v11
v_mul_f32 v14, v14, v11
v_accvgpr_write_b32 a102, v13
v_accvgpr_write_b32 a103, v14
v_accvgpr_read_b32 v13, a104
v_accvgpr_read_b32 v14, a105
v_mul_f32 v13, v13, v10
v_mul_f32 v14, v14, v10
v_accvgpr_write_b32 a104, v13
v_accvgpr_write_b32 a105, v14
v_accvgpr_read_b32 v13, a106
v_accvgpr_read_b32 v14, a107
v_mul_f32 v13, v13, v10
v_mul_f32 v14, v14, v10
v_accvgpr_write_b32 a106, v13
v_accvgpr_write_b32 a107, v14
v_accvgpr_read_b32 v13, a108
v_accvgpr_read_b32 v14, a109
v_mul_f32 v13, v13, v11
v_mul_f32 v14, v14, v11
v_accvgpr_write_b32 a108, v13
v_accvgpr_write_b32 a109, v14
v_accvgpr_read_b32 v13, a110
v_accvgpr_read_b32 v14, a111
v_mul_f32 v13, v13, v11
v_mul_f32 v14, v14, v11
v_accvgpr_write_b32 a110, v13
v_accvgpr_write_b32 a111, v14
v_accvgpr_read_b32 v13, a112
v_accvgpr_read_b32 v14, a113
v_mul_f32 v13, v13, v10
v_mul_f32 v14, v14, v10
v_accvgpr_write_b32 a112, v13
v_accvgpr_write_b32 a113, v14
v_accvgpr_read_b32 v13, a114
v_accvgpr_read_b32 v14, a115
v_mul_f32 v13, v13, v10
v_mul_f32 v14, v14, v10
v_accvgpr_write_b32 a114, v13
v_accvgpr_write_b32 a115, v14
v_accvgpr_read_b32 v13, a116
v_accvgpr_read_b32 v14, a117
v_mul_f32 v13, v13, v11
v_mul_f32 v14, v14, v11
v_accvgpr_write_b32 a116, v13
v_accvgpr_write_b32 a117, v14
v_accvgpr_read_b32 v13, a118
v_accvgpr_read_b32 v14, a119
v_mul_f32 v13, v13, v11
v_mul_f32 v14, v14, v11
v_accvgpr_write_b32 a118, v13
v_accvgpr_write_b32 a119, v14
v_accvgpr_read_b32 v13, a120
v_accvgpr_read_b32 v14, a121
v_mul_f32 v13, v13, v10
v_mul_f32 v14, v14, v10
v_accvgpr_write_b32 a120, v13
v_accvgpr_write_b32 a121, v14
v_accvgpr_read_b32 v13, a122
v_accvgpr_read_b32 v14, a123
v_mul_f32 v13, v13, v10
v_mul_f32 v14, v14, v10
v_accvgpr_write_b32 a122, v13
v_accvgpr_write_b32 a123, v14
v_accvgpr_read_b32 v13, a124
v_accvgpr_read_b32 v14, a125
v_mul_f32 v13, v13, v11
v_mul_f32 v14, v14, v11
v_accvgpr_write_b32 a124, v13
v_accvgpr_write_b32 a125, v14
v_accvgpr_read_b32 v13, a126
v_accvgpr_read_b32 v14, a127
v_mul_f32 v13, v13, v11
v_mul_f32 v14, v14, v11
v_accvgpr_write_b32 a126, v13
v_accvgpr_write_b32 a127, v14
v_accvgpr_read_b32 v13, a128
v_accvgpr_read_b32 v14, a129
v_mul_f32 v13, v13, v10
v_mul_f32 v14, v14, v10
v_accvgpr_write_b32 a128, v13
v_accvgpr_write_b32 a129, v14
v_accvgpr_read_b32 v13, a130
v_accvgpr_read_b32 v14, a131
v_mul_f32 v13, v13, v10
v_mul_f32 v14, v14, v10
v_accvgpr_write_b32 a130, v13
v_accvgpr_write_b32 a131, v14
v_accvgpr_read_b32 v13, a132
v_accvgpr_read_b32 v14, a133
v_mul_f32 v13, v13, v11
v_mul_f32 v14, v14, v11
v_accvgpr_write_b32 a132, v13
v_accvgpr_write_b32 a133, v14
v_accvgpr_read_b32 v13, a134
v_accvgpr_read_b32 v14, a135
v_mul_f32 v13, v13, v11
v_mul_f32 v14, v14, v11
v_accvgpr_write_b32 a134, v13
v_accvgpr_write_b32 a135, v14
v_accvgpr_read_b32 v13, a136
v_accvgpr_read_b32 v14, a137
v_mul_f32 v13, v13, v10
v_mul_f32 v14, v14, v10
v_accvgpr_write_b32 a136, v13
v_accvgpr_write_b32 a137, v14
v_accvgpr_read_b32 v13, a138
v_accvgpr_read_b32 v14, a139
v_mul_f32 v13, v13, v10
v_mul_f32 v14, v14, v10
v_accvgpr_write_b32 a138, v13
v_accvgpr_write_b32 a139, v14
v_accvgpr_read_b32 v13, a140
v_accvgpr_read_b32 v14, a141
v_mul_f32 v13, v13, v11
v_mul_f32 v14, v14, v11
v_accvgpr_write_b32 a140, v13
v_accvgpr_write_b32 a141, v14
v_accvgpr_read_b32 v13, a142
v_accvgpr_read_b32 v14, a143
v_mul_f32 v13, v13, v11
v_mul_f32 v14, v14, v11
v_accvgpr_write_b32 a142, v13
v_accvgpr_write_b32 a143, v14
v_accvgpr_read_b32 v13, a144
v_accvgpr_read_b32 v14, a145
v_mul_f32 v13, v13, v10
v_mul_f32 v14, v14, v10
v_accvgpr_write_b32 a144, v13
v_accvgpr_write_b32 a145, v14
v_accvgpr_read_b32 v13, a146
v_accvgpr_read_b32 v14, a147
v_mul_f32 v13, v13, v10
v_mul_f32 v14, v14, v10
v_accvgpr_write_b32 a146, v13
v_accvgpr_write_b32 a147, v14
v_accvgpr_read_b32 v13, a148
v_accvgpr_read_b32 v14, a149
v_mul_f32 v13, v13, v11
v_mul_f32 v14, v14, v11
v_accvgpr_write_b32 a148, v13
v_accvgpr_write_b32 a149, v14
v_accvgpr_read_b32 v13, a150
v_accvgpr_read_b32 v14, a151
v_mul_f32 v13, v13, v11
v_mul_f32 v14, v14, v11
v_accvgpr_write_b32 a150, v13
v_accvgpr_write_b32 a151, v14
v_accvgpr_read_b32 v13, a152
v_accvgpr_read_b32 v14, a153
v_mul_f32 v13, v13, v10
v_mul_f32 v14, v14, v10
v_accvgpr_write_b32 a152, v13
v_accvgpr_write_b32 a153, v14
v_accvgpr_read_b32 v13, a154
v_accvgpr_read_b32 v14, a155
v_mul_f32 v13, v13, v10
v_mul_f32 v14, v14, v10
v_accvgpr_write_b32 a154, v13
v_accvgpr_write_b32 a155, v14
v_accvgpr_read_b32 v13, a156
v_accvgpr_read_b32 v14, a157
v_mul_f32 v13, v13, v11
v_mul_f32 v14, v14, v11
v_accvgpr_write_b32 a156, v13
v_accvgpr_write_b32 a157, v14
v_accvgpr_read_b32 v13, a158
v_accvgpr_read_b32 v14, a159
v_mul_f32 v13, v13, v11
v_mul_f32 v14, v14, v11
v_accvgpr_write_b32 a158, v13
v_accvgpr_write_b32 a159, v14
v_accvgpr_read_b32 v13, a160
v_accvgpr_read_b32 v14, a161
v_mul_f32 v13, v13, v10
v_mul_f32 v14, v14, v10
v_accvgpr_write_b32 a160, v13
v_accvgpr_write_b32 a161, v14
v_accvgpr_read_b32 v13, a162
v_accvgpr_read_b32 v14, a163
v_mul_f32 v13, v13, v10
v_mul_f32 v14, v14, v10
v_accvgpr_write_b32 a162, v13
v_accvgpr_write_b32 a163, v14
v_accvgpr_read_b32 v13, a164
v_accvgpr_read_b32 v14, a165
v_mul_f32 v13, v13, v11
v_mul_f32 v14, v14, v11
v_accvgpr_write_b32 a164, v13
v_accvgpr_write_b32 a165, v14
v_accvgpr_read_b32 v13, a166
v_accvgpr_read_b32 v14, a167
v_mul_f32 v13, v13, v11
v_mul_f32 v14, v14, v11
v_accvgpr_write_b32 a166, v13
v_accvgpr_write_b32 a167, v14
v_accvgpr_read_b32 v13, a168
v_accvgpr_read_b32 v14, a169
v_mul_f32 v13, v13, v10
v_mul_f32 v14, v14, v10
v_accvgpr_write_b32 a168, v13
v_accvgpr_write_b32 a169, v14
v_accvgpr_read_b32 v13, a170
v_accvgpr_read_b32 v14, a171
v_mul_f32 v13, v13, v10
v_mul_f32 v14, v14, v10
v_accvgpr_write_b32 a170, v13
v_accvgpr_write_b32 a171, v14
v_accvgpr_read_b32 v13, a172
v_accvgpr_read_b32 v14, a173
v_mul_f32 v13, v13, v11
v_mul_f32 v14, v14, v11
v_accvgpr_write_b32 a172, v13
v_accvgpr_write_b32 a173, v14
v_accvgpr_read_b32 v13, a174
v_accvgpr_read_b32 v14, a175
v_mul_f32 v13, v13, v11
v_mul_f32 v14, v14, v11
v_accvgpr_write_b32 a174, v13
v_accvgpr_write_b32 a175, v14
v_accvgpr_read_b32 v13, a176
v_accvgpr_read_b32 v14, a177
v_mul_f32 v13, v13, v10
v_mul_f32 v14, v14, v10
v_accvgpr_write_b32 a176, v13
v_accvgpr_write_b32 a177, v14
v_accvgpr_read_b32 v13, a178
v_accvgpr_read_b32 v14, a179
v_mul_f32 v13, v13, v10
v_mul_f32 v14, v14, v10
v_accvgpr_write_b32 a178, v13
v_accvgpr_write_b32 a179, v14
v_accvgpr_read_b32 v13, a180
v_accvgpr_read_b32 v14, a181
v_mul_f32 v13, v13, v11
v_mul_f32 v14, v14, v11
v_accvgpr_write_b32 a180, v13
v_accvgpr_write_b32 a181, v14
v_accvgpr_read_b32 v13, a182
v_accvgpr_read_b32 v14, a183
v_mul_f32 v13, v13, v11
v_mul_f32 v14, v14, v11
v_accvgpr_write_b32 a182, v13
v_accvgpr_write_b32 a183, v14
v_accvgpr_read_b32 v13, a184
v_accvgpr_read_b32 v14, a185
v_mul_f32 v13, v13, v10
v_mul_f32 v14, v14, v10
v_accvgpr_write_b32 a184, v13
v_accvgpr_write_b32 a185, v14
v_accvgpr_read_b32 v13, a186
v_accvgpr_read_b32 v14, a187
v_mul_f32 v13, v13, v10
v_mul_f32 v14, v14, v10
v_accvgpr_write_b32 a186, v13
v_accvgpr_write_b32 a187, v14
v_accvgpr_read_b32 v13, a188
v_accvgpr_read_b32 v14, a189
v_mul_f32 v13, v13, v11
v_mul_f32 v14, v14, v11
v_accvgpr_write_b32 a188, v13
v_accvgpr_write_b32 a189, v14
v_accvgpr_read_b32 v13, a190
v_accvgpr_read_b32 v14, a191
v_mul_f32 v13, v13, v11
v_mul_f32 v14, v14, v11
v_accvgpr_write_b32 a190, v13
v_accvgpr_write_b32 a191, v14
v_accvgpr_read_b32 v13, a192
v_accvgpr_read_b32 v14, a193
v_mul_f32 v13, v13, v10
v_mul_f32 v14, v14, v10
v_accvgpr_write_b32 a192, v13
v_accvgpr_write_b32 a193, v14
v_accvgpr_read_b32 v13, a194
v_accvgpr_read_b32 v14, a195
v_mul_f32 v13, v13, v10
v_mul_f32 v14, v14, v10
v_accvgpr_write_b32 a194, v13
v_accvgpr_write_b32 a195, v14
v_accvgpr_read_b32 v13, a196
v_accvgpr_read_b32 v14, a197
v_mul_f32 v13, v13, v11
v_mul_f32 v14, v14, v11
v_accvgpr_write_b32 a196, v13
v_accvgpr_write_b32 a197, v14
v_accvgpr_read_b32 v13, a198
v_accvgpr_read_b32 v14, a199
v_mul_f32 v13, v13, v11
v_mul_f32 v14, v14, v11
v_accvgpr_write_b32 a198, v13
v_accvgpr_write_b32 a199, v14
v_accvgpr_read_b32 v13, a200
v_accvgpr_read_b32 v14, a201
v_mul_f32 v13, v13, v10
v_mul_f32 v14, v14, v10
v_accvgpr_write_b32 a200, v13
v_accvgpr_write_b32 a201, v14
v_accvgpr_read_b32 v13, a202
v_accvgpr_read_b32 v14, a203
v_mul_f32 v13, v13, v10
v_mul_f32 v14, v14, v10
v_accvgpr_write_b32 a202, v13
v_accvgpr_write_b32 a203, v14
v_accvgpr_read_b32 v13, a204
v_accvgpr_read_b32 v14, a205
v_mul_f32 v13, v13, v11
v_mul_f32 v14, v14, v11
v_accvgpr_write_b32 a204, v13
v_accvgpr_write_b32 a205, v14
v_accvgpr_read_b32 v13, a206
v_accvgpr_read_b32 v14, a207
v_mul_f32 v13, v13, v11
v_mul_f32 v14, v14, v11
v_accvgpr_write_b32 a206, v13
v_accvgpr_write_b32 a207, v14
v_accvgpr_read_b32 v13, a208
v_accvgpr_read_b32 v14, a209
v_mul_f32 v13, v13, v10
v_mul_f32 v14, v14, v10
v_accvgpr_write_b32 a208, v13
v_accvgpr_write_b32 a209, v14
v_accvgpr_read_b32 v13, a210
v_accvgpr_read_b32 v14, a211
v_mul_f32 v13, v13, v10
v_mul_f32 v14, v14, v10
v_accvgpr_write_b32 a210, v13
v_accvgpr_write_b32 a211, v14
v_accvgpr_read_b32 v13, a212
v_accvgpr_read_b32 v14, a213
v_mul_f32 v13, v13, v11
v_mul_f32 v14, v14, v11
v_accvgpr_write_b32 a212, v13
v_accvgpr_write_b32 a213, v14
v_accvgpr_read_b32 v13, a214
v_accvgpr_read_b32 v14, a215
v_mul_f32 v13, v13, v11
v_mul_f32 v14, v14, v11
v_accvgpr_write_b32 a214, v13
v_accvgpr_write_b32 a215, v14
v_accvgpr_read_b32 v13, a216
v_accvgpr_read_b32 v14, a217
v_mul_f32 v13, v13, v10
v_mul_f32 v14, v14, v10
v_accvgpr_write_b32 a216, v13
v_accvgpr_write_b32 a217, v14
v_accvgpr_read_b32 v13, a218
v_accvgpr_read_b32 v14, a219
v_mul_f32 v13, v13, v10
v_mul_f32 v14, v14, v10
v_accvgpr_write_b32 a218, v13
v_accvgpr_write_b32 a219, v14
v_accvgpr_read_b32 v13, a220
v_accvgpr_read_b32 v14, a221
v_mul_f32 v13, v13, v11
v_mul_f32 v14, v14, v11
v_accvgpr_write_b32 a220, v13
v_accvgpr_write_b32 a221, v14
v_accvgpr_read_b32 v13, a222
v_accvgpr_read_b32 v14, a223
v_mul_f32 v13, v13, v11
v_mul_f32 v14, v14, v11
v_accvgpr_write_b32 a222, v13
v_accvgpr_write_b32 a223, v14
v_accvgpr_read_b32 v13, a224
v_accvgpr_read_b32 v14, a225
v_mul_f32 v13, v13, v10
v_mul_f32 v14, v14, v10
v_accvgpr_write_b32 a224, v13
v_accvgpr_write_b32 a225, v14
v_accvgpr_read_b32 v13, a226
v_accvgpr_read_b32 v14, a227
v_mul_f32 v13, v13, v10
v_mul_f32 v14, v14, v10
v_accvgpr_write_b32 a226, v13
v_accvgpr_write_b32 a227, v14
v_accvgpr_read_b32 v13, a228
v_accvgpr_read_b32 v14, a229
v_mul_f32 v13, v13, v11
v_mul_f32 v14, v14, v11
v_accvgpr_write_b32 a228, v13
v_accvgpr_write_b32 a229, v14
v_accvgpr_read_b32 v13, a230
v_accvgpr_read_b32 v14, a231
v_mul_f32 v13, v13, v11
v_mul_f32 v14, v14, v11
v_accvgpr_write_b32 a230, v13
v_accvgpr_write_b32 a231, v14
v_accvgpr_read_b32 v13, a232
v_accvgpr_read_b32 v14, a233
v_mul_f32 v13, v13, v10
v_mul_f32 v14, v14, v10
v_accvgpr_write_b32 a232, v13
v_accvgpr_write_b32 a233, v14
v_accvgpr_read_b32 v13, a234
v_accvgpr_read_b32 v14, a235
v_mul_f32 v13, v13, v10
v_mul_f32 v14, v14, v10
v_accvgpr_write_b32 a234, v13
v_accvgpr_write_b32 a235, v14
v_accvgpr_read_b32 v13, a236
v_accvgpr_read_b32 v14, a237
v_mul_f32 v13, v13, v11
v_mul_f32 v14, v14, v11
v_accvgpr_write_b32 a236, v13
v_accvgpr_write_b32 a237, v14
v_accvgpr_read_b32 v13, a238
v_accvgpr_read_b32 v14, a239
v_mul_f32 v13, v13, v11
v_mul_f32 v14, v14, v11
v_accvgpr_write_b32 a238, v13
v_accvgpr_write_b32 a239, v14
v_accvgpr_read_b32 v13, a240
v_accvgpr_read_b32 v14, a241
v_mul_f32 v13, v13, v10
v_mul_f32 v14, v14, v10
v_accvgpr_write_b32 a240, v13
v_accvgpr_write_b32 a241, v14
v_accvgpr_read_b32 v13, a242
v_accvgpr_read_b32 v14, a243
v_mul_f32 v13, v13, v10
v_mul_f32 v14, v14, v10
v_accvgpr_write_b32 a242, v13
v_accvgpr_write_b32 a243, v14
v_accvgpr_read_b32 v13, a244
v_accvgpr_read_b32 v14, a245
v_mul_f32 v13, v13, v11
v_mul_f32 v14, v14, v11
v_accvgpr_write_b32 a244, v13
v_accvgpr_write_b32 a245, v14
v_accvgpr_read_b32 v13, a246
v_accvgpr_read_b32 v14, a247
v_mul_f32 v13, v13, v11
v_mul_f32 v14, v14, v11
v_accvgpr_write_b32 a246, v13
v_accvgpr_write_b32 a247, v14
v_accvgpr_read_b32 v13, a248
v_accvgpr_read_b32 v14, a249
v_mul_f32 v13, v13, v10
v_mul_f32 v14, v14, v10
v_accvgpr_write_b32 a248, v13
v_accvgpr_write_b32 a249, v14
v_accvgpr_read_b32 v13, a250
v_accvgpr_read_b32 v14, a251
v_mul_f32 v13, v13, v10
v_mul_f32 v14, v14, v10
v_accvgpr_write_b32 a250, v13
v_accvgpr_write_b32 a251, v14
v_accvgpr_read_b32 v13, a252
v_accvgpr_read_b32 v14, a253
v_mul_f32 v13, v13, v11
v_mul_f32 v14, v14, v11
v_accvgpr_write_b32 a252, v13
v_accvgpr_write_b32 a253, v14
v_accvgpr_read_b32 v13, a254
v_accvgpr_read_b32 v14, a255
v_mul_f32 v13, v13, v11
v_mul_f32 v14, v14, v11
v_accvgpr_write_b32 a254, v13
v_accvgpr_write_b32 a255, v14
s_nop 3
s_cmp_eq_u32 s42, 0
s_cbranch_scc1 L_B0
s_cmp_eq_u32 s42, 1
s_cbranch_scc1 L_B1
s_cmp_eq_u32 s42, 2
s_cbranch_scc1 L_B2
s_cmp_eq_u32 s42, 3
s_cbranch_scc1 L_B3
s_branch L_B4
L_sp2:
v_mfma_f32_16x16x32_bf16 v[32:35], v[64:67], v[128:131], v[48:51]
ds_read_b128 v[92:95], v4 offset:49968
v_mfma_f32_16x16x32_bf16 v[40:43], v[64:67], v[132:135], v[52:55]
v_exp_f32_e64 v16, v16
v_mfma_f32_16x16x32_bf16 v[36:39], v[68:71], v[128:131], v[48:51]
ds_read_b128 v[64:67], v4 offset:33344
v_mfma_f32_16x16x32_bf16 v[44:47], v[68:71], v[132:135], v[52:55]
s_waitcnt lgkmcnt(5)
v_exp_f32 v17, v17
v_mfma_f32_16x16x32_bf16 v[32:35], v[72:75], v[136:139], v[32:35]
ds_read_b128 v[68:71], v4 offset:49984
v_cvt_pk_bf16_f32 v56, v16, v17
v_mfma_f32_16x16x32_bf16 v[40:43], v[72:75], v[140:143], v[40:43]
buffer_load_dwordx4 v[112:115], v1, s[56:59], s46 offen offset:2048 sc1
v_mfma_f32_16x16x32_bf16 v[36:39], v[76:79], v[136:139], v[36:39]
ds_read_b128 v[72:75], v4 offset:33360
v_mfma_f32_16x16x32_bf16 v[44:47], v[76:79], v[140:143], v[44:47]
s_waitcnt lgkmcnt(5)
v_exp_f32 v18, v18
v_mfma_f32_16x16x32_bf16 v[32:35], v[80:83], v[144:147], v[32:35]
ds_read_b128 v[76:79], v4 offset:50000
v_mfma_f32_16x16x32_bf16 v[40:43], v[80:83], v[148:151], v[40:43]
buffer_load_dwordx4 v[116:119], v1, s[56:59], s47 offen offset:2048 sc1
v_mfma_f32_16x16x32_bf16 v[36:39], v[84:87], v[144:147], v[36:39]
ds_read_b128 v[80:83], v4 offset:33376
v_mfma_f32_16x16x32_bf16 v[44:47], v[84:87], v[148:151], v[44:47]
s_waitcnt lgkmcnt(5)
v_exp_f32 v19, v19
v_mfma_f32_16x16x32_bf16 v[32:35], v[88:91], v[152:155], v[32:35]
ds_read_b128 v[84:87], v4 offset:50016
v_cvt_pk_bf16_f32 v57, v18, v19
v_mfma_f32_16x16x32_bf16 v[40:43], v[88:91], v[156:159], v[40:43]
buffer_load_dwordx4 v[120:123], v1, s[56:59], s46 offen offset:3072 sc1
v_mfma_f32_16x16x32_bf16 v[36:39], v[92:95], v[152:155], v[36:39]
ds_read_b128 v[88:91], v4 offset:33392
v_mfma_f32_16x16x32_bf16 v[44:47], v[92:95], v[156:159], v[44:47]
s_waitcnt lgkmcnt(5)
v_exp_f32 v20, v20
v_mfma_f32_16x16x32_bf16 v[32:35], v[64:67], v[160:163], v[32:35]
ds_read_b128 v[92:95], v4 offset:50032
v_mfma_f32_16x16x32_bf16 v[40:43], v[64:67], v[164:167], v[40:43]
buffer_load_dwordx4 v[124:127], v1, s[56:59], s47 offen offset:3072 sc1
v_mfma_f32_16x16x32_bf16 v[36:39], v[68:71], v[160:163], v[36:39]
ds_read_b128 v[64:67], v4 offset:33408
v_mfma_f32_16x16x32_bf16 v[44:47], v[68:71], v[164:167], v[44:47]
s_waitcnt lgkmcnt(5)
v_exp_f32 v21, v21
v_mfma_f32_16x16x32_bf16 v[32:35], v[72:75], v[168:171], v[32:35]
ds_read_b128 v[68:71], v4 offset:50048
v_cvt_pk_bf16_f32 v58, v20, v21
v_mfma_f32_16x16x32_bf16 v[40:43], v[72:75], v[172:175], v[40:43]
buffer_load_dwordx4 v[128:131], v1, s[64:67], s39 offen offset:0 sc1
v_mfma_f32_16x16x32_bf16 v[36:39], v[76:79], v[168:171], v[36:39]
ds_read_b128 v[72:75], v4 offset:33424
v_mfma_f32_16x16x32_bf16 v[44:47], v[76:79], v[172:175], v[44:47]
s_waitcnt lgkmcnt(5)
v_exp_f32 v22, v22
v_mfma_f32_16x16x32_bf16 v[32:35], v[80:83], v[176:179], v[32:35]
ds_read_b128 v[76:79], v4 offset:50064
v_mfma_f32_16x16x32_bf16 v[40:43], v[80:83], v[180:183], v[40:43]
buffer_load_dwordx4 v[132:135], v1, s[64:67], s39 offen offset:1024 sc1
v_mfma_f32_16x16x32_bf16 v[36:39], v[84:87], v[176:179], v[36:39]
ds_read_b128 v[80:83], v4 offset:33440
v_mfma_f32_16x16x32_bf16 v[44:47], v[84:87], v[180:183], v[44:47]
s_waitcnt lgkmcnt(5)
v_exp_f32 v23, v23
v_mfma_f32_16x16x32_bf16 v[32:35], v[88:91], v[184:187], v[32:35]
ds_read_b128 v[84:87], v4 offset:50080
v_cvt_pk_bf16_f32 v59, v22, v23
v_mfma_f32_16x16x32_bf16 v[40:43], v[88:91], v[188:191], v[40:43]
buffer_load_dwordx4 v[136:139], v1, s[64:67], s39 offen offset:2048 sc1
v_mfma_f32_16x16x32_bf16 v[36:39], v[92:95], v[184:187], v[36:39]
ds_read_b128 v[88:91], v4 offset:33456
v_mfma_f32_16x16x32_bf16 v[44:47], v[92:95], v[188:191], v[44:47]
s_waitcnt lgkmcnt(5)
v_exp_f32 v24, v24
v_mfma_f32_16x16x32_bf16 v[32:35], v[64:67], v[192:195], v[32:35]
ds_read_b128 v[92:95], v4 offset:50096
v_mfma_f32_16x16x32_bf16 v[40:43], v[64:67], v[196:199], v[40:43]
buffer_load_dwordx4 v[140:143], v1, s[64:67], s39 offen offset:3072 sc1
v_mfma_f32_16x16x32_bf16 v[36:39], v[68:71], v[192:195], v[36:39]
ds_read_b128 v[64:67], v4 offset:33472
v_mfma_f32_16x16x32_bf16 v[44:47], v[68:71], v[196:199], v[44:47]
s_waitcnt lgkmcnt(5)
v_exp_f32 v25, v25
v_mfma_f32_16x16x32_bf16 v[32:35], v[72:75], v[200:203], v[32:35]
ds_read_b128 v[68:71], v4 offset:50112
v_cvt_pk_bf16_f32 v60, v24, v25
v_mfma_f32_16x16x32_bf16 v[40:43], v[72:75], v[204:207], v[40:43]
s_add_u32 s39, s39, 4096
buffer_load_dwordx4 v[144:147], v1, s[64:67], s39 offen offset:0 sc1
v_mfma_f32_16x16x32_bf16 v[36:39], v[76:79], v[200:203], v[36:39]
ds_read_b128 v[72:75], v4 offset:33488
v_mfma_f32_16x16x32_bf16 v[44:47], v[76:79], v[204:207], v[44:47]
s_waitcnt lgkmcnt(5)
v_exp_f32 v26, v26
v_mfma_f32_16x16x32_bf16 v[32:35], v[80:83], v[208:211], v[32:35]
ds_read_b128 v[76:79], v4 offset:50128
v_mfma_f32_16x16x32_bf16 v[40:43], v[80:83], v[212:215], v[40:43]
v_exp_f32_e64 v27, v27
v_mfma_f32_16x16x32_bf16 v[36:39], v[84:87], v[208:211], v[36:39]
ds_read_b128 v[80:83], v4 offset:33504
v_cvt_pk_bf16_f32 v61, v26, v27
v_mfma_f32_16x16x32_bf16 v[44:47], v[84:87], v[212:215], v[44:47]
s_waitcnt lgkmcnt(5)
v_exp_f32 v28, v28
v_mfma_f32_16x16x32_bf16 v[32:35], v[88:91], v[216:219], v[32:35]
ds_read_b128 v[84:87], v4 offset:50144
v_mfma_f32_16x16x32_bf16 v[40:43], v[88:91], v[220:223], v[40:43]
v_exp_f32_e64 v29, v29
v_mfma_f32_16x16x32_bf16 v[36:39], v[92:95], v[216:219], v[36:39]
ds_read_b128 v[88:91], v4 offset:33520
v_cvt_pk_bf16_f32 v62, v28, v29
v_mfma_f32_16x16x32_bf16 v[44:47], v[92:95], v[220:223], v[44:47]
s_waitcnt lgkmcnt(5)
v_exp_f32 v30, v30
v_mfma_f32_16x16x32_bf16 v[32:35], v[64:67], v[224:227], v[32:35]
ds_read_b128 v[92:95], v4 offset:50160
v_mfma_f32_16x16x32_bf16 v[40:43], v[64:67], v[228:231], v[40:43]
v_exp_f32_e64 v31, v31
v_mfma_f32_16x16x32_bf16 v[36:39], v[68:71], v[224:227], v[36:39]
ds_read_b64_tr_b16 v[64:65], v5 offset:0
v_cvt_pk_bf16_f32 v63, v30, v31
v_mfma_f32_16x16x32_bf16 v[44:47], v[68:71], v[228:231], v[44:47]
s_waitcnt lgkmcnt(5)
s_nop 0
ds_read_b64_tr_b16 v[66:67], v5 offset:16640
v_mfma_f32_16x16x32_bf16 v[32:35], v[72:75], v[232:235], v[32:35]
ds_read_b64_tr_b16 v[68:69], v5 offset:32
v_add_f32_e64 v8, v8, v16
v_mfma_f32_16x16x32_bf16 v[40:43], v[72:75], v[236:239], v[40:43]
ds_read_b64_tr_b16 v[70:71], v5 offset:16672
buffer_load_dwordx4 v[148:151], v1, s[64:67], s39 offen offset:1024 sc1
v_add_f32_e64 v8, v8, v17
v_mfma_f32_16x16x32_bf16 v[36:39], v[76:79], v[232:235], v[36:39]
ds_read_b64_tr_b16 v[72:73], v5 offset:64
v_add_f32_e64 v8, v8, v18
v_mfma_f32_16x16x32_bf16 v[44:47], v[76:79], v[236:239], v[44:47]
s_waitcnt lgkmcnt(7)
s_nop 0
ds_read_b64_tr_b16 v[74:75], v5 offset:16704
v_mfma_f32_16x16x32_bf16 v[32:35], v[80:83], v[240:243], v[32:35]
ds_read_b64_tr_b16 v[76:77], v5 offset:96
v_add_f32_e64 v8, v8, v19
v_mfma_f32_16x16x32_bf16 v[40:43], v[80:83], v[244:247], v[40:43]
ds_read_b64_tr_b16 v[78:79], v5 offset:16736
buffer_load_dwordx4 v[152:155], v1, s[64:67], s39 offen offset:2048 sc1
v_add_f32_e64 v8, v8, v20
v_mfma_f32_16x16x32_bf16 v[36:39], v[84:87], v[240:243], v[36:39]
ds_read_b64_tr_b16 v[80:81], v5 offset:128
v_add_f32_e64 v8, v8, v21
v_mfma_f32_16x16x32_bf16 v[44:47], v[84:87], v[244:247], v[44:47]
s_waitcnt lgkmcnt(9)
s_nop 0
ds_read_b64_tr_b16 v[82:83], v5 offset:16768
v_mfma_f32_16x16x32_bf16 v[32:35], v[88:91], v[248:251], v[32:35]
ds_read_b64_tr_b16 v[84:85], v5 offset:160
v_add_f32_e64 v8, v8, v22
v_mfma_f32_16x16x32_bf16 v[40:43], v[88:91], v[252:255], v[40:43]
ds_read_b64_tr_b16 v[86:87], v5 offset:16800
buffer_load_dwordx4 v[156:159], v1, s[64:67], s39 offen offset:3072 sc1
v_add_f32_e64 v8, v8, v23
v_mfma_f32_16x16x32_bf16 v[36:39], v[92:95], v[248:251], v[36:39]
ds_read_b64_tr_b16 v[88:89], v5 offset:192
v_add_f32_e64 v9, v9, v24
v_mfma_f32_16x16x32_bf16 v[44:47], v[92:95], v[252:255], v[44:47]
s_waitcnt lgkmcnt(9)
s_nop 0
ds_read_b64_tr_b16 v[90:91], v5 offset:16832
v_mfma_f32_16x16x32_bf16 a[0:3], v[64:67], v[56:59], a[0:3]
ds_read_b64_tr_b16 v[92:93], v5 offset:224
v_add_f32_e64 v9, v9, v25
v_mfma_f32_16x16x32_bf16 a[4:7], v[64:67], v[60:63], a[4:7]
s_add_u32 s39, s39, 4096
ds_read_b64_tr_b16 v[94:95], v5 offset:16864
buffer_load_dwordx4 v[160:163], v1, s[64:67], s39 offen offset:0 sc1
v_add_f32_e64 v9, v9, v26
v_mfma_f32_16x16x32_bf16 a[8:11], v[68:71], v[56:59], a[8:11]
ds_read_b64_tr_b16 v[64:65], v5 offset:256
v_add_f32_e64 v9, v9, v27
v_mfma_f32_16x16x32_bf16 a[12:15], v[68:71], v[60:63], a[12:15]
s_waitcnt lgkmcnt(9)
s_nop 0
ds_read_b64_tr_b16 v[66:67], v5 offset:16896
v_mfma_f32_16x16x32_bf16 a[16:19], v[72:75], v[56:59], a[16:19]
ds_read_b64_tr_b16 v[68:69], v5 offset:288
v_add_f32_e64 v9, v9, v28
v_mfma_f32_16x16x32_bf16 a[20:23], v[72:75], v[60:63], a[20:23]
ds_read_b64_tr_b16 v[70:71], v5 offset:16928
buffer_load_dwordx4 v[164:167], v1, s[64:67], s39 offen offset:1024 sc1
v_add_f32_e64 v9, v9, v29
v_mfma_f32_16x16x32_bf16 a[24:27], v[76:79], v[56:59], a[24:27]
ds_read_b64_tr_b16 v[72:73], v5 offset:320
v_add_f32_e64 v9, v9, v30
v_mfma_f32_16x16x32_bf16 a[28:31], v[76:79], v[60:63], a[28:31]
s_waitcnt lgkmcnt(9)
s_nop 0
ds_read_b64_tr_b16 v[74:75], v5 offset:16960
v_mfma_f32_16x16x32_bf16 a[32:35], v[80:83], v[56:59], a[32:35]
ds_read_b64_tr_b16 v[76:77], v5 offset:352
v_add_f32_e64 v9, v9, v31
v_mfma_f32_16x16x32_bf16 a[36:39], v[80:83], v[60:63], a[36:39]
ds_read_b64_tr_b16 v[78:79], v5 offset:16992
buffer_load_dwordx4 v[168:171], v1, s[64:67], s39 offen offset:2048 sc1
v_max3_f32 v10, v32, v33, v34
v_mfma_f32_16x16x32_bf16 a[40:43], v[84:87], v[56:59], a[40:43]
ds_read_b64_tr_b16 v[80:81], v5 offset:384
v_max3_f32 v11, v40, v41, v42
v_mfma_f32_16x16x32_bf16 a[44:47], v[84:87], v[60:63], a[44:47]
s_waitcnt lgkmcnt(9)
s_nop 0
ds_read_b64_tr_b16 v[82:83], v5 offset:17024
v_mfma_f32_16x16x32_bf16 a[48:51], v[88:91], v[56:59], a[48:51]
ds_read_b64_tr_b16 v[84:85], v5 offset:416
v_max3_f32 v10, v10, v35, v36
v_mfma_f32_16x16x32_bf16 a[52:55], v[88:91], v[60:63], a[52:55]
ds_read_b64_tr_b16 v[86:87], v5 offset:17056
buffer_load_dwordx4 v[172:175], v1, s[64:67], s39 offen offset:3072 sc1
v_max3_f32 v11, v11, v43, v44
v_mfma_f32_16x16x32_bf16 a[56:59], v[92:95], v[56:59], a[56:59]
ds_read_b64_tr_b16 v[88:89], v5 offset:448
v_max3_f32 v10, v10, v37, v38
v_mfma_f32_16x16x32_bf16 a[60:63], v[92:95], v[60:63], a[60:63]
s_waitcnt lgkmcnt(9)
s_nop 0
ds_read_b64_tr_b16 v[90:91], v5 offset:17088
v_mfma_f32_16x16x32_bf16 a[64:67], v[64:67], v[56:59], a[64:67]
ds_read_b64_tr_b16 v[92:93], v5 offset:480
v_max3_f32 v11, v11, v45, v46
v_mfma_f32_16x16x32_bf16 a[68:71], v[64:67], v[60:63], a[68:71]
s_add_u32 s39, s39, 4096
ds_read_b64_tr_b16 v[94:95], v5 offset:17120
buffer_load_dwordx4 v[176:179], v1, s[64:67], s39 offen offset:0 sc1
v_max_f32_e64 v10, v10, v39
v_mfma_f32_16x16x32_bf16 a[72:75], v[68:71], v[56:59], a[72:75]
ds_read_b64_tr_b16 v[64:65], v5 offset:512
v_max_f32_e64 v11, v11, v47
v_mfma_f32_16x16x32_bf16 a[76:79], v[68:71], v[60:63], a[76:79]
s_waitcnt lgkmcnt(9)
s_nop 0
ds_read_b64_tr_b16 v[66:67], v5 offset:17152
v_mfma_f32_16x16x32_bf16 a[80:83], v[72:75], v[56:59], a[80:83]
ds_read_b64_tr_b16 v[68:69], v5 offset:544
v_max_f32_e64 v15, v10, v11
v_mfma_f32_16x16x32_bf16 a[84:87], v[72:75], v[60:63], a[84:87]
ds_read_b64_tr_b16 v[70:71], v5 offset:17184
buffer_load_dwordx4 v[180:183], v1, s[64:67], s39 offen offset:1024 sc1
v_mfma_f32_16x16x32_bf16 a[88:91], v[76:79], v[56:59], a[88:91]
ds_read_b64_tr_b16 v[72:73], v5 offset:576
v_mfma_f32_16x16x32_bf16 a[92:95], v[76:79], v[60:63], a[92:95]
s_waitcnt lgkmcnt(9)
s_nop 0
ds_read_b64_tr_b16 v[74:75], v5 offset:17216
v_mfma_f32_16x16x32_bf16 a[96:99], v[80:83], v[56:59], a[96:99]
ds_read_b64_tr_b16 v[76:77], v5 offset:608
v_mfma_f32_16x16x32_bf16 a[100:103], v[80:83], v[60:63], a[100:103]
ds_read_b64_tr_b16 v[78:79], v5 offset:17248
buffer_load_dwordx4 v[184:187], v1, s[64:67], s39 offen offset:2048 sc1
v_mfma_f32_16x16x32_bf16 a[104:107], v[84:87], v[56:59], a[104:107]
ds_read_b64_tr_b16 v[80:81], v5 offset:640
v_mfma_f32_16x16x32_bf16 a[108:111], v[84:87], v[60:63], a[108:111]
s_waitcnt lgkmcnt(9)
s_nop 0
ds_read_b64_tr_b16 v[82:83], v5 offset:17280
v_mfma_f32_16x16x32_bf16 a[112:115], v[88:91], v[56:59], a[112:115]
ds_read_b64_tr_b16 v[84:85], v5 offset:672
v_mfma_f32_16x16x32_bf16 a[116:119], v[88:91], v[60:63], a[116:119]
ds_read_b64_tr_b16 v[86:87], v5 offset:17312
buffer_load_dwordx4 v[188:191], v1, s[64:67], s39 offen offset:3072 sc1
v_mfma_f32_16x16x32_bf16 a[120:123], v[92:95], v[56:59], a[120:123]
ds_read_b64_tr_b16 v[88:89], v5 offset:704
v_mfma_f32_16x16x32_bf16 a[124:127], v[92:95], v[60:63], a[124:127]
s_waitcnt lgkmcnt(9)
s_nop 0
ds_read_b64_tr_b16 v[90:91], v5 offset:17344
v_mfma_f32_16x16x32_bf16 a[128:131], v[64:67], v[56:59], a[128:131]
ds_read_b64_tr_b16 v[92:93], v5 offset:736
v_mfma_f32_16x16x32_bf16 a[132:135], v[64:67], v[60:63], a[132:135]
ds_read_b64_tr_b16 v[94:95], v5 offset:17376
buffer_load_dwordx4 v[96:99], v1, s[56:59], s46 offen offset:0 sc1
v_mfma_f32_16x16x32_bf16 a[136:139], v[68:71], v[56:59], a[136:139]
ds_read_b64_tr_b16 v[64:65], v5 offset:768
v_mfma_f32_16x16x32_bf16 a[140:143], v[68:71], v[60:63], a[140:143]
s_waitcnt lgkmcnt(9)
s_nop 0
ds_read_b64_tr_b16 v[66:67], v5 offset:17408
v_mfma_f32_16x16x32_bf16 a[144:147], v[72:75], v[56:59], a[144:147]
ds_read_b64_tr_b16 v[68:69], v5 offset:800
v_mfma_f32_16x16x32_bf16 a[148:151], v[72:75], v[60:63], a[148:151]
ds_read_b64_tr_b16 v[70:71], v5 offset:17440
buffer_load_dwordx4 v[100:103], v1, s[56:59], s47 offen offset:0 sc1
v_mfma_f32_16x16x32_bf16 a[152:155], v[76:79], v[56:59], a[152:155]
ds_read_b64_tr_b16 v[72:73], v5 offset:832
v_mfma_f32_16x16x32_bf16 a[156:159], v[76:79], v[60:63], a[156:159]
s_waitcnt lgkmcnt(9)
s_nop 0
ds_read_b64_tr_b16 v[74:75], v5 offset:17472
v_mfma_f32_16x16x32_bf16 a[160:163], v[80:83], v[56:59], a[160:163]
ds_read_b64_tr_b16 v[76:77], v5 offset:864
v_mfma_f32_16x16x32_bf16 a[164:167], v[80:83], v[60:63], a[164:167]
ds_read_b64_tr_b16 v[78:79], v5 offset:17504
buffer_load_dwordx4 v[104:107], v1, s[56:59], s46 offen offset:1024 sc1
v_mfma_f32_16x16x32_bf16 a[168:171], v[84:87], v[56:59], a[168:171]
ds_read_b64_tr_b16 v[80:81], v5 offset:896
v_mfma_f32_16x16x32_bf16 a[172:175], v[84:87], v[60:63], a[172:175]
s_waitcnt lgkmcnt(9)
s_nop 0
ds_read_b64_tr_b16 v[82:83], v5 offset:17536
v_mfma_f32_16x16x32_bf16 a[176:179], v[88:91], v[56:59], a[176:179]
ds_read_b64_tr_b16 v[84:85], v5 offset:928
v_mfma_f32_16x16x32_bf16 a[180:183], v[88:91], v[60:63], a[180:183]
ds_read_b64_tr_b16 v[86:87], v5 offset:17568
buffer_load_dwordx4 v[108:111], v1, s[56:59], s47 offen offset:1024 sc1
v_mfma_f32_16x16x32_bf16 a[184:187], v[92:95], v[56:59], a[184:187]
ds_read_b64_tr_b16 v[88:89], v5 offset:960
v_mfma_f32_16x16x32_bf16 a[188:191], v[92:95], v[60:63], a[188:191]
s_waitcnt lgkmcnt(9)
s_nop 0
ds_read_b64_tr_b16 v[90:91], v5 offset:17600
v_mfma_f32_16x16x32_bf16 a[192:195], v[64:67], v[56:59], a[192:195]
ds_read_b64_tr_b16 v[92:93], v5 offset:992
v_mfma_f32_16x16x32_bf16 a[196:199], v[64:67], v[60:63], a[196:199]
ds_read_b64_tr_b16 v[94:95], v5 offset:17632
buffer_load_dwordx4 v[192:195], v1, s[12:15], s38 offen offset:0 sc1
v_mfma_f32_16x16x32_bf16 a[200:203], v[68:71], v[56:59], a[200:203]
ds_read_b64_tr_b16 v[64:65], v5 offset:33280
v_mfma_f32_16x16x32_bf16 a[204:207], v[68:71], v[60:63], a[204:207]
s_waitcnt lgkmcnt(9)
s_nop 0
ds_read_b64_tr_b16 v[66:67], v5 offset:49920
v_mfma_f32_16x16x32_bf16 a[208:211], v[72:75], v[56:59], a[208:211]
ds_read_b64_tr_b16 v[68:69], v5 offset:33312
v_mfma_f32_16x16x32_bf16 a[212:215], v[72:75], v[60:63], a[212:215]
ds_read_b64_tr_b16 v[70:71], v5 offset:49952
buffer_load_dwordx4 v[196:199], v1, s[12:15], s38 offen offset:1024 sc1
v_mfma_f32_16x16x32_bf16 a[216:219], v[76:79], v[56:59], a[216:219]
ds_read_b64_tr_b16 v[72:73], v5 offset:33344
v_mfma_f32_16x16x32_bf16 a[220:223], v[76:79], v[60:63], a[220:223]
s_waitcnt lgkmcnt(9)
s_nop 0
ds_read_b64_tr_b16 v[74:75], v5 offset:49984
v_mfma_f32_16x16x32_bf16 a[224:227], v[80:83], v[56:59], a[224:227]
ds_read_b64_tr_b16 v[76:77], v5 offset:33376
v_mfma_f32_16x16x32_bf16 a[228:231], v[80:83], v[60:63], a[228:231]
ds_read_b64_tr_b16 v[78:79], v5 offset:50016
buffer_load_dwordx4 v[200:203], v1, s[12:15], s38 offen offset:2048 sc1
v_mfma_f32_16x16x32_bf16 a[232:235], v[84:87], v[56:59], a[232:235]
ds_read_b64_tr_b16 v[80:81], v5 offset:33408
v_mfma_f32_16x16x32_bf16 a[236:239], v[84:87], v[60:63], a[236:239]
s_waitcnt lgkmcnt(9)
s_nop 0
ds_read_b64_tr_b16 v[82:83], v5 offset:50048
v_mfma_f32_16x16x32_bf16 a[240:243], v[88:91], v[56:59], a[240:243]
ds_read_b64_tr_b16 v[84:85], v5 offset:33440
v_mfma_f32_16x16x32_bf16 a[244:247], v[88:91], v[60:63], a[244:247]
ds_read_b64_tr_b16 v[86:87], v5 offset:50080
v_cmp_lt_f32_e64 vcc, s45, v15
v_mfma_f32_16x16x32_bf16 a[248:251], v[92:95], v[56:59], a[248:251]
ds_read_b64_tr_b16 v[88:89], v5 offset:33472
v_mfma_f32_16x16x32_bf16 a[252:255], v[92:95], v[60:63], a[252:255]
s_waitcnt lgkmcnt(9)
ds_read_b64_tr_b16 v[90:91], v5 offset:50112
s_cbranch_vccnz L_R4
L_B4:
v_exp_f32 v32, v32
v_exp_f32 v33, v33
v_exp_f32 v34, v34
v_exp_f32 v35, v35
v_exp_f32 v36, v36
v_exp_f32 v37, v37
v_exp_f32 v38, v38
v_exp_f32 v39, v39
v_exp_f32 v40, v40
v_exp_f32 v41, v41
v_exp_f32 v42, v42
v_exp_f32 v43, v43
v_exp_f32 v44, v44
v_exp_f32 v45, v45
v_exp_f32 v46, v46
v_exp_f32 v47, v47
v_cvt_pk_bf16_f32 v56, v32, v33
v_cvt_pk_bf16_f32 v57, v34, v35
v_cvt_pk_bf16_f32 v58, v36, v37
v_cvt_pk_bf16_f32 v59, v38, v39
v_cvt_pk_bf16_f32 v60, v40, v41
v_cvt_pk_bf16_f32 v61, v42, v43
v_cvt_pk_bf16_f32 v62, v44, v45
v_cvt_pk_bf16_f32 v63, v46, v47
s_nop 0
s_waitcnt lgkmcnt(10)
v_mfma_f32_16x16x32_bf16 a[0:3], v[64:67], v[56:59], a[0:3]
s_add_u32 s52, s4, 52428800
s_addc_u32 s53, s5, 0
s_mov_b32 s54, 265216
ds_read_b64_tr_b16 v[92:93], v5 offset:33504
v_add_f32 v8, v8, v32
v_add_f32 v9, v9, v40
v_add_f32 v8, v8, v33
v_mfma_f32_16x16x32_bf16 a[4:7], v[64:67], v[60:63], a[4:7]
s_lshl_b32 s25, s30, 2
s_add_u32 s36, s25, s24
ds_read_b64_tr_b16 v[94:95], v5 offset:50144
buffer_load_dwordx4 v[204:207], v1, s[12:15], s38 offen offset:3072 sc1
v_mfma_f32_16x16x32_bf16 a[8:11], v[68:71], v[56:59], a[8:11]
s_add_u32 s25, s25, s32
s_cmp_eq_u32 s24, s32
s_cselect_b64 s[30:31], -1, 0
s_cselect_b32 s35, 0x4000, 0
ds_read_b64_tr_b16 v[64:65], v5 offset:33536
v_add_f32 v9, v9, v41
v_add_f32 v8, v8, v34
v_add_f32 v9, v9, v42
v_mfma_f32_16x16x32_bf16 a[12:15], v[68:71], v[60:63], a[12:15]
s_waitcnt lgkmcnt(9)
s_mul_i32 s37, s32, 259
ds_read_b64_tr_b16 v[66:67], v5 offset:50176
v_add_f32 v8, v8, v35
v_add_f32 v9, v9, v43
v_add_f32 v8, v8, v36
v_mfma_f32_16x16x32_bf16 a[16:19], v[72:75], v[56:59], a[16:19]
s_add_u32 s37, s37, s35
s_add_u32 s37, s37, s36
ds_read_b64_tr_b16 v[68:69], v5 offset:33568
v_add_f32 v9, v9, v44
v_add_f32 v8, v8, v37
v_add_f32_e64 v9, v9, v45
v_mfma_f32_16x16x32_bf16 a[20:23], v[72:75], v[60:63], a[20:23]
s_add_u32 s38, s38, 4096
s_lshl_b32 s35, s37, 8
s_lshl_b32 s29, s37, 15
ds_read_b64_tr_b16 v[70:71], v5 offset:50208
buffer_load_dwordx4 v[208:211], v1, s[12:15], s38 offen offset:0 sc1
v_mfma_f32_16x16x32_bf16 a[24:27], v[76:79], v[56:59], a[24:27]
s_lshl_b32 s40, s24, 17
s_add_u32 s40, s40, 81788928
ds_read_b64_tr_b16 v[72:73], v5 offset:33600
v_add_f32 v8, v8, v38
v_add_f32 v9, v9, v46
v_add_f32 v8, v8, v39
v_mfma_f32_16x16x32_bf16 a[28:31], v[76:79], v[60:63], a[28:31]
s_waitcnt lgkmcnt(9)
s_lshl_b32 s36, s36, 6
ds_read_b64_tr_b16 v[74:75], v5 offset:50240
v_add_f32 v9, v9, v47
v_and_b32 v24, 15, v0
v_lshrrev_b32_e64 v25, 4, v0
v_mfma_f32_16x16x32_bf16 a[32:35], v[80:83], v[56:59], a[32:35]
s_lshl_b32 s37, s32, 2
s_add_u32 s36, s36, s37
ds_read_b64_tr_b16 v[76:77], v5 offset:33632
v_lshrrev_b32 v26, 1, v25
v_mov_b32 v12, v8
v_mov_b32_e64 v13, v9
s_nop 1
v_permlane32_swap_b32 v12, v8
v_mfma_f32_16x16x32_bf16 a[36:39], v[80:83], v[60:63], a[36:39]
s_add_u32 s36, s36, 8192
s_mov_b32 s42, 0x3f803f80
ds_read_b64_tr_b16 v[78:79], v5 offset:50272
buffer_load_dwordx4 v[212:215], v1, s[12:15], s38 offen offset:1024 sc1
v_mfma_f32_16x16x32_bf16 a[40:43], v[84:87], v[56:59], a[40:43]
s_mov_b32 s43, 0xffff0000
s_mov_b32 s44, 989855744
ds_read_b64_tr_b16 v[80:81], v5 offset:33664
v_permlane32_swap_b32 v13, v9
s_nop 1
v_add_f32 v8, v8, v12
v_add_f32 v9, v9, v13
v_mov_b32_e64 v12, v8
v_mfma_f32_16x16x32_bf16 a[44:47], v[84:87], v[60:63], a[44:47]
s_waitcnt lgkmcnt(9)
s_lshl_b32 s39, s24, 13
ds_read_b64_tr_b16 v[82:83], v5 offset:50304
v_mov_b32 v13, v9
s_nop 1
v_permlane16_swap_b32 v12, v8
v_permlane16_swap_b32 v13, v9
s_nop 1
v_add_f32 v8, v8, v12
v_add_f32_e64 v9, v9, v13
v_mfma_f32_16x16x32_bf16 a[48:51], v[88:91], v[56:59], a[48:51]
s_lshl_b32 s59, s24, 11
s_add_u32 s37, s32, 1
ds_read_b64_tr_b16 v[84:85], v5 offset:33696
v_and_b32 v12, 16, v0
v_cmp_eq_u32 vcc, 0, v12
v_lshlrev_b32_e64 v13, 4, v24
v_mfma_f32_16x16x32_bf16 a[52:55], v[88:91], v[60:63], a[52:55]
s_and_b32 s37, s37, 3
s_mul_i32 s37, s37, 259
ds_read_b64_tr_b16 v[86:87], v5 offset:50336
buffer_load_dwordx4 v[216:219], v1, s[12:15], s38 offen offset:2048 sc1
v_mfma_f32_16x16x32_bf16 a[56:59], v[92:95], v[56:59], a[56:59]
s_add_u32 s37, s37, s25
s_lshl_b32 s26, s37, 8
ds_read_b64_tr_b16 v[88:89], v5 offset:33728
v_lshl_add_u32 v13, v25, 2, v13
v_cndmask_b32 v10, v52, v48, vcc
v_cndmask_b32_e64 v11, v9, v8, vcc
v_mfma_f32_16x16x32_bf16 a[60:63], v[92:95], v[60:63], a[60:63]
s_waitcnt lgkmcnt(9)
s_lshl_b32 s45, s37, 15
ds_read_b64_tr_b16 v[90:91], v5 offset:50368
v_cmp_gt_u32 vcc, 32, v0
s_nop 1
v_cndmask_b32 v10, v11, v10, vcc
v_lshrrev_b32 v27, 3, v24
v_cmp_eq_u32_e64 vcc, v27, v26
v_mfma_f32_16x16x32_bf16 a[64:67], v[64:67], v[56:59], a[64:67]
s_add_u32 s45, s45, s59
s_add_u32 s37, s32, 2
ds_read_b64_tr_b16 v[92:93], v5 offset:33760
v_bfe_u32 v27, v24, 1, 2
s_nop 0
v_cndmask_b32 v27, 8, v27, vcc
v_and_b32 v28, 1, v24
v_cmp_eq_u32 vcc, 1, v28
v_mfma_f32_16x16x32_bf16 a[68:71], v[64:67], v[60:63], a[68:71]
s_and_b32 s37, s37, 3
s_mul_i32 s37, s37, 259
ds_read_b64_tr_b16 v[94:95], v5 offset:50400
buffer_load_dwordx4 v[220:223], v1, s[12:15], s38 offen offset:3072 sc1
v_mfma_f32_16x16x32_bf16 a[72:75], v[68:71], v[56:59], a[72:75]
s_add_u32 s37, s37, s25
s_lshl_b32 s27, s37, 8
ds_read_b64_tr_b16 v[64:65], v5 offset:33792
v_mov_b32 v28, 202113280
v_mov_b32 v29, 16780300
v_cndmask_b32 v30, v28, v29, vcc
v_mfma_f32_16x16x32_bf16 a[76:79], v[68:71], v[60:63], a[76:79]
s_waitcnt lgkmcnt(9)
s_lshl_b32 s46, s37, 15
ds_read_b64_tr_b16 v[66:67], v5 offset:50432
v_mov_b32 v28, 202113794
v_mov_b32 v29, 50465804
v_cndmask_b32_e64 v31, v28, v29, vcc
v_mfma_f32_16x16x32_bf16 a[80:83], v[72:75], v[56:59], a[80:83]
s_add_u32 s46, s46, s59
s_add_u32 s37, s32, 3
ds_read_b64_tr_b16 v[68:69], v5 offset:33824
v_mov_b32 v28, 0x0c0c0c0c
v_cmp_eq_u32 vcc, 0, v27
s_nop 1
v_cndmask_b32 v16, v28, v30, vcc
v_cndmask_b32 v20, v28, v31, vcc
v_mfma_f32_16x16x32_bf16 a[84:87], v[72:75], v[60:63], a[84:87]
s_add_u32 s38, s38, 4096
s_and_b32 s37, s37, 3
s_mul_i32 s37, s37, 259
ds_read_b64_tr_b16 v[70:71], v5 offset:50464
buffer_load_dwordx4 v[224:227], v1, s[12:15], s38 offen offset:0 sc1
v_mfma_f32_16x16x32_bf16 a[88:91], v[76:79], v[56:59], a[88:91]
s_add_u32 s37, s37, s25
s_lshl_b32 s28, s37, 8
ds_read_b64_tr_b16 v[72:73], v5 offset:33856
v_cmp_eq_u32 vcc, 1, v27
s_nop 1
v_cndmask_b32 v17, v28, v30, vcc
v_cndmask_b32 v21, v28, v31, vcc
v_cmp_eq_u32 vcc, 2, v27
s_nop 1
v_cndmask_b32 v18, v28, v30, vcc
v_mfma_f32_16x16x32_bf16 a[92:95], v[76:79], v[60:63], a[92:95]
s_waitcnt lgkmcnt(9)
s_lshl_b32 s47, s37, 15
ds_read_b64_tr_b16 v[74:75], v5 offset:50496
v_cndmask_b32 v22, v28, v31, vcc
v_cmp_eq_u32 vcc, 3, v27
s_nop 1
v_cndmask_b32 v19, v28, v30, vcc
v_cndmask_b32_e64 v23, v28, v31, vcc
v_mfma_f32_16x16x32_bf16 a[96:99], v[80:83], v[56:59], a[96:99]
s_add_u32 s47, s47, s59
s_lshl_b32 s37, s25, 6
ds_read_b64_tr_b16 v[76:77], v5 offset:33888
v_lshl_add_u32 v2, s24, 4, v24
v_mul_u32_u24 v2, 1040, v2
v_lshl_add_u32 v2, v25, 4, v2
v_mfma_f32_16x16x32_bf16 a[100:103], v[80:83], v[60:63], a[100:103]
s_add_u32 s37, s37, 8192
s_lshl_b32 s50, s49, 15
s_nop 0
ds_read_b64_tr_b16 v[78:79], v5 offset:50528
buffer_load_dwordx4 v[228:231], v1, s[12:15], s38 offen offset:1024 sc1
v_mfma_f32_16x16x32_bf16 a[104:107], v[84:87], v[56:59], a[104:107]
s_add_u32 s51, s50, 16384
ds_read_b64_tr_b16 v[80:81], v5 offset:33920
v_add_u32 v2, 66560, v2
v_and_b32 v3, 1, v25
v_lshlrev_b32 v3, 4, v3
v_mfma_f32_16x16x32_bf16 a[108:111], v[84:87], v[60:63], a[108:111]
s_waitcnt lgkmcnt(9)
s_nop 0
ds_read_b64_tr_b16 v[82:83], v5 offset:50560
v_add3_u32 v3, v3, v24, 1
v_mul_u32_u24 v3, 1040, v3
v_lshl_add_u32 v3, v26, 4, v3
v_mfma_f32_16x16x32_bf16 a[112:115], v[88:91], v[56:59], a[112:115]
ds_read_b64_tr_b16 v[84:85], v5 offset:33952
v_lshl_add_u32 v3, s24, 8, v3
v_add_u32 v3, 66560, v3
v_lshlrev_b32_e64 v4, 10, v24
v_mfma_f32_16x16x32_bf16 a[116:119], v[88:91], v[60:63], a[116:119]
ds_read_b64_tr_b16 v[86:87], v5 offset:50592
buffer_load_dwordx4 v[232:235], v1, s[12:15], s38 offen offset:2048 sc1
v_mfma_f32_16x16x32_bf16 a[120:123], v[92:95], v[56:59], a[120:123]
ds_read_b64_tr_b16 v[88:89], v5 offset:33984
v_lshl_add_u32 v4, v25, 4, v4
v_lshl_add_u32 v4, s24, 8, v4
v_accvgpr_read_b32 v32, a0
v_mfma_f32_16x16x32_bf16 a[124:127], v[92:95], v[60:63], a[124:127]
s_waitcnt lgkmcnt(9)
s_nop 0
ds_read_b64_tr_b16 v[90:91], v5 offset:50624
v_accvgpr_read_b32 v33, a1
v_accvgpr_read_b32 v34, a2
v_accvgpr_read_b32 v35, a3
v_mfma_f32_16x16x32_bf16 a[128:131], v[64:67], v[56:59], a[128:131]
ds_read_b64_tr_b16 v[92:93], v5 offset:34016
v_accvgpr_read_b32 v36, a8
v_accvgpr_read_b32 v37, a9
v_accvgpr_read_b32 v38, a10
v_mfma_f32_16x16x32_bf16 a[132:135], v[64:67], v[60:63], a[132:135]
ds_read_b64_tr_b16 v[94:95], v5 offset:50656
buffer_load_dwordx4 v[236:239], v1, s[12:15], s38 offen offset:3072 sc1
v_mfma_f32_16x16x32_bf16 a[136:139], v[68:71], v[56:59], a[136:139]
ds_read_b64_tr_b16 v[64:65], v5 offset:34048
v_accvgpr_read_b32 v39, a11
v_cvt_pk_bf16_f32 v40, v32, v33
v_cvt_pk_bf16_f32 v41, v34, v35
v_mfma_f32_16x16x32_bf16 a[140:143], v[68:71], v[60:63], a[140:143]
s_waitcnt lgkmcnt(9)
s_nop 0
ds_read_b64_tr_b16 v[66:67], v5 offset:50688
v_cvt_pk_bf16_f32 v42, v36, v37
v_cvt_pk_bf16_f32 v43, v38, v39
v_mfma_f32_16x16x32_bf16 a[144:147], v[72:75], v[56:59], a[144:147]
ds_read_b64_tr_b16 v[68:69], v5 offset:34080
buffer_store_dwordx4 v[40:43], v1, s[68:71], s29 offen offset:0 sc1
s_mov_b64 exec, s[30:31]
ds_write_b128 v1, v[40:43] offset:33280
s_mov_b64 exec, -1
v_mfma_f32_16x16x32_bf16 a[148:151], v[72:75], v[60:63], a[148:151]
s_add_u32 s38, s38, 4096
ds_read_b64_tr_b16 v[70:71], v5 offset:50720
buffer_load_dwordx4 v[240:243], v1, s[12:15], s38 offen offset:0 sc1
v_mfma_f32_16x16x32_bf16 a[152:155], v[76:79], v[56:59], a[152:155]
ds_read_b64_tr_b16 v[72:73], v5 offset:34112
v_accvgpr_read_b32 v32, a4
v_accvgpr_read_b32 v33, a5
v_accvgpr_read_b32 v34, a6
v_mfma_f32_16x16x32_bf16 a[156:159], v[76:79], v[60:63], a[156:159]
s_waitcnt lgkmcnt(10)
s_nop 0
ds_read_b64_tr_b16 v[74:75], v5 offset:50752
v_accvgpr_read_b32 v35, a7
v_accvgpr_read_b32 v36, a12
v_accvgpr_read_b32 v37, a13
v_mfma_f32_16x16x32_bf16 a[160:163], v[80:83], v[56:59], a[160:163]
ds_read_b64_tr_b16 v[76:77], v5 offset:34144
v_accvgpr_read_b32 v38, a14
v_accvgpr_read_b32 v39, a15
v_cvt_pk_bf16_f32 v44, v32, v33
v_mfma_f32_16x16x32_bf16 a[164:167], v[80:83], v[60:63], a[164:167]
ds_read_b64_tr_b16 v[78:79], v5 offset:50784
buffer_load_dwordx4 v[244:247], v1, s[12:15], s38 offen offset:1024 sc1
v_mfma_f32_16x16x32_bf16 a[168:171], v[84:87], v[56:59], a[168:171]
ds_read_b64_tr_b16 v[80:81], v5 offset:34176
v_cvt_pk_bf16_f32 v45, v34, v35
v_cvt_pk_bf16_f32 v46, v36, v37
v_cvt_pk_bf16_f32 v47, v38, v39
v_mfma_f32_16x16x32_bf16 a[172:175], v[84:87], v[60:63], a[172:175]
s_waitcnt lgkmcnt(10)
ds_read_b64_tr_b16 v[82:83], v5 offset:50816
buffer_store_dwordx4 v[44:47], v1, s[68:71], s29 offen offset:1024 sc1
s_mov_b64 exec, s[30:31]
ds_write_b128 v1, v[44:47] offset:34304
s_mov_b64 exec, -1
s_nop 0
v_mfma_f32_16x16x32_bf16 a[176:179], v[88:91], v[56:59], a[176:179]
ds_read_b64_tr_b16 v[84:85], v5 offset:34208
v_accvgpr_read_b32 v32, a16
v_accvgpr_read_b32 v33, a17
v_accvgpr_read_b32 v34, a18
v_mfma_f32_16x16x32_bf16 a[180:183], v[88:91], v[60:63], a[180:183]
ds_read_b64_tr_b16 v[86:87], v5 offset:50848
buffer_load_dwordx4 v[248:251], v1, s[12:15], s38 offen offset:2048 sc1
v_mfma_f32_16x16x32_bf16 a[184:187], v[92:95], v[56:59], a[184:187]
ds_read_b64_tr_b16 v[88:89], v5 offset:34240
v_accvgpr_read_b32 v35, a19
v_accvgpr_read_b32 v36, a24
v_accvgpr_read_b32 v37, a25
v_mfma_f32_16x16x32_bf16 a[188:191], v[92:95], v[60:63], a[188:191]
s_waitcnt lgkmcnt(10)
s_nop 0
ds_read_b64_tr_b16 v[90:91], v5 offset:50880
v_accvgpr_read_b32 v38, a26
v_accvgpr_read_b32 v39, a27
v_cvt_pk_bf16_f32 v40, v32, v33
v_mfma_f32_16x16x32_bf16 a[192:195], v[64:67], v[56:59], a[192:195]
ds_read_b64_tr_b16 v[92:93], v5 offset:34272
v_cvt_pk_bf16_f32 v41, v34, v35
v_cvt_pk_bf16_f32 v42, v36, v37
v_cvt_pk_bf16_f32 v43, v38, v39
v_mfma_f32_16x16x32_bf16 a[196:199], v[64:67], v[60:63], a[196:199]
ds_read_b64_tr_b16 v[94:95], v5 offset:50912
buffer_load_dwordx4 v[252:255], v1, s[12:15], s38 offen offset:3072 sc1
v_mfma_f32_16x16x32_bf16 a[200:203], v[68:71], v[56:59], a[200:203]
buffer_store_dwordx4 v[40:43], v1, s[68:71], s29 offen offset:2048 sc1
s_mov_b64 exec, s[30:31]
ds_write_b128 v1, v[40:43] offset:35328
s_mov_b64 exec, -1
v_mfma_f32_16x16x32_bf16 a[204:207], v[68:71], v[60:63], a[204:207]
s_waitcnt lgkmcnt(10)
s_nop 0
v_accvgpr_read_b32 v32, a20
v_accvgpr_read_b32 v33, a21
v_accvgpr_read_b32 v34, a22
v_mfma_f32_16x16x32_bf16 a[208:211], v[72:75], v[56:59], a[208:211]
v_accvgpr_read_b32 v35, a23
v_accvgpr_read_b32 v36, a28
v_accvgpr_read_b32 v37, a29
v_mfma_f32_16x16x32_bf16 a[212:215], v[72:75], v[60:63], a[212:215]
v_accvgpr_read_b32 v38, a30
v_accvgpr_read_b32 v39, a31
v_cvt_pk_bf16_f32 v44, v32, v33
v_mfma_f32_16x16x32_bf16 a[216:219], v[76:79], v[56:59], a[216:219]
v_cvt_pk_bf16_f32 v45, v34, v35
v_cvt_pk_bf16_f32 v46, v36, v37
v_cvt_pk_bf16_f32 v47, v38, v39
v_mfma_f32_16x16x32_bf16 a[220:223], v[76:79], v[60:63], a[220:223]
s_waitcnt lgkmcnt(5)
buffer_store_dwordx4 v[44:47], v1, s[68:71], s29 offen offset:3072 sc1
s_mov_b64 exec, s[30:31]
ds_write_b128 v1, v[44:47] offset:36352
s_mov_b64 exec, -1
v_mfma_f32_16x16x32_bf16 a[224:227], v[80:83], v[56:59], a[224:227]
v_mfma_f32_16x16x32_bf16 a[228:231], v[80:83], v[60:63], a[228:231]
v_mfma_f32_16x16x32_bf16 a[232:235], v[84:87], v[56:59], a[232:235]
v_mfma_f32_16x16x32_bf16 a[236:239], v[84:87], v[60:63], a[236:239]
s_waitcnt lgkmcnt(2)
v_mfma_f32_16x16x32_bf16 a[240:243], v[88:91], v[56:59], a[240:243]
v_mfma_f32_16x16x32_bf16 a[244:247], v[88:91], v[60:63], a[244:247]
v_mfma_f32_16x16x32_bf16 a[248:251], v[92:95], v[56:59], a[248:251]
v_mfma_f32_16x16x32_bf16 a[252:255], v[92:95], v[60:63], a[252:255]
buffer_store_dword v10, v13, s[52:55], s35 offen sc1
s_waitcnt vmcnt(25)
s_barrier
v_add_u32 v5, 133120, v1
v_mul_u32_u24 v6, 1040, v24
v_lshl_add_u32 v6, v25, 4, v6
v_lshl_add_u32 v6, s24, 8, v6
v_add_u32 v13, 61952, v13
s_mov_b64 exec, s[30:31]
ds_write_b32 v13, v10 offset:4096
s_mov_b64 exec, -1
v_mov_b32 v72, 0
v_mov_b32 v74, 0
v_mov_b32 v73, 0
v_mov_b32 v75, 0
v_dot2_f32_bf16 v72, v128, s42, v72
v_dot2_f32_bf16 v73, v128, v128, v73
v_dot2_f32_bf16 v74, v129, s42, v74
v_dot2_f32_bf16 v75, v129, v129, v75
v_dot2_f32_bf16 v72, v130, s42, v72
v_dot2_f32_bf16 v73, v130, v130, v73
v_dot2_f32_bf16 v74, v131, s42, v74
v_dot2_f32_bf16 v75, v131, v131, v75
s_add_u32 s41, s40, 0
s_nop 0
buffer_load_dwordx4 a[0:3], v1, s[12:15], s41 offen offset:0 sc1
v_dot2_f32_bf16 v72, v132, s42, v72
v_dot2_f32_bf16 v73, v132, v132, v73
v_dot2_f32_bf16 v74, v133, s42, v74
v_dot2_f32_bf16 v75, v133, v133, v75
v_dot2_f32_bf16 v72, v134, s42, v72
v_dot2_f32_bf16 v73, v134, v134, v73
v_dot2_f32_bf16 v74, v135, s42, v74
v_dot2_f32_bf16 v75, v135, v135, v75
v_dot2_f32_bf16 v72, v136, s42, v72
v_dot2_f32_bf16 v73, v136, v136, v73
v_dot2_f32_bf16 v74, v137, s42, v74
v_dot2_f32_bf16 v75, v137, v137, v75
v_dot2_f32_bf16 v72, v138, s42, v72
v_dot2_f32_bf16 v73, v138, v138, v73
v_dot2_f32_bf16 v74, v139, s42, v74
v_dot2_f32_bf16 v75, v139, v139, v75
buffer_load_dwordx4 a[4:7], v1, s[12:15], s41 offen offset:1024 sc1
v_dot2_f32_bf16 v72, v140, s42, v72
v_dot2_f32_bf16 v73, v140, v140, v73
v_dot2_f32_bf16 v74, v141, s42, v74
v_dot2_f32_bf16 v75, v141, v141, v75
v_dot2_f32_bf16 v72, v142, s42, v72
v_dot2_f32_bf16 v73, v142, v142, v73
v_dot2_f32_bf16 v74, v143, s42, v74
v_dot2_f32_bf16 v75, v143, v143, v75
v_accvgpr_read_b32 v80, a32
v_accvgpr_read_b32 v81, a33
v_accvgpr_read_b32 v82, a34
v_accvgpr_read_b32 v83, a35
v_accvgpr_read_b32 v84, a40
v_accvgpr_read_b32 v85, a41
v_accvgpr_read_b32 v86, a42
v_accvgpr_read_b32 v87, a43
v_cvt_pk_bf16_f32 v88, v80, v81
v_cvt_pk_bf16_f32 v89, v82, v83
v_cvt_pk_bf16_f32 v90, v84, v85
v_cvt_pk_bf16_f32 v91, v86, v87
s_add_u32 s29, s29, 4096
buffer_store_dwordx4 v[88:91], v1, s[68:71], s29 offen offset:0 sc1
s_mov_b64 exec, s[30:31]
ds_write_b128 v1, v[88:91] offset:37376
s_mov_b64 exec, -1
buffer_load_dwordx4 a[8:11], v1, s[12:15], s41 offen offset:2048 sc1
v_dot2_f32_bf16 v72, v144, s42, v72
v_dot2_f32_bf16 v73, v144, v144, v73
v_dot2_f32_bf16 v74, v145, s42, v74
v_dot2_f32_bf16 v75, v145, v145, v75
v_dot2_f32_bf16 v72, v146, s42, v72
v_dot2_f32_bf16 v73, v146, v146, v73
v_dot2_f32_bf16 v74, v147, s42, v74
v_dot2_f32_bf16 v75, v147, v147, v75
buffer_load_dwordx4 a[12:15], v1, s[12:15], s41 offen offset:3072 sc1
v_dot2_f32_bf16 v72, v148, s42, v72
v_dot2_f32_bf16 v73, v148, v148, v73
v_dot2_f32_bf16 v74, v149, s42, v74
v_dot2_f32_bf16 v75, v149, v149, v75
v_dot2_f32_bf16 v72, v150, s42, v72
v_dot2_f32_bf16 v73, v150, v150, v73
v_dot2_f32_bf16 v74, v151, s42, v74
v_dot2_f32_bf16 v75, v151, v151, v75
v_dot2_f32_bf16 v72, v152, s42, v72
v_dot2_f32_bf16 v73, v152, v152, v73
v_dot2_f32_bf16 v74, v153, s42, v74
v_dot2_f32_bf16 v75, v153, v153, v75
v_dot2_f32_bf16 v72, v154, s42, v72
v_dot2_f32_bf16 v73, v154, v154, v73
v_dot2_f32_bf16 v74, v155, s42, v74
v_dot2_f32_bf16 v75, v155, v155, v75
s_add_u32 s41, s40, 4096
buffer_load_dwordx4 a[16:19], v1, s[12:15], s41 offen offset:0 sc1
v_dot2_f32_bf16 v72, v156, s42, v72
v_dot2_f32_bf16 v73, v156, v156, v73
v_dot2_f32_bf16 v74, v157, s42, v74
v_dot2_f32_bf16 v75, v157, v157, v75
v_dot2_f32_bf16 v72, v158, s42, v72
v_dot2_f32_bf16 v73, v158, v158, v73
v_dot2_f32_bf16 v74, v159, s42, v74
v_dot2_f32_bf16 v75, v159, v159, v75
v_accvgpr_read_b32 v80, a36
v_accvgpr_read_b32 v81, a37
v_accvgpr_read_b32 v82, a38
v_accvgpr_read_b32 v83, a39
v_accvgpr_read_b32 v84, a44
v_accvgpr_read_b32 v85, a45
v_accvgpr_read_b32 v86, a46
v_accvgpr_read_b32 v87, a47
v_cvt_pk_bf16_f32 v92, v80, v81
v_cvt_pk_bf16_f32 v93, v82, v83
v_cvt_pk_bf16_f32 v94, v84, v85
v_cvt_pk_bf16_f32 v95, v86, v87
buffer_store_dwordx4 v[92:95], v1, s[68:71], s29 offen offset:1024 sc1
s_mov_b64 exec, s[30:31]
ds_write_b128 v1, v[92:95] offset:38400
s_mov_b64 exec, -1
buffer_load_dwordx4 a[20:23], v1, s[12:15], s41 offen offset:1024 sc1
v_dot2_f32_bf16 v72, v160, s42, v72
v_dot2_f32_bf16 v73, v160, v160, v73
v_dot2_f32_bf16 v74, v161, s42, v74
v_dot2_f32_bf16 v75, v161, v161, v75
v_dot2_f32_bf16 v72, v162, s42, v72
v_dot2_f32_bf16 v73, v162, v162, v73
v_dot2_f32_bf16 v74, v163, s42, v74
v_dot2_f32_bf16 v75, v163, v163, v75
buffer_load_dwordx4 a[24:27], v1, s[12:15], s41 offen offset:2048 sc1
v_dot2_f32_bf16 v72, v164, s42, v72
v_dot2_f32_bf16 v73, v164, v164, v73
v_dot2_f32_bf16 v74, v165, s42, v74
v_dot2_f32_bf16 v75, v165, v165, v75
v_dot2_f32_bf16 v72, v166, s42, v72
v_dot2_f32_bf16 v73, v166, v166, v73
v_dot2_f32_bf16 v74, v167, s42, v74
v_dot2_f32_bf16 v75, v167, v167, v75
v_dot2_f32_bf16 v72, v168, s42, v72
v_dot2_f32_bf16 v73, v168, v168, v73
v_dot2_f32_bf16 v74, v169, s42, v74
v_dot2_f32_bf16 v75, v169, v169, v75
v_dot2_f32_bf16 v72, v170, s42, v72
v_dot2_f32_bf16 v73, v170, v170, v73
v_dot2_f32_bf16 v74, v171, s42, v74
v_dot2_f32_bf16 v75, v171, v171, v75
buffer_load_dwordx4 a[28:31], v1, s[12:15], s41 offen offset:3072 sc1
v_dot2_f32_bf16 v72, v172, s42, v72
v_dot2_f32_bf16 v73, v172, v172, v73
v_dot2_f32_bf16 v74, v173, s42, v74
v_dot2_f32_bf16 v75, v173, v173, v75
v_dot2_f32_bf16 v72, v174, s42, v72
v_dot2_f32_bf16 v73, v174, v174, v73
v_dot2_f32_bf16 v74, v175, s42, v74
v_dot2_f32_bf16 v75, v175, v175, v75
v_accvgpr_read_b32 v80, a48
v_accvgpr_read_b32 v81, a49
v_accvgpr_read_b32 v82, a50
v_accvgpr_read_b32 v83, a51
v_accvgpr_read_b32 v84, a56
v_accvgpr_read_b32 v85, a57
v_accvgpr_read_b32 v86, a58
v_accvgpr_read_b32 v87, a59
v_cvt_pk_bf16_f32 v88, v80, v81
v_cvt_pk_bf16_f32 v89, v82, v83
v_cvt_pk_bf16_f32 v90, v84, v85
v_cvt_pk_bf16_f32 v91, v86, v87
buffer_store_dwordx4 v[88:91], v1, s[68:71], s29 offen offset:2048 sc1
s_mov_b64 exec, s[30:31]
ds_write_b128 v1, v[88:91] offset:39424
s_mov_b64 exec, -1
s_add_u32 s41, s40, 32768
buffer_load_dwordx4 a[32:35], v1, s[12:15], s41 offen offset:0 sc1
v_dot2_f32_bf16 v72, v176, s42, v72
v_dot2_f32_bf16 v73, v176, v176, v73
v_dot2_f32_bf16 v74, v177, s42, v74
v_dot2_f32_bf16 v75, v177, v177, v75
v_dot2_f32_bf16 v72, v178, s42, v72
v_dot2_f32_bf16 v73, v178, v178, v73
v_dot2_f32_bf16 v74, v179, s42, v74
v_dot2_f32_bf16 v75, v179, v179, v75
buffer_load_dwordx4 a[36:39], v1, s[12:15], s41 offen offset:1024 sc1
v_dot2_f32_bf16 v72, v180, s42, v72
v_dot2_f32_bf16 v73, v180, v180, v73
v_dot2_f32_bf16 v74, v181, s42, v74
v_dot2_f32_bf16 v75, v181, v181, v75
v_dot2_f32_bf16 v72, v182, s42, v72
v_dot2_f32_bf16 v73, v182, v182, v73
v_dot2_f32_bf16 v74, v183, s42, v74
v_dot2_f32_bf16 v75, v183, v183, v75
v_dot2_f32_bf16 v72, v184, s42, v72
v_dot2_f32_bf16 v73, v184, v184, v73
v_dot2_f32_bf16 v74, v185, s42, v74
v_dot2_f32_bf16 v75, v185, v185, v75
v_dot2_f32_bf16 v72, v186, s42, v72
v_dot2_f32_bf16 v73, v186, v186, v73
v_dot2_f32_bf16 v74, v187, s42, v74
v_dot2_f32_bf16 v75, v187, v187, v75
buffer_load_dwordx4 a[40:43], v1, s[12:15], s41 offen offset:2048 sc1
v_dot2_f32_bf16 v72, v188, s42, v72
v_dot2_f32_bf16 v73, v188, v188, v73
v_dot2_f32_bf16 v74, v189, s42, v74
v_dot2_f32_bf16 v75, v189, v189, v75
v_dot2_f32_bf16 v72, v190, s42, v72
v_dot2_f32_bf16 v73, v190, v190, v73
v_dot2_f32_bf16 v74, v191, s42, v74
v_dot2_f32_bf16 v75, v191, v191, v75
v_accvgpr_read_b32 v80, a52
v_accvgpr_read_b32 v81, a53
v_accvgpr_read_b32 v82, a54
v_accvgpr_read_b32 v83, a55
v_accvgpr_read_b32 v84, a60
v_accvgpr_read_b32 v85, a61
v_accvgpr_read_b32 v86, a62
v_accvgpr_read_b32 v87, a63
v_cvt_pk_bf16_f32 v92, v80, v81
v_cvt_pk_bf16_f32 v93, v82, v83
v_cvt_pk_bf16_f32 v94, v84, v85
v_cvt_pk_bf16_f32 v95, v86, v87
buffer_store_dwordx4 v[92:95], v1, s[68:71], s29 offen offset:3072 sc1
s_mov_b64 exec, s[30:31]
ds_write_b128 v1, v[92:95] offset:40448
s_mov_b64 exec, -1
buffer_load_dwordx4 a[44:47], v1, s[12:15], s41 offen offset:3072 sc1
s_nop 2
v_add_f32 v72, v72, v74
v_add_f32 v73, v73, v75
v_mov_b32 v74, v72
v_mov_b32 v75, v73
s_nop 1
v_permlane16_swap_b32 v74, v72
v_permlane16_swap_b32 v75, v73
s_nop 0
v_add_f32 v72, v72, v74
v_add_f32 v73, v73, v75
v_mov_b32 v74, v72
v_mov_b32 v75, v73
s_nop 1
v_permlane32_swap_b32 v74, v72
v_permlane32_swap_b32 v75, v73
s_nop 0
v_add_f32 v72, v72, v74
v_add_f32 v73, v73, v75
v_mul_f32 v72, s44, v72
v_mul_f32_e64 v73, s44, v73
v_fma_f32 v73, -v72, v72, v73
v_max_f32_e64 v73, 0, v73
v_add_f32 v73, 925353388, v73
v_rsq_f32 v73, v73
s_nop 0
v_mul_f32 v72, -v72, v73
v_lshlrev_b32 v48, 16, v128
v_and_b32 v49, s43, v128
v_lshlrev_b32 v50, 16, v129
v_and_b32 v51, s43, v129
v_lshlrev_b32 v52, 16, v130
v_and_b32 v53, s43, v130
v_lshlrev_b32 v54, 16, v131
v_and_b32 v55, s43, v131
v_pk_fma_f32 v[48:49], v[48:49], v[72:73], v[72:73] op_sel:[0,1,0] op_sel_hi:[1,1,0]
v_pk_fma_f32 v[50:51], v[50:51], v[72:73], v[72:73] op_sel:[0,1,0] op_sel_hi:[1,1,0]
v_pk_fma_f32 v[52:53], v[52:53], v[72:73], v[72:73] op_sel:[0,1,0] op_sel_hi:[1,1,0]
v_pk_fma_f32 v[54:55], v[54:55], v[72:73], v[72:73] op_sel:[0,1,0] op_sel_hi:[1,1,0]
v_cvt_pk_bf16_f32 v128, v48, v49
v_cvt_pk_bf16_f32 v129, v50, v51
v_cvt_pk_bf16_f32 v130, v52, v53
v_cvt_pk_bf16_f32 v131, v54, v55
ds_write_b128 v2, v[128:131] offset:0
s_add_u32 s41, s40, 36864
buffer_load_dwordx4 a[48:51], v1, s[12:15], s41 offen offset:0 sc1
v_lshlrev_b32 v56, 16, v132
v_and_b32 v57, s43, v132
v_lshlrev_b32 v58, 16, v133
v_and_b32 v59, s43, v133
v_lshlrev_b32 v60, 16, v134
v_and_b32 v61, s43, v134
v_lshlrev_b32 v62, 16, v135
v_and_b32 v63, s43, v135
v_pk_fma_f32 v[56:57], v[56:57], v[72:73], v[72:73] op_sel:[0,1,0] op_sel_hi:[1,1,0]
v_pk_fma_f32 v[58:59], v[58:59], v[72:73], v[72:73] op_sel:[0,1,0] op_sel_hi:[1,1,0]
v_pk_fma_f32 v[60:61], v[60:61], v[72:73], v[72:73] op_sel:[0,1,0] op_sel_hi:[1,1,0]
v_pk_fma_f32 v[62:63], v[62:63], v[72:73], v[72:73] op_sel:[0,1,0] op_sel_hi:[1,1,0]
v_cvt_pk_bf16_f32 v132, v56, v57
v_cvt_pk_bf16_f32 v133, v58, v59
v_cvt_pk_bf16_f32 v134, v60, v61
v_cvt_pk_bf16_f32 v135, v62, v63
ds_write_b128 v2, v[132:135] offset:64
buffer_load_dwordx4 a[52:55], v1, s[12:15], s41 offen offset:1024 sc1
v_accvgpr_read_b32 v80, a64
v_accvgpr_read_b32 v81, a65
v_accvgpr_read_b32 v82, a66
v_accvgpr_read_b32 v83, a67
v_accvgpr_read_b32 v84, a72
v_accvgpr_read_b32 v85, a73
v_accvgpr_read_b32 v86, a74
v_accvgpr_read_b32 v87, a75
v_cvt_pk_bf16_f32 v88, v80, v81
v_cvt_pk_bf16_f32 v89, v82, v83
v_cvt_pk_bf16_f32 v90, v84, v85
v_cvt_pk_bf16_f32 v91, v86, v87
s_add_u32 s29, s29, 4096
buffer_store_dwordx4 v[88:91], v1, s[68:71], s29 offen offset:0 sc1
s_mov_b64 exec, s[30:31]
ds_write_b128 v1, v[88:91] offset:41472
s_mov_b64 exec, -1
v_lshlrev_b32 v48, 16, v136
v_and_b32 v49, s43, v136
v_lshlrev_b32 v50, 16, v137
v_and_b32 v51, s43, v137
v_lshlrev_b32 v52, 16, v138
v_and_b32 v53, s43, v138
v_lshlrev_b32 v54, 16, v139
v_and_b32 v55, s43, v139
v_pk_fma_f32 v[48:49], v[48:49], v[72:73], v[72:73] op_sel:[0,1,0] op_sel_hi:[1,1,0]
v_pk_fma_f32 v[50:51], v[50:51], v[72:73], v[72:73] op_sel:[0,1,0] op_sel_hi:[1,1,0]
v_pk_fma_f32 v[52:53], v[52:53], v[72:73], v[72:73] op_sel:[0,1,0] op_sel_hi:[1,1,0]
v_pk_fma_f32 v[54:55], v[54:55], v[72:73], v[72:73] op_sel:[0,1,0] op_sel_hi:[1,1,0]
v_cvt_pk_bf16_f32 v136, v48, v49
v_cvt_pk_bf16_f32 v137, v50, v51
v_cvt_pk_bf16_f32 v138, v52, v53
v_cvt_pk_bf16_f32 v139, v54, v55
ds_write_b128 v2, v[136:139] offset:128
buffer_load_dwordx4 a[56:59], v1, s[12:15], s41 offen offset:2048 sc1
v_lshlrev_b32 v56, 16, v140
v_and_b32 v57, s43, v140
v_lshlrev_b32 v58, 16, v141
v_and_b32 v59, s43, v141
v_lshlrev_b32 v60, 16, v142
v_and_b32 v61, s43, v142
v_lshlrev_b32 v62, 16, v143
v_and_b32 v63, s43, v143
v_pk_fma_f32 v[56:57], v[56:57], v[72:73], v[72:73] op_sel:[0,1,0] op_sel_hi:[1,1,0]
v_pk_fma_f32 v[58:59], v[58:59], v[72:73], v[72:73] op_sel:[0,1,0] op_sel_hi:[1,1,0]
v_pk_fma_f32 v[60:61], v[60:61], v[72:73], v[72:73] op_sel:[0,1,0] op_sel_hi:[1,1,0]
v_pk_fma_f32 v[62:63], v[62:63], v[72:73], v[72:73] op_sel:[0,1,0] op_sel_hi:[1,1,0]
v_cvt_pk_bf16_f32 v140, v56, v57
v_cvt_pk_bf16_f32 v141, v58, v59
v_cvt_pk_bf16_f32 v142, v60, v61
v_cvt_pk_bf16_f32 v143, v62, v63
ds_write_b128 v2, v[140:143] offset:192
buffer_load_dwordx4 a[60:63], v1, s[12:15], s41 offen offset:3072 sc1
v_accvgpr_read_b32 v80, a68
v_accvgpr_read_b32 v81, a69
v_accvgpr_read_b32 v82, a70
v_accvgpr_read_b32 v83, a71
v_accvgpr_read_b32 v84, a76
v_accvgpr_read_b32 v85, a77
v_accvgpr_read_b32 v86, a78
v_accvgpr_read_b32 v87, a79
v_cvt_pk_bf16_f32 v92, v80, v81
v_cvt_pk_bf16_f32 v93, v82, v83
v_cvt_pk_bf16_f32 v94, v84, v85
v_cvt_pk_bf16_f32 v95, v86, v87
buffer_store_dwordx4 v[92:95], v1, s[68:71], s29 offen offset:1024 sc1
s_mov_b64 exec, s[30:31]
ds_write_b128 v1, v[92:95] offset:42496
s_mov_b64 exec, -1
v_lshlrev_b32 v48, 16, v144
v_and_b32 v49, s43, v144
v_lshlrev_b32 v50, 16, v145
v_and_b32 v51, s43, v145
v_lshlrev_b32 v52, 16, v146
v_and_b32 v53, s43, v146
v_lshlrev_b32 v54, 16, v147
v_and_b32 v55, s43, v147
v_pk_fma_f32 v[48:49], v[48:49], v[72:73], v[72:73] op_sel:[0,1,0] op_sel_hi:[1,1,0]
v_pk_fma_f32 v[50:51], v[50:51], v[72:73], v[72:73] op_sel:[0,1,0] op_sel_hi:[1,1,0]
v_pk_fma_f32 v[52:53], v[52:53], v[72:73], v[72:73] op_sel:[0,1,0] op_sel_hi:[1,1,0]
v_pk_fma_f32 v[54:55], v[54:55], v[72:73], v[72:73] op_sel:[0,1,0] op_sel_hi:[1,1,0]
v_cvt_pk_bf16_f32 v144, v48, v49
v_cvt_pk_bf16_f32 v145, v50, v51
v_cvt_pk_bf16_f32 v146, v52, v53
v_cvt_pk_bf16_f32 v147, v54, v55
ds_write_b128 v2, v[144:147] offset:256
s_add_u32 s41, s40, 65536
buffer_load_dwordx4 a[64:67], v1, s[12:15], s41 offen offset:0 sc1
v_lshlrev_b32 v56, 16, v148
v_and_b32 v57, s43, v148
v_lshlrev_b32 v58, 16, v149
v_and_b32 v59, s43, v149
v_lshlrev_b32 v60, 16, v150
v_and_b32 v61, s43, v150
v_lshlrev_b32 v62, 16, v151
v_and_b32 v63, s43, v151
v_pk_fma_f32 v[56:57], v[56:57], v[72:73], v[72:73] op_sel:[0,1,0] op_sel_hi:[1,1,0]
v_pk_fma_f32 v[58:59], v[58:59], v[72:73], v[72:73] op_sel:[0,1,0] op_sel_hi:[1,1,0]
v_pk_fma_f32 v[60:61], v[60:61], v[72:73], v[72:73] op_sel:[0,1,0] op_sel_hi:[1,1,0]
v_pk_fma_f32 v[62:63], v[62:63], v[72:73], v[72:73] op_sel:[0,1,0] op_sel_hi:[1,1,0]
v_cvt_pk_bf16_f32 v148, v56, v57
v_cvt_pk_bf16_f32 v149, v58, v59
v_cvt_pk_bf16_f32 v150, v60, v61
v_cvt_pk_bf16_f32 v151, v62, v63
ds_write_b128 v2, v[148:151] offset:320
buffer_load_dwordx4 a[68:71], v1, s[12:15], s41 offen offset:1024 sc1
v_accvgpr_read_b32 v80, a80
v_accvgpr_read_b32 v81, a81
v_accvgpr_read_b32 v82, a82
v_accvgpr_read_b32 v83, a83
v_accvgpr_read_b32 v84, a88
v_accvgpr_read_b32 v85, a89
v_accvgpr_read_b32 v86, a90
v_accvgpr_read_b32 v87, a91
v_cvt_pk_bf16_f32 v88, v80, v81
v_cvt_pk_bf16_f32 v89, v82, v83
v_cvt_pk_bf16_f32 v90, v84, v85
v_cvt_pk_bf16_f32 v91, v86, v87
buffer_store_dwordx4 v[88:91], v1, s[68:71], s29 offen offset:2048 sc1
s_mov_b64 exec, s[30:31]
s_waitcnt lgkmcnt(12)
ds_write_b128 v1, v[88:91] offset:43520
s_mov_b64 exec, -1
v_lshlrev_b32 v48, 16, v152
v_and_b32 v49, s43, v152
v_lshlrev_b32 v50, 16, v153
v_and_b32 v51, s43, v153
v_lshlrev_b32 v52, 16, v154
v_and_b32 v53, s43, v154
v_lshlrev_b32 v54, 16, v155
v_and_b32_e64 v55, s43, v155
v_pk_fma_f32 v[48:49], v[48:49], v[72:73], v[72:73] op_sel:[0,1,0] op_sel_hi:[1,1,0]
v_pk_fma_f32 v[50:51], v[50:51], v[72:73], v[72:73] op_sel:[0,1,0] op_sel_hi:[1,1,0]
v_pk_fma_f32 v[52:53], v[52:53], v[72:73], v[72:73] op_sel:[0,1,0] op_sel_hi:[1,1,0]
v_pk_fma_f32 v[54:55], v[54:55], v[72:73], v[72:73] op_sel:[0,1,0] op_sel_hi:[1,1,0]
v_cvt_pk_bf16_f32 v152, v48, v49
v_cvt_pk_bf16_f32 v153, v50, v51
v_cvt_pk_bf16_f32 v154, v52, v53
v_cvt_pk_bf16_f32 v155, v54, v55
ds_write_b128 v2, v[152:155] offset:384
buffer_load_dwordx4 a[72:75], v1, s[12:15], s41 offen offset:2048 sc1
v_lshlrev_b32 v56, 16, v156
v_and_b32 v57, s43, v156
v_lshlrev_b32 v58, 16, v157
v_and_b32 v59, s43, v157
v_lshlrev_b32 v60, 16, v158
v_and_b32 v61, s43, v158
v_lshlrev_b32 v62, 16, v159
v_and_b32 v63, s43, v159
v_pk_fma_f32 v[56:57], v[56:57], v[72:73], v[72:73] op_sel:[0,1,0] op_sel_hi:[1,1,0]
v_pk_fma_f32 v[58:59], v[58:59], v[72:73], v[72:73] op_sel:[0,1,0] op_sel_hi:[1,1,0]
v_pk_fma_f32 v[60:61], v[60:61], v[72:73], v[72:73] op_sel:[0,1,0] op_sel_hi:[1,1,0]
v_pk_fma_f32 v[62:63], v[62:63], v[72:73], v[72:73] op_sel:[0,1,0] op_sel_hi:[1,1,0]
v_cvt_pk_bf16_f32 v156, v56, v57
v_cvt_pk_bf16_f32 v157, v58, v59
v_cvt_pk_bf16_f32 v158, v60, v61
v_cvt_pk_bf16_f32 v159, v62, v63
ds_write_b128 v2, v[156:159] offset:448
buffer_load_dwordx4 a[76:79], v1, s[12:15], s41 offen offset:3072 sc1
v_accvgpr_read_b32 v80, a84
v_accvgpr_read_b32 v81, a85
v_accvgpr_read_b32 v82, a86
v_accvgpr_read_b32 v83, a87
v_accvgpr_read_b32 v84, a92
v_accvgpr_read_b32 v85, a93
v_accvgpr_read_b32 v86, a94
v_accvgpr_read_b32 v87, a95
v_cvt_pk_bf16_f32 v92, v80, v81
v_cvt_pk_bf16_f32 v93, v82, v83
v_cvt_pk_bf16_f32 v94, v84, v85
v_cvt_pk_bf16_f32 v95, v86, v87
buffer_store_dwordx4 v[92:95], v1, s[68:71], s29 offen offset:3072 sc1
s_mov_b64 exec, s[30:31]
s_waitcnt lgkmcnt(12)
ds_write_b128 v1, v[92:95] offset:44544
s_mov_b64 exec, -1
v_lshlrev_b32 v48, 16, v160
v_and_b32 v49, s43, v160
v_lshlrev_b32 v50, 16, v161
v_and_b32 v51, s43, v161
v_lshlrev_b32 v52, 16, v162
v_and_b32 v53, s43, v162
v_lshlrev_b32 v54, 16, v163
v_and_b32_e64 v55, s43, v163
v_pk_fma_f32 v[48:49], v[48:49], v[72:73], v[72:73] op_sel:[0,1,0] op_sel_hi:[1,1,0]
v_pk_fma_f32 v[50:51], v[50:51], v[72:73], v[72:73] op_sel:[0,1,0] op_sel_hi:[1,1,0]
v_pk_fma_f32 v[52:53], v[52:53], v[72:73], v[72:73] op_sel:[0,1,0] op_sel_hi:[1,1,0]
v_pk_fma_f32 v[54:55], v[54:55], v[72:73], v[72:73] op_sel:[0,1,0] op_sel_hi:[1,1,0]
v_cvt_pk_bf16_f32 v160, v48, v49
v_cvt_pk_bf16_f32 v161, v50, v51
v_cvt_pk_bf16_f32 v162, v52, v53
v_cvt_pk_bf16_f32 v163, v54, v55
ds_write_b128 v2, v[160:163] offset:512
s_add_u32 s41, s40, 69632
buffer_load_dwordx4 a[80:83], v1, s[12:15], s41 offen offset:0 sc1
v_lshlrev_b32 v56, 16, v164
v_and_b32 v57, s43, v164
v_lshlrev_b32 v58, 16, v165
v_and_b32 v59, s43, v165
v_lshlrev_b32 v60, 16, v166
v_and_b32 v61, s43, v166
v_lshlrev_b32 v62, 16, v167
v_and_b32 v63, s43, v167
v_pk_fma_f32 v[56:57], v[56:57], v[72:73], v[72:73] op_sel:[0,1,0] op_sel_hi:[1,1,0]
v_pk_fma_f32 v[58:59], v[58:59], v[72:73], v[72:73] op_sel:[0,1,0] op_sel_hi:[1,1,0]
v_pk_fma_f32 v[60:61], v[60:61], v[72:73], v[72:73] op_sel:[0,1,0] op_sel_hi:[1,1,0]
v_pk_fma_f32 v[62:63], v[62:63], v[72:73], v[72:73] op_sel:[0,1,0] op_sel_hi:[1,1,0]
v_cvt_pk_bf16_f32 v164, v56, v57
v_cvt_pk_bf16_f32 v165, v58, v59
v_cvt_pk_bf16_f32 v166, v60, v61
v_cvt_pk_bf16_f32 v167, v62, v63
ds_write_b128 v2, v[164:167] offset:576
buffer_load_dwordx4 a[84:87], v1, s[12:15], s41 offen offset:1024 sc1
v_accvgpr_read_b32 v80, a96
v_accvgpr_read_b32 v81, a97
v_accvgpr_read_b32 v82, a98
v_accvgpr_read_b32 v83, a99
v_accvgpr_read_b32 v84, a104
v_accvgpr_read_b32 v85, a105
v_accvgpr_read_b32 v86, a106
v_accvgpr_read_b32 v87, a107
v_cvt_pk_bf16_f32 v88, v80, v81
v_cvt_pk_bf16_f32 v89, v82, v83
v_cvt_pk_bf16_f32 v90, v84, v85
v_cvt_pk_bf16_f32 v91, v86, v87
s_add_u32 s29, s29, 4096
buffer_store_dwordx4 v[88:91], v1, s[68:71], s29 offen offset:0 sc1
s_mov_b64 exec, s[30:31]
s_waitcnt lgkmcnt(12)
ds_write_b128 v1, v[88:91] offset:45568
s_mov_b64 exec, -1
v_lshlrev_b32 v48, 16, v168
v_and_b32 v49, s43, v168
v_lshlrev_b32 v50, 16, v169
v_and_b32 v51, s43, v169
v_lshlrev_b32 v52, 16, v170
v_and_b32 v53, s43, v170
v_lshlrev_b32 v54, 16, v171
v_and_b32_e64 v55, s43, v171
v_pk_fma_f32 v[48:49], v[48:49], v[72:73], v[72:73] op_sel:[0,1,0] op_sel_hi:[1,1,0]
v_pk_fma_f32 v[50:51], v[50:51], v[72:73], v[72:73] op_sel:[0,1,0] op_sel_hi:[1,1,0]
v_pk_fma_f32 v[52:53], v[52:53], v[72:73], v[72:73] op_sel:[0,1,0] op_sel_hi:[1,1,0]
v_pk_fma_f32 v[54:55], v[54:55], v[72:73], v[72:73] op_sel:[0,1,0] op_sel_hi:[1,1,0]
v_cvt_pk_bf16_f32 v168, v48, v49
v_cvt_pk_bf16_f32 v169, v50, v51
v_cvt_pk_bf16_f32 v170, v52, v53
v_cvt_pk_bf16_f32 v171, v54, v55
ds_write_b128 v2, v[168:171] offset:640
buffer_load_dwordx4 a[88:91], v1, s[12:15], s41 offen offset:2048 sc1
v_lshlrev_b32 v56, 16, v172
v_and_b32 v57, s43, v172
v_lshlrev_b32 v58, 16, v173
v_and_b32 v59, s43, v173
v_lshlrev_b32 v60, 16, v174
v_and_b32 v61, s43, v174
v_lshlrev_b32 v62, 16, v175
v_and_b32 v63, s43, v175
v_pk_fma_f32 v[56:57], v[56:57], v[72:73], v[72:73] op_sel:[0,1,0] op_sel_hi:[1,1,0]
v_pk_fma_f32 v[58:59], v[58:59], v[72:73], v[72:73] op_sel:[0,1,0] op_sel_hi:[1,1,0]
v_pk_fma_f32 v[60:61], v[60:61], v[72:73], v[72:73] op_sel:[0,1,0] op_sel_hi:[1,1,0]
v_pk_fma_f32 v[62:63], v[62:63], v[72:73], v[72:73] op_sel:[0,1,0] op_sel_hi:[1,1,0]
v_cvt_pk_bf16_f32 v172, v56, v57
v_cvt_pk_bf16_f32 v173, v58, v59
v_cvt_pk_bf16_f32 v174, v60, v61
v_cvt_pk_bf16_f32 v175, v62, v63
ds_write_b128 v2, v[172:175] offset:704
buffer_load_dwordx4 a[92:95], v1, s[12:15], s41 offen offset:3072 sc1
v_accvgpr_read_b32 v80, a100
v_accvgpr_read_b32 v81, a101
v_accvgpr_read_b32 v82, a102
v_accvgpr_read_b32 v83, a103
v_accvgpr_read_b32 v84, a108
v_accvgpr_read_b32 v85, a109
v_accvgpr_read_b32 v86, a110
v_accvgpr_read_b32 v87, a111
v_cvt_pk_bf16_f32 v92, v80, v81
v_cvt_pk_bf16_f32 v93, v82, v83
v_cvt_pk_bf16_f32 v94, v84, v85
v_cvt_pk_bf16_f32 v95, v86, v87
buffer_store_dwordx4 v[92:95], v1, s[68:71], s29 offen offset:1024 sc1
s_mov_b64 exec, s[30:31]
s_waitcnt lgkmcnt(12)
ds_write_b128 v1, v[92:95] offset:46592
s_mov_b64 exec, -1
v_lshlrev_b32 v48, 16, v176
v_and_b32 v49, s43, v176
v_lshlrev_b32 v50, 16, v177
v_and_b32 v51, s43, v177
v_lshlrev_b32 v52, 16, v178
v_and_b32 v53, s43, v178
v_lshlrev_b32 v54, 16, v179
v_and_b32_e64 v55, s43, v179
v_pk_fma_f32 v[48:49], v[48:49], v[72:73], v[72:73] op_sel:[0,1,0] op_sel_hi:[1,1,0]
v_pk_fma_f32 v[50:51], v[50:51], v[72:73], v[72:73] op_sel:[0,1,0] op_sel_hi:[1,1,0]
v_pk_fma_f32 v[52:53], v[52:53], v[72:73], v[72:73] op_sel:[0,1,0] op_sel_hi:[1,1,0]
v_pk_fma_f32 v[54:55], v[54:55], v[72:73], v[72:73] op_sel:[0,1,0] op_sel_hi:[1,1,0]
v_cvt_pk_bf16_f32 v176, v48, v49
v_cvt_pk_bf16_f32 v177, v50, v51
v_cvt_pk_bf16_f32 v178, v52, v53
v_cvt_pk_bf16_f32 v179, v54, v55
ds_write_b128 v2, v[176:179] offset:768
s_add_u32 s41, s40, 98304
buffer_load_dwordx4 a[96:99], v1, s[12:15], s41 offen offset:0 sc1
v_lshlrev_b32 v56, 16, v180
v_and_b32 v57, s43, v180
v_lshlrev_b32 v58, 16, v181
v_and_b32 v59, s43, v181
v_lshlrev_b32 v60, 16, v182
v_and_b32 v61, s43, v182
v_lshlrev_b32 v62, 16, v183
v_and_b32 v63, s43, v183
v_pk_fma_f32 v[56:57], v[56:57], v[72:73], v[72:73] op_sel:[0,1,0] op_sel_hi:[1,1,0]
v_pk_fma_f32 v[58:59], v[58:59], v[72:73], v[72:73] op_sel:[0,1,0] op_sel_hi:[1,1,0]
v_pk_fma_f32 v[60:61], v[60:61], v[72:73], v[72:73] op_sel:[0,1,0] op_sel_hi:[1,1,0]
v_pk_fma_f32 v[62:63], v[62:63], v[72:73], v[72:73] op_sel:[0,1,0] op_sel_hi:[1,1,0]
v_cvt_pk_bf16_f32 v180, v56, v57
v_cvt_pk_bf16_f32 v181, v58, v59
v_cvt_pk_bf16_f32 v182, v60, v61
v_cvt_pk_bf16_f32 v183, v62, v63
ds_write_b128 v2, v[180:183] offset:832
buffer_load_dwordx4 a[100:103], v1, s[12:15], s41 offen offset:1024 sc1
v_accvgpr_read_b32 v80, a112
v_accvgpr_read_b32 v81, a113
v_accvgpr_read_b32 v82, a114
v_accvgpr_read_b32 v83, a115
v_accvgpr_read_b32 v84, a120
v_accvgpr_read_b32 v85, a121
v_accvgpr_read_b32 v86, a122
v_accvgpr_read_b32 v87, a123
v_cvt_pk_bf16_f32 v88, v80, v81
v_cvt_pk_bf16_f32 v89, v82, v83
v_cvt_pk_bf16_f32 v90, v84, v85
v_cvt_pk_bf16_f32 v91, v86, v87
buffer_store_dwordx4 v[88:91], v1, s[68:71], s29 offen offset:2048 sc1
s_mov_b64 exec, s[30:31]
s_waitcnt lgkmcnt(12)
ds_write_b128 v1, v[88:91] offset:47616
s_mov_b64 exec, -1
v_lshlrev_b32 v48, 16, v184
v_and_b32 v49, s43, v184
v_lshlrev_b32 v50, 16, v185
v_and_b32 v51, s43, v185
v_lshlrev_b32 v52, 16, v186
v_and_b32 v53, s43, v186
v_lshlrev_b32 v54, 16, v187
v_and_b32_e64 v55, s43, v187
v_pk_fma_f32 v[48:49], v[48:49], v[72:73], v[72:73] op_sel:[0,1,0] op_sel_hi:[1,1,0]
v_pk_fma_f32 v[50:51], v[50:51], v[72:73], v[72:73] op_sel:[0,1,0] op_sel_hi:[1,1,0]
v_pk_fma_f32 v[52:53], v[52:53], v[72:73], v[72:73] op_sel:[0,1,0] op_sel_hi:[1,1,0]
v_pk_fma_f32 v[54:55], v[54:55], v[72:73], v[72:73] op_sel:[0,1,0] op_sel_hi:[1,1,0]
v_cvt_pk_bf16_f32 v184, v48, v49
v_cvt_pk_bf16_f32 v185, v50, v51
v_cvt_pk_bf16_f32 v186, v52, v53
v_cvt_pk_bf16_f32 v187, v54, v55
ds_write_b128 v2, v[184:187] offset:896
buffer_load_dwordx4 a[104:107], v1, s[12:15], s41 offen offset:2048 sc1
v_lshlrev_b32 v56, 16, v188
v_and_b32 v57, s43, v188
v_lshlrev_b32 v58, 16, v189
v_and_b32 v59, s43, v189
v_lshlrev_b32 v60, 16, v190
v_and_b32 v61, s43, v190
v_lshlrev_b32 v62, 16, v191
v_and_b32 v63, s43, v191
v_pk_fma_f32 v[56:57], v[56:57], v[72:73], v[72:73] op_sel:[0,1,0] op_sel_hi:[1,1,0]
v_pk_fma_f32 v[58:59], v[58:59], v[72:73], v[72:73] op_sel:[0,1,0] op_sel_hi:[1,1,0]
v_pk_fma_f32 v[60:61], v[60:61], v[72:73], v[72:73] op_sel:[0,1,0] op_sel_hi:[1,1,0]
v_pk_fma_f32 v[62:63], v[62:63], v[72:73], v[72:73] op_sel:[0,1,0] op_sel_hi:[1,1,0]
v_cvt_pk_bf16_f32 v188, v56, v57
v_cvt_pk_bf16_f32 v189, v58, v59
v_cvt_pk_bf16_f32 v190, v60, v61
v_cvt_pk_bf16_f32 v191, v62, v63
ds_write_b128 v2, v[188:191] offset:960
s_waitcnt vmcnt(62)
s_nop 0
buffer_load_dwordx4 a[108:111], v1, s[12:15], s41 offen offset:3072 sc1
v_accvgpr_read_b32 v80, a116
v_accvgpr_read_b32 v81, a117
v_accvgpr_read_b32 v82, a118
v_accvgpr_read_b32 v83, a119
v_accvgpr_read_b32 v84, a124
v_accvgpr_read_b32 v85, a125
v_accvgpr_read_b32 v86, a126
v_accvgpr_read_b32 v87, a127
v_cvt_pk_bf16_f32 v92, v80, v81
v_cvt_pk_bf16_f32 v93, v82, v83
v_cvt_pk_bf16_f32 v94, v84, v85
v_cvt_pk_bf16_f32 v95, v86, v87
s_waitcnt vmcnt(62)
buffer_store_dwordx4 v[92:95], v1, s[68:71], s29 offen offset:3072 sc1
s_mov_b64 exec, s[30:31]
s_waitcnt lgkmcnt(12)
ds_write_b128 v1, v[92:95] offset:48640
s_mov_b64 exec, -1
v_add_u32_e64 v2, s59, v5
s_waitcnt lgkmcnt(0)
s_barrier
ds_read_b128 v[32:35], v3 offset:0
ds_read_b128 v[36:39], v3 offset:16640
ds_read_b128 v[40:43], v3 offset:1040
ds_read_b128 v[44:47], v3 offset:17680
ds_read_b128 v[48:51], v3 offset:2080
ds_read_b128 v[52:55], v3 offset:18720
ds_read_b128 v[56:59], v3 offset:3120
ds_read_b128 v[60:63], v3 offset:19760
ds_read_b128 v[128:131], v3 offset:4160
ds_read_b128 v[132:135], v3 offset:20800
s_waitcnt vmcnt(57)
s_nop 0
v_perm_b32 v8, v192, v192, v16
v_perm_b32 v9, v192, v192, v17
v_perm_b32 v10, v192, v192, v18
v_perm_b32 v11, v192, v192, v19
v_perm_b32 v12, v192, v192, v20
v_perm_b32 v13, v192, v192, v21
v_perm_b32 v14, v192, v192, v22
v_perm_b32 v15, v192, v192, v23
s_waitcnt lgkmcnt(6)
s_nop 0
v_mfma_f32_16x16x32_bf16 v[64:67], v[8:11], v[32:35], 0
ds_read_b128 v[136:139], v3 offset:5200
s_add_u32 s41, s40, 102400
buffer_load_dwordx4 a[112:115], v1, s[12:15], s41 offen offset:0 sc1
v_perm_b32 v24, v193, v193, v16
v_perm_b32 v25, v193, v193, v17
v_accvgpr_read_b32 v80, a128
v_accvgpr_read_b32 v81, a129
v_accvgpr_read_b32 v82, a130
v_mfma_f32_16x16x32_bf16 v[68:71], v[8:11], v[36:39], 0
ds_read_b128 v[140:143], v3 offset:21840
v_perm_b32 v26, v193, v193, v18
v_perm_b32 v27, v193, v193, v19
v_accvgpr_read_b32 v83, a131
v_accvgpr_read_b32 v84, a136
v_accvgpr_read_b32 v85, a137
v_mfma_f32_16x16x32_bf16 v[64:67], v[12:15], v[40:43], v[64:67]
ds_read_b128 v[32:35], v3 offset:6240
buffer_load_dwordx4 a[116:119], v1, s[12:15], s41 offen offset:1024 sc1
v_perm_b32 v28, v193, v193, v20
v_perm_b32 v29, v193, v193, v21
v_accvgpr_read_b32 v86, a138
v_accvgpr_read_b32 v87, a139
v_cvt_pk_bf16_f32 v88, v80, v81
v_mfma_f32_16x16x32_bf16 v[68:71], v[12:15], v[44:47], v[68:71]
s_waitcnt lgkmcnt(5)
s_nop 0
ds_read_b128 v[36:39], v3 offset:22880
v_perm_b32 v30, v193, v193, v22
v_perm_b32 v31, v193, v193, v23
v_cvt_pk_bf16_f32 v89, v82, v83
v_cvt_pk_bf16_f32 v90, v84, v85
v_cvt_pk_bf16_f32 v91, v86, v87
v_mfma_f32_16x16x32_bf16 v[64:67], v[24:27], v[48:51], v[64:67]
ds_read_b128 v[40:43], v3 offset:7280
buffer_load_dwordx4 a[120:123], v1, s[12:15], s41 offen offset:2048 sc1
v_perm_b32 v8, v194, v194, v16
v_perm_b32 v9, v194, v194, v17
v_mfma_f32_16x16x32_bf16 v[68:71], v[24:27], v[52:55], v[68:71]
ds_read_b128 v[44:47], v3 offset:23920
s_add_u32 s29, s29, 4096
buffer_store_dwordx4 v[88:91], v1, s[68:71], s29 offen offset:0 sc1
s_mov_b64 exec, s[30:31]
ds_write_b128 v1, v[88:91] offset:49664
s_mov_b64 exec, -1
v_perm_b32 v10, v194, v194, v18
v_perm_b32 v11, v194, v194, v19
v_accvgpr_read_b32 v80, a132
v_accvgpr_read_b32 v81, a133
v_accvgpr_read_b32 v82, a134
v_mfma_f32_16x16x32_bf16 v[64:67], v[28:31], v[56:59], v[64:67]
ds_read_b128 v[48:51], v3 offset:8320
buffer_load_dwordx4 a[124:127], v1, s[12:15], s41 offen offset:3072 sc1
v_perm_b32 v12, v194, v194, v20
v_perm_b32 v13, v194, v194, v21
v_accvgpr_read_b32 v83, a135
v_accvgpr_read_b32 v84, a140
v_accvgpr_read_b32 v85, a141
v_mfma_f32_16x16x32_bf16 v[68:71], v[28:31], v[60:63], v[68:71]
s_waitcnt lgkmcnt(6)
s_nop 0
ds_read_b128 v[52:55], v3 offset:24960
v_perm_b32 v14, v194, v194, v22
v_perm_b32 v15, v194, v194, v23
v_accvgpr_read_b32 v86, a142
v_accvgpr_read_b32 v87, a143
v_cvt_pk_bf16_f32 v92, v80, v81
v_mfma_f32_16x16x32_bf16 v[64:67], v[8:11], v[128:131], v[64:67]
ds_read_b128 v[56:59], v3 offset:9360
v_perm_b32 v24, v195, v195, v16
v_perm_b32 v25, v195, v195, v17
v_cvt_pk_bf16_f32 v93, v82, v83
v_cvt_pk_bf16_f32 v94, v84, v85
v_cvt_pk_bf16_f32 v95, v86, v87
v_mfma_f32_16x16x32_bf16 v[68:71], v[8:11], v[132:135], v[68:71]
ds_read_b128 v[60:63], v3 offset:26000
buffer_store_dwordx4 v[92:95], v1, s[68:71], s29 offen offset:1024 sc1
s_mov_b64 exec, s[30:31]
ds_write_b128 v1, v[92:95] offset:50688
s_mov_b64 exec, -1
v_perm_b32 v26, v195, v195, v18
v_perm_b32 v27, v195, v195, v19
v_accvgpr_read_b32 v80, a144
v_accvgpr_read_b32 v81, a145
v_accvgpr_read_b32 v82, a146
v_mfma_f32_16x16x32_bf16 v[64:67], v[12:15], v[136:139], v[64:67]
ds_read_b128 v[128:131], v3 offset:10400
s_add_u32 s41, s40, 8192
s_waitcnt vmcnt(62)
s_nop 0
buffer_load_dwordx4 a[128:131], v1, s[12:15], s41 offen offset:0 sc1
v_perm_b32 v28, v195, v195, v20
v_perm_b32 v29, v195, v195, v21
v_accvgpr_read_b32 v83, a147
v_accvgpr_read_b32 v84, a152
v_accvgpr_read_b32 v85, a153
v_mfma_f32_16x16x32_bf16 v[68:71], v[12:15], v[140:143], v[68:71]
s_waitcnt lgkmcnt(7)
s_nop 0
ds_read_b128 v[132:135], v3 offset:27040
v_perm_b32 v30, v195, v195, v22
v_perm_b32 v31, v195, v195, v23
v_accvgpr_read_b32 v86, a154
v_accvgpr_read_b32 v87, a155
v_cvt_pk_bf16_f32 v88, v80, v81
v_mfma_f32_16x16x32_bf16 v[64:67], v[24:27], v[32:35], v[64:67]
ds_read_b128 v[136:139], v3 offset:11440
s_waitcnt vmcnt(62)
s_nop 0
buffer_load_dwordx4 a[132:135], v1, s[12:15], s41 offen offset:1024 sc1
v_perm_b32 v8, v196, v196, v16
v_perm_b32 v9, v196, v196, v17
v_cvt_pk_bf16_f32 v89, v82, v83
v_cvt_pk_bf16_f32 v90, v84, v85
v_cvt_pk_bf16_f32 v91, v86, v87
v_mfma_f32_16x16x32_bf16 v[68:71], v[24:27], v[36:39], v[68:71]
ds_read_b128 v[140:143], v3 offset:28080
s_waitcnt vmcnt(62)
buffer_store_dwordx4 v[88:91], v1, s[68:71], s29 offen offset:2048 sc1
s_mov_b64 exec, s[30:31]
ds_write_b128 v1, v[88:91] offset:51712
s_mov_b64 exec, -1
s_nop 0
v_perm_b32 v10, v196, v196, v18
v_perm_b32 v11, v196, v196, v19
v_accvgpr_read_b32 v80, a148
v_accvgpr_read_b32 v81, a149
v_accvgpr_read_b32 v82, a150
v_mfma_f32_16x16x32_bf16 v[64:67], v[28:31], v[40:43], v[64:67]
ds_read_b128 v[32:35], v3 offset:12480
s_waitcnt vmcnt(62)
s_nop 0
buffer_load_dwordx4 a[136:139], v1, s[12:15], s41 offen offset:2048 sc1
v_perm_b32 v12, v196, v196, v20
v_perm_b32 v13, v196, v196, v21
v_accvgpr_read_b32 v83, a151
v_accvgpr_read_b32 v84, a156
v_accvgpr_read_b32 v85, a157
v_mfma_f32_16x16x32_bf16 v[68:71], v[28:31], v[44:47], v[68:71]
s_waitcnt lgkmcnt(7)
s_nop 0
ds_read_b128 v[36:39], v3 offset:29120
v_perm_b32 v14, v196, v196, v22
v_perm_b32 v15, v196, v196, v23
v_accvgpr_read_b32 v86, a158
v_accvgpr_read_b32 v87, a159
v_cvt_pk_bf16_f32 v92, v80, v81
v_mfma_f32_16x16x32_bf16 v[64:67], v[8:11], v[48:51], v[64:67]
ds_read_b128 v[40:43], v3 offset:13520
s_waitcnt vmcnt(62)
s_nop 0
buffer_load_dwordx4 a[140:143], v1, s[12:15], s41 offen offset:3072 sc1
v_perm_b32 v24, v197, v197, v16
v_perm_b32 v25, v197, v197, v17
v_cvt_pk_bf16_f32 v93, v82, v83
v_cvt_pk_bf16_f32 v94, v84, v85
v_cvt_pk_bf16_f32 v95, v86, v87
v_mfma_f32_16x16x32_bf16 v[68:71], v[8:11], v[52:55], v[68:71]
ds_read_b128 v[44:47], v3 offset:30160
s_waitcnt vmcnt(62)
buffer_store_dwordx4 v[92:95], v1, s[68:71], s29 offen offset:3072 sc1
s_mov_b64 exec, s[30:31]
ds_write_b128 v1, v[92:95] offset:52736
s_mov_b64 exec, -1
s_nop 0
v_perm_b32 v26, v197, v197, v18
v_perm_b32 v27, v197, v197, v19
v_accvgpr_read_b32 v80, a160
v_accvgpr_read_b32 v81, a161
v_accvgpr_read_b32 v82, a162
v_mfma_f32_16x16x32_bf16 v[64:67], v[12:15], v[56:59], v[64:67]
ds_read_b128 v[48:51], v3 offset:14560
s_add_u32 s41, s40, 12288
s_waitcnt vmcnt(62)
s_nop 0
buffer_load_dwordx4 a[144:147], v1, s[12:15], s41 offen offset:0 sc1
v_perm_b32 v28, v197, v197, v20
v_perm_b32 v29, v197, v197, v21
v_accvgpr_read_b32 v83, a163
v_accvgpr_read_b32 v84, a168
v_accvgpr_read_b32 v85, a169
v_mfma_f32_16x16x32_bf16 v[68:71], v[12:15], v[60:63], v[68:71]
s_waitcnt lgkmcnt(7)
s_nop 0
ds_read_b128 v[52:55], v3 offset:31200
v_perm_b32 v30, v197, v197, v22
v_perm_b32 v31, v197, v197, v23
v_accvgpr_read_b32 v86, a170
v_accvgpr_read_b32 v87, a171
v_cvt_pk_bf16_f32 v88, v80, v81
v_mfma_f32_16x16x32_bf16 v[64:67], v[24:27], v[128:131], v[64:67]
ds_read_b128 v[56:59], v3 offset:15600
s_waitcnt vmcnt(62)
s_nop 0
buffer_load_dwordx4 a[148:151], v1, s[12:15], s41 offen offset:1024 sc1
v_perm_b32 v8, v198, v198, v16
v_perm_b32 v9, v198, v198, v17
v_cvt_pk_bf16_f32 v89, v82, v83
v_cvt_pk_bf16_f32 v90, v84, v85
v_cvt_pk_bf16_f32 v91, v86, v87
v_mfma_f32_16x16x32_bf16 v[68:71], v[24:27], v[132:135], v[68:71]
ds_read_b128 v[60:63], v3 offset:32240
s_add_u32 s29, s29, 4096
s_waitcnt vmcnt(62)
buffer_store_dwordx4 v[88:91], v1, s[68:71], s29 offen offset:0 sc1
s_mov_b64 exec, s[30:31]
ds_write_b128 v1, v[88:91] offset:53760
s_mov_b64 exec, -1
s_nop 0
v_perm_b32 v10, v198, v198, v18
v_perm_b32 v11, v198, v198, v19
v_accvgpr_read_b32 v80, a164
v_accvgpr_read_b32 v81, a165
v_accvgpr_read_b32 v82, a166
v_mfma_f32_16x16x32_bf16 v[64:67], v[28:31], v[136:139], v[64:67]
ds_read_b128 v[128:131], v3 offset:32
s_waitcnt vmcnt(62)
s_nop 0
buffer_load_dwordx4 a[152:155], v1, s[12:15], s41 offen offset:2048 sc1
v_perm_b32 v12, v198, v198, v20
v_perm_b32 v13, v198, v198, v21
v_accvgpr_read_b32 v83, a167
v_accvgpr_read_b32 v84, a172
v_accvgpr_read_b32 v85, a173
v_mfma_f32_16x16x32_bf16 v[68:71], v[28:31], v[140:143], v[68:71]
s_waitcnt lgkmcnt(7)
s_nop 0
ds_read_b128 v[132:135], v3 offset:16672
v_perm_b32 v14, v198, v198, v22
v_perm_b32 v15, v198, v198, v23
v_accvgpr_read_b32 v86, a174
v_accvgpr_read_b32 v87, a175
v_cvt_pk_bf16_f32 v92, v80, v81
v_mfma_f32_16x16x32_bf16 v[64:67], v[8:11], v[32:35], v[64:67]
ds_read_b128 v[136:139], v3 offset:1072
s_waitcnt vmcnt(62)
s_nop 0
buffer_load_dwordx4 a[156:159], v1, s[12:15], s41 offen offset:3072 sc1
v_perm_b32 v24, v199, v199, v16
v_perm_b32 v25, v199, v199, v17
v_cvt_pk_bf16_f32 v93, v82, v83
v_cvt_pk_bf16_f32 v94, v84, v85
v_cvt_pk_bf16_f32 v95, v86, v87
v_mfma_f32_16x16x32_bf16 v[68:71], v[8:11], v[36:39], v[68:71]
ds_read_b128 v[140:143], v3 offset:17712
s_waitcnt vmcnt(62)
buffer_store_dwordx4 v[92:95], v1, s[68:71], s29 offen offset:1024 sc1
s_mov_b64 exec, s[30:31]
ds_write_b128 v1, v[92:95] offset:54784
s_mov_b64 exec, -1
s_nop 0
v_perm_b32 v26, v199, v199, v18
v_perm_b32 v27, v199, v199, v19
v_accvgpr_read_b32 v80, a176
v_accvgpr_read_b32 v81, a177
v_accvgpr_read_b32 v82, a178
v_mfma_f32_16x16x32_bf16 v[64:67], v[12:15], v[40:43], v[64:67]
ds_read_b128 v[32:35], v3 offset:2112
s_add_u32 s41, s40, 40960
s_waitcnt vmcnt(62)
s_nop 0
buffer_load_dwordx4 a[160:163], v1, s[12:15], s41 offen offset:0 sc1
v_perm_b32 v28, v199, v199, v20
v_perm_b32 v29, v199, v199, v21
v_accvgpr_read_b32 v83, a179
v_accvgpr_read_b32 v84, a184
v_accvgpr_read_b32 v85, a185
v_mfma_f32_16x16x32_bf16 v[68:71], v[12:15], v[44:47], v[68:71]
s_waitcnt lgkmcnt(7)
s_nop 0
ds_read_b128 v[36:39], v3 offset:18752
v_perm_b32 v30, v199, v199, v22
v_perm_b32 v31, v199, v199, v23
v_accvgpr_read_b32 v86, a186
v_accvgpr_read_b32 v87, a187
v_cvt_pk_bf16_f32 v88, v80, v81
v_mfma_f32_16x16x32_bf16 v[64:67], v[24:27], v[48:51], v[64:67]
ds_read_b128 v[40:43], v3 offset:3152
s_waitcnt vmcnt(62)
s_nop 0
buffer_load_dwordx4 a[164:167], v1, s[12:15], s41 offen offset:1024 sc1
v_perm_b32 v8, v200, v200, v16
v_perm_b32 v9, v200, v200, v17
v_cvt_pk_bf16_f32 v89, v82, v83
v_cvt_pk_bf16_f32 v90, v84, v85
v_cvt_pk_bf16_f32 v91, v86, v87
v_mfma_f32_16x16x32_bf16 v[68:71], v[24:27], v[52:55], v[68:71]
ds_read_b128 v[44:47], v3 offset:19792
s_waitcnt vmcnt(62)
buffer_store_dwordx4 v[88:91], v1, s[68:71], s29 offen offset:2048 sc1
s_mov_b64 exec, s[30:31]
ds_write_b128 v1, v[88:91] offset:55808
s_mov_b64 exec, -1
v_perm_b32 v10, v200, v200, v18
v_perm_b32 v11, v200, v200, v19
v_mfma_f32_16x16x32_bf16 v[64:67], v[28:31], v[56:59], v[64:67]
ds_read_b128 v[48:51], v3 offset:4192
s_waitcnt vmcnt(62)
buffer_load_dwordx4 a[168:171], v1, s[12:15], s41 offen offset:2048 sc1
v_perm_b32 v12, v200, v200, v20
v_perm_b32 v13, v200, v200, v21
v_mfma_f32_16x16x32_bf16 v[68:71], v[28:31], v[60:63], v[68:71]
s_waitcnt lgkmcnt(7)
ds_read_b128 v[52:55], v3 offset:20832
v_perm_b32 v14, v200, v200, v22
v_perm_b32 v15, v200, v200, v23
v_mfma_f32_16x16x32_bf16 v[72:75], v[8:11], v[128:131], 0
ds_read_b128 v[56:59], v3 offset:5232
s_waitcnt vmcnt(62)
buffer_load_dwordx4 a[172:175], v1, s[12:15], s41 offen offset:3072 sc1
v_perm_b32 v24, v201, v201, v16
v_perm_b32 v25, v201, v201, v17
v_mfma_f32_16x16x32_bf16 v[76:79], v[8:11], v[132:135], 0
ds_read_b128 v[60:63], v3 offset:21872
v_perm_b32 v26, v201, v201, v18
v_perm_b32 v27, v201, v201, v19
v_mfma_f32_16x16x32_bf16 v[72:75], v[12:15], v[136:139], v[72:75]
ds_read_b128 v[128:131], v3 offset:6272
v_perm_b32 v28, v201, v201, v20
v_perm_b32 v29, v201, v201, v21
v_mfma_f32_16x16x32_bf16 v[76:79], v[12:15], v[140:143], v[76:79]
s_waitcnt lgkmcnt(6)
s_nop 0
ds_read_b128 v[132:135], v3 offset:22912
v_perm_b32 v30, v201, v201, v22
v_perm_b32 v31, v201, v201, v23
v_mfma_f32_16x16x32_bf16 v[72:75], v[24:27], v[32:35], v[72:75]
ds_read_b128 v[136:139], v3 offset:7312
v_perm_b32 v8, v202, v202, v16
v_perm_b32 v9, v202, v202, v17
v_mfma_f32_16x16x32_bf16 v[76:79], v[24:27], v[36:39], v[76:79]
ds_read_b128 v[140:143], v3 offset:23952
v_perm_b32 v10, v202, v202, v18
v_perm_b32 v11, v202, v202, v19
v_mfma_f32_16x16x32_bf16 v[72:75], v[28:31], v[40:43], v[72:75]
ds_read_b128 v[32:35], v3 offset:8352
v_perm_b32 v12, v202, v202, v20
v_perm_b32 v13, v202, v202, v21
v_mfma_f32_16x16x32_bf16 v[76:79], v[28:31], v[44:47], v[76:79]
s_waitcnt lgkmcnt(5)
s_nop 0
ds_read_b128 v[36:39], v3 offset:24992
v_perm_b32 v14, v202, v202, v22
v_perm_b32 v15, v202, v202, v23
v_mfma_f32_16x16x32_bf16 v[72:75], v[8:11], v[48:51], v[72:75]
ds_read_b128 v[40:43], v3 offset:9392
v_perm_b32 v24, v203, v203, v16
v_perm_b32 v25, v203, v203, v17
v_mfma_f32_16x16x32_bf16 v[76:79], v[8:11], v[52:55], v[76:79]
ds_read_b128 v[44:47], v3 offset:26032
v_perm_b32 v26, v203, v203, v18
v_perm_b32 v27, v203, v203, v19
v_mfma_f32_16x16x32_bf16 v[72:75], v[12:15], v[56:59], v[72:75]
ds_read_b128 v[48:51], v3 offset:10432
v_perm_b32 v28, v203, v203, v20
v_perm_b32 v29, v203, v203, v21
v_mfma_f32_16x16x32_bf16 v[76:79], v[12:15], v[60:63], v[76:79]
s_waitcnt lgkmcnt(5)
s_nop 0
ds_read_b128 v[52:55], v3 offset:27072
v_perm_b32 v30, v203, v203, v22
v_perm_b32 v31, v203, v203, v23
v_mfma_f32_16x16x32_bf16 v[72:75], v[24:27], v[128:131], v[72:75]
ds_read_b128 v[56:59], v3 offset:11472
v_perm_b32 v8, v204, v204, v16
v_perm_b32 v9, v204, v204, v17
v_mfma_f32_16x16x32_bf16 v[76:79], v[24:27], v[132:135], v[76:79]
ds_read_b128 v[60:63], v3 offset:28112
v_perm_b32 v10, v204, v204, v18
v_perm_b32 v11, v204, v204, v19
v_mfma_f32_16x16x32_bf16 v[72:75], v[28:31], v[136:139], v[72:75]
ds_read_b128 v[128:131], v3 offset:12512
v_perm_b32 v12, v204, v204, v20
v_perm_b32 v13, v204, v204, v21
v_mfma_f32_16x16x32_bf16 v[76:79], v[28:31], v[140:143], v[76:79]
s_waitcnt lgkmcnt(5)
s_nop 0
ds_read_b128 v[132:135], v3 offset:29152
v_perm_b32 v14, v204, v204, v22
v_perm_b32 v15, v204, v204, v23
v_mfma_f32_16x16x32_bf16 v[72:75], v[8:11], v[32:35], v[72:75]
ds_read_b128 v[136:139], v3 offset:13552
v_perm_b32 v24, v205, v205, v16
v_perm_b32 v25, v205, v205, v17
v_mfma_f32_16x16x32_bf16 v[76:79], v[8:11], v[36:39], v[76:79]
ds_read_b128 v[140:143], v3 offset:30192
v_perm_b32 v26, v205, v205, v18
v_perm_b32 v27, v205, v205, v19
v_mfma_f32_16x16x32_bf16 v[72:75], v[12:15], v[40:43], v[72:75]
ds_read_b128 v[32:35], v3 offset:14592
v_perm_b32 v28, v205, v205, v20
v_perm_b32 v29, v205, v205, v21
v_mfma_f32_16x16x32_bf16 v[76:79], v[12:15], v[44:47], v[76:79]
s_waitcnt lgkmcnt(5)
s_nop 0
ds_read_b128 v[36:39], v3 offset:31232
v_perm_b32 v30, v205, v205, v22
v_perm_b32 v31, v205, v205, v23
v_mfma_f32_16x16x32_bf16 v[72:75], v[24:27], v[48:51], v[72:75]
ds_read_b128 v[40:43], v3 offset:15632
v_perm_b32 v8, v206, v206, v16
v_perm_b32 v9, v206, v206, v17
v_mfma_f32_16x16x32_bf16 v[76:79], v[24:27], v[52:55], v[76:79]
ds_read_b128 v[44:47], v3 offset:32272
v_perm_b32 v10, v206, v206, v18
v_perm_b32 v11, v206, v206, v19
v_mfma_f32_16x16x32_bf16 v[72:75], v[28:31], v[56:59], v[72:75]
v_perm_b32 v12, v206, v206, v20
v_perm_b32 v13, v206, v206, v21
v_mfma_f32_16x16x32_bf16 v[76:79], v[28:31], v[60:63], v[76:79]
s_waitcnt lgkmcnt(4)
v_perm_b32 v14, v206, v206, v22
v_perm_b32 v15, v206, v206, v23
v_mfma_f32_16x16x32_bf16 v[72:75], v[8:11], v[128:131], v[72:75]
s_waitcnt vmcnt(23)
s_mov_b64 exec, 1
buffer_store_dword v7, off, s[72:75], s36 offset:0 sc1
s_mov_b64 exec, -1
v_perm_b32 v24, v207, v207, v16
v_perm_b32 v25, v207, v207, v17
v_mfma_f32_16x16x32_bf16 v[76:79], v[8:11], v[132:135], v[76:79]
v_perm_b32 v26, v207, v207, v18
v_perm_b32 v27, v207, v207, v19
v_mfma_f32_16x16x32_bf16 v[72:75], v[12:15], v[136:139], v[72:75]
v_perm_b32 v28, v207, v207, v20
v_perm_b32 v29, v207, v207, v21
v_mfma_f32_16x16x32_bf16 v[76:79], v[12:15], v[140:143], v[76:79]
s_waitcnt lgkmcnt(0)
s_nop 0
v_perm_b32 v30, v207, v207, v22
v_perm_b32 v31, v207, v207, v23
v_mfma_f32_16x16x32_bf16 v[72:75], v[24:27], v[32:35], v[72:75]
v_mfma_f32_16x16x32_bf16 v[76:79], v[24:27], v[36:39], v[76:79]
v_mfma_f32_16x16x32_bf16 v[72:75], v[28:31], v[40:43], v[72:75]
v_mfma_f32_16x16x32_bf16 v[76:79], v[28:31], v[44:47], v[76:79]
s_nop 7
v_lshlrev_b32 v8, 16, v96
v_and_b32 v9, s43, v96
v_lshlrev_b32 v10, 16, v97
v_and_b32 v11, s43, v97
v_lshlrev_b32 v12, 16, v98
v_and_b32 v13, s43, v98
v_lshlrev_b32 v14, 16, v99
v_and_b32_e64 v15, s43, v99
v_pk_mul_f32 v[8:9], v[8:9], v[64:65]
v_pk_mul_f32 v[10:11], v[10:11], v[66:67]
v_pk_mul_f32 v[12:13], v[12:13], v[72:73]
v_pk_mul_f32 v[14:15], v[14:15], v[74:75]
v_cvt_pk_bf16_f32 v96, v8, v9
v_cvt_pk_bf16_f32 v97, v10, v11
v_cvt_pk_bf16_f32 v98, v12, v13
v_cvt_pk_bf16_f32 v99, v14, v15
ds_write_b128 v2, v[96:99] offset:0
v_lshlrev_b32 v24, 16, v100
v_and_b32 v25, s43, v100
v_lshlrev_b32 v26, 16, v101
v_and_b32 v27, s43, v101
v_lshlrev_b32 v28, 16, v102
v_and_b32 v29, s43, v102
v_lshlrev_b32 v30, 16, v103
v_and_b32 v31, s43, v103
v_pk_mul_f32 v[24:25], v[24:25], v[68:69]
v_pk_mul_f32 v[26:27], v[26:27], v[70:71]
v_pk_mul_f32 v[28:29], v[28:29], v[76:77]
v_pk_mul_f32 v[30:31], v[30:31], v[78:79]
v_cvt_pk_bf16_f32 v100, v24, v25
v_cvt_pk_bf16_f32 v101, v26, v27
v_cvt_pk_bf16_f32 v102, v28, v29
v_cvt_pk_bf16_f32 v103, v30, v31
ds_write_b128 v2, v[100:103] offset:1024
s_waitcnt lgkmcnt(0)
s_barrier
ds_read_b128 v[80:83], v5 offset:0
ds_read_b128 v[84:87], v5 offset:1024
ds_read_b128 v[32:35], v3 offset:64
ds_read_b128 v[36:39], v3 offset:16704
ds_read_b128 v[40:43], v3 offset:1104
ds_read_b128 v[44:47], v3 offset:17744
ds_read_b128 v[48:51], v3 offset:2144
ds_read_b128 v[52:55], v3 offset:18784
v_perm_b32 v8, v208, v208, v16
v_perm_b32 v9, v208, v208, v17
v_perm_b32 v10, v208, v208, v18
v_perm_b32 v11, v208, v208, v19
v_perm_b32 v12, v208, v208, v20
v_perm_b32 v13, v208, v208, v21
v_perm_b32 v14, v208, v208, v22
v_perm_b32 v15, v208, v208, v23
s_waitcnt lgkmcnt(2)
s_nop 0
v_mfma_f32_16x16x32_bf16 v[64:67], v[8:11], v[32:35], 0
ds_read_b128 v[56:59], v3 offset:3184
v_perm_b32 v24, v209, v209, v16
v_mfma_f32_16x16x32_bf16 v[68:71], v[8:11], v[36:39], 0
ds_read_b128 v[60:63], v3 offset:19824
v_perm_b32 v25, v209, v209, v17
v_mfma_f32_16x16x32_bf16 v[128:131], a[0:3], v[80:83], 0
v_perm_b32 v26, v209, v209, v18
v_perm_b32 v27, v209, v209, v19
v_mfma_f32_16x16x32_bf16 v[136:139], a[0:3], v[84:87], 0
s_add_u32 s41, s40, 45056
buffer_load_dwordx4 a[0:3], v1, s[12:15], s41 offen offset:0 sc1
v_accvgpr_read_b32 v192, a180
v_accvgpr_read_b32 v193, a181
v_accvgpr_read_b32 v194, a182
v_accvgpr_read_b32 v195, a183
v_accvgpr_read_b32 v196, a188
v_mfma_f32_16x16x32_bf16 v[64:67], v[12:15], v[40:43], v[64:67]
ds_read_b128 v[32:35], v3 offset:4224
v_perm_b32 v28, v209, v209, v20
v_mfma_f32_16x16x32_bf16 v[68:71], v[12:15], v[44:47], v[68:71]
ds_read_b128 v[36:39], v3 offset:20864
v_perm_b32 v29, v209, v209, v21
v_mfma_f32_16x16x32_bf16 v[132:135], a[4:7], v[80:83], 0
v_perm_b32 v30, v209, v209, v22
v_perm_b32 v31, v209, v209, v23
v_mfma_f32_16x16x32_bf16 v[140:143], a[4:7], v[84:87], 0
s_waitcnt lgkmcnt(2)
s_nop 0
ds_read_b128 v[88:91], v5 offset:2048
buffer_load_dwordx4 a[4:7], v1, s[12:15], s41 offen offset:1024 sc1
v_accvgpr_read_b32 v197, a189
v_accvgpr_read_b32 v198, a190
v_accvgpr_read_b32 v199, a191
v_cvt_pk_bf16_f32 v204, v192, v193
v_cvt_pk_bf16_f32 v205, v194, v195
v_mfma_f32_16x16x32_bf16 v[64:67], v[24:27], v[48:51], v[64:67]
ds_read_b128 v[40:43], v3 offset:5264
v_perm_b32 v8, v210, v210, v16
v_mfma_f32_16x16x32_bf16 v[68:71], v[24:27], v[52:55], v[68:71]
ds_read_b128 v[44:47], v3 offset:21904
v_perm_b32 v9, v210, v210, v17
v_mfma_f32_16x16x32_bf16 v[144:147], a[8:11], v[80:83], 0
v_perm_b32 v10, v210, v210, v18
v_perm_b32 v11, v210, v210, v19
v_mfma_f32_16x16x32_bf16 v[152:155], a[8:11], v[84:87], 0
ds_read_b128 v[92:95], v5 offset:3072
buffer_load_dwordx4 a[8:11], v1, s[12:15], s41 offen offset:2048 sc1
v_cvt_pk_bf16_f32 v206, v196, v197
v_cvt_pk_bf16_f32 v207, v198, v199
v_mfma_f32_16x16x32_bf16 v[64:67], v[28:31], v[56:59], v[64:67]
ds_read_b128 v[48:51], v3 offset:6304
v_perm_b32 v12, v210, v210, v20
v_mfma_f32_16x16x32_bf16 v[68:71], v[28:31], v[60:63], v[68:71]
ds_read_b128 v[52:55], v3 offset:22944
v_perm_b32 v13, v210, v210, v21
v_mfma_f32_16x16x32_bf16 v[148:151], a[12:15], v[80:83], 0
v_perm_b32 v14, v210, v210, v22
v_perm_b32 v15, v210, v210, v23
v_mfma_f32_16x16x32_bf16 v[156:159], a[12:15], v[84:87], 0
s_waitcnt lgkmcnt(3)
buffer_store_dwordx4 v[204:207], v1, s[68:71], s29 offen offset:3072 sc1
s_mov_b64 exec, s[30:31]
ds_write_b128 v1, v[204:207] offset:56832
s_mov_b64 exec, -1
s_nop 0
v_accvgpr_read_b32 v192, a192
v_accvgpr_read_b32 v193, a193
v_accvgpr_read_b32 v194, a194
v_accvgpr_read_b32 v195, a195
v_accvgpr_read_b32 v196, a200
v_mfma_f32_16x16x32_bf16 v[64:67], v[8:11], v[32:35], v[64:67]
ds_read_b128 v[56:59], v3 offset:7344
v_perm_b32 v24, v211, v211, v16
v_mfma_f32_16x16x32_bf16 v[68:71], v[8:11], v[36:39], v[68:71]
ds_read_b128 v[60:63], v3 offset:23984
v_perm_b32 v25, v211, v211, v17
v_mfma_f32_16x16x32_bf16 v[160:163], a[16:19], v[80:83], 0
v_perm_b32 v26, v211, v211, v18
v_perm_b32 v27, v211, v211, v19
v_mfma_f32_16x16x32_bf16 v[168:171], a[16:19], v[84:87], 0
buffer_load_dwordx4 a[12:15], v1, s[12:15], s41 offen offset:3072 sc1
s_add_u32 s41, s40, 73728
buffer_load_dwordx4 a[176:179], v1, s[12:15], s41 offen offset:0 sc1
v_accvgpr_read_b32 v197, a201
v_accvgpr_read_b32 v198, a202
v_accvgpr_read_b32 v199, a203
v_cvt_pk_bf16_f32 v200, v192, v193
v_cvt_pk_bf16_f32 v201, v194, v195
v_mfma_f32_16x16x32_bf16 v[64:67], v[12:15], v[40:43], v[64:67]
ds_read_b128 v[32:35], v3 offset:8384
v_perm_b32 v28, v211, v211, v20
v_mfma_f32_16x16x32_bf16 v[68:71], v[12:15], v[44:47], v[68:71]
ds_read_b128 v[36:39], v3 offset:25024
v_perm_b32 v29, v211, v211, v21
v_mfma_f32_16x16x32_bf16 v[164:167], a[20:23], v[80:83], 0
v_perm_b32 v30, v211, v211, v22
v_perm_b32 v31, v211, v211, v23
v_mfma_f32_16x16x32_bf16 v[172:175], a[20:23], v[84:87], 0
s_waitcnt lgkmcnt(2)
s_nop 0
buffer_load_dwordx4 a[180:183], v1, s[12:15], s41 offen offset:1024 sc1
v_cvt_pk_bf16_f32 v202, v196, v197
v_cvt_pk_bf16_f32 v203, v198, v199
v_mfma_f32_16x16x32_bf16 v[64:67], v[24:27], v[48:51], v[64:67]
ds_read_b128 v[40:43], v3 offset:9424
v_perm_b32 v8, v212, v212, v16
v_mfma_f32_16x16x32_bf16 v[68:71], v[24:27], v[52:55], v[68:71]
ds_read_b128 v[44:47], v3 offset:26064
v_perm_b32 v9, v212, v212, v17
v_mfma_f32_16x16x32_bf16 v[176:179], a[24:27], v[80:83], 0
v_perm_b32 v10, v212, v212, v18
v_perm_b32 v11, v212, v212, v19
v_mfma_f32_16x16x32_bf16 v[184:187], a[24:27], v[84:87], 0
s_add_u32 s29, s29, 4096
buffer_store_dwordx4 v[200:203], v1, s[68:71], s29 offen offset:0 sc1
s_mov_b64 exec, s[30:31]
ds_write_b128 v1, v[200:203] offset:57856
s_mov_b64 exec, -1
buffer_load_dwordx4 a[184:187], v1, s[12:15], s41 offen offset:2048 sc1
v_accvgpr_read_b32 v192, a196
v_accvgpr_read_b32 v193, a197
v_accvgpr_read_b32 v194, a198
v_accvgpr_read_b32 v195, a199
v_accvgpr_read_b32 v196, a204
v_mfma_f32_16x16x32_bf16 v[64:67], v[28:31], v[56:59], v[64:67]
ds_read_b128 v[48:51], v3 offset:10464
v_perm_b32 v12, v212, v212, v20
v_mfma_f32_16x16x32_bf16 v[68:71], v[28:31], v[60:63], v[68:71]
ds_read_b128 v[52:55], v3 offset:27104
v_perm_b32 v13, v212, v212, v21
v_mfma_f32_16x16x32_bf16 v[180:183], a[28:31], v[80:83], 0
v_perm_b32 v14, v212, v212, v22
v_perm_b32 v15, v212, v212, v23
v_mfma_f32_16x16x32_bf16 v[188:191], a[28:31], v[84:87], 0
s_waitcnt lgkmcnt(3)
s_nop 0
buffer_load_dwordx4 a[188:191], v1, s[12:15], s41 offen offset:3072 sc1
v_accvgpr_read_b32 v197, a205
v_accvgpr_read_b32 v198, a206
v_accvgpr_read_b32 v199, a207
v_cvt_pk_bf16_f32 v204, v192, v193
v_cvt_pk_bf16_f32 v205, v194, v195
v_mfma_f32_16x16x32_bf16 v[64:67], v[8:11], v[32:35], v[64:67]
ds_read_b128 v[56:59], v3 offset:11504
v_perm_b32 v24, v213, v213, v16
v_mfma_f32_16x16x32_bf16 v[68:71], v[8:11], v[36:39], v[68:71]
ds_read_b128 v[60:63], v3 offset:28144
v_perm_b32 v25, v213, v213, v17
v_mfma_f32_16x16x32_bf16 v[128:131], a[32:35], v[88:91], v[128:131]
v_perm_b32 v26, v213, v213, v18
v_perm_b32 v27, v213, v213, v19
v_mfma_f32_16x16x32_bf16 v[136:139], a[32:35], v[92:95], v[136:139]
s_add_u32 s41, s40, 77824
buffer_load_dwordx4 a[16:19], v1, s[12:15], s41 offen offset:0 sc1
buffer_load_dwordx4 a[20:23], v1, s[12:15], s41 offen offset:1024 sc1
v_cvt_pk_bf16_f32 v206, v196, v197
v_cvt_pk_bf16_f32 v207, v198, v199
v_mfma_f32_16x16x32_bf16 v[64:67], v[12:15], v[40:43], v[64:67]
ds_read_b128 v[32:35], v3 offset:12544
v_perm_b32 v28, v213, v213, v20
v_mfma_f32_16x16x32_bf16 v[68:71], v[12:15], v[44:47], v[68:71]
ds_read_b128 v[36:39], v3 offset:29184
v_perm_b32 v29, v213, v213, v21
v_mfma_f32_16x16x32_bf16 v[132:135], a[36:39], v[88:91], v[132:135]
v_perm_b32 v30, v213, v213, v22
v_perm_b32 v31, v213, v213, v23
v_mfma_f32_16x16x32_bf16 v[140:143], a[36:39], v[92:95], v[140:143]
s_waitcnt lgkmcnt(2)
ds_read_b128 v[80:83], v5 offset:4096
buffer_store_dwordx4 v[204:207], v1, s[68:71], s29 offen offset:1024 sc1
s_mov_b64 exec, s[30:31]
ds_write_b128 v1, v[204:207] offset:58880
s_mov_b64 exec, -1
s_nop 0
v_accvgpr_read_b32 v192, a208
v_accvgpr_read_b32 v193, a209
v_accvgpr_read_b32 v194, a210
v_accvgpr_read_b32 v195, a211
v_accvgpr_read_b32 v196, a216
v_mfma_f32_16x16x32_bf16 v[64:67], v[24:27], v[48:51], v[64:67]
ds_read_b128 v[40:43], v3 offset:13584
v_perm_b32 v8, v214, v214, v16
v_mfma_f32_16x16x32_bf16 v[68:71], v[24:27], v[52:55], v[68:71]
ds_read_b128 v[44:47], v3 offset:30224
v_perm_b32 v9, v214, v214, v17
v_mfma_f32_16x16x32_bf16 v[144:147], a[40:43], v[88:91], v[144:147]
v_perm_b32 v10, v214, v214, v18
v_perm_b32 v11, v214, v214, v19
v_mfma_f32_16x16x32_bf16 v[152:155], a[40:43], v[92:95], v[152:155]
ds_read_b128 v[84:87], v5 offset:5120
buffer_load_dwordx4 a[24:27], v1, s[12:15], s41 offen offset:2048 sc1
buffer_load_dwordx4 a[28:31], v1, s[12:15], s41 offen offset:3072 sc1
v_accvgpr_read_b32 v197, a217
v_accvgpr_read_b32 v198, a218
v_accvgpr_read_b32 v199, a219
v_cvt_pk_bf16_f32 v200, v192, v193
v_cvt_pk_bf16_f32 v201, v194, v195
v_mfma_f32_16x16x32_bf16 v[64:67], v[28:31], v[56:59], v[64:67]
ds_read_b128 v[48:51], v3 offset:14624
v_perm_b32 v12, v214, v214, v20
v_mfma_f32_16x16x32_bf16 v[68:71], v[28:31], v[60:63], v[68:71]
ds_read_b128 v[52:55], v3 offset:31264
v_perm_b32 v13, v214, v214, v21
v_mfma_f32_16x16x32_bf16 v[148:151], a[44:47], v[88:91], v[148:151]
v_perm_b32 v14, v214, v214, v22
v_perm_b32 v15, v214, v214, v23
v_mfma_f32_16x16x32_bf16 v[156:159], a[44:47], v[92:95], v[156:159]
s_waitcnt lgkmcnt(3)
s_nop 0
s_add_u32 s41, s40, 106496
buffer_load_dwordx4 a[32:35], v1, s[12:15], s41 offen offset:0 sc1
v_cvt_pk_bf16_f32 v202, v196, v197
v_cvt_pk_bf16_f32 v203, v198, v199
v_mfma_f32_16x16x32_bf16 v[64:67], v[8:11], v[32:35], v[64:67]
ds_read_b128 v[56:59], v3 offset:15664
v_perm_b32 v24, v215, v215, v16
v_mfma_f32_16x16x32_bf16 v[68:71], v[8:11], v[36:39], v[68:71]
ds_read_b128 v[60:63], v3 offset:32304
v_perm_b32 v25, v215, v215, v17
v_mfma_f32_16x16x32_bf16 v[160:163], a[48:51], v[88:91], v[160:163]
v_perm_b32 v26, v215, v215, v18
v_perm_b32 v27, v215, v215, v19
v_mfma_f32_16x16x32_bf16 v[168:171], a[48:51], v[92:95], v[168:171]
buffer_store_dwordx4 v[200:203], v1, s[68:71], s29 offen offset:2048 sc1
s_mov_b64 exec, s[30:31]
ds_write_b128 v1, v[200:203] offset:59904
s_mov_b64 exec, -1
buffer_load_dwordx4 a[36:39], v1, s[12:15], s41 offen offset:1024 sc1
v_accvgpr_read_b32 v192, a212
v_accvgpr_read_b32 v193, a213
v_accvgpr_read_b32 v194, a214
v_accvgpr_read_b32 v195, a215
v_accvgpr_read_b32 v196, a220
v_mfma_f32_16x16x32_bf16 v[64:67], v[12:15], v[40:43], v[64:67]
ds_read_b128 v[32:35], v3 offset:96
v_perm_b32 v28, v215, v215, v20
v_mfma_f32_16x16x32_bf16 v[68:71], v[12:15], v[44:47], v[68:71]
ds_read_b128 v[36:39], v3 offset:16736
v_perm_b32 v29, v215, v215, v21
v_mfma_f32_16x16x32_bf16 v[164:167], a[52:55], v[88:91], v[164:167]
v_perm_b32 v30, v215, v215, v22
v_perm_b32 v31, v215, v215, v23
v_mfma_f32_16x16x32_bf16 v[172:175], a[52:55], v[92:95], v[172:175]
s_waitcnt lgkmcnt(3)
s_nop 0
buffer_load_dwordx4 a[192:195], v1, s[12:15], s41 offen offset:2048 sc1
v_accvgpr_read_b32 v197, a221
v_accvgpr_read_b32 v198, a222
v_accvgpr_read_b32 v199, a223
v_cvt_pk_bf16_f32 v204, v192, v193
v_cvt_pk_bf16_f32 v205, v194, v195
v_mfma_f32_16x16x32_bf16 v[64:67], v[24:27], v[48:51], v[64:67]
ds_read_b128 v[40:43], v3 offset:1136
v_perm_b32 v8, v216, v216, v16
v_mfma_f32_16x16x32_bf16 v[68:71], v[24:27], v[52:55], v[68:71]
ds_read_b128 v[44:47], v3 offset:17776
v_perm_b32 v9, v216, v216, v17
v_mfma_f32_16x16x32_bf16 v[176:179], a[56:59], v[88:91], v[176:179]
v_perm_b32 v10, v216, v216, v18
v_perm_b32 v11, v216, v216, v19
v_mfma_f32_16x16x32_bf16 v[184:187], a[56:59], v[92:95], v[184:187]
buffer_load_dwordx4 a[196:199], v1, s[12:15], s41 offen offset:3072 sc1
s_add_u32 s41, s40, 110592
buffer_load_dwordx4 a[200:203], v1, s[12:15], s41 offen offset:0 sc1
v_cvt_pk_bf16_f32 v206, v196, v197
v_cvt_pk_bf16_f32 v207, v198, v199
v_mfma_f32_16x16x32_bf16 v[64:67], v[28:31], v[56:59], v[64:67]
ds_read_b128 v[48:51], v3 offset:2176
v_perm_b32 v12, v216, v216, v20
v_mfma_f32_16x16x32_bf16 v[68:71], v[28:31], v[60:63], v[68:71]
ds_read_b128 v[52:55], v3 offset:18816
v_perm_b32 v13, v216, v216, v21
v_mfma_f32_16x16x32_bf16 v[180:183], a[60:63], v[88:91], v[180:183]
v_perm_b32 v14, v216, v216, v22
v_perm_b32 v15, v216, v216, v23
v_mfma_f32_16x16x32_bf16 v[188:191], a[60:63], v[92:95], v[188:191]
s_waitcnt lgkmcnt(2)
buffer_store_dwordx4 v[204:207], v1, s[68:71], s29 offen offset:3072 sc1
s_mov_b64 exec, s[30:31]
ds_write_b128 v1, v[204:207] offset:60928
s_mov_b64 exec, -1
s_nop 0
v_accvgpr_read_b32 v192, a224
v_accvgpr_read_b32 v193, a225
v_accvgpr_read_b32 v194, a226
v_accvgpr_read_b32 v195, a227
v_accvgpr_read_b32 v196, a232
v_mfma_f32_16x16x32_bf16 v[72:75], v[8:11], v[32:35], 0
ds_read_b128 v[56:59], v3 offset:3216
v_perm_b32 v24, v217, v217, v16
v_mfma_f32_16x16x32_bf16 v[76:79], v[8:11], v[36:39], 0
ds_read_b128 v[60:63], v3 offset:19856
v_perm_b32 v25, v217, v217, v17
v_mfma_f32_16x16x32_bf16 v[128:131], a[64:67], v[80:83], v[128:131]
v_perm_b32 v26, v217, v217, v18
v_perm_b32 v27, v217, v217, v19
v_mfma_f32_16x16x32_bf16 v[136:139], a[64:67], v[84:87], v[136:139]
buffer_load_dwordx4 a[204:207], v1, s[12:15], s41 offen offset:1024 sc1
buffer_load_dwordx4 a[40:43], v1, s[12:15], s41 offen offset:2048 sc1
v_accvgpr_read_b32 v197, a233
v_accvgpr_read_b32 v198, a234
v_accvgpr_read_b32 v199, a235
v_cvt_pk_bf16_f32 v200, v192, v193
v_cvt_pk_bf16_f32 v201, v194, v195
v_mfma_f32_16x16x32_bf16 v[72:75], v[12:15], v[40:43], v[72:75]
ds_read_b128 v[32:35], v3 offset:4256
v_perm_b32 v28, v217, v217, v20
v_mfma_f32_16x16x32_bf16 v[76:79], v[12:15], v[44:47], v[76:79]
ds_read_b128 v[36:39], v3 offset:20896
v_perm_b32 v29, v217, v217, v21
v_mfma_f32_16x16x32_bf16 v[132:135], a[68:71], v[80:83], v[132:135]
v_perm_b32 v30, v217, v217, v22
v_perm_b32 v31, v217, v217, v23
v_mfma_f32_16x16x32_bf16 v[140:143], a[68:71], v[84:87], v[140:143]
s_waitcnt lgkmcnt(2)
s_nop 0
ds_read_b128 v[88:91], v5 offset:6144
buffer_load_dwordx4 a[44:47], v1, s[12:15], s41 offen offset:3072 sc1
v_cvt_pk_bf16_f32 v202, v196, v197
v_cvt_pk_bf16_f32 v203, v198, v199
v_mfma_f32_16x16x32_bf16 v[72:75], v[24:27], v[48:51], v[72:75]
ds_read_b128 v[40:43], v3 offset:5296
v_perm_b32 v8, v218, v218, v16
v_mfma_f32_16x16x32_bf16 v[76:79], v[24:27], v[52:55], v[76:79]
ds_read_b128 v[44:47], v3 offset:21936
v_perm_b32 v9, v218, v218, v17
v_mfma_f32_16x16x32_bf16 v[144:147], a[72:75], v[80:83], v[144:147]
v_perm_b32 v10, v218, v218, v18
v_perm_b32 v11, v218, v218, v19
v_mfma_f32_16x16x32_bf16 v[152:155], a[72:75], v[84:87], v[152:155]
ds_read_b128 v[92:95], v5 offset:7168
s_add_u32 s29, s29, 4096
buffer_store_dwordx4 v[200:203], v1, s[68:71], s29 offen offset:0 sc1
s_mov_b64 exec, s[30:31]
ds_write_b128 v1, v[200:203] offset:61952
s_mov_b64 exec, -1
s_add_u32 s41, s40, 16384
buffer_load_dwordx4 a[48:51], v1, s[12:15], s41 offen offset:0 sc1
v_accvgpr_read_b32 v192, a228
v_accvgpr_read_b32 v193, a229
v_accvgpr_read_b32 v194, a230
v_accvgpr_read_b32 v195, a231
v_accvgpr_read_b32 v196, a236
v_mfma_f32_16x16x32_bf16 v[72:75], v[28:31], v[56:59], v[72:75]
ds_read_b128 v[48:51], v3 offset:6336
v_perm_b32 v12, v218, v218, v20
v_mfma_f32_16x16x32_bf16 v[76:79], v[28:31], v[60:63], v[76:79]
ds_read_b128 v[52:55], v3 offset:22976
v_perm_b32 v13, v218, v218, v21
v_mfma_f32_16x16x32_bf16 v[148:151], a[76:79], v[80:83], v[148:151]
v_perm_b32 v14, v218, v218, v22
v_perm_b32 v15, v218, v218, v23
v_mfma_f32_16x16x32_bf16 v[156:159], a[76:79], v[84:87], v[156:159]
s_waitcnt lgkmcnt(4)
s_nop 0
buffer_load_dwordx4 a[52:55], v1, s[12:15], s41 offen offset:1024 sc1
v_accvgpr_read_b32 v197, a237
v_accvgpr_read_b32 v198, a238
v_accvgpr_read_b32 v199, a239
v_cvt_pk_bf16_f32 v204, v192, v193
v_cvt_pk_bf16_f32 v205, v194, v195
v_mfma_f32_16x16x32_bf16 v[72:75], v[8:11], v[32:35], v[72:75]
ds_read_b128 v[56:59], v3 offset:7376
v_perm_b32 v24, v219, v219, v16
v_mfma_f32_16x16x32_bf16 v[76:79], v[8:11], v[36:39], v[76:79]
ds_read_b128 v[60:63], v3 offset:24016
v_perm_b32 v25, v219, v219, v17
v_mfma_f32_16x16x32_bf16 v[160:163], a[80:83], v[80:83], v[160:163]
v_perm_b32 v26, v219, v219, v18
v_perm_b32 v27, v219, v219, v19
v_mfma_f32_16x16x32_bf16 v[168:171], a[80:83], v[84:87], v[168:171]
buffer_load_dwordx4 a[56:59], v1, s[12:15], s41 offen offset:2048 sc1
buffer_load_dwordx4 a[60:63], v1, s[12:15], s41 offen offset:3072 sc1
v_cvt_pk_bf16_f32 v206, v196, v197
v_cvt_pk_bf16_f32 v207, v198, v199
v_mfma_f32_16x16x32_bf16 v[72:75], v[12:15], v[40:43], v[72:75]
ds_read_b128 v[32:35], v3 offset:8416
v_perm_b32 v28, v219, v219, v20
v_mfma_f32_16x16x32_bf16 v[76:79], v[12:15], v[44:47], v[76:79]
ds_read_b128 v[36:39], v3 offset:25056
v_perm_b32 v29, v219, v219, v21
v_mfma_f32_16x16x32_bf16 v[164:167], a[84:87], v[80:83], v[164:167]
v_perm_b32 v30, v219, v219, v22
v_perm_b32 v31, v219, v219, v23
v_mfma_f32_16x16x32_bf16 v[172:175], a[84:87], v[84:87], v[172:175]
s_waitcnt lgkmcnt(2)
buffer_store_dwordx4 v[204:207], v1, s[68:71], s29 offen offset:1024 sc1
s_mov_b64 exec, s[30:31]
ds_write_b128 v1, v[204:207] offset:62976
s_mov_b64 exec, -1
s_nop 0
v_accvgpr_read_b32 v192, a240
v_accvgpr_read_b32 v193, a241
v_accvgpr_read_b32 v194, a242
v_accvgpr_read_b32 v195, a243
v_accvgpr_read_b32 v196, a248
v_mfma_f32_16x16x32_bf16 v[72:75], v[24:27], v[48:51], v[72:75]
ds_read_b128 v[40:43], v3 offset:9456
v_perm_b32 v8, v220, v220, v16
v_mfma_f32_16x16x32_bf16 v[76:79], v[24:27], v[52:55], v[76:79]
ds_read_b128 v[44:47], v3 offset:26096
v_perm_b32 v9, v220, v220, v17
v_mfma_f32_16x16x32_bf16 v[176:179], a[88:91], v[80:83], v[176:179]
v_perm_b32 v10, v220, v220, v18
v_perm_b32 v11, v220, v220, v19
v_mfma_f32_16x16x32_bf16 v[184:187], a[88:91], v[84:87], v[184:187]
s_add_u32 s41, s40, 20480
buffer_load_dwordx4 a[208:211], v1, s[12:15], s41 offen offset:0 sc1
buffer_load_dwordx4 a[212:215], v1, s[12:15], s41 offen offset:1024 sc1
v_accvgpr_read_b32 v197, a249
v_accvgpr_read_b32 v198, a250
v_accvgpr_read_b32 v199, a251
v_cvt_pk_bf16_f32 v200, v192, v193
v_cvt_pk_bf16_f32 v201, v194, v195
v_mfma_f32_16x16x32_bf16 v[72:75], v[28:31], v[56:59], v[72:75]
ds_read_b128 v[48:51], v3 offset:10496
v_perm_b32 v12, v220, v220, v20
v_mfma_f32_16x16x32_bf16 v[76:79], v[28:31], v[60:63], v[76:79]
ds_read_b128 v[52:55], v3 offset:27136
v_perm_b32 v13, v220, v220, v21
v_mfma_f32_16x16x32_bf16 v[180:183], a[92:95], v[80:83], v[180:183]
v_perm_b32 v14, v220, v220, v22
v_perm_b32 v15, v220, v220, v23
v_mfma_f32_16x16x32_bf16 v[188:191], a[92:95], v[84:87], v[188:191]
s_waitcnt lgkmcnt(2)
s_nop 0
buffer_load_dwordx4 a[216:219], v1, s[12:15], s41 offen offset:2048 sc1
v_cvt_pk_bf16_f32 v202, v196, v197
v_cvt_pk_bf16_f32 v203, v198, v199
v_mfma_f32_16x16x32_bf16 v[72:75], v[8:11], v[32:35], v[72:75]
ds_read_b128 v[56:59], v3 offset:11536
v_perm_b32 v24, v221, v221, v16
v_mfma_f32_16x16x32_bf16 v[76:79], v[8:11], v[36:39], v[76:79]
ds_read_b128 v[60:63], v3 offset:28176
v_perm_b32 v25, v221, v221, v17
v_mfma_f32_16x16x32_bf16 v[128:131], a[96:99], v[88:91], v[128:131]
v_perm_b32 v26, v221, v221, v18
v_perm_b32 v27, v221, v221, v19
v_mfma_f32_16x16x32_bf16 v[136:139], a[96:99], v[92:95], v[136:139]
buffer_store_dwordx4 v[200:203], v1, s[68:71], s29 offen offset:2048 sc1
s_mov_b64 exec, s[30:31]
ds_write_b128 v1, v[200:203] offset:64000
s_mov_b64 exec, -1
buffer_load_dwordx4 a[220:223], v1, s[12:15], s41 offen offset:3072 sc1
v_accvgpr_read_b32 v192, a244
v_accvgpr_read_b32 v193, a245
v_accvgpr_read_b32 v194, a246
v_accvgpr_read_b32 v195, a247
v_accvgpr_read_b32 v196, a252
v_mfma_f32_16x16x32_bf16 v[72:75], v[12:15], v[40:43], v[72:75]
ds_read_b128 v[32:35], v3 offset:12576
v_perm_b32 v28, v221, v221, v20
v_mfma_f32_16x16x32_bf16 v[76:79], v[12:15], v[44:47], v[76:79]
ds_read_b128 v[36:39], v3 offset:29216
v_perm_b32 v29, v221, v221, v21
v_mfma_f32_16x16x32_bf16 v[132:135], a[100:103], v[88:91], v[132:135]
v_perm_b32 v30, v221, v221, v22
v_perm_b32 v31, v221, v221, v23
v_mfma_f32_16x16x32_bf16 v[140:143], a[100:103], v[92:95], v[140:143]
s_waitcnt lgkmcnt(3)
s_nop 0
s_add_u32 s41, s40, 49152
buffer_load_dwordx4 a[64:67], v1, s[12:15], s41 offen offset:0 sc1
v_accvgpr_read_b32 v197, a253
v_accvgpr_read_b32 v198, a254
v_accvgpr_read_b32 v199, a255
v_cvt_pk_bf16_f32 v204, v192, v193
v_cvt_pk_bf16_f32 v205, v194, v195
v_mfma_f32_16x16x32_bf16 v[72:75], v[24:27], v[48:51], v[72:75]
ds_read_b128 v[40:43], v3 offset:13616
v_perm_b32 v8, v222, v222, v16
v_mfma_f32_16x16x32_bf16 v[76:79], v[24:27], v[52:55], v[76:79]
ds_read_b128 v[44:47], v3 offset:30256
v_perm_b32 v9, v222, v222, v17
v_mfma_f32_16x16x32_bf16 v[144:147], a[104:107], v[88:91], v[144:147]
v_perm_b32 v10, v222, v222, v18
v_perm_b32 v11, v222, v222, v19
v_mfma_f32_16x16x32_bf16 v[152:155], a[104:107], v[92:95], v[152:155]
buffer_load_dwordx4 a[68:71], v1, s[12:15], s41 offen offset:1024 sc1
buffer_load_dwordx4 a[72:75], v1, s[12:15], s41 offen offset:2048 sc1
v_cvt_pk_bf16_f32 v206, v196, v197
v_cvt_pk_bf16_f32 v207, v198, v199
v_mfma_f32_16x16x32_bf16 v[72:75], v[28:31], v[56:59], v[72:75]
ds_read_b128 v[48:51], v3 offset:14656
v_perm_b32 v12, v222, v222, v20
v_mfma_f32_16x16x32_bf16 v[76:79], v[28:31], v[60:63], v[76:79]
ds_read_b128 v[52:55], v3 offset:31296
v_perm_b32 v13, v222, v222, v21
v_mfma_f32_16x16x32_bf16 v[148:151], a[108:111], v[88:91], v[148:151]
v_perm_b32 v14, v222, v222, v22
v_perm_b32 v15, v222, v222, v23
v_mfma_f32_16x16x32_bf16 v[156:159], a[108:111], v[92:95], v[156:159]
s_waitcnt lgkmcnt(2)
s_waitcnt vmcnt(62)
buffer_store_dwordx4 v[204:207], v1, s[68:71], s29 offen offset:3072 sc1
s_mov_b64 exec, s[30:31]
ds_write_b128 v1, v[204:207] offset:65024
s_mov_b64 exec, -1
v_mfma_f32_16x16x32_bf16 v[72:75], v[8:11], v[32:35], v[72:75]
ds_read_b128 v[56:59], v3 offset:15696
v_perm_b32 v24, v223, v223, v16
v_mfma_f32_16x16x32_bf16 v[76:79], v[8:11], v[36:39], v[76:79]
ds_read_b128 v[60:63], v3 offset:32336
v_perm_b32 v25, v223, v223, v17
v_mfma_f32_16x16x32_bf16 v[160:163], a[112:115], v[88:91], v[160:163]
v_perm_b32 v26, v223, v223, v18
v_perm_b32 v27, v223, v223, v19
v_mfma_f32_16x16x32_bf16 v[168:171], a[112:115], v[92:95], v[168:171]
s_waitcnt vmcnt(62)
buffer_load_dwordx4 a[76:79], v1, s[12:15], s41 offen offset:3072 sc1
s_add_u32 s41, s40, 53248
s_waitcnt vmcnt(62)
buffer_load_dwordx4 a[80:83], v1, s[12:15], s41 offen offset:0 sc1
v_mfma_f32_16x16x32_bf16 v[72:75], v[12:15], v[40:43], v[72:75]
v_perm_b32 v28, v223, v223, v20
v_mfma_f32_16x16x32_bf16 v[76:79], v[12:15], v[44:47], v[76:79]
v_perm_b32 v29, v223, v223, v21
v_mfma_f32_16x16x32_bf16 v[164:167], a[116:119], v[88:91], v[164:167]
v_perm_b32 v30, v223, v223, v22
v_perm_b32 v31, v223, v223, v23
v_mfma_f32_16x16x32_bf16 v[172:175], a[116:119], v[92:95], v[172:175]
s_waitcnt lgkmcnt(0)
s_waitcnt vmcnt(62)
buffer_load_dwordx4 a[84:87], v1, s[12:15], s41 offen offset:1024 sc1
v_mfma_f32_16x16x32_bf16 v[72:75], v[24:27], v[48:51], v[72:75]
v_mfma_f32_16x16x32_bf16 v[76:79], v[24:27], v[52:55], v[76:79]
v_mfma_f32_16x16x32_bf16 v[176:179], a[120:123], v[88:91], v[176:179]
v_mfma_f32_16x16x32_bf16 v[184:187], a[120:123], v[92:95], v[184:187]
s_waitcnt vmcnt(62)
buffer_load_dwordx4 a[224:227], v1, s[12:15], s41 offen offset:2048 sc1
s_waitcnt vmcnt(62)
buffer_load_dwordx4 a[228:231], v1, s[12:15], s41 offen offset:3072 sc1
v_mfma_f32_16x16x32_bf16 v[72:75], v[28:31], v[56:59], v[72:75]
v_mfma_f32_16x16x32_bf16 v[76:79], v[28:31], v[60:63], v[76:79]
v_mfma_f32_16x16x32_bf16 v[180:183], a[124:127], v[88:91], v[180:183]
v_mfma_f32_16x16x32_bf16 v[188:191], a[124:127], v[92:95], v[188:191]
s_add_u32 s41, s40, 81920
s_waitcnt vmcnt(62)
buffer_load_dwordx4 a[232:235], v1, s[12:15], s41 offen offset:0 sc1
s_nop 7
v_lshlrev_b32 v8, 16, v104
v_and_b32 v9, s43, v104
v_lshlrev_b32 v10, 16, v105
v_and_b32 v11, s43, v105
v_lshlrev_b32 v12, 16, v106
v_and_b32 v13, s43, v106
v_lshlrev_b32 v14, 16, v107
v_and_b32 v15, s43, v107
v_pk_mul_f32 v[8:9], v[8:9], v[64:65]
v_pk_mul_f32 v[10:11], v[10:11], v[66:67]
v_pk_mul_f32 v[12:13], v[12:13], v[72:73]
v_pk_mul_f32 v[14:15], v[14:15], v[74:75]
v_cvt_pk_bf16_f32 v104, v8, v9
v_cvt_pk_bf16_f32 v105, v10, v11
v_cvt_pk_bf16_f32 v106, v12, v13
v_cvt_pk_bf16_f32 v107, v14, v15
ds_write_b128 v2, v[104:107] offset:8192
s_waitcnt vmcnt(62)
buffer_load_dwordx4 a[236:239], v1, s[12:15], s41 offen offset:1024 sc1
v_lshlrev_b32 v24, 16, v108
v_and_b32 v25, s43, v108
v_lshlrev_b32 v26, 16, v109
v_and_b32 v27, s43, v109
v_lshlrev_b32 v28, 16, v110
v_and_b32 v29, s43, v110
v_lshlrev_b32 v30, 16, v111
v_and_b32_e64 v31, s43, v111
v_pk_mul_f32 v[24:25], v[24:25], v[68:69]
v_pk_mul_f32 v[26:27], v[26:27], v[70:71]
v_pk_mul_f32 v[28:29], v[28:29], v[76:77]
v_pk_mul_f32 v[30:31], v[30:31], v[78:79]
v_cvt_pk_bf16_f32 v108, v24, v25
v_cvt_pk_bf16_f32 v109, v26, v27
v_cvt_pk_bf16_f32 v110, v28, v29
v_cvt_pk_bf16_f32 v111, v30, v31
ds_write_b128 v2, v[108:111] offset:9216
s_waitcnt vmcnt(62)
buffer_load_dwordx4 a[88:91], v1, s[12:15], s41 offen offset:2048 sc1
s_waitcnt lgkmcnt(0)
s_barrier
s_cmp_lt_u32 s48, 125
s_cbranch_scc1 L_cont
s_waitcnt vmcnt(0)
s_mov_b64 exec, 1
buffer_store_dword v7, off, s[72:75], s36 sc1
s_mov_b64 exec, -1
s_mov_b64 exec, 1
buffer_store_dword v7, off, s[72:75], s36 offset:16 sc1
s_mov_b64 exec, -1
s_endpgm
L_cont:
ds_read_b128 v[80:83], v5 offset:8192
ds_read_b128 v[84:87], v5 offset:9216
ds_read_b128 v[32:35], v3 offset:128
ds_read_b128 v[36:39], v3 offset:16768
ds_read_b128 v[40:43], v3 offset:1168
ds_read_b128 v[44:47], v3 offset:17808
ds_read_b128 v[48:51], v3 offset:2208
ds_read_b128 v[52:55], v3 offset:18848
v_perm_b32 v8, v224, v224, v16
v_perm_b32 v9, v224, v224, v17
v_perm_b32 v10, v224, v224, v18
v_perm_b32 v11, v224, v224, v19
v_perm_b32 v12, v224, v224, v20
v_perm_b32 v13, v224, v224, v21
v_perm_b32 v14, v224, v224, v22
v_perm_b32 v15, v224, v224, v23
s_waitcnt lgkmcnt(2)
s_nop 0
v_mfma_f32_16x16x32_bf16 v[64:67], v[8:11], v[32:35], 0
ds_read_b128 v[56:59], v3 offset:3248
v_perm_b32 v24, v225, v225, v16
v_mfma_f32_16x16x32_bf16 v[68:71], v[8:11], v[36:39], 0
ds_read_b128 v[60:63], v3 offset:19888
v_perm_b32 v25, v225, v225, v17
v_mfma_f32_16x16x32_bf16 v[128:131], a[128:131], v[80:83], v[128:131]
v_perm_b32 v26, v225, v225, v18
v_perm_b32 v27, v225, v225, v19
v_mfma_f32_16x16x32_bf16 v[136:139], a[128:131], v[84:87], v[136:139]
s_waitcnt vmcnt(62)
buffer_load_dwordx4 v[108:111], off, s[72:75], s37 offset:0 sc1
s_waitcnt vmcnt(62)
buffer_load_dwordx4 a[92:95], v1, s[12:15], s41 offen offset:3072 sc1
v_mfma_f32_16x16x32_bf16 v[64:67], v[12:15], v[40:43], v[64:67]
ds_read_b128 v[32:35], v3 offset:4288
v_perm_b32 v28, v225, v225, v20
v_mfma_f32_16x16x32_bf16 v[68:71], v[12:15], v[44:47], v[68:71]
ds_read_b128 v[36:39], v3 offset:20928
v_perm_b32 v29, v225, v225, v21
v_mfma_f32_16x16x32_bf16 v[132:135], a[132:135], v[80:83], v[132:135]
v_perm_b32 v30, v225, v225, v22
v_perm_b32 v31, v225, v225, v23
v_mfma_f32_16x16x32_bf16 v[140:143], a[132:135], v[84:87], v[140:143]
s_waitcnt lgkmcnt(2)
ds_read_b128 v[88:91], v5 offset:10240
s_add_u32 s41, s40, 86016
s_waitcnt vmcnt(62)
buffer_load_dwordx4 a[96:99], v1, s[12:15], s41 offen offset:0 sc1
v_mfma_f32_16x16x32_bf16 v[64:67], v[24:27], v[48:51], v[64:67]
ds_read_b128 v[40:43], v3 offset:5328
v_perm_b32 v8, v226, v226, v16
v_mfma_f32_16x16x32_bf16 v[68:71], v[24:27], v[52:55], v[68:71]
ds_read_b128 v[44:47], v3 offset:21968
v_perm_b32 v9, v226, v226, v17
v_mfma_f32_16x16x32_bf16 v[144:147], a[136:139], v[80:83], v[144:147]
v_perm_b32 v10, v226, v226, v18
v_perm_b32 v11, v226, v226, v19
v_mfma_f32_16x16x32_bf16 v[152:155], a[136:139], v[84:87], v[152:155]
ds_read_b128 v[92:95], v5 offset:11264
s_waitcnt vmcnt(62)
buffer_load_dwordx4 a[100:103], v1, s[12:15], s41 offen offset:1024 sc1
s_waitcnt vmcnt(62)
buffer_load_dwordx4 a[104:107], v1, s[12:15], s41 offen offset:2048 sc1
v_mfma_f32_16x16x32_bf16 v[64:67], v[28:31], v[56:59], v[64:67]
ds_read_b128 v[48:51], v3 offset:6368
v_perm_b32 v12, v226, v226, v20
v_mfma_f32_16x16x32_bf16 v[68:71], v[28:31], v[60:63], v[68:71]
ds_read_b128 v[52:55], v3 offset:23008
v_perm_b32 v13, v226, v226, v21
v_mfma_f32_16x16x32_bf16 v[148:151], a[140:143], v[80:83], v[148:151]
v_perm_b32 v14, v226, v226, v22
v_perm_b32 v15, v226, v226, v23
v_mfma_f32_16x16x32_bf16 v[156:159], a[140:143], v[84:87], v[156:159]
s_waitcnt lgkmcnt(3)
s_waitcnt vmcnt(62)
buffer_load_dwordx4 a[108:111], v1, s[12:15], s41 offen offset:3072 sc1
v_mfma_f32_16x16x32_bf16 v[64:67], v[8:11], v[32:35], v[64:67]
ds_read_b128 v[56:59], v3 offset:7408
v_perm_b32 v24, v227, v227, v16
v_mfma_f32_16x16x32_bf16 v[68:71], v[8:11], v[36:39], v[68:71]
ds_read_b128 v[60:63], v3 offset:24048
v_perm_b32 v25, v227, v227, v17
v_mfma_f32_16x16x32_bf16 v[160:163], a[144:147], v[80:83], v[160:163]
v_perm_b32 v26, v227, v227, v18
v_perm_b32 v27, v227, v227, v19
v_mfma_f32_16x16x32_bf16 v[168:171], a[144:147], v[84:87], v[168:171]
s_add_u32 s41, s40, 114688
s_waitcnt vmcnt(62)
buffer_load_dwordx4 a[240:243], v1, s[12:15], s41 offen offset:0 sc1
s_waitcnt vmcnt(62)
buffer_load_dwordx4 a[244:247], v1, s[12:15], s41 offen offset:1024 sc1
v_mfma_f32_16x16x32_bf16 v[64:67], v[12:15], v[40:43], v[64:67]
ds_read_b128 v[32:35], v3 offset:8448
v_perm_b32 v28, v227, v227, v20
v_mfma_f32_16x16x32_bf16 v[68:71], v[12:15], v[44:47], v[68:71]
ds_read_b128 v[36:39], v3 offset:25088
v_perm_b32 v29, v227, v227, v21
v_mfma_f32_16x16x32_bf16 v[164:167], a[148:151], v[80:83], v[164:167]
v_perm_b32 v30, v227, v227, v22
v_perm_b32 v31, v227, v227, v23
v_mfma_f32_16x16x32_bf16 v[172:175], a[148:151], v[84:87], v[172:175]
s_waitcnt lgkmcnt(2)
s_waitcnt vmcnt(62)
buffer_load_dwordx4 a[248:251], v1, s[12:15], s41 offen offset:2048 sc1
v_mfma_f32_16x16x32_bf16 v[64:67], v[24:27], v[48:51], v[64:67]
ds_read_b128 v[40:43], v3 offset:9488
v_perm_b32 v8, v228, v228, v16
v_mfma_f32_16x16x32_bf16 v[68:71], v[24:27], v[52:55], v[68:71]
ds_read_b128 v[44:47], v3 offset:26128
v_perm_b32 v9, v228, v228, v17
v_mfma_f32_16x16x32_bf16 v[176:179], a[152:155], v[80:83], v[176:179]
v_perm_b32 v10, v228, v228, v18
v_perm_b32 v11, v228, v228, v19
v_mfma_f32_16x16x32_bf16 v[184:187], a[152:155], v[84:87], v[184:187]
s_waitcnt vmcnt(62)
buffer_load_dwordx4 a[252:255], v1, s[12:15], s41 offen offset:3072 sc1
s_add_u32 s41, s40, 118784
s_waitcnt vmcnt(62)
buffer_load_dwordx4 a[112:115], v1, s[12:15], s41 offen offset:0 sc1
v_mfma_f32_16x16x32_bf16 v[64:67], v[28:31], v[56:59], v[64:67]
ds_read_b128 v[48:51], v3 offset:10528
v_perm_b32 v12, v228, v228, v20
v_mfma_f32_16x16x32_bf16 v[68:71], v[28:31], v[60:63], v[68:71]
ds_read_b128 v[52:55], v3 offset:27168
v_perm_b32 v13, v228, v228, v21
v_mfma_f32_16x16x32_bf16 v[180:183], a[156:159], v[80:83], v[180:183]
v_perm_b32 v14, v228, v228, v22
v_perm_b32 v15, v228, v228, v23
v_mfma_f32_16x16x32_bf16 v[188:191], a[156:159], v[84:87], v[188:191]
s_waitcnt lgkmcnt(2)
s_waitcnt vmcnt(62)
buffer_load_dwordx4 a[116:119], v1, s[12:15], s41 offen offset:1024 sc1
v_mfma_f32_16x16x32_bf16 v[64:67], v[8:11], v[32:35], v[64:67]
ds_read_b128 v[56:59], v3 offset:11568
v_perm_b32 v24, v229, v229, v16
v_mfma_f32_16x16x32_bf16 v[68:71], v[8:11], v[36:39], v[68:71]
ds_read_b128 v[60:63], v3 offset:28208
v_perm_b32 v25, v229, v229, v17
v_mfma_f32_16x16x32_bf16 v[128:131], a[160:163], v[88:91], v[128:131]
v_perm_b32 v26, v229, v229, v18
v_perm_b32 v27, v229, v229, v19
v_mfma_f32_16x16x32_bf16 v[136:139], a[160:163], v[92:95], v[136:139]
s_waitcnt vmcnt(11)
v_xor_b32 v108, v108, v7
v_bitop3_b32 v108, v109, v7, v108 bitop3:0xbe
v_bitop3_b32 v108, v110, v7, v108 bitop3:0xbe
v_bitop3_b32 v108, v111, v7, v108 bitop3:0xbe
v_cmp_ne_u32 vcc, 0, v108
s_cbranch_vccnz L_sp_19
L_bk_20:
buffer_load_dwordx4 a[120:123], v1, s[12:15], s41 offen offset:2048 sc1
v_mfma_f32_16x16x32_bf16 v[64:67], v[12:15], v[40:43], v[64:67]
ds_read_b128 v[32:35], v3 offset:12608
v_perm_b32 v28, v229, v229, v20
v_mfma_f32_16x16x32_bf16 v[68:71], v[12:15], v[44:47], v[68:71]
ds_read_b128 v[36:39], v3 offset:29248
v_perm_b32 v29, v229, v229, v21
v_mfma_f32_16x16x32_bf16 v[132:135], a[164:167], v[88:91], v[132:135]
v_perm_b32 v30, v229, v229, v22
v_perm_b32 v31, v229, v229, v23
v_mfma_f32_16x16x32_bf16 v[140:143], a[164:167], v[92:95], v[140:143]
s_waitcnt lgkmcnt(2)
s_nop 0
ds_read_b128 v[80:83], v5 offset:12288
buffer_load_dwordx4 a[124:127], v1, s[12:15], s41 offen offset:3072 sc1
v_mfma_f32_16x16x32_bf16 v[64:67], v[24:27], v[48:51], v[64:67]
ds_read_b128 v[40:43], v3 offset:13648
v_perm_b32 v8, v230, v230, v16
v_mfma_f32_16x16x32_bf16 v[68:71], v[24:27], v[52:55], v[68:71]
ds_read_b128 v[44:47], v3 offset:30288
v_perm_b32 v9, v230, v230, v17
v_mfma_f32_16x16x32_bf16 v[144:147], a[168:171], v[88:91], v[144:147]
v_perm_b32 v10, v230, v230, v18
v_perm_b32 v11, v230, v230, v19
v_mfma_f32_16x16x32_bf16 v[152:155], a[168:171], v[92:95], v[152:155]
ds_read_b128 v[84:87], v5 offset:13312
s_add_u32 s41, s40, 24576
buffer_load_dwordx4 a[128:131], v1, s[12:15], s41 offen offset:0 sc1
buffer_load_dwordx4 v[192:195], v1, s[68:71], s45 offen offset:0 sc1
v_mfma_f32_16x16x32_bf16 v[64:67], v[28:31], v[56:59], v[64:67]
ds_read_b128 v[48:51], v3 offset:14688
v_perm_b32 v12, v230, v230, v20
v_mfma_f32_16x16x32_bf16 v[68:71], v[28:31], v[60:63], v[68:71]
ds_read_b128 v[52:55], v3 offset:31328
v_perm_b32 v13, v230, v230, v21
v_mfma_f32_16x16x32_bf16 v[148:151], a[172:175], v[88:91], v[148:151]
v_perm_b32 v14, v230, v230, v22
v_perm_b32 v15, v230, v230, v23
v_mfma_f32_16x16x32_bf16 v[156:159], a[172:175], v[92:95], v[156:159]
s_waitcnt lgkmcnt(3)
s_nop 0
buffer_load_dwordx4 a[132:135], v1, s[12:15], s41 offen offset:1024 sc1
v_mfma_f32_16x16x32_bf16 v[64:67], v[8:11], v[32:35], v[64:67]
ds_read_b128 v[56:59], v3 offset:15728
v_perm_b32 v24, v231, v231, v16
v_mfma_f32_16x16x32_bf16 v[68:71], v[8:11], v[36:39], v[68:71]
ds_read_b128 v[60:63], v3 offset:32368
v_perm_b32 v25, v231, v231, v17
v_mfma_f32_16x16x32_bf16 v[160:163], a[0:3], v[88:91], v[160:163]
v_perm_b32 v26, v231, v231, v18
v_perm_b32 v27, v231, v231, v19
v_mfma_f32_16x16x32_bf16 v[168:171], a[0:3], v[92:95], v[168:171]
buffer_load_dwordx4 a[136:139], v1, s[12:15], s41 offen offset:2048 sc1
buffer_load_dwordx4 v[196:199], v1, s[68:71], s46 offen offset:0 sc1
v_mfma_f32_16x16x32_bf16 v[64:67], v[12:15], v[40:43], v[64:67]
ds_read_b128 v[32:35], v3 offset:160
v_perm_b32 v28, v231, v231, v20
v_mfma_f32_16x16x32_bf16 v[68:71], v[12:15], v[44:47], v[68:71]
ds_read_b128 v[36:39], v3 offset:16800
v_perm_b32 v29, v231, v231, v21
v_mfma_f32_16x16x32_bf16 v[164:167], a[4:7], v[88:91], v[164:167]
v_perm_b32 v30, v231, v231, v22
v_perm_b32 v31, v231, v231, v23
v_mfma_f32_16x16x32_bf16 v[172:175], a[4:7], v[92:95], v[172:175]
s_waitcnt lgkmcnt(2)
s_nop 0
buffer_load_dwordx4 a[140:143], v1, s[12:15], s41 offen offset:3072 sc1
v_mfma_f32_16x16x32_bf16 v[64:67], v[24:27], v[48:51], v[64:67]
ds_read_b128 v[40:43], v3 offset:1200
v_perm_b32 v8, v232, v232, v16
v_mfma_f32_16x16x32_bf16 v[68:71], v[24:27], v[52:55], v[68:71]
ds_read_b128 v[44:47], v3 offset:17840
v_perm_b32 v9, v232, v232, v17
v_mfma_f32_16x16x32_bf16 v[176:179], a[8:11], v[88:91], v[176:179]
v_perm_b32 v10, v232, v232, v18
v_perm_b32 v11, v232, v232, v19
v_mfma_f32_16x16x32_bf16 v[184:187], a[8:11], v[92:95], v[184:187]
s_add_u32 s41, s40, 28672
buffer_load_dwordx4 a[144:147], v1, s[12:15], s41 offen offset:0 sc1
buffer_load_dwordx4 v[200:203], v1, s[68:71], s47 offen offset:0 sc1
v_mfma_f32_16x16x32_bf16 v[64:67], v[28:31], v[56:59], v[64:67]
ds_read_b128 v[48:51], v3 offset:2240
v_perm_b32 v12, v232, v232, v20
v_mfma_f32_16x16x32_bf16 v[68:71], v[28:31], v[60:63], v[68:71]
ds_read_b128 v[52:55], v3 offset:18880
v_perm_b32 v13, v232, v232, v21
v_mfma_f32_16x16x32_bf16 v[180:183], a[12:15], v[88:91], v[180:183]
v_perm_b32 v14, v232, v232, v22
v_perm_b32 v15, v232, v232, v23
v_mfma_f32_16x16x32_bf16 v[188:191], a[12:15], v[92:95], v[188:191]
s_waitcnt lgkmcnt(2)
s_nop 0
buffer_load_dwordx4 a[148:151], v1, s[12:15], s41 offen offset:1024 sc1
v_mfma_f32_16x16x32_bf16 v[72:75], v[8:11], v[32:35], 0
ds_read_b128 v[56:59], v3 offset:3280
v_perm_b32 v24, v233, v233, v16
v_mfma_f32_16x16x32_bf16 v[76:79], v[8:11], v[36:39], 0
ds_read_b128 v[60:63], v3 offset:19920
v_perm_b32 v25, v233, v233, v17
v_mfma_f32_16x16x32_bf16 v[128:131], a[176:179], v[80:83], v[128:131]
v_perm_b32 v26, v233, v233, v18
v_perm_b32 v27, v233, v233, v19
v_mfma_f32_16x16x32_bf16 v[136:139], a[176:179], v[84:87], v[136:139]
buffer_load_dwordx4 a[152:155], v1, s[12:15], s41 offen offset:2048 sc1
buffer_load_dwordx4 v[204:207], v1, s[68:71], s45 offen offset:1024 sc1
v_mfma_f32_16x16x32_bf16 v[72:75], v[12:15], v[40:43], v[72:75]
ds_read_b128 v[32:35], v3 offset:4320
v_perm_b32 v28, v233, v233, v20
v_mfma_f32_16x16x32_bf16 v[76:79], v[12:15], v[44:47], v[76:79]
ds_read_b128 v[36:39], v3 offset:20960
v_perm_b32 v29, v233, v233, v21
v_mfma_f32_16x16x32_bf16 v[132:135], a[180:183], v[80:83], v[132:135]
v_perm_b32 v30, v233, v233, v22
v_perm_b32 v31, v233, v233, v23
v_mfma_f32_16x16x32_bf16 v[140:143], a[180:183], v[84:87], v[140:143]
s_waitcnt lgkmcnt(2)
s_nop 0
ds_read_b128 v[88:91], v5 offset:14336
buffer_load_dwordx4 a[156:159], v1, s[12:15], s41 offen offset:3072 sc1
v_mfma_f32_16x16x32_bf16 v[72:75], v[24:27], v[48:51], v[72:75]
ds_read_b128 v[40:43], v3 offset:5360
v_perm_b32 v8, v234, v234, v16
v_mfma_f32_16x16x32_bf16 v[76:79], v[24:27], v[52:55], v[76:79]
ds_read_b128 v[44:47], v3 offset:22000
v_perm_b32 v9, v234, v234, v17
v_mfma_f32_16x16x32_bf16 v[144:147], a[184:187], v[80:83], v[144:147]
v_perm_b32 v10, v234, v234, v18
v_perm_b32 v11, v234, v234, v19
v_mfma_f32_16x16x32_bf16 v[152:155], a[184:187], v[84:87], v[152:155]
ds_read_b128 v[92:95], v5 offset:15360
s_mov_b64 exec, 1
buffer_store_dword v7, off, s[72:75], s36 offset:16 sc1
s_mov_b64 exec, -1
s_add_u32 s41, s40, 57344
buffer_load_dwordx4 a[160:163], v1, s[12:15], s41 offen offset:0 sc1
v_mfma_f32_16x16x32_bf16 v[72:75], v[28:31], v[56:59], v[72:75]
ds_read_b128 v[48:51], v3 offset:6400
v_perm_b32 v12, v234, v234, v20
v_mfma_f32_16x16x32_bf16 v[76:79], v[28:31], v[60:63], v[76:79]
ds_read_b128 v[52:55], v3 offset:23040
v_perm_b32 v13, v234, v234, v21
v_mfma_f32_16x16x32_bf16 v[148:151], a[188:191], v[80:83], v[148:151]
v_perm_b32 v14, v234, v234, v22
v_perm_b32 v15, v234, v234, v23
v_mfma_f32_16x16x32_bf16 v[156:159], a[188:191], v[84:87], v[156:159]
s_waitcnt lgkmcnt(3)
s_nop 0
buffer_load_dwordx4 a[164:167], v1, s[12:15], s41 offen offset:1024 sc1
v_mfma_f32_16x16x32_bf16 v[72:75], v[8:11], v[32:35], v[72:75]
ds_read_b128 v[56:59], v3 offset:7440
v_perm_b32 v24, v235, v235, v16
v_mfma_f32_16x16x32_bf16 v[76:79], v[8:11], v[36:39], v[76:79]
ds_read_b128 v[60:63], v3 offset:24080
v_perm_b32 v25, v235, v235, v17
v_mfma_f32_16x16x32_bf16 v[160:163], a[16:19], v[80:83], v[160:163]
v_perm_b32 v26, v235, v235, v18
v_perm_b32 v27, v235, v235, v19
v_mfma_f32_16x16x32_bf16 v[168:171], a[16:19], v[84:87], v[168:171]
buffer_load_dwordx4 a[168:171], v1, s[12:15], s41 offen offset:2048 sc1
buffer_load_dwordx4 v[96:99], v1, s[68:71], s46 offen offset:1024 sc1
v_mfma_f32_16x16x32_bf16 v[72:75], v[12:15], v[40:43], v[72:75]
ds_read_b128 v[32:35], v3 offset:8480
v_perm_b32 v28, v235, v235, v20
v_mfma_f32_16x16x32_bf16 v[76:79], v[12:15], v[44:47], v[76:79]
ds_read_b128 v[36:39], v3 offset:25120
v_perm_b32 v29, v235, v235, v21
v_mfma_f32_16x16x32_bf16 v[164:167], a[20:23], v[80:83], v[164:167]
v_perm_b32 v30, v235, v235, v22
v_perm_b32 v31, v235, v235, v23
v_mfma_f32_16x16x32_bf16 v[172:175], a[20:23], v[84:87], v[172:175]
s_waitcnt lgkmcnt(2)
s_nop 0
buffer_load_dwordx4 a[172:175], v1, s[12:15], s41 offen offset:3072 sc1
v_mfma_f32_16x16x32_bf16 v[72:75], v[24:27], v[48:51], v[72:75]
ds_read_b128 v[40:43], v3 offset:9520
v_perm_b32 v8, v236, v236, v16
v_mfma_f32_16x16x32_bf16 v[76:79], v[24:27], v[52:55], v[76:79]
ds_read_b128 v[44:47], v3 offset:26160
v_perm_b32 v9, v236, v236, v17
v_mfma_f32_16x16x32_bf16 v[176:179], a[24:27], v[80:83], v[176:179]
v_perm_b32 v10, v236, v236, v18
v_perm_b32 v11, v236, v236, v19
v_mfma_f32_16x16x32_bf16 v[184:187], a[24:27], v[84:87], v[184:187]
s_add_u32 s41, s40, 61440
buffer_load_dwordx4 a[0:3], v1, s[12:15], s41 offen offset:0 sc1
buffer_load_dwordx4 v[100:103], v1, s[68:71], s47 offen offset:1024 sc1
v_mfma_f32_16x16x32_bf16 v[72:75], v[28:31], v[56:59], v[72:75]
ds_read_b128 v[48:51], v3 offset:10560
v_perm_b32 v12, v236, v236, v20
v_mfma_f32_16x16x32_bf16 v[76:79], v[28:31], v[60:63], v[76:79]
ds_read_b128 v[52:55], v3 offset:27200
v_perm_b32 v13, v236, v236, v21
v_mfma_f32_16x16x32_bf16 v[180:183], a[28:31], v[80:83], v[180:183]
v_perm_b32 v14, v236, v236, v22
v_perm_b32 v15, v236, v236, v23
v_mfma_f32_16x16x32_bf16 v[188:191], a[28:31], v[84:87], v[188:191]
s_waitcnt lgkmcnt(2)
s_nop 0
buffer_load_dwordx4 a[4:7], v1, s[12:15], s41 offen offset:1024 sc1
v_mfma_f32_16x16x32_bf16 v[72:75], v[8:11], v[32:35], v[72:75]
ds_read_b128 v[56:59], v3 offset:11600
v_perm_b32 v24, v237, v237, v16
v_mfma_f32_16x16x32_bf16 v[76:79], v[8:11], v[36:39], v[76:79]
ds_read_b128 v[60:63], v3 offset:28240
v_perm_b32 v25, v237, v237, v17
v_mfma_f32_16x16x32_bf16 v[128:131], a[32:35], v[88:91], v[128:131]
v_perm_b32 v26, v237, v237, v18
v_perm_b32 v27, v237, v237, v19
v_mfma_f32_16x16x32_bf16 v[136:139], a[32:35], v[92:95], v[136:139]
buffer_load_dwordx4 a[8:11], v1, s[12:15], s41 offen offset:2048 sc1
s_add_u32 s45, s45, 8192
buffer_load_dwordx4 v[208:211], v1, s[68:71], s45 offen offset:0 sc1
v_mfma_f32_16x16x32_bf16 v[72:75], v[12:15], v[40:43], v[72:75]
ds_read_b128 v[32:35], v3 offset:12640
v_perm_b32 v28, v237, v237, v20
v_mfma_f32_16x16x32_bf16 v[76:79], v[12:15], v[44:47], v[76:79]
ds_read_b128 v[36:39], v3 offset:29280
v_perm_b32 v29, v237, v237, v21
v_mfma_f32_16x16x32_bf16 v[132:135], a[36:39], v[88:91], v[132:135]
v_perm_b32 v30, v237, v237, v22
v_perm_b32 v31, v237, v237, v23
v_mfma_f32_16x16x32_bf16 v[140:143], a[36:39], v[92:95], v[140:143]
s_waitcnt lgkmcnt(2)
s_nop 0
buffer_load_dwordx4 a[12:15], v1, s[12:15], s41 offen offset:3072 sc1
v_mfma_f32_16x16x32_bf16 v[72:75], v[24:27], v[48:51], v[72:75]
ds_read_b128 v[40:43], v3 offset:13680
v_perm_b32 v8, v238, v238, v16
v_mfma_f32_16x16x32_bf16 v[76:79], v[24:27], v[52:55], v[76:79]
ds_read_b128 v[44:47], v3 offset:30320
v_perm_b32 v9, v238, v238, v17
v_mfma_f32_16x16x32_bf16 v[144:147], a[192:195], v[88:91], v[144:147]
v_perm_b32 v10, v238, v238, v18
v_perm_b32 v11, v238, v238, v19
v_mfma_f32_16x16x32_bf16 v[152:155], a[192:195], v[92:95], v[152:155]
s_add_u32 s41, s40, 90112
buffer_load_dwordx4 a[176:179], v1, s[12:15], s41 offen offset:0 sc1
s_add_u32 s46, s46, 8192
buffer_load_dwordx4 v[212:215], v1, s[68:71], s46 offen offset:0 sc1
v_mfma_f32_16x16x32_bf16 v[72:75], v[28:31], v[56:59], v[72:75]
ds_read_b128 v[48:51], v3 offset:14720
v_perm_b32 v12, v238, v238, v20
v_mfma_f32_16x16x32_bf16 v[76:79], v[28:31], v[60:63], v[76:79]
ds_read_b128 v[52:55], v3 offset:31360
v_perm_b32 v13, v238, v238, v21
v_mfma_f32_16x16x32_bf16 v[148:151], a[196:199], v[88:91], v[148:151]
v_perm_b32 v14, v238, v238, v22
v_perm_b32 v15, v238, v238, v23
v_mfma_f32_16x16x32_bf16 v[156:159], a[196:199], v[92:95], v[156:159]
s_waitcnt lgkmcnt(2)
s_nop 0
buffer_load_dwordx4 a[180:183], v1, s[12:15], s41 offen offset:1024 sc1
v_mfma_f32_16x16x32_bf16 v[72:75], v[8:11], v[32:35], v[72:75]
ds_read_b128 v[56:59], v3 offset:15760
v_perm_b32 v24, v239, v239, v16
v_mfma_f32_16x16x32_bf16 v[76:79], v[8:11], v[36:39], v[76:79]
ds_read_b128 v[60:63], v3 offset:32400
v_perm_b32 v25, v239, v239, v17
v_mfma_f32_16x16x32_bf16 v[160:163], a[200:203], v[88:91], v[160:163]
v_perm_b32 v26, v239, v239, v18
v_perm_b32 v27, v239, v239, v19
v_mfma_f32_16x16x32_bf16 v[168:171], a[200:203], v[92:95], v[168:171]
buffer_load_dwordx4 a[184:187], v1, s[12:15], s41 offen offset:2048 sc1
s_add_u32 s47, s47, 8192
buffer_load_dwordx4 v[216:219], v1, s[68:71], s47 offen offset:0 sc1
v_mfma_f32_16x16x32_bf16 v[72:75], v[12:15], v[40:43], v[72:75]
v_perm_b32 v28, v239, v239, v20
v_mfma_f32_16x16x32_bf16 v[76:79], v[12:15], v[44:47], v[76:79]
v_perm_b32 v29, v239, v239, v21
v_mfma_f32_16x16x32_bf16 v[164:167], a[204:207], v[88:91], v[164:167]
v_perm_b32 v30, v239, v239, v22
v_perm_b32 v31, v239, v239, v23
v_mfma_f32_16x16x32_bf16 v[172:175], a[204:207], v[92:95], v[172:175]
s_waitcnt lgkmcnt(0)
s_nop 0
buffer_load_dwordx4 a[188:191], v1, s[12:15], s41 offen offset:3072 sc1
v_mfma_f32_16x16x32_bf16 v[72:75], v[24:27], v[48:51], v[72:75]
v_mfma_f32_16x16x32_bf16 v[76:79], v[24:27], v[52:55], v[76:79]
v_mfma_f32_16x16x32_bf16 v[176:179], a[40:43], v[88:91], v[176:179]
v_mfma_f32_16x16x32_bf16 v[184:187], a[40:43], v[92:95], v[184:187]
s_add_u32 s41, s40, 94208
buffer_load_dwordx4 a[16:19], v1, s[12:15], s41 offen offset:0 sc1
buffer_load_dwordx4 v[220:223], v1, s[68:71], s45 offen offset:1024 sc1
v_mfma_f32_16x16x32_bf16 v[72:75], v[28:31], v[56:59], v[72:75]
v_mfma_f32_16x16x32_bf16 v[76:79], v[28:31], v[60:63], v[76:79]
v_mfma_f32_16x16x32_bf16 v[180:183], a[44:47], v[88:91], v[180:183]
v_mfma_f32_16x16x32_bf16 v[188:191], a[44:47], v[92:95], v[188:191]
buffer_load_dwordx4 a[20:23], v1, s[12:15], s41 offen offset:1024 sc1
s_nop 7
v_lshlrev_b32 v8, 16, v112
v_and_b32 v9, s43, v112
v_lshlrev_b32 v10, 16, v113
v_and_b32 v11, s43, v113
v_lshlrev_b32 v12, 16, v114
v_and_b32 v13, s43, v114
v_lshlrev_b32 v14, 16, v115
v_and_b32_e64 v15, s43, v115
v_pk_mul_f32 v[8:9], v[8:9], v[64:65]
v_pk_mul_f32 v[10:11], v[10:11], v[66:67]
v_pk_mul_f32 v[12:13], v[12:13], v[72:73]
v_pk_mul_f32 v[14:15], v[14:15], v[74:75]
v_cvt_pk_bf16_f32 v112, v8, v9
v_cvt_pk_bf16_f32 v113, v10, v11
v_cvt_pk_bf16_f32 v114, v12, v13
v_cvt_pk_bf16_f32 v115, v14, v15
ds_write_b128 v2, v[112:115] offset:0
buffer_load_dwordx4 a[24:27], v1, s[12:15], s41 offen offset:2048 sc1
v_lshlrev_b32 v24, 16, v116
v_and_b32 v25, s43, v116
v_lshlrev_b32 v26, 16, v117
v_and_b32 v27, s43, v117
v_lshlrev_b32 v28, 16, v118
v_and_b32 v29, s43, v118
v_lshlrev_b32 v30, 16, v119
v_and_b32 v31, s43, v119
v_pk_mul_f32 v[24:25], v[24:25], v[68:69]
v_pk_mul_f32 v[26:27], v[26:27], v[70:71]
v_pk_mul_f32 v[28:29], v[28:29], v[76:77]
v_pk_mul_f32 v[30:31], v[30:31], v[78:79]
v_cvt_pk_bf16_f32 v116, v24, v25
v_cvt_pk_bf16_f32 v117, v26, v27
v_cvt_pk_bf16_f32 v118, v28, v29
v_cvt_pk_bf16_f32 v119, v30, v31
ds_write_b128 v2, v[116:119] offset:1024
buffer_load_dwordx4 a[28:31], v1, s[12:15], s41 offen offset:3072 sc1
s_waitcnt lgkmcnt(0)
s_barrier
v_and_b32 v0, 0xf0, v1
buffer_load_dwordx4 v[236:239], v0, s[52:55], s26 offen sc1
buffer_load_dwordx4 v[112:115], v0, s[52:55], s27 offen sc1
buffer_load_dwordx4 v[116:119], v0, s[52:55], s28 offen sc1
ds_read_b128 v[80:83], v5 offset:0
ds_read_b128 v[84:87], v5 offset:1024
ds_read_b128 v[32:35], v3 offset:192
ds_read_b128 v[36:39], v3 offset:16832
ds_read_b128 v[40:43], v3 offset:1232
ds_read_b128 v[44:47], v3 offset:17872
ds_read_b128 v[48:51], v3 offset:2272
ds_read_b128 v[52:55], v3 offset:18912
v_perm_b32 v8, v240, v240, v16
v_perm_b32 v9, v240, v240, v17
v_perm_b32 v10, v240, v240, v18
v_perm_b32 v11, v240, v240, v19
v_perm_b32 v12, v240, v240, v20
v_perm_b32 v13, v240, v240, v21
v_perm_b32 v14, v240, v240, v22
v_perm_b32 v15, v240, v240, v23
s_waitcnt lgkmcnt(2)
s_nop 0
v_mfma_f32_16x16x32_bf16 v[64:67], v[8:11], v[32:35], 0
ds_read_b128 v[56:59], v3 offset:3312
v_perm_b32 v24, v241, v241, v16
v_mfma_f32_16x16x32_bf16 v[68:71], v[8:11], v[36:39], 0
ds_read_b128 v[60:63], v3 offset:19952
v_perm_b32 v25, v241, v241, v17
v_mfma_f32_16x16x32_bf16 v[128:131], a[48:51], v[80:83], v[128:131]
v_perm_b32 v26, v241, v241, v18
v_perm_b32 v27, v241, v241, v19
v_mfma_f32_16x16x32_bf16 v[136:139], a[48:51], v[84:87], v[136:139]
s_add_u32 s41, s40, 122880
buffer_load_dwordx4 a[32:35], v1, s[12:15], s41 offen offset:0 sc1
buffer_load_dwordx4 v[104:107], v1, s[68:71], s46 offen offset:1024 sc1
v_mfma_f32_16x16x32_bf16 v[64:67], v[12:15], v[40:43], v[64:67]
ds_read_b128 v[32:35], v3 offset:4352
v_perm_b32 v28, v241, v241, v20
v_mfma_f32_16x16x32_bf16 v[68:71], v[12:15], v[44:47], v[68:71]
ds_read_b128 v[36:39], v3 offset:20992
v_perm_b32 v29, v241, v241, v21
v_mfma_f32_16x16x32_bf16 v[132:135], a[52:55], v[80:83], v[132:135]
v_perm_b32 v30, v241, v241, v22
v_perm_b32 v31, v241, v241, v23
v_mfma_f32_16x16x32_bf16 v[140:143], a[52:55], v[84:87], v[140:143]
s_waitcnt lgkmcnt(2)
s_nop 0
ds_read_b128 v[88:91], v5 offset:2048
buffer_load_dwordx4 a[36:39], v1, s[12:15], s41 offen offset:1024 sc1
v_mfma_f32_16x16x32_bf16 v[64:67], v[24:27], v[48:51], v[64:67]
ds_read_b128 v[40:43], v3 offset:5392
v_perm_b32 v8, v242, v242, v16
v_mfma_f32_16x16x32_bf16 v[68:71], v[24:27], v[52:55], v[68:71]
ds_read_b128 v[44:47], v3 offset:22032
v_perm_b32 v9, v242, v242, v17
v_mfma_f32_16x16x32_bf16 v[144:147], a[56:59], v[80:83], v[144:147]
v_perm_b32 v10, v242, v242, v18
v_perm_b32 v11, v242, v242, v19
v_mfma_f32_16x16x32_bf16 v[152:155], a[56:59], v[84:87], v[152:155]
ds_read_b128 v[92:95], v5 offset:3072
buffer_load_dwordx4 a[192:195], v1, s[12:15], s41 offen offset:2048 sc1
buffer_load_dwordx4 v[108:111], v1, s[68:71], s47 offen offset:1024 sc1
v_mfma_f32_16x16x32_bf16 v[64:67], v[28:31], v[56:59], v[64:67]
ds_read_b128 v[48:51], v3 offset:6432
v_perm_b32 v12, v242, v242, v20
v_mfma_f32_16x16x32_bf16 v[68:71], v[28:31], v[60:63], v[68:71]
ds_read_b128 v[52:55], v3 offset:23072
v_perm_b32 v13, v242, v242, v21
v_mfma_f32_16x16x32_bf16 v[148:151], a[60:63], v[80:83], v[148:151]
v_perm_b32 v14, v242, v242, v22
v_perm_b32 v15, v242, v242, v23
v_mfma_f32_16x16x32_bf16 v[156:159], a[60:63], v[84:87], v[156:159]
s_waitcnt lgkmcnt(3)
s_nop 0
buffer_load_dwordx4 a[196:199], v1, s[12:15], s41 offen offset:3072 sc1
v_mfma_f32_16x16x32_bf16 v[64:67], v[8:11], v[32:35], v[64:67]
ds_read_b128 v[56:59], v3 offset:7472
v_perm_b32 v24, v243, v243, v16
v_mfma_f32_16x16x32_bf16 v[68:71], v[8:11], v[36:39], v[68:71]
ds_read_b128 v[60:63], v3 offset:24112
v_perm_b32 v25, v243, v243, v17
v_mfma_f32_16x16x32_bf16 v[160:163], a[208:211], v[80:83], v[160:163]
v_perm_b32 v26, v243, v243, v18
v_perm_b32 v27, v243, v243, v19
v_mfma_f32_16x16x32_bf16 v[168:171], a[208:211], v[84:87], v[168:171]
s_add_u32 s41, s40, 126976
buffer_load_dwordx4 a[200:203], v1, s[12:15], s41 offen offset:0 sc1
buffer_load_dwordx4 a[204:207], v1, s[12:15], s41 offen offset:1024 sc1
v_mfma_f32_16x16x32_bf16 v[64:67], v[12:15], v[40:43], v[64:67]
ds_read_b128 v[32:35], v3 offset:8512
v_perm_b32 v28, v243, v243, v20
v_mfma_f32_16x16x32_bf16 v[68:71], v[12:15], v[44:47], v[68:71]
ds_read_b128 v[36:39], v3 offset:25152
v_perm_b32 v29, v243, v243, v21
v_mfma_f32_16x16x32_bf16 v[164:167], a[212:215], v[80:83], v[164:167]
v_perm_b32 v30, v243, v243, v22
v_perm_b32 v31, v243, v243, v23
v_mfma_f32_16x16x32_bf16 v[172:175], a[212:215], v[84:87], v[172:175]
s_waitcnt lgkmcnt(2)
s_nop 0
buffer_load_dwordx4 a[40:43], v1, s[12:15], s41 offen offset:2048 sc1
v_mfma_f32_16x16x32_bf16 v[64:67], v[24:27], v[48:51], v[64:67]
ds_read_b128 v[40:43], v3 offset:9552
v_perm_b32 v8, v244, v244, v16
v_mfma_f32_16x16x32_bf16 v[68:71], v[24:27], v[52:55], v[68:71]
ds_read_b128 v[44:47], v3 offset:26192
v_perm_b32 v9, v244, v244, v17
v_mfma_f32_16x16x32_bf16 v[176:179], a[216:219], v[80:83], v[176:179]
v_perm_b32 v10, v244, v244, v18
v_perm_b32 v11, v244, v244, v19
v_mfma_f32_16x16x32_bf16 v[184:187], a[216:219], v[84:87], v[184:187]
buffer_load_dwordx4 a[44:47], v1, s[12:15], s41 offen offset:3072 sc1
s_add_u32 s41, s40, 524288
buffer_load_dwordx4 a[48:51], v1, s[12:15], s41 offen offset:0 sc1
v_mfma_f32_16x16x32_bf16 v[64:67], v[28:31], v[56:59], v[64:67]
ds_read_b128 v[48:51], v3 offset:10592
v_perm_b32 v12, v244, v244, v20
v_mfma_f32_16x16x32_bf16 v[68:71], v[28:31], v[60:63], v[68:71]
ds_read_b128 v[52:55], v3 offset:27232
v_perm_b32 v13, v244, v244, v21
v_mfma_f32_16x16x32_bf16 v[180:183], a[220:223], v[80:83], v[180:183]
v_perm_b32 v14, v244, v244, v22
v_perm_b32 v15, v244, v244, v23
v_mfma_f32_16x16x32_bf16 v[188:191], a[220:223], v[84:87], v[188:191]
s_waitcnt lgkmcnt(2)
s_nop 0
buffer_load_dwordx4 a[52:55], v1, s[12:15], s41 offen offset:1024 sc1
v_mfma_f32_16x16x32_bf16 v[64:67], v[8:11], v[32:35], v[64:67]
ds_read_b128 v[56:59], v3 offset:11632
v_perm_b32 v24, v245, v245, v16
v_mfma_f32_16x16x32_bf16 v[68:71], v[8:11], v[36:39], v[68:71]
ds_read_b128 v[60:63], v3 offset:28272
v_perm_b32 v25, v245, v245, v17
v_mfma_f32_16x16x32_bf16 v[128:131], a[64:67], v[88:91], v[128:131]
v_perm_b32 v26, v245, v245, v18
v_perm_b32 v27, v245, v245, v19
v_mfma_f32_16x16x32_bf16 v[136:139], a[64:67], v[92:95], v[136:139]
s_waitcnt vmcnt(62)
buffer_load_dwordx4 a[56:59], v1, s[12:15], s41 offen offset:2048 sc1
s_waitcnt vmcnt(62)
buffer_load_dwordx4 a[60:63], v1, s[12:15], s41 offen offset:3072 sc1
v_mfma_f32_16x16x32_bf16 v[64:67], v[12:15], v[40:43], v[64:67]
ds_read_b128 v[32:35], v3 offset:12672
v_perm_b32 v28, v245, v245, v20
v_mfma_f32_16x16x32_bf16 v[68:71], v[12:15], v[44:47], v[68:71]
ds_read_b128 v[36:39], v3 offset:29312
v_perm_b32 v29, v245, v245, v21
v_mfma_f32_16x16x32_bf16 v[132:135], a[68:71], v[88:91], v[132:135]
v_perm_b32 v30, v245, v245, v22
v_perm_b32 v31, v245, v245, v23
v_mfma_f32_16x16x32_bf16 v[140:143], a[68:71], v[92:95], v[140:143]
s_waitcnt lgkmcnt(2)
ds_read_b128 v[80:83], v5 offset:4096
s_add_u32 s41, s40, 528384
s_waitcnt vmcnt(62)
buffer_load_dwordx4 a[208:211], v1, s[12:15], s41 offen offset:0 sc1
v_mfma_f32_16x16x32_bf16 v[64:67], v[24:27], v[48:51], v[64:67]
ds_read_b128 v[40:43], v3 offset:13712
v_perm_b32 v8, v246, v246, v16
v_mfma_f32_16x16x32_bf16 v[68:71], v[24:27], v[52:55], v[68:71]
ds_read_b128 v[44:47], v3 offset:30352
v_perm_b32 v9, v246, v246, v17
v_mfma_f32_16x16x32_bf16 v[144:147], a[72:75], v[88:91], v[144:147]
v_perm_b32 v10, v246, v246, v18
v_perm_b32 v11, v246, v246, v19
v_mfma_f32_16x16x32_bf16 v[152:155], a[72:75], v[92:95], v[152:155]
ds_read_b128 v[84:87], v5 offset:5120
s_waitcnt vmcnt(62)
buffer_load_dwordx4 v[232:235], off, s[72:75], s37 offset:16 sc1
s_waitcnt vmcnt(62)
buffer_load_dwordx4 a[212:215], v1, s[12:15], s41 offen offset:1024 sc1
v_mfma_f32_16x16x32_bf16 v[64:67], v[28:31], v[56:59], v[64:67]
ds_read_b128 v[48:51], v3 offset:14752
v_perm_b32 v12, v246, v246, v20
v_mfma_f32_16x16x32_bf16 v[68:71], v[28:31], v[60:63], v[68:71]
ds_read_b128 v[52:55], v3 offset:31392
v_perm_b32 v13, v246, v246, v21
v_mfma_f32_16x16x32_bf16 v[148:151], a[76:79], v[88:91], v[148:151]
v_perm_b32 v14, v246, v246, v22
v_perm_b32 v15, v246, v246, v23
v_mfma_f32_16x16x32_bf16 v[156:159], a[76:79], v[92:95], v[156:159]
s_waitcnt lgkmcnt(3)
s_waitcnt vmcnt(62)
buffer_load_dwordx4 a[216:219], v1, s[12:15], s41 offen offset:2048 sc1
v_mfma_f32_16x16x32_bf16 v[64:67], v[8:11], v[32:35], v[64:67]
ds_read_b128 v[56:59], v3 offset:15792
v_perm_b32 v24, v247, v247, v16
v_mfma_f32_16x16x32_bf16 v[68:71], v[8:11], v[36:39], v[68:71]
ds_read_b128 v[60:63], v3 offset:32432
v_perm_b32 v25, v247, v247, v17
v_mfma_f32_16x16x32_bf16 v[160:163], a[80:83], v[88:91], v[160:163]
v_perm_b32 v26, v247, v247, v18
v_perm_b32 v27, v247, v247, v19
v_mfma_f32_16x16x32_bf16 v[168:171], a[80:83], v[92:95], v[168:171]
s_waitcnt vmcnt(62)
buffer_load_dwordx4 a[220:223], v1, s[12:15], s41 offen offset:3072 sc1
s_add_u32 s41, s40, 532480
s_waitcnt vmcnt(62)
buffer_load_dwordx4 a[64:67], v1, s[12:15], s41 offen offset:0 sc1
v_mfma_f32_16x16x32_bf16 v[64:67], v[12:15], v[40:43], v[64:67]
ds_read_b128 v[32:35], v3 offset:224
v_perm_b32 v28, v247, v247, v20
v_mfma_f32_16x16x32_bf16 v[68:71], v[12:15], v[44:47], v[68:71]
ds_read_b128 v[36:39], v3 offset:16864
v_perm_b32 v29, v247, v247, v21
v_mfma_f32_16x16x32_bf16 v[164:167], a[84:87], v[88:91], v[164:167]
v_perm_b32 v30, v247, v247, v22
v_perm_b32 v31, v247, v247, v23
v_mfma_f32_16x16x32_bf16 v[172:175], a[84:87], v[92:95], v[172:175]
s_waitcnt lgkmcnt(2)
s_waitcnt vmcnt(62)
buffer_load_dwordx4 a[68:71], v1, s[12:15], s41 offen offset:1024 sc1
v_mfma_f32_16x16x32_bf16 v[64:67], v[24:27], v[48:51], v[64:67]
ds_read_b128 v[40:43], v3 offset:1264
v_perm_b32 v8, v248, v248, v16
v_mfma_f32_16x16x32_bf16 v[68:71], v[24:27], v[52:55], v[68:71]
ds_read_b128 v[44:47], v3 offset:17904
v_perm_b32 v9, v248, v248, v17
v_mfma_f32_16x16x32_bf16 v[176:179], a[224:227], v[88:91], v[176:179]
v_perm_b32 v10, v248, v248, v18
v_perm_b32 v11, v248, v248, v19
v_mfma_f32_16x16x32_bf16 v[184:187], a[224:227], v[92:95], v[184:187]
s_waitcnt vmcnt(62)
buffer_load_dwordx4 a[72:75], v1, s[12:15], s41 offen offset:2048 sc1
s_waitcnt vmcnt(62)
buffer_load_dwordx4 a[76:79], v1, s[12:15], s41 offen offset:3072 sc1
v_mfma_f32_16x16x32_bf16 v[64:67], v[28:31], v[56:59], v[64:67]
ds_read_b128 v[48:51], v3 offset:2304
v_perm_b32 v12, v248, v248, v20
v_mfma_f32_16x16x32_bf16 v[68:71], v[28:31], v[60:63], v[68:71]
ds_read_b128 v[52:55], v3 offset:18944
v_perm_b32 v13, v248, v248, v21
v_mfma_f32_16x16x32_bf16 v[180:183], a[228:231], v[88:91], v[180:183]
v_perm_b32 v14, v248, v248, v22
v_perm_b32 v15, v248, v248, v23
v_mfma_f32_16x16x32_bf16 v[188:191], a[228:231], v[92:95], v[188:191]
s_waitcnt lgkmcnt(2)
s_add_u32 s41, s40, 536576
s_waitcnt vmcnt(62)
buffer_load_dwordx4 a[80:83], v1, s[12:15], s41 offen offset:0 sc1
v_mfma_f32_16x16x32_bf16 v[72:75], v[8:11], v[32:35], 0
ds_read_b128 v[56:59], v3 offset:3344
v_perm_b32 v24, v249, v249, v16
v_mfma_f32_16x16x32_bf16 v[76:79], v[8:11], v[36:39], 0
ds_read_b128 v[60:63], v3 offset:19984
v_perm_b32 v25, v249, v249, v17
v_mfma_f32_16x16x32_bf16 v[128:131], a[232:235], v[80:83], v[128:131]
v_perm_b32 v26, v249, v249, v18
v_perm_b32 v27, v249, v249, v19
v_mfma_f32_16x16x32_bf16 v[136:139], a[232:235], v[84:87], v[136:139]
s_waitcnt vmcnt(62)
buffer_load_dwordx4 a[84:87], v1, s[12:15], s41 offen offset:1024 sc1
s_waitcnt vmcnt(62)
buffer_load_dwordx4 a[224:227], v1, s[12:15], s41 offen offset:2048 sc1
v_mfma_f32_16x16x32_bf16 v[72:75], v[12:15], v[40:43], v[72:75]
ds_read_b128 v[32:35], v3 offset:4384
v_perm_b32 v28, v249, v249, v20
v_mfma_f32_16x16x32_bf16 v[76:79], v[12:15], v[44:47], v[76:79]
ds_read_b128 v[36:39], v3 offset:21024
v_perm_b32 v29, v249, v249, v21
v_mfma_f32_16x16x32_bf16 v[132:135], a[236:239], v[80:83], v[132:135]
v_perm_b32 v30, v249, v249, v22
v_perm_b32 v31, v249, v249, v23
v_mfma_f32_16x16x32_bf16 v[140:143], a[236:239], v[84:87], v[140:143]
s_waitcnt lgkmcnt(2)
ds_read_b128 v[88:91], v5 offset:6144
s_waitcnt vmcnt(62)
buffer_load_dwordx4 a[228:231], v1, s[12:15], s41 offen offset:3072 sc1
v_mfma_f32_16x16x32_bf16 v[72:75], v[24:27], v[48:51], v[72:75]
ds_read_b128 v[40:43], v3 offset:5424
v_perm_b32 v8, v250, v250, v16
v_mfma_f32_16x16x32_bf16 v[76:79], v[24:27], v[52:55], v[76:79]
ds_read_b128 v[44:47], v3 offset:22064
v_perm_b32 v9, v250, v250, v17
v_mfma_f32_16x16x32_bf16 v[144:147], a[88:91], v[80:83], v[144:147]
v_perm_b32 v10, v250, v250, v18
v_perm_b32 v11, v250, v250, v19
v_mfma_f32_16x16x32_bf16 v[152:155], a[88:91], v[84:87], v[152:155]
ds_read_b128 v[92:95], v5 offset:7168
s_waitcnt vmcnt(11)
v_xor_b32 v232, v232, v7
v_bitop3_b32 v232, v233, v7, v232 bitop3:0xbe
v_bitop3_b32 v232, v234, v7, v232 bitop3:0xbe
v_bitop3_b32 v232, v235, v7, v232 bitop3:0xbe
v_cmp_ne_u32 vcc, 0, v232
s_cbranch_vccnz L_sp_21
L_bk_22:
s_add_u32 s41, s40, 540672
buffer_load_dwordx4 a[232:235], v1, s[12:15], s41 offen offset:0 sc1
v_mfma_f32_16x16x32_bf16 v[72:75], v[28:31], v[56:59], v[72:75]
ds_read_b128 v[48:51], v3 offset:6464
v_perm_b32 v12, v250, v250, v20
v_mfma_f32_16x16x32_bf16 v[76:79], v[28:31], v[60:63], v[76:79]
ds_read_b128 v[52:55], v3 offset:23104
v_perm_b32 v13, v250, v250, v21
v_mfma_f32_16x16x32_bf16 v[148:151], a[92:95], v[80:83], v[148:151]
v_perm_b32 v14, v250, v250, v22
v_perm_b32 v15, v250, v250, v23
v_mfma_f32_16x16x32_bf16 v[156:159], a[92:95], v[84:87], v[156:159]
s_waitcnt lgkmcnt(3)
s_nop 0
buffer_load_dwordx4 a[236:239], v1, s[12:15], s41 offen offset:1024 sc1
v_mfma_f32_16x16x32_bf16 v[72:75], v[8:11], v[32:35], v[72:75]
ds_read_b128 v[56:59], v3 offset:7504
v_perm_b32 v24, v251, v251, v16
v_mfma_f32_16x16x32_bf16 v[76:79], v[8:11], v[36:39], v[76:79]
ds_read_b128 v[60:63], v3 offset:24144
v_perm_b32 v25, v251, v251, v17
v_mfma_f32_16x16x32_bf16 v[160:163], a[96:99], v[80:83], v[160:163]
v_perm_b32 v26, v251, v251, v18
v_perm_b32 v27, v251, v251, v19
v_mfma_f32_16x16x32_bf16 v[168:171], a[96:99], v[84:87], v[168:171]
buffer_load_dwordx4 a[88:91], v1, s[12:15], s41 offen offset:2048 sc1
s_add_u32 s45, s45, 8192
buffer_load_dwordx4 v[224:227], v1, s[68:71], s45 offen offset:0 sc1
v_mfma_f32_16x16x32_bf16 v[72:75], v[12:15], v[40:43], v[72:75]
ds_read_b128 v[32:35], v3 offset:8544
v_perm_b32 v28, v251, v251, v20
v_mfma_f32_16x16x32_bf16 v[76:79], v[12:15], v[44:47], v[76:79]
ds_read_b128 v[36:39], v3 offset:25184
v_perm_b32 v29, v251, v251, v21
v_mfma_f32_16x16x32_bf16 v[164:167], a[100:103], v[80:83], v[164:167]
v_perm_b32 v30, v251, v251, v22
v_perm_b32 v31, v251, v251, v23
v_mfma_f32_16x16x32_bf16 v[172:175], a[100:103], v[84:87], v[172:175]
s_waitcnt lgkmcnt(2)
s_nop 0
buffer_load_dwordx4 a[92:95], v1, s[12:15], s41 offen offset:3072 sc1
v_mfma_f32_16x16x32_bf16 v[72:75], v[24:27], v[48:51], v[72:75]
ds_read_b128 v[40:43], v3 offset:9584
v_perm_b32 v8, v252, v252, v16
v_mfma_f32_16x16x32_bf16 v[76:79], v[24:27], v[52:55], v[76:79]
ds_read_b128 v[44:47], v3 offset:26224
v_perm_b32 v9, v252, v252, v17
v_mfma_f32_16x16x32_bf16 v[176:179], a[104:107], v[80:83], v[176:179]
v_perm_b32 v10, v252, v252, v18
v_perm_b32 v11, v252, v252, v19
v_mfma_f32_16x16x32_bf16 v[184:187], a[104:107], v[84:87], v[184:187]
s_add_u32 s41, s40, 544768
buffer_load_dwordx4 a[96:99], v1, s[12:15], s41 offen offset:0 sc1
s_add_u32 s46, s46, 8192
buffer_load_dwordx4 v[228:231], v1, s[68:71], s46 offen offset:0 sc1
v_mfma_f32_16x16x32_bf16 v[72:75], v[28:31], v[56:59], v[72:75]
ds_read_b128 v[48:51], v3 offset:10624
v_perm_b32 v12, v252, v252, v20
v_mfma_f32_16x16x32_bf16 v[76:79], v[28:31], v[60:63], v[76:79]
ds_read_b128 v[52:55], v3 offset:27264
v_perm_b32 v13, v252, v252, v21
v_mfma_f32_16x16x32_bf16 v[180:183], a[108:111], v[80:83], v[180:183]
v_perm_b32 v14, v252, v252, v22
v_perm_b32 v15, v252, v252, v23
v_mfma_f32_16x16x32_bf16 v[188:191], a[108:111], v[84:87], v[188:191]
s_waitcnt lgkmcnt(2)
s_nop 0
buffer_load_dwordx4 a[100:103], v1, s[12:15], s41 offen offset:1024 sc1
v_mfma_f32_16x16x32_bf16 v[72:75], v[8:11], v[32:35], v[72:75]
ds_read_b128 v[56:59], v3 offset:11664
v_perm_b32 v24, v253, v253, v16
v_mfma_f32_16x16x32_bf16 v[76:79], v[8:11], v[36:39], v[76:79]
ds_read_b128 v[60:63], v3 offset:28304
v_perm_b32 v25, v253, v253, v17
v_mfma_f32_16x16x32_bf16 v[128:131], a[240:243], v[88:91], v[128:131]
v_perm_b32 v26, v253, v253, v18
v_perm_b32 v27, v253, v253, v19
v_mfma_f32_16x16x32_bf16 v[136:139], a[240:243], v[92:95], v[136:139]
buffer_load_dwordx4 a[104:107], v1, s[12:15], s41 offen offset:2048 sc1
s_add_u32 s47, s47, 8192
buffer_load_dwordx4 v[232:235], v1, s[68:71], s47 offen offset:0 sc1
v_mfma_f32_16x16x32_bf16 v[72:75], v[12:15], v[40:43], v[72:75]
ds_read_b128 v[32:35], v3 offset:12704
v_perm_b32 v28, v253, v253, v20
v_mfma_f32_16x16x32_bf16 v[76:79], v[12:15], v[44:47], v[76:79]
ds_read_b128 v[36:39], v3 offset:29344
v_perm_b32 v29, v253, v253, v21
v_mfma_f32_16x16x32_bf16 v[132:135], a[244:247], v[88:91], v[132:135]
v_perm_b32 v30, v253, v253, v22
v_perm_b32 v31, v253, v253, v23
v_mfma_f32_16x16x32_bf16 v[140:143], a[244:247], v[92:95], v[140:143]
s_waitcnt lgkmcnt(2)
s_nop 0
buffer_load_dwordx4 a[108:111], v1, s[12:15], s41 offen offset:3072 sc1
v_mfma_f32_16x16x32_bf16 v[72:75], v[24:27], v[48:51], v[72:75]
ds_read_b128 v[40:43], v3 offset:13744
v_perm_b32 v8, v254, v254, v16
v_mfma_f32_16x16x32_bf16 v[76:79], v[24:27], v[52:55], v[76:79]
ds_read_b128 v[44:47], v3 offset:30384
v_perm_b32 v9, v254, v254, v17
v_mfma_f32_16x16x32_bf16 v[144:147], a[248:251], v[88:91], v[144:147]
v_perm_b32 v10, v254, v254, v18
v_perm_b32 v11, v254, v254, v19
v_mfma_f32_16x16x32_bf16 v[152:155], a[248:251], v[92:95], v[152:155]
s_add_u32 s41, s40, 548864
buffer_load_dwordx4 a[240:243], v1, s[12:15], s41 offen offset:0 sc1
buffer_load_dwordx4 a[244:247], v1, s[12:15], s41 offen offset:1024 sc1
v_mfma_f32_16x16x32_bf16 v[72:75], v[28:31], v[56:59], v[72:75]
ds_read_b128 v[48:51], v3 offset:14784
v_perm_b32 v12, v254, v254, v20
v_mfma_f32_16x16x32_bf16 v[76:79], v[28:31], v[60:63], v[76:79]
ds_read_b128 v[52:55], v3 offset:31424
v_perm_b32 v13, v254, v254, v21
v_mfma_f32_16x16x32_bf16 v[148:151], a[252:255], v[88:91], v[148:151]
v_perm_b32 v14, v254, v254, v22
v_perm_b32 v15, v254, v254, v23
v_mfma_f32_16x16x32_bf16 v[156:159], a[252:255], v[92:95], v[156:159]
s_waitcnt lgkmcnt(2)
s_nop 0
buffer_load_dwordx4 a[248:251], v1, s[12:15], s41 offen offset:2048 sc1
v_mfma_f32_16x16x32_bf16 v[72:75], v[8:11], v[32:35], v[72:75]
ds_read_b128 v[56:59], v3 offset:15824
v_perm_b32 v24, v255, v255, v16
v_mfma_f32_16x16x32_bf16 v[76:79], v[8:11], v[36:39], v[76:79]
ds_read_b128 v[60:63], v3 offset:32464
v_perm_b32 v25, v255, v255, v17
v_mfma_f32_16x16x32_bf16 v[160:163], a[112:115], v[88:91], v[160:163]
v_perm_b32 v26, v255, v255, v18
v_perm_b32 v27, v255, v255, v19
v_mfma_f32_16x16x32_bf16 v[168:171], a[112:115], v[92:95], v[168:171]
buffer_load_dwordx4 a[252:255], v1, s[12:15], s41 offen offset:3072 sc1
s_add_u32 s41, s40, 552960
buffer_load_dwordx4 a[112:115], v1, s[12:15], s41 offen offset:0 sc1
v_mfma_f32_16x16x32_bf16 v[72:75], v[12:15], v[40:43], v[72:75]
v_perm_b32 v28, v255, v255, v20
v_mfma_f32_16x16x32_bf16 v[76:79], v[12:15], v[44:47], v[76:79]
v_perm_b32 v29, v255, v255, v21
v_mfma_f32_16x16x32_bf16 v[164:167], a[116:119], v[88:91], v[164:167]
v_perm_b32 v30, v255, v255, v22
v_perm_b32 v31, v255, v255, v23
v_mfma_f32_16x16x32_bf16 v[172:175], a[116:119], v[92:95], v[172:175]
s_waitcnt lgkmcnt(0)
s_nop 0
buffer_load_dwordx4 a[116:119], v1, s[12:15], s41 offen offset:1024 sc1
v_mfma_f32_16x16x32_bf16 v[72:75], v[24:27], v[48:51], v[72:75]
v_mfma_f32_16x16x32_bf16 v[76:79], v[24:27], v[52:55], v[76:79]
v_mfma_f32_16x16x32_bf16 v[176:179], a[120:123], v[88:91], v[176:179]
v_mfma_f32_16x16x32_bf16 v[184:187], a[120:123], v[92:95], v[184:187]
buffer_load_dwordx4 a[120:123], v1, s[12:15], s41 offen offset:2048 sc1
v_mfma_f32_16x16x32_bf16 v[72:75], v[28:31], v[56:59], v[72:75]
v_mfma_f32_16x16x32_bf16 v[76:79], v[28:31], v[60:63], v[76:79]
v_mfma_f32_16x16x32_bf16 v[180:183], a[124:127], v[88:91], v[180:183]
v_mfma_f32_16x16x32_bf16 v[188:191], a[124:127], v[92:95], v[188:191]
buffer_load_dwordx4 a[124:127], v1, s[12:15], s41 offen offset:3072 sc1
s_nop 7
v_lshlrev_b32 v8, 16, v120
v_and_b32 v9, s43, v120
v_lshlrev_b32 v10, 16, v121
v_and_b32 v11, s43, v121
v_lshlrev_b32 v12, 16, v122
v_and_b32 v13, s43, v122
v_lshlrev_b32 v14, 16, v123
v_and_b32_e64 v15, s43, v123
v_pk_mul_f32 v[8:9], v[8:9], v[64:65]
v_pk_mul_f32 v[10:11], v[10:11], v[66:67]
v_pk_mul_f32 v[12:13], v[12:13], v[72:73]
v_pk_mul_f32 v[14:15], v[14:15], v[74:75]
v_cvt_pk_bf16_f32 v120, v8, v9
v_cvt_pk_bf16_f32 v121, v10, v11
v_cvt_pk_bf16_f32 v122, v12, v13
v_cvt_pk_bf16_f32 v123, v14, v15
ds_write_b128 v2, v[120:123] offset:8192
v_lshlrev_b32 v24, 16, v124
v_and_b32 v25, s43, v124
v_lshlrev_b32 v26, 16, v125
v_and_b32 v27, s43, v125
v_lshlrev_b32 v28, 16, v126
v_and_b32 v29, s43, v126
v_lshlrev_b32 v30, 16, v127
v_and_b32 v31, s43, v127
v_pk_mul_f32 v[24:25], v[24:25], v[68:69]
v_pk_mul_f32 v[26:27], v[26:27], v[70:71]
v_pk_mul_f32 v[28:29], v[28:29], v[76:77]
v_pk_mul_f32 v[30:31], v[30:31], v[78:79]
v_cvt_pk_bf16_f32 v124, v24, v25
v_cvt_pk_bf16_f32 v125, v26, v27
v_cvt_pk_bf16_f32 v126, v28, v29
v_cvt_pk_bf16_f32 v127, v30, v31
ds_write_b128 v2, v[124:127] offset:9216
s_waitcnt lgkmcnt(0)
s_barrier
v_add_u32_e64 v2, s59, v1
v_add_u32 v0, 66048, v0
ds_read_b128 v[32:35], v0
ds_read_b128 v[48:51], v2 offset:33280
ds_read_b128 v[52:55], v2 offset:34304
ds_read_b128 v[56:59], v2 offset:41472
ds_read_b128 v[60:63], v2 offset:42496
ds_read_b128 v[64:67], v2 offset:49664
ds_read_b128 v[68:71], v2 offset:50688
ds_read_b128 v[72:75], v2 offset:57856
ds_read_b128 v[76:79], v2 offset:58880
ds_read_b128 v[80:83], v5 offset:8192
ds_read_b128 v[84:87], v5 offset:9216
s_waitcnt lgkmcnt(0)
v_mfma_f32_16x16x32_bf16 v[128:131], a[128:131], v[80:83], v[128:131]
v_mfma_f32_16x16x32_bf16 v[136:139], a[128:131], v[84:87], v[136:139]
s_add_u32 s41, s40, 557056
buffer_load_dwordx4 a[128:131], v1, s[12:15], s41 offen offset:0 sc1
v_min3_f32 v16, v236, v112, v116
v_min_f32 v16, v16, v32
v_sub_f32 v236, v16, v236
v_sub_f32 v112, v16, v112
v_sub_f32 v116, v16, v116
v_sub_f32 v32, v16, v32
v_exp_f32_e64 v236, v236
v_mfma_f32_16x16x32_bf16 v[132:135], a[132:135], v[80:83], v[132:135]
v_mfma_f32_16x16x32_bf16 v[140:143], a[132:135], v[84:87], v[140:143]
ds_read_b128 v[88:91], v5 offset:10240
buffer_load_dwordx4 a[132:135], v1, s[12:15], s41 offen offset:1024 sc1
v_exp_f32 v112, v112
v_exp_f32 v116, v116
v_exp_f32 v32, v32
v_mul_f32 v16, v236, v238
v_fmac_f32 v16, v112, v114
v_fmac_f32 v16, v116, v118
v_fmac_f32_e64 v16, v32, v34
v_mfma_f32_16x16x32_bf16 v[144:147], a[136:139], v[80:83], v[144:147]
v_mfma_f32_16x16x32_bf16 v[152:155], a[136:139], v[84:87], v[152:155]
ds_read_b128 v[92:95], v5 offset:11264
buffer_load_dwordx4 a[136:139], v1, s[12:15], s41 offen offset:2048 sc1
v_rcp_f32 v16, v16
s_nop 0
v_mul_f32 v8, v236, v16
v_mul_f32 v10, v112, v16
v_mul_f32 v12, v116, v16
v_mul_f32 v14, v32, v16
v_min3_f32 v17, v237, v113, v117
v_mfma_f32_16x16x32_bf16 v[148:151], a[140:143], v[80:83], v[148:151]
v_mfma_f32_16x16x32_bf16 v[156:159], a[140:143], v[84:87], v[156:159]
buffer_load_dwordx4 a[140:143], v1, s[12:15], s41 offen offset:3072 sc1
v_min_f32 v17, v17, v33
v_sub_f32 v237, v17, v237
v_sub_f32 v113, v17, v113
v_sub_f32 v117, v17, v117
v_sub_f32 v33, v17, v33
v_exp_f32 v237, v237
v_exp_f32_e64 v113, v113
v_mfma_f32_16x16x32_bf16 v[160:163], a[144:147], v[80:83], v[160:163]
v_mfma_f32_16x16x32_bf16 v[168:171], a[144:147], v[84:87], v[168:171]
s_add_u32 s41, s40, 561152
buffer_load_dwordx4 a[144:147], v1, s[12:15], s41 offen offset:0 sc1
v_exp_f32 v117, v117
v_exp_f32 v33, v33
v_mul_f32 v17, v237, v239
v_fmac_f32 v17, v113, v115
v_fmac_f32 v17, v117, v119
v_fmac_f32 v17, v33, v35
v_rcp_f32_e64 v17, v17
v_mfma_f32_16x16x32_bf16 v[164:167], a[148:151], v[80:83], v[164:167]
v_mfma_f32_16x16x32_bf16 v[172:175], a[148:151], v[84:87], v[172:175]
buffer_load_dwordx4 a[148:151], v1, s[12:15], s41 offen offset:1024 sc1
s_nop 0
v_mul_f32 v9, v237, v17
v_mul_f32 v11, v113, v17
v_mul_f32 v13, v117, v17
v_mul_f32 v15, v33, v17
v_lshlrev_b32 v16, 16, v192
v_and_b32_e64 v17, s43, v192
v_mfma_f32_16x16x32_bf16 v[176:179], a[152:155], v[80:83], v[176:179]
v_mfma_f32_16x16x32_bf16 v[184:187], a[152:155], v[84:87], v[184:187]
buffer_load_dwordx4 v[236:239], v1, s[68:71], s45 offen offset:1024 sc1
v_lshlrev_b32 v18, 16, v193
v_and_b32 v19, s43, v193
v_lshlrev_b32 v20, 16, v194
v_and_b32 v21, s43, v194
v_lshlrev_b32 v22, 16, v195
v_and_b32 v23, s43, v195
v_mul_f32_e64 v24, v16, v8
v_mfma_f32_16x16x32_bf16 v[180:183], a[156:159], v[80:83], v[180:183]
v_mfma_f32_16x16x32_bf16 v[188:191], a[156:159], v[84:87], v[188:191]
s_waitcnt lgkmcnt(0)
buffer_load_dwordx4 a[152:155], v1, s[12:15], s41 offen offset:2048 sc1
v_mul_f32 v25, v17, v8
v_mul_f32 v26, v18, v8
v_mul_f32 v27, v19, v8
v_mul_f32 v28, v20, v8
v_mul_f32 v29, v21, v8
v_mul_f32 v30, v22, v8
v_mul_f32 v31, v23, v8
v_mfma_f32_16x16x32_bf16 v[128:131], a[160:163], v[88:91], v[128:131]
v_mfma_f32_16x16x32_bf16 v[136:139], a[160:163], v[92:95], v[136:139]
buffer_load_dwordx4 v[112:115], v1, s[68:71], s46 offen offset:1024 sc1
v_lshlrev_b32 v16, 16, v196
v_and_b32 v17, s43, v196
v_lshlrev_b32 v18, 16, v197
v_and_b32 v19, s43, v197
v_lshlrev_b32 v20, 16, v198
v_and_b32 v21, s43, v198
v_lshlrev_b32_e64 v22, 16, v199
v_mfma_f32_16x16x32_bf16 v[132:135], a[164:167], v[88:91], v[132:135]
v_mfma_f32_16x16x32_bf16 v[140:143], a[164:167], v[92:95], v[140:143]
ds_read_b128 v[80:83], v5 offset:12288
buffer_load_dwordx4 v[192:195], v1, s[12:15], s41 offen offset:3072 sc1
v_and_b32 v23, s43, v199
v_fmac_f32 v24, v16, v10
v_fmac_f32 v25, v17, v10
v_fmac_f32 v26, v18, v10
v_fmac_f32 v27, v19, v10
v_fmac_f32 v28, v20, v10
v_fmac_f32_e64 v29, v21, v10
v_mfma_f32_16x16x32_bf16 v[144:147], a[168:171], v[88:91], v[144:147]
v_mfma_f32_16x16x32_bf16 v[152:155], a[168:171], v[92:95], v[152:155]
ds_read_b128 v[84:87], v5 offset:13312
buffer_load_dwordx4 v[116:119], v1, s[68:71], s47 offen offset:1024 sc1
v_fmac_f32 v30, v22, v10
v_fmac_f32 v31, v23, v10
v_lshlrev_b32 v16, 16, v200
v_and_b32 v17, s43, v200
v_lshlrev_b32 v18, 16, v201
v_and_b32 v19, s43, v201
v_lshlrev_b32_e64 v20, 16, v202
v_mfma_f32_16x16x32_bf16 v[148:151], a[172:175], v[88:91], v[148:151]
v_mfma_f32_16x16x32_bf16 v[156:159], a[172:175], v[92:95], v[156:159]
s_add_u32 s41, s40, 565248
buffer_load_dwordx4 a[156:159], v1, s[12:15], s41 offen offset:0 sc1
v_and_b32 v21, s43, v202
v_lshlrev_b32 v22, 16, v203
v_and_b32 v23, s43, v203
v_fmac_f32 v24, v16, v12
v_fmac_f32 v25, v17, v12
v_fmac_f32 v26, v18, v12
v_fmac_f32_e64 v27, v19, v12
v_mfma_f32_16x16x32_bf16 v[160:163], a[0:3], v[88:91], v[160:163]
v_mfma_f32_16x16x32_bf16 v[168:171], a[0:3], v[92:95], v[168:171]
s_add_u32 s45, s45, 8192
buffer_load_dwordx4 v[240:243], v1, s[68:71], s45 offen offset:0 sc1
v_fmac_f32 v28, v20, v12
v_fmac_f32 v29, v21, v12
v_fmac_f32 v30, v22, v12
v_fmac_f32 v31, v23, v12
v_lshlrev_b32 v16, 16, v48
v_and_b32 v17, s43, v48
v_lshlrev_b32_e64 v18, 16, v49
v_mfma_f32_16x16x32_bf16 v[164:167], a[4:7], v[88:91], v[164:167]
v_mfma_f32_16x16x32_bf16 v[172:175], a[4:7], v[92:95], v[172:175]
buffer_load_dwordx4 a[160:163], v1, s[12:15], s41 offen offset:1024 sc1
v_and_b32 v19, s43, v49
v_lshlrev_b32 v20, 16, v50
v_and_b32 v21, s43, v50
v_lshlrev_b32 v22, 16, v51
v_and_b32 v23, s43, v51
v_fmac_f32 v24, v16, v14
v_fmac_f32_e64 v25, v17, v14
v_mfma_f32_16x16x32_bf16 v[176:179], a[8:11], v[88:91], v[176:179]
v_mfma_f32_16x16x32_bf16 v[184:187], a[8:11], v[92:95], v[184:187]
s_add_u32 s46, s46, 8192
buffer_load_dwordx4 v[244:247], v1, s[68:71], s46 offen offset:0 sc1
v_fmac_f32 v26, v18, v14
v_fmac_f32 v27, v19, v14
v_fmac_f32 v28, v20, v14
v_fmac_f32 v29, v21, v14
v_fmac_f32 v30, v22, v14
v_fmac_f32 v31, v23, v14
v_cvt_pk_bf16_f32 v48, v24, v25
v_mfma_f32_16x16x32_bf16 v[180:183], a[12:15], v[88:91], v[180:183]
v_mfma_f32_16x16x32_bf16 v[188:191], a[12:15], v[92:95], v[188:191]
s_waitcnt lgkmcnt(0)
s_nop 0
buffer_load_dwordx4 a[164:167], v1, s[12:15], s41 offen offset:2048 sc1
v_cvt_pk_bf16_f32 v49, v26, v27
v_cvt_pk_bf16_f32 v50, v28, v29
v_cvt_pk_bf16_f32 v51, v30, v31
v_mfma_f32_16x16x32_bf16 v[128:131], a[176:179], v[80:83], v[128:131]
v_mfma_f32_16x16x32_bf16 v[136:139], a[176:179], v[84:87], v[136:139]
ds_write_b128 v2, v[48:51] offset:33280
s_add_u32 s47, s47, 8192
buffer_load_dwordx4 v[248:251], v1, s[68:71], s47 offen offset:0 sc1
v_lshlrev_b32 v16, 16, v204
v_and_b32 v17, s43, v204
v_lshlrev_b32 v18, 16, v205
v_and_b32 v19, s43, v205
v_lshlrev_b32 v20, 16, v206
v_and_b32 v21, s43, v206
v_lshlrev_b32_e64 v22, 16, v207
v_mfma_f32_16x16x32_bf16 v[132:135], a[180:183], v[80:83], v[132:135]
v_mfma_f32_16x16x32_bf16 v[140:143], a[180:183], v[84:87], v[140:143]
ds_read_b128 v[88:91], v5 offset:14336
buffer_load_dwordx4 v[196:199], v1, s[12:15], s41 offen offset:3072 sc1
v_and_b32 v23, s43, v207
v_mul_f32 v24, v16, v9
v_mul_f32 v25, v17, v9
v_mul_f32 v26, v18, v9
v_mul_f32 v27, v19, v9
v_mul_f32 v28, v20, v9
v_mul_f32_e64 v29, v21, v9
v_mfma_f32_16x16x32_bf16 v[144:147], a[184:187], v[80:83], v[144:147]
v_mfma_f32_16x16x32_bf16 v[152:155], a[184:187], v[84:87], v[152:155]
ds_read_b128 v[92:95], v5 offset:15360
buffer_load_dwordx4 v[252:255], v1, s[68:71], s45 offen offset:1024 sc1
v_mul_f32 v30, v22, v9
v_mul_f32 v31, v23, v9
v_lshlrev_b32 v16, 16, v96
v_and_b32 v17, s43, v96
v_lshlrev_b32 v18, 16, v97
v_and_b32 v19, s43, v97
v_lshlrev_b32_e64 v20, 16, v98
v_mfma_f32_16x16x32_bf16 v[148:151], a[188:191], v[80:83], v[148:151]
v_mfma_f32_16x16x32_bf16 v[156:159], a[188:191], v[84:87], v[156:159]
s_add_u32 s41, s40, 569344
buffer_load_dwordx4 a[168:171], v1, s[12:15], s41 offen offset:0 sc1
v_and_b32 v21, s43, v98
v_lshlrev_b32 v22, 16, v99
v_and_b32 v23, s43, v99
v_fmac_f32 v24, v16, v11
v_fmac_f32 v25, v17, v11
v_fmac_f32 v26, v18, v11
v_fmac_f32_e64 v27, v19, v11
v_mfma_f32_16x16x32_bf16 v[160:163], a[16:19], v[80:83], v[160:163]
v_mfma_f32_16x16x32_bf16 v[168:171], a[16:19], v[84:87], v[168:171]
buffer_load_dwordx4 v[120:123], v1, s[68:71], s46 offen offset:1024 sc1
v_fmac_f32 v28, v20, v11
v_fmac_f32 v29, v21, v11
v_fmac_f32 v30, v22, v11
v_fmac_f32 v31, v23, v11
v_lshlrev_b32 v16, 16, v100
v_and_b32 v17, s43, v100
v_lshlrev_b32_e64 v18, 16, v101
v_mfma_f32_16x16x32_bf16 v[164:167], a[20:23], v[80:83], v[164:167]
v_mfma_f32_16x16x32_bf16 v[172:175], a[20:23], v[84:87], v[172:175]
buffer_load_dwordx4 a[172:175], v1, s[12:15], s41 offen offset:1024 sc1
v_and_b32 v19, s43, v101
v_lshlrev_b32 v20, 16, v102
v_and_b32 v21, s43, v102
v_lshlrev_b32 v22, 16, v103
v_and_b32 v23, s43, v103
v_fmac_f32 v24, v16, v13
v_fmac_f32_e64 v25, v17, v13
v_mfma_f32_16x16x32_bf16 v[176:179], a[24:27], v[80:83], v[176:179]
v_mfma_f32_16x16x32_bf16 v[184:187], a[24:27], v[84:87], v[184:187]
buffer_load_dwordx4 v[124:127], v1, s[68:71], s47 offen offset:1024 sc1
v_fmac_f32 v26, v18, v13
v_fmac_f32 v27, v19, v13
v_fmac_f32 v28, v20, v13
v_fmac_f32 v29, v21, v13
v_fmac_f32 v30, v22, v13
v_fmac_f32 v31, v23, v13
v_lshlrev_b32_e64 v16, 16, v52
v_mfma_f32_16x16x32_bf16 v[180:183], a[28:31], v[80:83], v[180:183]
v_mfma_f32_16x16x32_bf16 v[188:191], a[28:31], v[84:87], v[188:191]
s_waitcnt lgkmcnt(0)
buffer_load_dwordx4 v[200:203], v1, s[12:15], s41 offen offset:2048 sc1
v_and_b32 v17, s43, v52
v_lshlrev_b32 v18, 16, v53
v_and_b32 v19, s43, v53
v_lshlrev_b32 v20, 16, v54
v_and_b32 v21, s43, v54
v_lshlrev_b32 v22, 16, v55
v_and_b32 v23, s43, v55
v_mfma_f32_16x16x32_bf16 v[128:131], a[32:35], v[88:91], v[128:131]
v_mfma_f32_16x16x32_bf16 v[136:139], a[32:35], v[92:95], v[136:139]
buffer_load_dwordx4 a[0:3], v1, s[12:15], s41 offen offset:3072 sc1
v_fmac_f32 v24, v16, v15
v_fmac_f32 v25, v17, v15
v_fmac_f32 v26, v18, v15
v_fmac_f32 v27, v19, v15
v_fmac_f32 v28, v20, v15
v_fmac_f32 v29, v21, v15
v_fmac_f32_e64 v30, v22, v15
v_mfma_f32_16x16x32_bf16 v[132:135], a[36:39], v[88:91], v[132:135]
v_mfma_f32_16x16x32_bf16 v[140:143], a[36:39], v[92:95], v[140:143]
s_add_u32 s41, s40, 573440
buffer_load_dwordx4 a[4:7], v1, s[12:15], s41 offen offset:0 sc1
v_fmac_f32_e64 v31, v23, v15
v_cvt_pk_bf16_f32 v52, v24, v25
v_cvt_pk_bf16_f32 v53, v26, v27
v_cvt_pk_bf16_f32 v54, v28, v29
v_cvt_pk_bf16_f32 v55, v30, v31
v_mfma_f32_16x16x32_bf16 v[144:147], a[192:195], v[88:91], v[144:147]
v_mfma_f32_16x16x32_bf16 v[152:155], a[192:195], v[92:95], v[152:155]
ds_write_b128 v2, v[52:55] offset:34304
buffer_load_dwordx4 a[8:11], v1, s[12:15], s41 offen offset:1024 sc1
v_mfma_f32_16x16x32_bf16 v[148:151], a[196:199], v[88:91], v[148:151]
v_mfma_f32_16x16x32_bf16 v[156:159], a[196:199], v[92:95], v[156:159]
buffer_load_dwordx4 a[12:15], v1, s[12:15], s41 offen offset:2048 sc1
v_mfma_f32_16x16x32_bf16 v[160:163], a[200:203], v[88:91], v[160:163]
v_mfma_f32_16x16x32_bf16 v[168:171], a[200:203], v[92:95], v[168:171]
buffer_load_dwordx4 a[176:179], v1, s[12:15], s41 offen offset:3072 sc1
v_mfma_f32_16x16x32_bf16 v[164:167], a[204:207], v[88:91], v[164:167]
v_mfma_f32_16x16x32_bf16 v[172:175], a[204:207], v[92:95], v[172:175]
s_add_u32 s41, s40, 577536
buffer_load_dwordx4 a[180:183], v1, s[12:15], s41 offen offset:0 sc1
v_mfma_f32_16x16x32_bf16 v[176:179], a[40:43], v[88:91], v[176:179]
v_mfma_f32_16x16x32_bf16 v[184:187], a[40:43], v[92:95], v[184:187]
buffer_load_dwordx4 v[204:207], v1, s[12:15], s41 offen offset:1024 sc1
v_mfma_f32_16x16x32_bf16 v[180:183], a[44:47], v[88:91], v[180:183]
v_mfma_f32_16x16x32_bf16 v[188:191], a[44:47], v[92:95], v[188:191]
buffer_load_dwordx4 a[184:187], v1, s[12:15], s41 offen offset:2048 sc1
s_waitcnt lgkmcnt(0)
s_barrier
ds_read_b128 v[80:83], v1 offset:33280
ds_read_b128 v[84:87], v1 offset:34304
s_waitcnt lgkmcnt(0)
v_mfma_f32_16x16x32_bf16 v[128:131], a[48:51], v[80:83], v[128:131]
v_mfma_f32_16x16x32_bf16 v[136:139], a[48:51], v[84:87], v[136:139]
buffer_load_dwordx4 a[188:191], v1, s[12:15], s41 offen offset:3072 sc1
v_lshlrev_b32 v16, 16, v208
v_and_b32 v17, s43, v208
v_lshlrev_b32 v18, 16, v209
v_and_b32 v19, s43, v209
v_lshlrev_b32 v20, 16, v210
v_mfma_f32_16x16x32_bf16 v[132:135], a[52:55], v[80:83], v[132:135]
v_mfma_f32_16x16x32_bf16 v[140:143], a[52:55], v[84:87], v[140:143]
ds_read_b128 v[88:91], v1 offset:35328
s_add_u32 s41, s40, 581632
s_waitcnt vmcnt(62)
buffer_load_dwordx4 v[96:99], v1, s[12:15], s41 offen offset:0 sc1
v_and_b32 v21, s43, v210
v_lshlrev_b32 v22, 16, v211
v_and_b32 v23, s43, v211
v_mul_f32 v24, v16, v8
v_mul_f32 v25, v17, v8
v_mfma_f32_16x16x32_bf16 v[144:147], a[56:59], v[80:83], v[144:147]
v_mfma_f32_16x16x32_bf16 v[152:155], a[56:59], v[84:87], v[152:155]
ds_read_b128 v[92:95], v1 offset:36352
s_waitcnt vmcnt(62)
buffer_load_dwordx4 a[16:19], v1, s[12:15], s41 offen offset:1024 sc1
v_mul_f32 v26, v18, v8
v_mul_f32 v27, v19, v8
v_mul_f32 v28, v20, v8
v_mul_f32 v29, v21, v8
v_mul_f32 v30, v22, v8
v_mfma_f32_16x16x32_bf16 v[148:151], a[60:63], v[80:83], v[148:151]
v_mfma_f32_16x16x32_bf16 v[156:159], a[60:63], v[84:87], v[156:159]
s_waitcnt vmcnt(62)
buffer_load_dwordx4 a[20:23], v1, s[12:15], s41 offen offset:2048 sc1
v_mul_f32 v31, v23, v8
v_lshlrev_b32 v16, 16, v212
v_and_b32 v17, s43, v212
v_lshlrev_b32 v18, 16, v213
v_and_b32 v19, s43, v213
v_mfma_f32_16x16x32_bf16 v[160:163], a[208:211], v[80:83], v[160:163]
v_mfma_f32_16x16x32_bf16 v[168:171], a[208:211], v[84:87], v[168:171]
s_waitcnt vmcnt(62)
buffer_load_dwordx4 v[100:103], v1, s[12:15], s41 offen offset:3072 sc1
v_lshlrev_b32 v20, 16, v214
v_and_b32 v21, s43, v214
v_lshlrev_b32 v22, 16, v215
v_and_b32 v23, s43, v215
v_fmac_f32 v24, v16, v10
v_mfma_f32_16x16x32_bf16 v[164:167], a[212:215], v[80:83], v[164:167]
v_mfma_f32_16x16x32_bf16 v[172:175], a[212:215], v[84:87], v[172:175]
s_add_u32 s41, s40, 585728
s_waitcnt vmcnt(62)
buffer_load_dwordx4 a[24:27], v1, s[12:15], s41 offen offset:0 sc1
v_fmac_f32 v25, v17, v10
v_fmac_f32 v26, v18, v10
v_fmac_f32 v27, v19, v10
v_fmac_f32 v28, v20, v10
v_fmac_f32 v29, v21, v10
v_mfma_f32_16x16x32_bf16 v[176:179], a[216:219], v[80:83], v[176:179]
v_mfma_f32_16x16x32_bf16 v[184:187], a[216:219], v[84:87], v[184:187]
s_waitcnt vmcnt(62)
buffer_load_dwordx4 a[28:31], v1, s[12:15], s41 offen offset:1024 sc1
v_fmac_f32 v30, v22, v10
v_fmac_f32 v31, v23, v10
v_lshlrev_b32 v16, 16, v216
v_and_b32 v17, s43, v216
v_lshlrev_b32 v18, 16, v217
v_mfma_f32_16x16x32_bf16 v[180:183], a[220:223], v[80:83], v[180:183]
v_mfma_f32_16x16x32_bf16 v[188:191], a[220:223], v[84:87], v[188:191]
s_waitcnt lgkmcnt(0)
s_waitcnt vmcnt(62)
buffer_load_dwordx4 a[32:35], v1, s[12:15], s41 offen offset:2048 sc1
v_and_b32 v19, s43, v217
v_lshlrev_b32 v20, 16, v218
v_and_b32 v21, s43, v218
v_lshlrev_b32 v22, 16, v219
v_and_b32_e64 v23, s43, v219
v_mfma_f32_16x16x32_bf16 v[128:131], a[64:67], v[88:91], v[128:131]
v_mfma_f32_16x16x32_bf16 v[136:139], a[64:67], v[92:95], v[136:139]
s_waitcnt vmcnt(62)
buffer_load_dwordx4 a[36:39], v1, s[12:15], s41 offen offset:3072 sc1
v_fmac_f32 v24, v16, v12
v_fmac_f32 v25, v17, v12
v_fmac_f32 v26, v18, v12
v_fmac_f32 v27, v19, v12
v_fmac_f32 v28, v20, v12
v_mfma_f32_16x16x32_bf16 v[132:135], a[68:71], v[88:91], v[132:135]
v_mfma_f32_16x16x32_bf16 v[140:143], a[68:71], v[92:95], v[140:143]
ds_read_b128 v[80:83], v1 offset:37376
s_add_u32 s41, s40, 589824
s_waitcnt vmcnt(62)
buffer_load_dwordx4 a[192:195], v1, s[12:15], s41 offen offset:0 sc1
v_fmac_f32 v29, v21, v12
v_fmac_f32 v30, v22, v12
v_fmac_f32 v31, v23, v12
v_lshlrev_b32 v16, 16, v56
v_and_b32 v17, s43, v56
v_mfma_f32_16x16x32_bf16 v[144:147], a[72:75], v[88:91], v[144:147]
v_mfma_f32_16x16x32_bf16 v[152:155], a[72:75], v[92:95], v[152:155]
ds_read_b128 v[84:87], v1 offset:38400
s_waitcnt vmcnt(62)
buffer_load_dwordx4 a[196:199], v1, s[12:15], s41 offen offset:1024 sc1
v_lshlrev_b32 v18, 16, v57
v_and_b32 v19, s43, v57
v_lshlrev_b32 v20, 16, v58
v_and_b32 v21, s43, v58
v_lshlrev_b32 v22, 16, v59
v_mfma_f32_16x16x32_bf16 v[148:151], a[76:79], v[88:91], v[148:151]
v_mfma_f32_16x16x32_bf16 v[156:159], a[76:79], v[92:95], v[156:159]
s_waitcnt vmcnt(62)
buffer_load_dwordx4 a[200:203], v1, s[12:15], s41 offen offset:2048 sc1
v_and_b32 v23, s43, v59
v_fmac_f32 v24, v16, v14
v_fmac_f32 v25, v17, v14
v_fmac_f32 v26, v18, v14
v_fmac_f32 v27, v19, v14
v_mfma_f32_16x16x32_bf16 v[160:163], a[80:83], v[88:91], v[160:163]
v_mfma_f32_16x16x32_bf16 v[168:171], a[80:83], v[92:95], v[168:171]
s_waitcnt vmcnt(62)
buffer_load_dwordx4 a[204:207], v1, s[12:15], s41 offen offset:3072 sc1
v_fmac_f32 v28, v20, v14
v_fmac_f32 v29, v21, v14
v_fmac_f32 v30, v22, v14
v_fmac_f32_e64 v31, v23, v14
v_cvt_pk_bf16_f32 v56, v24, v25
v_mfma_f32_16x16x32_bf16 v[164:167], a[84:87], v[88:91], v[164:167]
v_mfma_f32_16x16x32_bf16 v[172:175], a[84:87], v[92:95], v[172:175]
s_add_u32 s41, s40, 593920
s_waitcnt vmcnt(62)
s_nop 0
buffer_load_dwordx4 a[40:43], v1, s[12:15], s41 offen offset:0 sc1
v_cvt_pk_bf16_f32 v57, v26, v27
v_cvt_pk_bf16_f32 v58, v28, v29
v_cvt_pk_bf16_f32 v59, v30, v31
v_mfma_f32_16x16x32_bf16 v[176:179], a[224:227], v[88:91], v[176:179]
v_mfma_f32_16x16x32_bf16 v[184:187], a[224:227], v[92:95], v[184:187]
ds_write_b128 v2, v[56:59] offset:41472
s_waitcnt vmcnt(62)
buffer_load_dwordx4 a[44:47], v1, s[12:15], s41 offen offset:1024 sc1
v_lshlrev_b32 v16, 16, v220
v_and_b32 v17, s43, v220
v_lshlrev_b32 v18, 16, v221
v_and_b32 v19, s43, v221
v_lshlrev_b32 v20, 16, v222
v_mfma_f32_16x16x32_bf16 v[180:183], a[228:231], v[88:91], v[180:183]
v_mfma_f32_16x16x32_bf16 v[188:191], a[228:231], v[92:95], v[188:191]
s_waitcnt lgkmcnt(1)
s_waitcnt vmcnt(62)
buffer_load_dwordx4 a[48:51], v1, s[12:15], s41 offen offset:2048 sc1
v_and_b32 v21, s43, v222
v_lshlrev_b32 v22, 16, v223
v_and_b32 v23, s43, v223
v_mul_f32 v24, v16, v9
v_mul_f32_e64 v25, v17, v9
v_mfma_f32_16x16x32_bf16 v[128:131], a[232:235], v[80:83], v[128:131]
v_mfma_f32_16x16x32_bf16 v[136:139], a[232:235], v[84:87], v[136:139]
s_waitcnt vmcnt(62)
buffer_load_dwordx4 a[52:55], v1, s[12:15], s41 offen offset:3072 sc1
v_mul_f32 v26, v18, v9
v_mul_f32 v27, v19, v9
v_mul_f32 v28, v20, v9
v_mul_f32 v29, v21, v9
v_mul_f32 v30, v22, v9
v_mfma_f32_16x16x32_bf16 v[132:135], a[236:239], v[80:83], v[132:135]
v_mfma_f32_16x16x32_bf16 v[140:143], a[236:239], v[84:87], v[140:143]
ds_read_b128 v[88:91], v1 offset:39424
s_add_u32 s41, s40, 598016
s_waitcnt vmcnt(62)
buffer_load_dwordx4 v[208:211], v1, s[12:15], s41 offen offset:0 sc1
v_mul_f32 v31, v23, v9
v_lshlrev_b32 v16, 16, v104
v_and_b32 v17, s43, v104
v_lshlrev_b32 v18, 16, v105
v_and_b32 v19, s43, v105
v_mfma_f32_16x16x32_bf16 v[144:147], a[88:91], v[80:83], v[144:147]
v_mfma_f32_16x16x32_bf16 v[152:155], a[88:91], v[84:87], v[152:155]
ds_read_b128 v[92:95], v1 offset:40448
s_waitcnt vmcnt(62)
buffer_load_dwordx4 a[56:59], v1, s[12:15], s41 offen offset:1024 sc1
v_lshlrev_b32 v20, 16, v106
v_and_b32 v21, s43, v106
v_lshlrev_b32 v22, 16, v107
v_and_b32 v23, s43, v107
v_fmac_f32 v24, v16, v11
v_mfma_f32_16x16x32_bf16 v[148:151], a[92:95], v[80:83], v[148:151]
v_mfma_f32_16x16x32_bf16 v[156:159], a[92:95], v[84:87], v[156:159]
s_waitcnt vmcnt(62)
buffer_load_dwordx4 a[60:63], v1, s[12:15], s41 offen offset:2048 sc1
v_fmac_f32 v25, v17, v11
v_fmac_f32 v26, v18, v11
v_fmac_f32 v27, v19, v11
v_fmac_f32 v28, v20, v11
v_fmac_f32 v29, v21, v11
v_mfma_f32_16x16x32_bf16 v[160:163], a[96:99], v[80:83], v[160:163]
v_mfma_f32_16x16x32_bf16 v[168:171], a[96:99], v[84:87], v[168:171]
s_waitcnt vmcnt(62)
buffer_load_dwordx4 a[208:211], v1, s[12:15], s41 offen offset:3072 sc1
v_fmac_f32 v30, v22, v11
v_fmac_f32 v31, v23, v11
v_lshlrev_b32 v16, 16, v108
v_and_b32 v17, s43, v108
v_lshlrev_b32 v18, 16, v109
v_mfma_f32_16x16x32_bf16 v[164:167], a[100:103], v[80:83], v[164:167]
v_mfma_f32_16x16x32_bf16 v[172:175], a[100:103], v[84:87], v[172:175]
s_add_u32 s41, s40, 602112
s_waitcnt vmcnt(62)
buffer_load_dwordx4 v[212:215], v1, s[12:15], s41 offen offset:0 sc1
v_and_b32 v19, s43, v109
v_lshlrev_b32 v20, 16, v110
v_and_b32 v21, s43, v110
v_lshlrev_b32 v22, 16, v111
v_and_b32 v23, s43, v111
v_mfma_f32_16x16x32_bf16 v[176:179], a[104:107], v[80:83], v[176:179]
v_mfma_f32_16x16x32_bf16 v[184:187], a[104:107], v[84:87], v[184:187]
s_waitcnt vmcnt(62)
buffer_load_dwordx4 a[212:215], v1, s[12:15], s41 offen offset:1024 sc1
v_fmac_f32 v24, v16, v13
v_fmac_f32 v25, v17, v13
v_fmac_f32 v26, v18, v13
v_fmac_f32 v27, v19, v13
v_fmac_f32 v28, v20, v13
v_mfma_f32_16x16x32_bf16 v[180:183], a[108:111], v[80:83], v[180:183]
v_mfma_f32_16x16x32_bf16 v[188:191], a[108:111], v[84:87], v[188:191]
s_waitcnt vmcnt(62) lgkmcnt(0)
buffer_load_dwordx4 a[216:219], v1, s[12:15], s41 offen offset:2048 sc1
v_fmac_f32 v29, v21, v13
v_fmac_f32 v30, v22, v13
v_fmac_f32 v31, v23, v13
v_lshlrev_b32 v16, 16, v60
v_and_b32 v17, s43, v60
v_mfma_f32_16x16x32_bf16 v[128:131], a[240:243], v[88:91], v[128:131]
v_mfma_f32_16x16x32_bf16 v[136:139], a[240:243], v[92:95], v[136:139]
s_waitcnt vmcnt(62)
buffer_load_dwordx4 a[220:223], v1, s[12:15], s41 offen offset:3072 sc1
v_lshlrev_b32 v18, 16, v61
v_and_b32 v19, s43, v61
v_lshlrev_b32 v20, 16, v62
v_and_b32 v21, s43, v62
v_lshlrev_b32 v22, 16, v63
v_mfma_f32_16x16x32_bf16 v[132:135], a[244:247], v[88:91], v[132:135]
v_mfma_f32_16x16x32_bf16 v[140:143], a[244:247], v[92:95], v[140:143]
s_waitcnt vmcnt(62)
s_add_u32 s41, s40, 606208
buffer_load_dwordx4 a[64:67], v1, s[12:15], s41 offen offset:0 sc1
v_and_b32 v23, s43, v63
v_fmac_f32 v24, v16, v15
v_fmac_f32 v25, v17, v15
v_fmac_f32 v26, v18, v15
v_fmac_f32 v27, v19, v15
v_mfma_f32_16x16x32_bf16 v[144:147], a[248:251], v[88:91], v[144:147]
v_mfma_f32_16x16x32_bf16 v[152:155], a[248:251], v[92:95], v[152:155]
s_waitcnt vmcnt(62)
buffer_load_dwordx4 v[216:219], v1, s[12:15], s41 offen offset:1024 sc1
v_fmac_f32 v28, v20, v15
v_fmac_f32 v29, v21, v15
v_fmac_f32 v30, v22, v15
v_fmac_f32_e64 v31, v23, v15
v_cvt_pk_bf16_f32 v60, v24, v25
v_mfma_f32_16x16x32_bf16 v[148:151], a[252:255], v[88:91], v[148:151]
v_mfma_f32_16x16x32_bf16 v[156:159], a[252:255], v[92:95], v[156:159]
s_waitcnt vmcnt(62)
s_nop 0
buffer_load_dwordx4 a[68:71], v1, s[12:15], s41 offen offset:2048 sc1
v_cvt_pk_bf16_f32 v61, v26, v27
v_cvt_pk_bf16_f32 v62, v28, v29
v_cvt_pk_bf16_f32 v63, v30, v31
v_mfma_f32_16x16x32_bf16 v[160:163], a[112:115], v[88:91], v[160:163]
v_mfma_f32_16x16x32_bf16 v[168:171], a[112:115], v[92:95], v[168:171]
s_waitcnt vmcnt(62)
ds_write_b128 v2, v[60:63] offset:42496
buffer_load_dwordx4 a[72:75], v1, s[12:15], s41 offen offset:3072 sc1
v_mfma_f32_16x16x32_bf16 v[164:167], a[116:119], v[88:91], v[164:167]
v_mfma_f32_16x16x32_bf16 v[172:175], a[116:119], v[92:95], v[172:175]
s_waitcnt vmcnt(62)
s_add_u32 s41, s40, 610304
buffer_load_dwordx4 a[76:79], v1, s[12:15], s41 offen offset:0 sc1
v_mfma_f32_16x16x32_bf16 v[176:179], a[120:123], v[88:91], v[176:179]
v_mfma_f32_16x16x32_bf16 v[184:187], a[120:123], v[92:95], v[184:187]
s_waitcnt vmcnt(62)
buffer_load_dwordx4 a[80:83], v1, s[12:15], s41 offen offset:1024 sc1
v_mfma_f32_16x16x32_bf16 v[180:183], a[124:127], v[88:91], v[180:183]
v_mfma_f32_16x16x32_bf16 v[188:191], a[124:127], v[92:95], v[188:191]
s_waitcnt vmcnt(62)
buffer_load_dwordx4 a[84:87], v1, s[12:15], s41 offen offset:2048 sc1
s_waitcnt lgkmcnt(0)
s_barrier
ds_read_b128 v[80:83], v1 offset:41472
ds_read_b128 v[84:87], v1 offset:42496
s_waitcnt lgkmcnt(0)
v_mfma_f32_16x16x32_bf16 v[128:131], a[128:131], v[80:83], v[128:131]
v_mfma_f32_16x16x32_bf16 v[136:139], a[128:131], v[84:87], v[136:139]
s_waitcnt vmcnt(62)
buffer_load_dwordx4 a[224:227], v1, s[12:15], s41 offen offset:3072 sc1
v_lshlrev_b32 v16, 16, v224
v_and_b32 v17, s43, v224
v_lshlrev_b32 v18, 16, v225
v_and_b32 v19, s43, v225
v_lshlrev_b32_e64 v20, 16, v226
v_mfma_f32_16x16x32_bf16 v[132:135], a[132:135], v[80:83], v[132:135]
v_mfma_f32_16x16x32_bf16 v[140:143], a[132:135], v[84:87], v[140:143]
s_waitcnt vmcnt(62)
ds_read_b128 v[88:91], v1 offset:43520
s_add_u32 s41, s40, 614400
buffer_load_dwordx4 a[228:231], v1, s[12:15], s41 offen offset:0 sc1
v_and_b32 v21, s43, v226
v_lshlrev_b32 v22, 16, v227
v_and_b32 v23, s43, v227
v_mul_f32 v24, v16, v8
v_mul_f32 v25, v17, v8
v_mfma_f32_16x16x32_bf16 v[144:147], a[136:139], v[80:83], v[144:147]
v_mfma_f32_16x16x32_bf16 v[152:155], a[136:139], v[84:87], v[152:155]
s_waitcnt vmcnt(62)
ds_read_b128 v[92:95], v1 offset:44544
buffer_load_dwordx4 v[220:223], v1, s[12:15], s41 offen offset:1024 sc1
v_mul_f32 v26, v18, v8
v_mul_f32 v27, v19, v8
v_mul_f32 v28, v20, v8
v_mul_f32 v29, v21, v8
v_mul_f32 v30, v22, v8
v_mfma_f32_16x16x32_bf16 v[148:151], a[140:143], v[80:83], v[148:151]
v_mfma_f32_16x16x32_bf16 v[156:159], a[140:143], v[84:87], v[156:159]
s_waitcnt vmcnt(62)
buffer_load_dwordx4 a[232:235], v1, s[12:15], s41 offen offset:2048 sc1
v_mul_f32 v31, v23, v8
v_lshlrev_b32 v16, 16, v228
v_and_b32 v17, s43, v228
v_lshlrev_b32 v18, 16, v229
v_and_b32 v19, s43, v229
v_mfma_f32_16x16x32_bf16 v[160:163], a[144:147], v[80:83], v[160:163]
v_mfma_f32_16x16x32_bf16 v[168:171], a[144:147], v[84:87], v[168:171]
s_waitcnt vmcnt(62)
buffer_load_dwordx4 a[236:239], v1, s[12:15], s41 offen offset:3072 sc1
v_lshlrev_b32 v20, 16, v230
v_and_b32 v21, s43, v230
v_lshlrev_b32 v22, 16, v231
v_and_b32 v23, s43, v231
v_fmac_f32 v24, v16, v10
v_mfma_f32_16x16x32_bf16 v[164:167], a[148:151], v[80:83], v[164:167]
v_mfma_f32_16x16x32_bf16 v[172:175], a[148:151], v[84:87], v[172:175]
s_waitcnt vmcnt(61)
s_add_u32 s41, s40, 618496
buffer_load_dwordx4 a[88:91], v1, s[12:15], s41 offen offset:0 sc1
v_fmac_f32 v25, v17, v10
v_fmac_f32 v26, v18, v10
v_fmac_f32 v27, v19, v10
v_fmac_f32 v28, v20, v10
v_fmac_f32 v29, v21, v10
v_mfma_f32_16x16x32_bf16 v[176:179], a[152:155], v[80:83], v[176:179]
v_mfma_f32_16x16x32_bf16 v[184:187], a[152:155], v[84:87], v[184:187]
s_waitcnt vmcnt(60)
buffer_load_dwordx4 v[104:107], v1, s[12:15], s41 offen offset:1024 sc1
v_fmac_f32 v30, v22, v10
v_fmac_f32 v31, v23, v10
v_lshlrev_b32 v16, 16, v232
v_and_b32 v17, s43, v232
v_lshlrev_b32 v18, 16, v233
v_mfma_f32_16x16x32_bf16 v[180:183], v[192:195], v[80:83], v[180:183]
v_mfma_f32_16x16x32_bf16 v[188:191], v[192:195], v[84:87], v[188:191]
s_waitcnt vmcnt(59) lgkmcnt(0)
buffer_load_dwordx4 a[92:95], v1, s[12:15], s41 offen offset:2048 sc1
v_and_b32 v19, s43, v233
v_lshlrev_b32 v20, 16, v234
v_and_b32 v21, s43, v234
v_lshlrev_b32 v22, 16, v235
v_and_b32 v23, s43, v235
v_mfma_f32_16x16x32_bf16 v[128:131], a[156:159], v[88:91], v[128:131]
v_mfma_f32_16x16x32_bf16 v[136:139], a[156:159], v[92:95], v[136:139]
s_waitcnt vmcnt(58)
buffer_load_dwordx4 a[96:99], v1, s[12:15], s41 offen offset:3072 sc1
v_fmac_f32 v24, v16, v12
v_fmac_f32 v25, v17, v12
v_fmac_f32 v26, v18, v12
v_fmac_f32 v27, v19, v12
v_fmac_f32 v28, v20, v12
v_mfma_f32_16x16x32_bf16 v[132:135], a[160:163], v[88:91], v[132:135]
v_mfma_f32_16x16x32_bf16 v[140:143], a[160:163], v[92:95], v[140:143]
s_waitcnt vmcnt(57)
ds_read_b128 v[80:83], v1 offset:45568
s_add_u32 s41, s40, 622592
buffer_load_dwordx4 a[100:103], v1, s[12:15], s41 offen offset:0 sc1
v_fmac_f32 v29, v21, v12
v_fmac_f32 v30, v22, v12
v_fmac_f32 v31, v23, v12
v_lshlrev_b32 v16, 16, v64
v_and_b32 v17, s43, v64
v_mfma_f32_16x16x32_bf16 v[144:147], a[164:167], v[88:91], v[144:147]
v_mfma_f32_16x16x32_bf16 v[152:155], a[164:167], v[92:95], v[152:155]
s_waitcnt vmcnt(56)
ds_read_b128 v[84:87], v1 offset:46592
buffer_load_dwordx4 a[104:107], v1, s[12:15], s41 offen offset:1024 sc1
v_lshlrev_b32 v18, 16, v65
v_and_b32 v19, s43, v65
v_lshlrev_b32 v20, 16, v66
v_and_b32 v21, s43, v66
v_lshlrev_b32 v22, 16, v67
v_mfma_f32_16x16x32_bf16 v[148:151], v[196:199], v[88:91], v[148:151]
v_mfma_f32_16x16x32_bf16 v[156:159], v[196:199], v[92:95], v[156:159]
s_waitcnt vmcnt(55)
s_add_u32 s41, s40, 630784
buffer_load_dwordx4 v[108:111], v1, s[12:15], s41 offen offset:0 sc1
v_and_b32 v23, s43, v67
v_fmac_f32 v24, v16, v14
v_fmac_f32 v25, v17, v14
v_fmac_f32 v26, v18, v14
v_fmac_f32 v27, v19, v14
v_mfma_f32_16x16x32_bf16 v[160:163], a[168:171], v[88:91], v[160:163]
v_mfma_f32_16x16x32_bf16 v[168:171], a[168:171], v[92:95], v[168:171]
s_waitcnt vmcnt(54)
buffer_load_dwordx4 a[108:111], v1, s[12:15], s41 offen offset:1024 sc1
v_fmac_f32 v28, v20, v14
v_fmac_f32 v29, v21, v14
v_fmac_f32 v30, v22, v14
v_fmac_f32_e64 v31, v23, v14
v_cvt_pk_bf16_f32 v64, v24, v25
v_mfma_f32_16x16x32_bf16 v[164:167], a[172:175], v[88:91], v[164:167]
v_mfma_f32_16x16x32_bf16 v[172:175], a[172:175], v[92:95], v[172:175]
s_waitcnt vmcnt(53)
s_nop 0
s_add_u32 s41, s40, 638976
buffer_load_dwordx4 a[240:243], v1, s[12:15], s41 offen offset:0 sc1
v_cvt_pk_bf16_f32 v65, v26, v27
v_cvt_pk_bf16_f32 v66, v28, v29
v_cvt_pk_bf16_f32 v67, v30, v31
v_mfma_f32_16x16x32_bf16 v[176:179], v[200:203], v[88:91], v[176:179]
v_mfma_f32_16x16x32_bf16 v[184:187], v[200:203], v[92:95], v[184:187]
s_waitcnt vmcnt(53)
ds_write_b128 v2, v[64:67] offset:49664
buffer_load_dwordx4 a[244:247], v1, s[12:15], s41 offen offset:1024 sc1
v_lshlrev_b32 v16, 16, v236
v_and_b32 v17, s43, v236
v_lshlrev_b32 v18, 16, v237
v_and_b32 v19, s43, v237
v_lshlrev_b32 v20, 16, v238
v_mfma_f32_16x16x32_bf16 v[180:183], a[0:3], v[88:91], v[180:183]
v_mfma_f32_16x16x32_bf16 v[188:191], a[0:3], v[92:95], v[188:191]
s_waitcnt vmcnt(53) lgkmcnt(1)
s_add_u32 s41, s40, 647168
buffer_load_dwordx4 a[248:251], v1, s[12:15], s41 offen offset:0 sc1
v_and_b32 v21, s43, v238
v_lshlrev_b32 v22, 16, v239
v_and_b32 v23, s43, v239
v_mul_f32 v24, v16, v9
v_mul_f32 v25, v17, v9
v_mfma_f32_16x16x32_bf16 v[128:131], a[4:7], v[80:83], v[128:131]
v_mfma_f32_16x16x32_bf16 v[136:139], a[4:7], v[84:87], v[136:139]
s_waitcnt vmcnt(53)
buffer_load_dwordx4 a[252:255], v1, s[12:15], s41 offen offset:1024 sc1
v_mul_f32 v26, v18, v9
v_mul_f32 v27, v19, v9
v_mul_f32 v28, v20, v9
v_mul_f32 v29, v21, v9
v_mul_f32 v30, v22, v9
v_mfma_f32_16x16x32_bf16 v[132:135], a[8:11], v[80:83], v[132:135]
v_mfma_f32_16x16x32_bf16 v[140:143], a[8:11], v[84:87], v[140:143]
s_waitcnt vmcnt(53)
ds_read_b128 v[88:91], v1 offset:47616
s_add_u32 s41, s40, 624640
buffer_load_dwordx4 a[112:115], v1, s[12:15], s41 offen offset:0 sc1
v_mul_f32 v31, v23, v9
v_lshlrev_b32 v16, 16, v112
v_and_b32 v17, s43, v112
v_lshlrev_b32 v18, 16, v113
v_and_b32 v19, s43, v113
v_mfma_f32_16x16x32_bf16 v[144:147], a[12:15], v[80:83], v[144:147]
v_mfma_f32_16x16x32_bf16 v[152:155], a[12:15], v[84:87], v[152:155]
s_waitcnt vmcnt(53)
ds_read_b128 v[92:95], v1 offset:48640
buffer_load_dwordx4 a[116:119], v1, s[12:15], s41 offen offset:1024 sc1
v_lshlrev_b32 v20, 16, v114
v_and_b32 v21, s43, v114
v_lshlrev_b32 v22, 16, v115
v_and_b32 v23, s43, v115
v_fmac_f32 v24, v16, v11
v_mfma_f32_16x16x32_bf16 v[148:151], a[176:179], v[80:83], v[148:151]
v_mfma_f32_16x16x32_bf16 v[156:159], a[176:179], v[84:87], v[156:159]
s_waitcnt vmcnt(53)
s_add_u32 s41, s40, 632832
buffer_load_dwordx4 a[120:123], v1, s[12:15], s41 offen offset:0 sc1
v_fmac_f32 v25, v17, v11
v_fmac_f32 v26, v18, v11
v_fmac_f32 v27, v19, v11
v_fmac_f32 v28, v20, v11
v_fmac_f32 v29, v21, v11
v_mfma_f32_16x16x32_bf16 v[160:163], a[180:183], v[80:83], v[160:163]
v_mfma_f32_16x16x32_bf16 v[168:171], a[180:183], v[84:87], v[168:171]
s_waitcnt vmcnt(53)
buffer_load_dwordx4 a[124:127], v1, s[12:15], s41 offen offset:1024 sc1
v_fmac_f32 v30, v22, v11
v_fmac_f32 v31, v23, v11
v_lshlrev_b32 v16, 16, v116
v_and_b32 v17, s43, v116
v_lshlrev_b32 v18, 16, v117
v_mfma_f32_16x16x32_bf16 v[164:167], v[204:207], v[80:83], v[164:167]
v_mfma_f32_16x16x32_bf16 v[172:175], v[204:207], v[84:87], v[172:175]
s_waitcnt vmcnt(53)
s_add_u32 s41, s40, 641024
buffer_load_dwordx4 a[128:131], v1, s[12:15], s41 offen offset:0 sc1
v_and_b32 v19, s43, v117
v_lshlrev_b32 v20, 16, v118
v_and_b32 v21, s43, v118
v_lshlrev_b32 v22, 16, v119
v_and_b32 v23, s43, v119
v_mfma_f32_16x16x32_bf16 v[176:179], a[184:187], v[80:83], v[176:179]
v_mfma_f32_16x16x32_bf16 v[184:187], a[184:187], v[84:87], v[184:187]
s_waitcnt vmcnt(53)
buffer_load_dwordx4 a[132:135], v1, s[12:15], s41 offen offset:1024 sc1
v_fmac_f32 v24, v16, v13
v_fmac_f32 v25, v17, v13
v_fmac_f32 v26, v18, v13
v_fmac_f32 v27, v19, v13
v_fmac_f32 v28, v20, v13
v_mfma_f32_16x16x32_bf16 v[180:183], a[188:191], v[80:83], v[180:183]
v_mfma_f32_16x16x32_bf16 v[188:191], a[188:191], v[84:87], v[188:191]
s_waitcnt vmcnt(53) lgkmcnt(0)
s_add_u32 s41, s40, 649216
buffer_load_dwordx4 v[224:227], v1, s[12:15], s41 offen offset:0 sc1
v_fmac_f32 v29, v21, v13
v_fmac_f32 v30, v22, v13
v_fmac_f32 v31, v23, v13
v_lshlrev_b32 v16, 16, v68
v_and_b32 v17, s43, v68
v_mfma_f32_16x16x32_bf16 v[128:131], v[96:99], v[88:91], v[128:131]
v_mfma_f32_16x16x32_bf16 v[136:139], v[96:99], v[92:95], v[136:139]
s_waitcnt vmcnt(53)
buffer_load_dwordx4 a[136:139], v1, s[12:15], s41 offen offset:1024 sc1
v_lshlrev_b32 v18, 16, v69
v_and_b32 v19, s43, v69
v_lshlrev_b32 v20, 16, v70
v_and_b32 v21, s43, v70
v_lshlrev_b32 v22, 16, v71
v_mfma_f32_16x16x32_bf16 v[132:135], a[16:19], v[88:91], v[132:135]
v_mfma_f32_16x16x32_bf16 v[140:143], a[16:19], v[92:95], v[140:143]
s_waitcnt vmcnt(53)
s_add_u32 s41, s40, 626688
buffer_load_dwordx4 a[140:143], v1, s[12:15], s41 offen offset:0 sc1
v_and_b32 v23, s43, v71
v_fmac_f32 v24, v16, v15
v_fmac_f32 v25, v17, v15
v_fmac_f32 v26, v18, v15
v_fmac_f32 v27, v19, v15
v_mfma_f32_16x16x32_bf16 v[144:147], a[20:23], v[88:91], v[144:147]
v_mfma_f32_16x16x32_bf16 v[152:155], a[20:23], v[92:95], v[152:155]
s_waitcnt vmcnt(53)
buffer_load_dwordx4 a[144:147], v1, s[12:15], s41 offen offset:1024 sc1
v_fmac_f32 v28, v20, v15
v_fmac_f32 v29, v21, v15
v_fmac_f32 v30, v22, v15
v_fmac_f32_e64 v31, v23, v15
v_cvt_pk_bf16_f32 v68, v24, v25
v_mfma_f32_16x16x32_bf16 v[148:151], v[100:103], v[88:91], v[148:151]
v_mfma_f32_16x16x32_bf16 v[156:159], v[100:103], v[92:95], v[156:159]
s_waitcnt vmcnt(53)
s_nop 0
s_add_u32 s41, s40, 634880
buffer_load_dwordx4 v[228:231], v1, s[12:15], s41 offen offset:0 sc1
v_cvt_pk_bf16_f32 v69, v26, v27
v_cvt_pk_bf16_f32 v70, v28, v29
v_cvt_pk_bf16_f32 v71, v30, v31
v_mfma_f32_16x16x32_bf16 v[160:163], a[24:27], v[88:91], v[160:163]
v_mfma_f32_16x16x32_bf16 v[168:171], a[24:27], v[92:95], v[168:171]
s_waitcnt vmcnt(53)
ds_write_b128 v2, v[68:71] offset:50688
buffer_load_dwordx4 a[148:151], v1, s[12:15], s41 offen offset:1024 sc1
v_mfma_f32_16x16x32_bf16 v[164:167], a[28:31], v[88:91], v[164:167]
v_mfma_f32_16x16x32_bf16 v[172:175], a[28:31], v[92:95], v[172:175]
s_waitcnt vmcnt(53)
s_add_u32 s41, s40, 643072
buffer_load_dwordx4 a[152:155], v1, s[12:15], s41 offen offset:0 sc1
v_mfma_f32_16x16x32_bf16 v[176:179], a[32:35], v[88:91], v[176:179]
v_mfma_f32_16x16x32_bf16 v[184:187], a[32:35], v[92:95], v[184:187]
s_waitcnt vmcnt(53)
buffer_load_dwordx4 v[192:195], v1, s[12:15], s41 offen offset:1024 sc1
v_mfma_f32_16x16x32_bf16 v[180:183], a[36:39], v[88:91], v[180:183]
v_mfma_f32_16x16x32_bf16 v[188:191], a[36:39], v[92:95], v[188:191]
s_add_u32 s41, s40, 651264
buffer_load_dwordx4 a[156:159], v1, s[12:15], s41 offen offset:0 sc1
s_waitcnt lgkmcnt(0)
s_barrier
ds_read_b128 v[80:83], v1 offset:49664
ds_read_b128 v[84:87], v1 offset:50688
s_waitcnt vmcnt(54) lgkmcnt(0)
v_mfma_f32_16x16x32_bf16 v[128:131], a[192:195], v[80:83], v[128:131]
v_mfma_f32_16x16x32_bf16 v[136:139], a[192:195], v[84:87], v[136:139]
s_waitcnt vmcnt(53)
buffer_load_dwordx4 v[232:235], v1, s[12:15], s41 offen offset:1024 sc1
v_lshlrev_b32 v16, 16, v240
v_and_b32 v17, s43, v240
v_lshlrev_b32 v18, 16, v241
v_and_b32 v19, s43, v241
v_lshlrev_b32 v20, 16, v242
v_mfma_f32_16x16x32_bf16 v[132:135], a[196:199], v[80:83], v[132:135]
v_mfma_f32_16x16x32_bf16 v[140:143], a[196:199], v[84:87], v[140:143]
s_waitcnt vmcnt(53)
ds_read_b128 v[88:91], v1 offset:51712
s_add_u32 s41, s40, 628736
buffer_load_dwordx4 a[160:163], v1, s[12:15], s41 offen offset:0 sc1
v_and_b32 v21, s43, v242
v_lshlrev_b32 v22, 16, v243
v_and_b32 v23, s43, v243
v_mul_f32 v24, v16, v8
v_mul_f32 v25, v17, v8
v_mfma_f32_16x16x32_bf16 v[144:147], a[200:203], v[80:83], v[144:147]
v_mfma_f32_16x16x32_bf16 v[152:155], a[200:203], v[84:87], v[152:155]
s_waitcnt vmcnt(53)
ds_read_b128 v[92:95], v1 offset:52736
buffer_load_dwordx4 a[164:167], v1, s[12:15], s41 offen offset:1024 sc1
v_mul_f32 v26, v18, v8
v_mul_f32 v27, v19, v8
v_mul_f32 v28, v20, v8
v_mul_f32 v29, v21, v8
v_mul_f32 v30, v22, v8
v_mfma_f32_16x16x32_bf16 v[148:151], a[204:207], v[80:83], v[148:151]
v_mfma_f32_16x16x32_bf16 v[156:159], a[204:207], v[84:87], v[156:159]
s_waitcnt vmcnt(53)
s_add_u32 s41, s40, 636928
buffer_load_dwordx4 v[196:199], v1, s[12:15], s41 offen offset:0 sc1
v_mul_f32 v31, v23, v8
v_lshlrev_b32 v16, 16, v244
v_and_b32 v17, s43, v244
v_lshlrev_b32 v18, 16, v245
v_and_b32 v19, s43, v245
v_mfma_f32_16x16x32_bf16 v[160:163], a[40:43], v[80:83], v[160:163]
v_mfma_f32_16x16x32_bf16 v[168:171], a[40:43], v[84:87], v[168:171]
s_waitcnt vmcnt(53)
ds_read_b128 v[32:35], v6 offset:0
buffer_load_dwordx4 a[168:171], v1, s[12:15], s41 offen offset:1024 sc1
v_lshlrev_b32 v20, 16, v246
v_and_b32 v21, s43, v246
v_lshlrev_b32 v22, 16, v247
v_and_b32 v23, s43, v247
v_fmac_f32 v24, v16, v10
v_mfma_f32_16x16x32_bf16 v[164:167], a[44:47], v[80:83], v[164:167]
v_mfma_f32_16x16x32_bf16 v[172:175], a[44:47], v[84:87], v[172:175]
s_waitcnt vmcnt(53)
s_add_u32 s41, s40, 645120
buffer_load_dwordx4 a[172:175], v1, s[12:15], s41 offen offset:0 sc1
v_fmac_f32 v25, v17, v10
v_fmac_f32 v26, v18, v10
v_fmac_f32 v27, v19, v10
v_fmac_f32 v28, v20, v10
v_fmac_f32 v29, v21, v10
v_mfma_f32_16x16x32_bf16 v[176:179], a[48:51], v[80:83], v[176:179]
v_mfma_f32_16x16x32_bf16 v[184:187], a[48:51], v[84:87], v[184:187]
s_waitcnt vmcnt(53)
ds_read_b128 v[36:39], v6 offset:16640
buffer_load_dwordx4 v[200:203], v1, s[12:15], s41 offen offset:1024 sc1
v_fmac_f32 v30, v22, v10
v_fmac_f32 v31, v23, v10
v_lshlrev_b32 v16, 16, v248
v_and_b32 v17, s43, v248
v_lshlrev_b32 v18, 16, v249
v_mfma_f32_16x16x32_bf16 v[180:183], a[52:55], v[80:83], v[180:183]
v_mfma_f32_16x16x32_bf16 v[188:191], a[52:55], v[84:87], v[188:191]
s_waitcnt vmcnt(53) lgkmcnt(2)
s_add_u32 s41, s40, 653312
buffer_load_dwordx4 a[0:3], v1, s[12:15], s41 offen offset:0 sc1
v_and_b32 v19, s43, v249
v_lshlrev_b32 v20, 16, v250
v_and_b32 v21, s43, v250
v_lshlrev_b32 v22, 16, v251
v_and_b32 v23, s43, v251
v_mfma_f32_16x16x32_bf16 v[128:131], v[208:211], v[88:91], v[128:131]
v_mfma_f32_16x16x32_bf16 v[136:139], v[208:211], v[92:95], v[136:139]
s_waitcnt vmcnt(53)
buffer_load_dwordx4 v[236:239], v1, s[12:15], s41 offen offset:1024 sc1
v_fmac_f32 v24, v16, v12
v_fmac_f32 v25, v17, v12
v_fmac_f32 v26, v18, v12
v_fmac_f32 v27, v19, v12
v_fmac_f32 v28, v20, v12
v_mfma_f32_16x16x32_bf16 v[132:135], a[56:59], v[88:91], v[132:135]
v_mfma_f32_16x16x32_bf16 v[140:143], a[56:59], v[92:95], v[140:143]
s_waitcnt vmcnt(53)
ds_read_b128 v[80:83], v1 offset:53760
v_fmac_f32 v29, v21, v12
v_fmac_f32 v30, v22, v12
v_fmac_f32 v31, v23, v12
v_lshlrev_b32 v16, 16, v72
v_and_b32 v17, s43, v72
v_mfma_f32_16x16x32_bf16 v[144:147], a[60:63], v[88:91], v[144:147]
v_mfma_f32_16x16x32_bf16 v[152:155], a[60:63], v[92:95], v[152:155]
s_waitcnt vmcnt(52)
ds_read_b128 v[84:87], v1 offset:54784
v_lshlrev_b32 v18, 16, v73
v_and_b32 v19, s43, v73
v_lshlrev_b32 v20, 16, v74
v_and_b32 v21, s43, v74
v_lshlrev_b32 v22, 16, v75
v_mfma_f32_16x16x32_bf16 v[148:151], a[208:211], v[88:91], v[148:151]
v_mfma_f32_16x16x32_bf16 v[156:159], a[208:211], v[92:95], v[156:159]
s_waitcnt vmcnt(51)
v_and_b32 v23, s43, v75
v_fmac_f32 v24, v16, v14
v_fmac_f32 v25, v17, v14
v_fmac_f32 v26, v18, v14
v_fmac_f32 v27, v19, v14
v_mfma_f32_16x16x32_bf16 v[160:163], v[212:215], v[88:91], v[160:163]
v_mfma_f32_16x16x32_bf16 v[168:171], v[212:215], v[92:95], v[168:171]
s_waitcnt vmcnt(50)
ds_read_b128 v[40:43], v6 offset:64
v_fmac_f32 v28, v20, v14
v_fmac_f32 v29, v21, v14
v_fmac_f32 v30, v22, v14
v_fmac_f32_e64 v31, v23, v14
v_cvt_pk_bf16_f32 v72, v24, v25
v_mfma_f32_16x16x32_bf16 v[164:167], a[212:215], v[88:91], v[164:167]
v_mfma_f32_16x16x32_bf16 v[172:175], a[212:215], v[92:95], v[172:175]
s_waitcnt vmcnt(49)
v_cvt_pk_bf16_f32 v73, v26, v27
v_cvt_pk_bf16_f32 v74, v28, v29
v_cvt_pk_bf16_f32 v75, v30, v31
v_mfma_f32_16x16x32_bf16 v[176:179], a[216:219], v[88:91], v[176:179]
v_mfma_f32_16x16x32_bf16 v[184:187], a[216:219], v[92:95], v[184:187]
s_waitcnt vmcnt(48)
ds_read_b128 v[44:47], v6 offset:16704
ds_write_b128 v2, v[72:75] offset:57856
v_lshlrev_b32 v16, 16, v252
v_and_b32 v17, s43, v252
v_lshlrev_b32 v18, 16, v253
v_and_b32 v19, s43, v253
v_lshlrev_b32_e64 v20, 16, v254
v_mfma_f32_16x16x32_bf16 v[180:183], a[220:223], v[88:91], v[180:183]
v_mfma_f32_16x16x32_bf16 v[188:191], a[220:223], v[92:95], v[188:191]
s_waitcnt vmcnt(47) lgkmcnt(3)
v_and_b32 v21, s43, v254
v_lshlrev_b32 v22, 16, v255
v_and_b32 v23, s43, v255
v_mul_f32 v24, v16, v9
v_mul_f32 v25, v17, v9
v_mfma_f32_16x16x32_bf16 v[128:131], a[64:67], v[80:83], v[128:131]
v_mfma_f32_16x16x32_bf16 v[136:139], a[64:67], v[84:87], v[136:139]
s_waitcnt vmcnt(46)
v_mul_f32 v26, v18, v9
v_mul_f32 v27, v19, v9
v_mul_f32 v28, v20, v9
v_mul_f32 v29, v21, v9
v_mul_f32 v30, v22, v9
v_mfma_f32_16x16x32_bf16 v[132:135], v[216:219], v[80:83], v[132:135]
v_mfma_f32_16x16x32_bf16 v[140:143], v[216:219], v[84:87], v[140:143]
s_waitcnt vmcnt(45)
ds_read_b128 v[88:91], v1 offset:55808
v_mul_f32 v31, v23, v9
v_lshlrev_b32 v16, 16, v120
v_and_b32 v17, s43, v120
v_lshlrev_b32 v18, 16, v121
v_and_b32 v19, s43, v121
v_mfma_f32_16x16x32_bf16 v[144:147], a[68:71], v[80:83], v[144:147]
v_mfma_f32_16x16x32_bf16 v[152:155], a[68:71], v[84:87], v[152:155]
s_waitcnt vmcnt(44)
ds_read_b128 v[92:95], v1 offset:56832
v_lshlrev_b32 v20, 16, v122
v_and_b32 v21, s43, v122
v_lshlrev_b32 v22, 16, v123
v_and_b32 v23, s43, v123
v_fmac_f32 v24, v16, v11
v_mfma_f32_16x16x32_bf16 v[148:151], a[72:75], v[80:83], v[148:151]
v_mfma_f32_16x16x32_bf16 v[156:159], a[72:75], v[84:87], v[156:159]
s_waitcnt vmcnt(43)
v_fmac_f32 v25, v17, v11
v_fmac_f32 v26, v18, v11
v_fmac_f32 v27, v19, v11
v_fmac_f32 v28, v20, v11
v_fmac_f32 v29, v21, v11
v_mfma_f32_16x16x32_bf16 v[160:163], a[76:79], v[80:83], v[160:163]
v_mfma_f32_16x16x32_bf16 v[168:171], a[76:79], v[84:87], v[168:171]
s_waitcnt vmcnt(42)
ds_read_b128 v[48:51], v6 offset:128
v_fmac_f32 v30, v22, v11
v_fmac_f32 v31, v23, v11
v_lshlrev_b32 v16, 16, v124
v_and_b32 v17, s43, v124
v_lshlrev_b32 v18, 16, v125
v_mfma_f32_16x16x32_bf16 v[164:167], a[80:83], v[80:83], v[164:167]
v_mfma_f32_16x16x32_bf16 v[172:175], a[80:83], v[84:87], v[172:175]
s_waitcnt vmcnt(41)
v_and_b32 v19, s43, v125
v_lshlrev_b32 v20, 16, v126
v_and_b32 v21, s43, v126
v_lshlrev_b32 v22, 16, v127
v_and_b32 v23, s43, v127
v_mfma_f32_16x16x32_bf16 v[176:179], a[84:87], v[80:83], v[176:179]
v_mfma_f32_16x16x32_bf16 v[184:187], a[84:87], v[84:87], v[184:187]
s_waitcnt vmcnt(40)
ds_read_b128 v[52:55], v6 offset:16768
v_fmac_f32 v24, v16, v13
v_fmac_f32 v25, v17, v13
v_fmac_f32 v26, v18, v13
v_fmac_f32 v27, v19, v13
v_fmac_f32 v28, v20, v13
v_mfma_f32_16x16x32_bf16 v[180:183], a[224:227], v[80:83], v[180:183]
v_mfma_f32_16x16x32_bf16 v[188:191], a[224:227], v[84:87], v[188:191]
s_waitcnt vmcnt(39) lgkmcnt(2)
v_fmac_f32 v29, v21, v13
v_fmac_f32 v30, v22, v13
v_fmac_f32 v31, v23, v13
v_lshlrev_b32 v16, 16, v76
v_and_b32 v17, s43, v76
v_mfma_f32_16x16x32_bf16 v[128:131], a[228:231], v[88:91], v[128:131]
v_mfma_f32_16x16x32_bf16 v[136:139], a[228:231], v[92:95], v[136:139]
s_waitcnt vmcnt(38)
v_lshlrev_b32 v18, 16, v77
v_and_b32 v19, s43, v77
v_lshlrev_b32 v20, 16, v78
v_and_b32 v21, s43, v78
v_lshlrev_b32 v22, 16, v79
v_mfma_f32_16x16x32_bf16 v[132:135], v[220:223], v[88:91], v[132:135]
v_mfma_f32_16x16x32_bf16 v[140:143], v[220:223], v[92:95], v[140:143]
s_waitcnt vmcnt(37)
v_and_b32 v23, s43, v79
v_fmac_f32 v24, v16, v15
v_fmac_f32 v25, v17, v15
v_fmac_f32 v26, v18, v15
v_fmac_f32 v27, v19, v15
v_mfma_f32_16x16x32_bf16 v[144:147], a[232:235], v[88:91], v[144:147]
v_mfma_f32_16x16x32_bf16 v[152:155], a[232:235], v[92:95], v[152:155]
s_waitcnt vmcnt(36)
v_fmac_f32 v28, v20, v15
v_fmac_f32 v29, v21, v15
v_fmac_f32 v30, v22, v15
v_fmac_f32_e64 v31, v23, v15
v_cvt_pk_bf16_f32 v76, v24, v25
v_mfma_f32_16x16x32_bf16 v[148:151], a[236:239], v[88:91], v[148:151]
v_mfma_f32_16x16x32_bf16 v[156:159], a[236:239], v[92:95], v[156:159]
s_waitcnt vmcnt(35)
v_cvt_pk_bf16_f32 v77, v26, v27
v_cvt_pk_bf16_f32 v78, v28, v29
v_cvt_pk_bf16_f32 v79, v30, v31
v_mfma_f32_16x16x32_bf16 v[160:163], a[88:91], v[88:91], v[160:163]
v_mfma_f32_16x16x32_bf16 v[168:171], a[88:91], v[92:95], v[168:171]
s_waitcnt vmcnt(34)
ds_read_b128 v[56:59], v6 offset:192
ds_write_b128 v2, v[76:79] offset:58880
v_mfma_f32_16x16x32_bf16 v[164:167], v[104:107], v[88:91], v[164:167]
v_mfma_f32_16x16x32_bf16 v[172:175], v[104:107], v[92:95], v[172:175]
s_waitcnt vmcnt(33)
v_mfma_f32_16x16x32_bf16 v[176:179], a[92:95], v[88:91], v[176:179]
v_mfma_f32_16x16x32_bf16 v[184:187], a[92:95], v[92:95], v[184:187]
s_waitcnt vmcnt(32)
ds_read_b128 v[60:63], v6 offset:16832
v_mfma_f32_16x16x32_bf16 v[180:183], a[96:99], v[88:91], v[180:183]
v_mfma_f32_16x16x32_bf16 v[188:191], a[96:99], v[92:95], v[188:191]
s_waitcnt lgkmcnt(0)
s_barrier
ds_read_b128 v[64:67], v1 offset:57856
ds_read_b128 v[68:71], v1 offset:58880
ds_read_b128 v[72:75], v1 offset:59904
ds_read_b128 v[76:79], v1 offset:60928
ds_read_b128 v[80:83], v1 offset:61952
ds_read_b128 v[84:87], v1 offset:62976
ds_read_b128 v[88:91], v1 offset:64000
ds_read_b128 v[92:95], v1 offset:65024
s_waitcnt vmcnt(31) lgkmcnt(6)
v_mfma_f32_16x16x32_bf16 v[128:131], a[100:103], v[64:67], v[128:131]
v_mfma_f32_16x16x32_bf16 v[136:139], a[100:103], v[68:71], v[136:139]
s_waitcnt vmcnt(30)
v_mfma_f32_16x16x32_bf16 v[132:135], a[104:107], v[64:67], v[132:135]
v_mfma_f32_16x16x32_bf16 v[140:143], a[104:107], v[68:71], v[140:143]
s_waitcnt vmcnt(29) lgkmcnt(4)
v_mfma_f32_16x16x32_bf16 v[128:131], v[108:111], v[72:75], v[128:131]
v_mfma_f32_16x16x32_bf16 v[136:139], v[108:111], v[76:79], v[136:139]
s_waitcnt vmcnt(28)
v_mfma_f32_16x16x32_bf16 v[132:135], a[108:111], v[72:75], v[132:135]
v_mfma_f32_16x16x32_bf16 v[140:143], a[108:111], v[76:79], v[140:143]
s_waitcnt vmcnt(27) lgkmcnt(2)
v_mfma_f32_16x16x32_bf16 v[128:131], a[240:243], v[80:83], v[128:131]
v_mfma_f32_16x16x32_bf16 v[136:139], a[240:243], v[84:87], v[136:139]
s_waitcnt vmcnt(26)
v_mfma_f32_16x16x32_bf16 v[132:135], a[244:247], v[80:83], v[132:135]
v_mfma_f32_16x16x32_bf16 v[140:143], a[244:247], v[84:87], v[140:143]
s_waitcnt vmcnt(25) lgkmcnt(0)
v_mfma_f32_16x16x32_bf16 v[128:131], a[248:251], v[88:91], v[128:131]
v_mfma_f32_16x16x32_bf16 v[136:139], a[248:251], v[92:95], v[136:139]
s_waitcnt vmcnt(24)
v_mfma_f32_16x16x32_bf16 v[132:135], a[252:255], v[88:91], v[132:135]
v_mfma_f32_16x16x32_bf16 v[140:143], a[252:255], v[92:95], v[140:143]
s_waitcnt vmcnt(23)
v_mfma_f32_16x16x32_bf16 v[144:147], a[112:115], v[64:67], v[144:147]
v_mfma_f32_16x16x32_bf16 v[152:155], a[112:115], v[68:71], v[152:155]
s_waitcnt vmcnt(22)
v_mfma_f32_16x16x32_bf16 v[148:151], a[116:119], v[64:67], v[148:151]
v_lshlrev_b32 v16, 16, v32
v_and_b32 v17, s43, v32
v_lshlrev_b32_e64 v18, 16, v33
v_mfma_f32_16x16x32_bf16 v[156:159], a[116:119], v[68:71], v[156:159]
v_and_b32 v19, s43, v33
v_lshlrev_b32 v20, 16, v34
v_and_b32 v21, s43, v34
s_waitcnt vmcnt(21)
v_mfma_f32_16x16x32_bf16 v[144:147], a[120:123], v[72:75], v[144:147]
v_lshlrev_b32 v22, 16, v35
v_and_b32 v23, s43, v35
v_add_f32_e64 v16, v16, v128
v_mfma_f32_16x16x32_bf16 v[152:155], a[120:123], v[76:79], v[152:155]
v_add_f32 v17, v17, v129
v_add_f32 v18, v18, v130
v_add_f32 v19, v19, v131
s_waitcnt vmcnt(20)
v_mfma_f32_16x16x32_bf16 v[148:151], a[124:127], v[72:75], v[148:151]
v_add_f32 v20, v20, v132
v_add_f32 v21, v21, v133
v_add_f32_e64 v22, v22, v134
v_mfma_f32_16x16x32_bf16 v[156:159], a[124:127], v[76:79], v[156:159]
v_add_f32_e64 v23, v23, v135
v_cvt_pk_bf16_f32 v32, v16, v17
v_cvt_pk_bf16_f32 v33, v18, v19
s_waitcnt vmcnt(19)
v_mfma_f32_16x16x32_bf16 v[144:147], a[128:131], v[80:83], v[144:147]
v_cvt_pk_bf16_f32 v34, v20, v21
v_cvt_pk_bf16_f32 v35, v22, v23
v_mfma_f32_16x16x32_bf16 v[152:155], a[128:131], v[84:87], v[152:155]
buffer_store_dwordx4 v[32:35], v4, s[20:23], s50 offen offset:0 sc1
v_lshlrev_b32 v24, 16, v36
v_and_b32_e64 v25, s43, v36
v_lshlrev_b32 v26, 16, v37
s_waitcnt vmcnt(19)
v_mfma_f32_16x16x32_bf16 v[148:151], a[132:135], v[80:83], v[148:151]
v_and_b32 v27, s43, v37
v_lshlrev_b32 v28, 16, v38
v_and_b32_e64 v29, s43, v38
v_mfma_f32_16x16x32_bf16 v[156:159], a[132:135], v[84:87], v[156:159]
v_lshlrev_b32 v30, 16, v39
v_and_b32 v31, s43, v39
v_add_f32 v24, v24, v136
s_waitcnt vmcnt(18)
v_mfma_f32_16x16x32_bf16 v[144:147], v[224:227], v[88:91], v[144:147]
v_add_f32 v25, v25, v137
v_add_f32 v26, v26, v138
v_add_f32_e64 v27, v27, v139
v_mfma_f32_16x16x32_bf16 v[152:155], v[224:227], v[92:95], v[152:155]
v_add_f32 v28, v28, v140
v_add_f32 v29, v29, v141
v_add_f32 v30, v30, v142
s_waitcnt vmcnt(17)
v_mfma_f32_16x16x32_bf16 v[148:151], a[136:139], v[88:91], v[148:151]
v_add_f32_e64 v31, v31, v143
v_cvt_pk_bf16_f32 v36, v24, v25
v_cvt_pk_bf16_f32 v37, v26, v27
v_mfma_f32_16x16x32_bf16 v[156:159], a[136:139], v[92:95], v[156:159]
v_cvt_pk_bf16_f32 v38, v28, v29
v_cvt_pk_bf16_f32 v39, v30, v31
s_waitcnt vmcnt(16)
v_mfma_f32_16x16x32_bf16 v[160:163], a[140:143], v[64:67], v[160:163]
v_mfma_f32_16x16x32_bf16 v[168:171], a[140:143], v[68:71], v[168:171]
buffer_store_dwordx4 v[36:39], v4, s[20:23], s51 offen offset:0 sc1
s_waitcnt vmcnt(16)
v_mfma_f32_16x16x32_bf16 v[164:167], a[144:147], v[64:67], v[164:167]
v_lshlrev_b32 v16, 16, v40
v_and_b32 v17, s43, v40
v_lshlrev_b32_e64 v18, 16, v41
v_mfma_f32_16x16x32_bf16 v[172:175], a[144:147], v[68:71], v[172:175]
v_and_b32 v19, s43, v41
v_lshlrev_b32 v20, 16, v42
v_and_b32 v21, s43, v42
s_waitcnt vmcnt(15)
v_mfma_f32_16x16x32_bf16 v[160:163], v[228:231], v[72:75], v[160:163]
v_lshlrev_b32 v22, 16, v43
v_and_b32 v23, s43, v43
v_add_f32_e64 v16, v16, v144
v_mfma_f32_16x16x32_bf16 v[168:171], v[228:231], v[76:79], v[168:171]
v_add_f32 v17, v17, v145
v_add_f32 v18, v18, v146
v_add_f32 v19, v19, v147
s_waitcnt vmcnt(14)
v_mfma_f32_16x16x32_bf16 v[164:167], a[148:151], v[72:75], v[164:167]
v_add_f32 v20, v20, v148
v_add_f32 v21, v21, v149
v_add_f32_e64 v22, v22, v150
v_mfma_f32_16x16x32_bf16 v[172:175], a[148:151], v[76:79], v[172:175]
v_add_f32_e64 v23, v23, v151
v_cvt_pk_bf16_f32 v40, v16, v17
v_cvt_pk_bf16_f32 v41, v18, v19
s_waitcnt vmcnt(13)
v_mfma_f32_16x16x32_bf16 v[160:163], a[152:155], v[80:83], v[160:163]
v_cvt_pk_bf16_f32 v42, v20, v21
v_cvt_pk_bf16_f32 v43, v22, v23
v_mfma_f32_16x16x32_bf16 v[168:171], a[152:155], v[84:87], v[168:171]
buffer_store_dwordx4 v[40:43], v4, s[20:23], s50 offen offset:64 sc1
v_lshlrev_b32 v24, 16, v44
v_and_b32_e64 v25, s43, v44
v_lshlrev_b32 v26, 16, v45
s_waitcnt vmcnt(13)
v_mfma_f32_16x16x32_bf16 v[164:167], v[192:195], v[80:83], v[164:167]
v_and_b32 v27, s43, v45
v_lshlrev_b32 v28, 16, v46
v_and_b32_e64 v29, s43, v46
v_mfma_f32_16x16x32_bf16 v[172:175], v[192:195], v[84:87], v[172:175]
v_lshlrev_b32 v30, 16, v47
v_and_b32 v31, s43, v47
v_add_f32 v24, v24, v152
s_waitcnt vmcnt(12)
v_mfma_f32_16x16x32_bf16 v[160:163], a[156:159], v[88:91], v[160:163]
v_add_f32 v25, v25, v153
v_add_f32 v26, v26, v154
v_add_f32_e64 v27, v27, v155
v_mfma_f32_16x16x32_bf16 v[168:171], a[156:159], v[92:95], v[168:171]
v_add_f32 v28, v28, v156
v_add_f32 v29, v29, v157
v_add_f32 v30, v30, v158
s_waitcnt vmcnt(11)
v_mfma_f32_16x16x32_bf16 v[164:167], v[232:235], v[88:91], v[164:167]
v_add_f32_e64 v31, v31, v159
v_cvt_pk_bf16_f32 v44, v24, v25
v_cvt_pk_bf16_f32 v45, v26, v27
v_mfma_f32_16x16x32_bf16 v[172:175], v[232:235], v[92:95], v[172:175]
v_cvt_pk_bf16_f32 v46, v28, v29
v_cvt_pk_bf16_f32 v47, v30, v31
s_waitcnt vmcnt(10)
v_mfma_f32_16x16x32_bf16 v[176:179], a[160:163], v[64:67], v[176:179]
v_mfma_f32_16x16x32_bf16 v[184:187], a[160:163], v[68:71], v[184:187]
buffer_store_dwordx4 v[44:47], v4, s[20:23], s51 offen offset:64 sc1
s_waitcnt vmcnt(10)
v_mfma_f32_16x16x32_bf16 v[180:183], a[164:167], v[64:67], v[180:183]
v_lshlrev_b32 v16, 16, v48
v_and_b32 v17, s43, v48
v_lshlrev_b32_e64 v18, 16, v49
v_mfma_f32_16x16x32_bf16 v[188:191], a[164:167], v[68:71], v[188:191]
v_and_b32 v19, s43, v49
v_lshlrev_b32 v20, 16, v50
v_and_b32 v21, s43, v50
s_waitcnt vmcnt(9)
v_mfma_f32_16x16x32_bf16 v[176:179], v[196:199], v[72:75], v[176:179]
v_lshlrev_b32 v22, 16, v51
v_and_b32 v23, s43, v51
v_add_f32_e64 v16, v16, v160
v_mfma_f32_16x16x32_bf16 v[184:187], v[196:199], v[76:79], v[184:187]
v_add_f32 v17, v17, v161
v_add_f32 v18, v18, v162
v_add_f32 v19, v19, v163
s_waitcnt vmcnt(8)
v_mfma_f32_16x16x32_bf16 v[180:183], a[168:171], v[72:75], v[180:183]
v_add_f32 v20, v20, v164
v_add_f32 v21, v21, v165
v_add_f32_e64 v22, v22, v166
v_mfma_f32_16x16x32_bf16 v[188:191], a[168:171], v[76:79], v[188:191]
v_add_f32_e64 v23, v23, v167
v_cvt_pk_bf16_f32 v48, v16, v17
v_cvt_pk_bf16_f32 v49, v18, v19
s_waitcnt vmcnt(7)
v_mfma_f32_16x16x32_bf16 v[176:179], a[172:175], v[80:83], v[176:179]
v_cvt_pk_bf16_f32 v50, v20, v21
v_cvt_pk_bf16_f32 v51, v22, v23
v_mfma_f32_16x16x32_bf16 v[184:187], a[172:175], v[84:87], v[184:187]
buffer_store_dwordx4 v[48:51], v4, s[20:23], s50 offen offset:128 sc1
v_lshlrev_b32 v24, 16, v52
v_and_b32_e64 v25, s43, v52
v_lshlrev_b32 v26, 16, v53
s_waitcnt vmcnt(7)
v_mfma_f32_16x16x32_bf16 v[180:183], v[200:203], v[80:83], v[180:183]
v_and_b32 v27, s43, v53
v_lshlrev_b32 v28, 16, v54
v_and_b32_e64 v29, s43, v54
v_mfma_f32_16x16x32_bf16 v[188:191], v[200:203], v[84:87], v[188:191]
v_lshlrev_b32 v30, 16, v55
v_and_b32 v31, s43, v55
v_add_f32 v24, v24, v168
s_waitcnt vmcnt(6)
v_mfma_f32_16x16x32_bf16 v[176:179], a[0:3], v[88:91], v[176:179]
v_add_f32 v25, v25, v169
v_add_f32 v26, v26, v170
v_add_f32_e64 v27, v27, v171
v_mfma_f32_16x16x32_bf16 v[184:187], a[0:3], v[92:95], v[184:187]
v_add_f32 v28, v28, v172
v_add_f32 v29, v29, v173
v_add_f32 v30, v30, v174
s_waitcnt vmcnt(5)
v_mfma_f32_16x16x32_bf16 v[180:183], v[236:239], v[88:91], v[180:183]
v_add_f32_e64 v31, v31, v175
v_cvt_pk_bf16_f32 v52, v24, v25
v_cvt_pk_bf16_f32 v53, v26, v27
v_mfma_f32_16x16x32_bf16 v[188:191], v[236:239], v[92:95], v[188:191]
v_cvt_pk_bf16_f32 v54, v28, v29
v_cvt_pk_bf16_f32 v55, v30, v31
buffer_store_dwordx4 v[52:55], v4, s[20:23], s51 offen offset:128 sc1
s_nop 7
v_lshlrev_b32 v16, 16, v56
v_and_b32 v17, s43, v56
v_lshlrev_b32 v18, 16, v57
v_and_b32 v19, s43, v57
v_lshlrev_b32 v20, 16, v58
v_and_b32 v21, s43, v58
v_lshlrev_b32 v22, 16, v59
v_and_b32_e64 v23, s43, v59
v_pk_add_f32 v[16:17], v[16:17], v[176:177]
v_pk_add_f32 v[18:19], v[18:19], v[178:179]
v_pk_add_f32 v[20:21], v[20:21], v[180:181]
v_pk_add_f32 v[22:23], v[22:23], v[182:183]
v_cvt_pk_bf16_f32 v56, v16, v17
v_cvt_pk_bf16_f32 v57, v18, v19
v_cvt_pk_bf16_f32 v58, v20, v21
v_cvt_pk_bf16_f32 v59, v22, v23
buffer_store_dwordx4 v[56:59], v4, s[20:23], s50 offen offset:192 sc1
v_lshlrev_b32 v24, 16, v60
v_and_b32 v25, s43, v60
v_lshlrev_b32 v26, 16, v61
v_and_b32 v27, s43, v61
v_lshlrev_b32 v28, 16, v62
v_and_b32 v29, s43, v62
v_lshlrev_b32 v30, 16, v63
v_and_b32 v31, s43, v63
v_pk_add_f32 v[24:25], v[24:25], v[184:185]
v_pk_add_f32 v[26:27], v[26:27], v[186:187]
v_pk_add_f32 v[28:29], v[28:29], v[188:189]
v_pk_add_f32 v[30:31], v[30:31], v[190:191]
v_cvt_pk_bf16_f32 v60, v24, v25
v_cvt_pk_bf16_f32 v61, v26, v27
v_cvt_pk_bf16_f32 v62, v28, v29
v_cvt_pk_bf16_f32 v63, v30, v31
buffer_store_dwordx4 v[60:63], v4, s[20:23], s51 offen offset:192 sc1
s_or_b32 s38, s2, s24
s_cmp_eq_u32 s38, 0
s_cselect_b32 s38, 0, 0x10000
s_add_u32 s38, s38, 36864
s_mov_b64 exec, 1
buffer_store_dword v7, off, s[72:75], s38
s_mov_b64 exec, -1
s_endpgm
L_sp_2:
s_mov_b32 s3, 1048576
L_sl_23:
s_sleep 4
buffer_load_dword v14, v15, s[72:75], 0 offen sc1
s_waitcnt vmcnt(0)
v_cmp_ne_u32_e64 vcc, v7, v14
s_cbranch_vccz L_bk_3
s_sub_u32 s3, s3, 1
s_cmp_lg_u32 s3, 0
s_cbranch_scc1 L_sl_23
s_branch L_bk_3
L_sp_4:
s_mov_b32 s3, 1048576
L_sl_24:
s_sleep 4
buffer_load_dword v14, v15, s[72:75], 0 offen sc1
s_waitcnt vmcnt(0)
v_cmp_ne_u32 vcc, v7, v14
s_cbranch_vccz L_bk_5
s_sub_u32 s3, s3, 1
s_cmp_lg_u32 s3, 0
s_cbranch_scc1 L_sl_24
s_branch L_bk_5
L_sp_6:
s_mov_b32 s3, 1048576
L_sl_25:
s_sleep 4
buffer_load_dword v14, v15, s[72:75], 0 offen sc1
s_waitcnt vmcnt(0)
v_cmp_ne_u32 vcc, v7, v14
s_cbranch_vccz L_bk_7
s_sub_u32 s3, s3, 1
s_cmp_lg_u32 s3, 0
s_cbranch_scc1 L_sl_25
s_branch L_bk_7
L_sp_8:
s_mov_b32 s3, 1048576
L_sl_26:
s_sleep 4
buffer_load_dword v4, v5, s[72:75], 0 offen sc1
s_waitcnt vmcnt(0)
v_cmp_ne_u32 vcc, v7, v4
s_cbranch_vccz L_bk_9
s_sub_u32 s3, s3, 1
s_cmp_lg_u32 s3, 0
s_cbranch_scc1 L_sl_26
s_branch L_bk_9
L_sp_10:
s_mov_b32 s3, 1048576
L_sl_27:
s_sleep 4
buffer_load_dword v9, v15, s[72:75], s7 offen sc1
s_waitcnt vmcnt(0)
v_cmp_ne_u32 vcc, v7, v9
s_cbranch_vccz L_bk_11
s_sub_u32 s3, s3, 1
s_cmp_lg_u32 s3, 0
s_cbranch_scc1 L_sl_27
s_branch L_bk_11
L_sp_12:
s_mov_b32 s3, 1048576
L_sl_28:
s_sleep 4
buffer_load_dwordx4 v[192:195], v1, s[72:75], s6 offen offset:0 sc1
buffer_load_dwordx4 v[196:199], v1, s[72:75], s6 offen offset:1024 sc1
buffer_load_dwordx4 v[200:203], v1, s[72:75], s6 offen offset:2048 sc1
buffer_load_dwordx4 v[204:207], v1, s[72:75], s6 offen offset:3072 sc1
s_waitcnt vmcnt(0)
v_xor_b32_e64 v192, v192, v7
v_bitop3_b32 v192, v193, v7, v192 bitop3:0xbe
v_bitop3_b32 v192, v194, v7, v192 bitop3:0xbe
v_bitop3_b32 v192, v195, v7, v192 bitop3:0xbe
v_bitop3_b32 v192, v196, v7, v192 bitop3:0xbe
v_bitop3_b32 v192, v197, v7, v192 bitop3:0xbe
v_bitop3_b32 v192, v198, v7, v192 bitop3:0xbe
v_bitop3_b32 v192, v199, v7, v192 bitop3:0xbe
v_bitop3_b32 v192, v200, v7, v192 bitop3:0xbe
v_bitop3_b32 v192, v201, v7, v192 bitop3:0xbe
v_bitop3_b32 v192, v202, v7, v192 bitop3:0xbe
v_bitop3_b32 v192, v203, v7, v192 bitop3:0xbe
v_bitop3_b32 v192, v204, v7, v192 bitop3:0xbe
v_bitop3_b32 v192, v205, v7, v192 bitop3:0xbe
v_bitop3_b32 v192, v206, v7, v192 bitop3:0xbe
v_bitop3_b32 v192, v207, v7, v192 bitop3:0xbe
v_cmp_ne_u32 vcc, 0, v192
s_cbranch_vccz L_bk_13
s_sub_u32 s3, s3, 1
s_cmp_lg_u32 s3, 0
s_cbranch_scc1 L_sl_28
s_branch L_bk_13
L_sp_14:
s_mov_b32 s3, 1048576
L_sl_29:
s_sleep 4
buffer_load_dword v9, v8, s[72:75], s40 offen offset:0 sc1
s_waitcnt vmcnt(0)
v_cmp_ne_u32 vcc, v7, v9
s_cbranch_vccz L_bk_15
s_sub_u32 s3, s3, 1
s_cmp_lg_u32 s3, 0
s_cbranch_scc1 L_sl_29
s_branch L_bk_15
L_sp_17:
s_mov_b32 s3, 1048576
L_sl_30:
s_sleep 4
buffer_load_dwordx4 v[96:99], v1, s[72:75], s44 offen offset:0 sc1
buffer_load_dwordx4 v[100:103], v1, s[72:75], s44 offen offset:1024 sc1
buffer_load_dwordx4 v[104:107], v1, s[72:75], s44 offen offset:2048 sc1
buffer_load_dwordx4 v[108:111], v1, s[72:75], s44 offen offset:3072 sc1
s_waitcnt vmcnt(0)
v_xor_b32_e64 v96, v96, v7
v_bitop3_b32 v96, v97, v7, v96 bitop3:0xbe
v_bitop3_b32 v96, v98, v7, v96 bitop3:0xbe
v_bitop3_b32 v96, v99, v7, v96 bitop3:0xbe
v_bitop3_b32 v96, v100, v7, v96 bitop3:0xbe
v_bitop3_b32 v96, v101, v7, v96 bitop3:0xbe
v_bitop3_b32 v96, v102, v7, v96 bitop3:0xbe
v_bitop3_b32 v96, v103, v7, v96 bitop3:0xbe
v_bitop3_b32 v96, v104, v7, v96 bitop3:0xbe
v_bitop3_b32 v96, v105, v7, v96 bitop3:0xbe
v_bitop3_b32 v96, v106, v7, v96 bitop3:0xbe
v_bitop3_b32 v96, v107, v7, v96 bitop3:0xbe
v_bitop3_b32 v96, v108, v7, v96 bitop3:0xbe
v_bitop3_b32 v96, v109, v7, v96 bitop3:0xbe
v_bitop3_b32 v96, v110, v7, v96 bitop3:0xbe
v_bitop3_b32 v96, v111, v7, v96 bitop3:0xbe
v_cmp_ne_u32 vcc, 0, v96
s_cbranch_vccz L_bk_18
s_sub_u32 s3, s3, 1
s_cmp_lg_u32 s3, 0
s_cbranch_scc1 L_sl_30
s_branch L_bk_18
L_sp_19:
s_mov_b32 s3, 1048576
L_sl_31:
s_sleep 4
buffer_load_dwordx4 v[108:111], off, s[72:75], s37 offset:0 sc1
s_waitcnt vmcnt(0)
v_xor_b32_e64 v108, v108, v7
v_bitop3_b32 v108, v109, v7, v108 bitop3:0xbe
v_bitop3_b32 v108, v110, v7, v108 bitop3:0xbe
v_bitop3_b32 v108, v111, v7, v108 bitop3:0xbe
v_cmp_ne_u32 vcc, 0, v108
s_cbranch_vccz L_bk_20
s_sub_u32 s3, s3, 1
s_cmp_lg_u32 s3, 0
s_cbranch_scc1 L_sl_31
s_branch L_bk_20
L_sp_21:
s_mov_b32 s3, 1048576
L_sl_32:
s_sleep 4
buffer_load_dwordx4 v[232:235], off, s[72:75], s37 offset:16 sc1
s_waitcnt vmcnt(0)
v_xor_b32_e64 v232, v232, v7
v_bitop3_b32 v232, v233, v7, v232 bitop3:0xbe
v_bitop3_b32 v232, v234, v7, v232 bitop3:0xbe
v_bitop3_b32 v232, v235, v7, v232 bitop3:0xbe
v_cmp_ne_u32 vcc, 0, v232
s_cbranch_vccz L_bk_22
s_sub_u32 s3, s3, 1
s_cmp_lg_u32 s3, 0
s_cbranch_scc1 L_sl_32
s_branch L_bk_22
L_end:
s_endpgm
.section .rodata,"a"
.p2align 6
.amdhsa_kernel standalone__conformer_family_branchformer__speech_kernel
  .amdhsa_next_free_vgpr 512
  .amdhsa_next_free_sgpr 102
  .amdhsa_accum_offset 256
  .amdhsa_group_segment_fixed_size 0
  .amdhsa_kernarg_size 96
  .amdhsa_user_sgpr_count 2
  .amdhsa_user_sgpr_kernarg_segment_ptr 1
  .amdhsa_system_sgpr_workgroup_id_x 1
.end_amdhsa_kernel
```
